```python
import torch

def _softmax(x, axis=-1):
    return torch.softmax(x, dim=axis)
def _gelu(x):
    return torch.nn.functional.gelu(x, approximate="tanh")
def _silu(x):
    return torch.nn.functional.silu(x)
def _sigmoid(x):
    return torch.sigmoid(x)
def _layernorm(x, axis=-1, eps=1e-5):
    m = x.mean(dim=axis, keepdim=True)
    v = x.var(dim=axis, keepdim=True, unbiased=False)
    return (x - m) / torch.sqrt(v + eps)
def _scatter_add(tgt, idx, src, axis=0):
    return tgt.clone().index_add_(axis, idx, src)
def _segment_sum(src, seg, n):
    out = torch.zeros((n,) + src.shape[1:], dtype=src.dtype)
    return out.index_add_(0, seg, src)
def _pad(x, pw):
    flat = tuple(v for pair in reversed(pw) for v in pair)
    return torch.nn.functional.pad(x, flat)

kernel_name = 'concat_heads__mha_block_cached__mha_block_cached__near_ridge'

def setup_inputs():

    _w = (lambda a: (lambda t: t.to(torch.bfloat16) if t.is_floating_point() else t)(torch.as_tensor(a)))
    def _A_setup():
        B, Sq, D = 16, 224, 640
        H, Sk, Dh = 32, 1024, 128
        return {
            "x": _w((lambda *s: torch.randn(*s, dtype=torch.bfloat16) * 0.8)(B, Sq, D)),
            "k_cache": _w((lambda *s: torch.randn(*s, dtype=torch.bfloat16) * 0.8)(B, H, Sk, Dh)),
            "v_cache": _w((lambda *s: torch.randn(*s, dtype=torch.bfloat16) * 0.05)(B, H, Sk, Dh)),
            "wq": _w((lambda *s: torch.randn(*s, dtype=torch.bfloat16) * 0.8)(D, H * Dh) * (D ** -0.5)),
            "wo": _w((lambda *s: torch.randn(*s, dtype=torch.bfloat16) * 0.05)(H * Dh, D) * ((H * Dh) ** -0.5)),
        }
    _A_in = _A_setup()

    def _B_setup():
        B, Sq, D = 16, 224, 640
        H, Sk, Dh = 32, 1024, 128
        return {
            "x": _w((lambda *s: torch.randn(*s, dtype=torch.bfloat16) * 0.8)(B, Sq, D)),
            "k_cache": _w((lambda *s: torch.randn(*s, dtype=torch.bfloat16) * 0.8)(B, H, Sk, Dh)),
            "v_cache": _w((lambda *s: torch.randn(*s, dtype=torch.bfloat16) * 0.05)(B, H, Sk, Dh)),
            "wq": _w((lambda *s: torch.randn(*s, dtype=torch.bfloat16) * 0.8)(D, H * Dh) * (D ** -0.5)),
            "wo": _w((lambda *s: torch.randn(*s, dtype=torch.bfloat16) * 0.05)(H * Dh, D) * ((H * Dh) ** -0.5)),
        }
    _B_in = _B_setup()

    return {
        "A_x": _A_in["x"],
        "A_k_cache": _A_in["k_cache"],
        "A_v_cache": _A_in["v_cache"],
        "A_wq": _A_in["wq"],
        "A_wo": _A_in["wo"],
        "B_x": _B_in["x"],
        "B_k_cache": _B_in["k_cache"],
        "B_v_cache": _B_in["v_cache"],
        "B_wq": _B_in["wq"],
        "B_wo": _B_in["wo"],
    }

def reference(A_x, A_k_cache, A_v_cache, A_wq, A_wo, B_x, B_k_cache, B_v_cache, B_wq, B_wo):
    def _A_ref(x, k_cache, v_cache, wq, wo):
        B, Sq, D = x.shape
        H, Dh = 32, 128
        q = (lambda x, *d: x.permute(*d))((x @ wq).reshape(B, Sq, H, Dh), 0, 2, 1, 3)
        scores = torch.einsum("bhqd,bhkd->bhqk", q, k_cache) * (Dh ** -0.5)
        p = _softmax(scores, axis=-1)
        o = torch.einsum("bhqk,bhkd->bhqd", p, v_cache)
        return (lambda x, *d: x.permute(*d))(o, 0, 2, 1, 3).reshape(B, Sq, H * Dh) @ wo

    def _B_ref(x, k_cache, v_cache, wq, wo):
        B, Sq, D = x.shape
        H, Dh = 32, 128
        q = (lambda x, *d: x.permute(*d))((x @ wq).reshape(B, Sq, H, Dh), 0, 2, 1, 3)
        scores = torch.einsum("bhqd,bhkd->bhqk", q, k_cache) * (Dh ** -0.5)
        p = _softmax(scores, axis=-1)
        o = torch.einsum("bhqk,bhkd->bhqd", p, v_cache)
        return (lambda x, *d: x.permute(*d))(o, 0, 2, 1, 3).reshape(B, Sq, H * Dh) @ wo

    a = _A_ref(A_x, A_k_cache, A_v_cache, A_wq, A_wo)
    b = _B_ref(B_x, B_k_cache, B_v_cache, B_wq, B_wo)
    return torch.concatenate([a, b], axis=-1)
```

```asm
; @launch grid=(256,1,1) block=(256,1,1) lds=156736
.amdgcn_target "amdgcn-amd-amdhsa--gfx950"
.text
.globl concat_heads__mha_block_cached__mha_block_cached__near_ridge_kernel
.p2align 8
.type concat_heads__mha_block_cached__mha_block_cached__near_ridge_kernel,@function
concat_heads__mha_block_cached__mha_block_cached__near_ridge_kernel:
  s_cmp_ge_u32 s2, 256
  s_cbranch_scc1 A_END
  v_lshrrev_b32 v1, 6, v0
  v_and_b32 v0, 63, v0
  v_readfirstlane_b32 s20, v1
  s_load_dwordx2 s[52:53], s[0:1], 96
  s_load_dwordx4 s[56:59], s[0:1], 80
  s_bfe_u32 s37, s2, 0x10001
  s_mul_i32 s41, s37, 40
  s_and_b32 s22, s20, 1
  s_mul_i32 s42, s22, 24
  s_sub_u32 s42, 24, s42
  s_add_u32 s42, s42, s41
  s_load_dwordx2 s[50:51], s[0:1], s42
  s_mul_i32 s46, s37, -80
  s_mov_b32 s46, 0
  s_add_u32 s42, s42, s46
  s_load_dwordx2 s[34:35], s[0:1], s42
  s_lshl_b32 s40, s22, 3
  s_add_u32 s40, s40, 8
  s_add_u32 s40, s40, s41
  s_add_u32 s41, s41, 32
  s_load_dwordx2 s[48:49], s[0:1], s40
  s_load_dwordx2 s[54:55], s[0:1], s41
  s_add_u32 s46, s46, s40
  v_lshlrev_b32 v228, 14, v0
  s_mov_b32 s7, 0x20000
  s_mov_b32 s11, 0x20000
  s_mov_b32 s15, 0x20000
  s_mov_b32 s19, 0x20000
  s_mov_b32 s99, 0x20000
  s_lshr_b32 s21, s20, 1
  s_mul_i32 s24, s21, 78336
  s_mul_i32 s40, s22, 34816
  s_add_u32 s24, s24, s40
  s_and_b32 s40, s2, 1
  s_lshl_b32 s40, s40, 3
  s_lshr_b32 s41, s2, 5
  s_add_u32 s32, s40, s41
  s_bfe_u32 s41, s2, 0x20003
  s_lshl_b32 s41, s41, 1
  s_add_u32 s41, s41, s21
  s_bfe_u32 s40, s2, 0x10002
  s_lshl_b32 s40, s40, 3
  s_add_u32 s3, s40, s41
  s_lshl_b32 s42, s32, 1
  s_add_u32 s42, s42, s21
  s_mul_i32 s36, s42, 143360
  s_cmp_eq_u32 s22, 0
  s_mov_b32 s40, 8192
  s_cselect_b32 s27, s40, 10240
  s_mov_b32 s40, 262144
  s_cselect_b32 s29, s40, 81920
  s_cselect_b32 s28, s40, 4294885504
  s_cselect_b64 vcc, -1, 0
  v_lshrrev_b32 v1, 4, v0
  v_and_b32 v14, 15, v0
  v_lshlrev_b32 v5, 4, v14
  v_lshl_add_u32 v6, v1, 16, v5
  v_lshrrev_b32 v7, 3, v0
  v_mul_u32_u24 v7, 1280, v7
  v_and_b32 v8, 7, v0
  v_xor_b32 v8, v8, v1
  v_lshl_add_u32 v7, v8, 4, v7
  v_cndmask_b32 v229, v7, v6, vcc
  s_mov_b32 s23, 0
  s_waitcnt lgkmcnt(0)
  s_mov_b32 s96, s58
  s_mov_b32 s97, s59
  s_load_dwordx2 s[58:59], s[0:1], s46
  s_add_u32 s40, s3, 0
  s_lshl_b32 s40, s40, 8
  s_sub_u32 s41, 5242880, s40
  s_cmp_eq_u32 s22, 0
  s_cselect_b32 s40, s40, s36
  s_cselect_b32 s10, s41, 143360
  s_add_u32 s8, s50, s40
  s_addc_u32 s9, s51, 0
  s_mul_i32 s26, s22, 81920
  s_mov_b32 s31, s26
  s_cmp_eq_u32 s22, 0
  s_cbranch_scc1 A_NX0
  s_add_u32 m0, s24, 34816
  s_mov_b32 s40, 0
  buffer_load_dwordx4 v229, s[8:11], s40 offen nt lds
  s_add_u32 m0, s24, 35904
  s_mov_b32 s40, 10240
  buffer_load_dwordx4 v229, s[8:11], s40 offen nt lds
  s_add_u32 m0, s24, 36992
  s_mov_b32 s40, 20480
  buffer_load_dwordx4 v229, s[8:11], s40 offen nt lds
  s_add_u32 m0, s24, 38080
  s_mov_b32 s40, 30720
  buffer_load_dwordx4 v229, s[8:11], s40 offen nt lds
  s_add_u32 m0, s24, 39168
  s_mov_b32 s40, 40960
  buffer_load_dwordx4 v229, s[8:11], s40 offen nt lds
  s_add_u32 m0, s24, 40256
  s_mov_b32 s40, 51200
  buffer_load_dwordx4 v229, s[8:11], s40 offen nt lds
  s_add_u32 m0, s24, 41344
  s_mov_b32 s40, 61440
  buffer_load_dwordx4 v229, s[8:11], s40 offen nt lds
  s_add_u32 m0, s24, 42432
  s_mov_b32 s40, 71680
  buffer_load_dwordx4 v229, s[8:11], s40 offen nt lds
A_NX0:
  s_add_u32 m0, s24, 0
  s_nop 0
  buffer_load_dwordx4 v229, s[8:11], s31 offen nt lds
  s_add_u32 s31, s31, s27
  s_add_u32 m0, s24, 1088
  s_nop 0
  buffer_load_dwordx4 v229, s[8:11], s31 offen nt lds
  s_add_u32 s31, s31, s27
  s_add_u32 m0, s24, 2176
  s_nop 0
  buffer_load_dwordx4 v229, s[8:11], s31 offen nt lds
  s_add_u32 s31, s31, s27
  s_add_u32 m0, s24, 3264
  s_nop 0
  buffer_load_dwordx4 v229, s[8:11], s31 offen nt lds
  s_add_u32 s31, s31, s27
  s_add_u32 m0, s24, 4352
  s_nop 0
  buffer_load_dwordx4 v229, s[8:11], s31 offen nt lds
  s_add_u32 s31, s31, s27
  s_add_u32 m0, s24, 5440
  s_nop 0
  buffer_load_dwordx4 v229, s[8:11], s31 offen nt lds
  s_add_u32 s31, s31, s27
  s_add_u32 m0, s24, 6528
  s_nop 0
  buffer_load_dwordx4 v229, s[8:11], s31 offen nt lds
  s_add_u32 s31, s31, s27
  s_add_u32 m0, s24, 7616
  s_nop 0
  buffer_load_dwordx4 v229, s[8:11], s31 offen nt lds
  s_add_u32 s26, s26, s28
  s_mov_b32 s31, s26
  s_add_u32 m0, s24, 8704
  s_nop 0
  buffer_load_dwordx4 v229, s[8:11], s31 offen lds
  s_add_u32 s31, s31, s27
  s_add_u32 m0, s24, 9792
  s_nop 0
  buffer_load_dwordx4 v229, s[8:11], s31 offen lds
  s_add_u32 s31, s31, s27
  s_add_u32 m0, s24, 10880
  s_nop 0
  buffer_load_dwordx4 v229, s[8:11], s31 offen lds
  s_add_u32 s31, s31, s27
  s_add_u32 m0, s24, 11968
  s_nop 0
  buffer_load_dwordx4 v229, s[8:11], s31 offen lds
  s_add_u32 s31, s31, s27
  s_add_u32 m0, s24, 13056
  s_nop 0
  buffer_load_dwordx4 v229, s[8:11], s31 offen lds
  s_add_u32 s31, s31, s27
  s_add_u32 m0, s24, 14144
  s_nop 0
  buffer_load_dwordx4 v229, s[8:11], s31 offen lds
  s_add_u32 s31, s31, s27
  s_add_u32 m0, s24, 15232
  s_nop 0
  buffer_load_dwordx4 v229, s[8:11], s31 offen lds
  s_add_u32 s31, s31, s27
  s_add_u32 m0, s24, 16320
  s_nop 0
  buffer_load_dwordx4 v229, s[8:11], s31 offen lds
  s_add_u32 s26, s26, s29
  s_mov_b32 s31, s26
  s_add_u32 m0, s24, 17408
  s_nop 0
  buffer_load_dwordx4 v229, s[8:11], s31 offen lds
  s_add_u32 s31, s31, s27
  s_add_u32 m0, s24, 18496
  s_nop 0
  buffer_load_dwordx4 v229, s[8:11], s31 offen lds
  s_add_u32 s31, s31, s27
  s_add_u32 m0, s24, 19584
  s_nop 0
  buffer_load_dwordx4 v229, s[8:11], s31 offen lds
  s_add_u32 s31, s31, s27
  s_add_u32 m0, s24, 20672
  s_nop 0
  buffer_load_dwordx4 v229, s[8:11], s31 offen lds
  s_add_u32 s31, s31, s27
  s_add_u32 m0, s24, 21760
  s_nop 0
  buffer_load_dwordx4 v229, s[8:11], s31 offen lds
  s_add_u32 s31, s31, s27
  s_add_u32 m0, s24, 22848
  s_nop 0
  buffer_load_dwordx4 v229, s[8:11], s31 offen lds
  s_add_u32 s31, s31, s27
  s_add_u32 m0, s24, 23936
  s_nop 0
  buffer_load_dwordx4 v229, s[8:11], s31 offen lds
  s_add_u32 s31, s31, s27
  s_add_u32 m0, s24, 25024
  s_nop 0
  buffer_load_dwordx4 v229, s[8:11], s31 offen lds
  s_add_u32 s26, s26, s28
  s_mov_b32 s31, s26
  s_add_u32 m0, s24, 26112
  s_nop 0
  buffer_load_dwordx4 v229, s[8:11], s31 offen lds
  s_add_u32 s31, s31, s27
  s_add_u32 m0, s24, 27200
  s_nop 0
  buffer_load_dwordx4 v229, s[8:11], s31 offen lds
  s_add_u32 s31, s31, s27
  s_add_u32 m0, s24, 28288
  s_nop 0
  buffer_load_dwordx4 v229, s[8:11], s31 offen lds
  s_add_u32 s31, s31, s27
  s_add_u32 m0, s24, 29376
  s_nop 0
  buffer_load_dwordx4 v229, s[8:11], s31 offen lds
  s_add_u32 s31, s31, s27
  s_add_u32 m0, s24, 30464
  s_nop 0
  buffer_load_dwordx4 v229, s[8:11], s31 offen lds
  s_add_u32 s31, s31, s27
  s_add_u32 m0, s24, 31552
  s_nop 0
  buffer_load_dwordx4 v229, s[8:11], s31 offen lds
  s_add_u32 s31, s31, s27
  s_add_u32 m0, s24, 32640
  s_nop 0
  buffer_load_dwordx4 v229, s[8:11], s31 offen lds
  s_add_u32 s31, s31, s27
  s_add_u32 m0, s24, 33728
  s_nop 0
  buffer_load_dwordx4 v229, s[8:11], s31 offen lds
  s_add_u32 s26, s26, s29
  s_mov_b32 s31, s26
  s_mov_b32 s60, 1040356334
  s_mov_b32 s61, 1233125376
  s_mov_b32 s62, 562036736
  s_mov_b32 s33, 0
  s_mov_b32 s6, 262144
  s_and_b32 s40, s2, 1
  s_bfe_u32 s41, s2, 0x10002
  s_lshl_b32 s41, s41, 5
  s_lshr_b32 s42, s2, 3
  s_add_u32 s41, s41, s42
  s_add_u32 s42, s41, s40
  s_mul_i32 s40, s40, 63
  s_add_u32 s40, s40, s41
  s_cmp_ge_u32 s42, 63
  s_cselect_b32 s40, 125, s40
  s_mul_i32 s92, s40, 205
  s_lshr_b32 s92, s92, 10
  s_mul_i32 s41, s92, 5
  s_sub_u32 s93, s40, s41
  s_mul_i32 s42, s92, 9
  s_add_u32 s41, s42, 8
  s_min_u32 s41, s41, 223
  s_min_u32 s42, s42, 223
  s_lshl_b32 s43, s37, 4
  s_mul_i32 s94, s42, 4682
  s_lshr_b32 s94, s94, 16
  s_add_u32 s94, s94, s43
  s_lshl_b32 s94, s94, 8
  s_mul_i32 s95, s41, 4682
  s_lshr_b32 s95, s95, 16
  s_add_u32 s95, s95, s43
  s_lshl_b32 s95, s95, 8
  v_bfe_u32 v3, v0, 2, 2
  v_and_b32 v4, 3, v0
  v_lshlrev_b32 v230, 4, v0
  s_mul_i32 s40, s21, 78336
  s_add_u32 s41, s40, 34816
  s_mul_i32 s42, s22, 78336
  s_add_u32 s42, s42, 34816
  v_and_b32 v8, 7, v14
  v_lshrrev_b32 v9, 3, v14
  v_mul_u32_u24 v10, 1056, v8
  v_lshl_add_u32 v10, v9, 8, v10
  v_lshl_add_u32 v10, v1, 4, v10
  v_add_u32 v224, s40, v10
  v_add_u32 v231, s24, v230
  v_and_b32 v11, 1, v1
  v_lshl_add_u32 v11, v11, 2, v3
  v_mul_u32_u24 v11, 1056, v11
  v_lshrrev_b32 v12, 1, v1
  v_lshl_add_u32 v11, v12, 8, v11
  v_lshl_add_u32 v12, v4, 3, v11
  v_add_u32 v225, s41, v12
  v_mul_u32_u24 v12, 1088, v3
  v_lshl_add_u32 v12, v1, 8, v12
  v_lshl_add_u32 v12, v4, 4, v12
  v_add_u32 v226, s40, v12
  v_mul_u32_u24 v12, 1088, v9
  v_lshl_add_u32 v12, v8, 7, v12
  v_bfe_u32 v13, v14, 1, 2
  v_xor_b32 v13, v13, v1
  v_lshl_add_u32 v12, v13, 4, v12
  v_add_u32 v227, s42, v12
  s_waitcnt vmcnt(24) lgkmcnt(0)
  s_barrier
  ds_read_b128 a[192:195], v227 offset:34816
  ds_read_b128 a[196:199], v227 offset:36992
  ds_read_b128 a[200:203], v227 offset:39168
  ds_read_b128 a[204:207], v227 offset:41344
  ds_read_b128 a[208:211], v227 offset:0
  ds_read_b128 a[212:215], v227 offset:2176
  ds_read_b128 a[216:219], v227 offset:4352
  ds_read_b64_tr_b16 a[224:225], v226 offset:0
  ds_read_b64_tr_b16 a[226:227], v226 offset:4352
  ds_read_b64_tr_b16 a[228:229], v226 offset:8
  ds_read_b64_tr_b16 a[230:231], v226 offset:4360
  ds_read_b64_tr_b16 a[232:233], v226 offset:64
  ds_read_b64_tr_b16 a[234:235], v226 offset:4416
  ds_read_b64_tr_b16 a[236:237], v226 offset:72
  ds_read_b64_tr_b16 a[238:239], v226 offset:4424
  ds_read_b64_tr_b16 a[240:241], v226 offset:128
  ds_read_b64_tr_b16 a[242:243], v226 offset:4480
  ds_read_b64_tr_b16 a[244:245], v226 offset:136
  ds_read_b64_tr_b16 a[246:247], v226 offset:4488
  ds_read_b64_tr_b16 a[248:249], v226 offset:192
  ds_read_b64_tr_b16 a[250:251], v226 offset:4544
  ds_read_b64_tr_b16 a[252:253], v226 offset:200
  ds_read_b64_tr_b16 a[254:255], v226 offset:4552
  ds_read_b128 a[160:163], v227 offset:34880
  ds_read_b128 a[164:167], v227 offset:37056
  ds_read_b128 a[168:171], v227 offset:39232
  ds_read_b128 a[172:175], v227 offset:41408
  ds_read_b128 a[176:179], v227 offset:64
  ds_read_b128 a[180:183], v227 offset:2240
  ds_read_b128 a[184:187], v227 offset:4416
  s_add_u32 s16, s52, 58720256
  s_addc_u32 s17, s53, 0
  s_mov_b32 s18, 16384
  s_lshl_b32 s40, s20, 8
  s_add_u32 s40, s40, s2
  s_lshl_b32 s41, s2, 8
  s_cmp_lt_u32 s40, 64
  s_cselect_b32 s40, s41, 2147418112
  s_cselect_b32 s77, 0, 2147418112
  s_mov_b32 s98, 4
  v_mov_b32 v244, 0
  buffer_store_dword v244, v228, s[16:19], s40 offen sc0 sc1
  s_mov_b32 s12, s52
  s_mov_b32 s13, s53
  s_mov_b32 s14, 0
.p2align 3
A_QP:
  s_waitcnt lgkmcnt(7)
  s_cmp_eq_u32 s23, 1
  s_cbranch_scc1 A_WARM0
  s_waitcnt vmcnt(17)
A_WARM0:
  v_mfma_f32_16x16x32_bf16 v[0:3], a[224:227], a[192:195], 0
  v_mfma_f32_16x16x32_bf16 v[32:35], a[224:227], a[196:199], 0
  s_mul_i32 s46, s22, 34816
  v_mfma_f32_16x16x32_bf16 v[64:67], a[224:227], a[200:203], 0
  s_add_u32 s46, s46, s24
  v_mfma_f32_16x16x32_bf16 v[96:99], a[224:227], a[204:207], 0
  s_add_u32 s46, s46, 0
  v_mfma_f32_16x16x32_bf16 v[128:131], a[224:227], a[208:211], 0
  s_waitcnt vmcnt(44) lgkmcnt(0)
  s_barrier
  s_add_u32 m0, s46, 0
  v_mfma_f32_16x16x32_bf16 v[160:163], a[224:227], a[212:215], 0
  buffer_load_dwordx4 v229, s[8:11], s31 offen lds
  v_mfma_f32_16x16x32_bf16 v[192:195], a[224:227], a[216:219], 0
  ds_read_b64_tr_b16 a[224:225], v226 offset:8704
  s_add_u32 s31, s31, s27
  v_mfma_f32_16x16x32_bf16 v[4:7], a[228:231], a[192:195], 0
  ds_read_b64_tr_b16 a[226:227], v226 offset:13056
  v_mfma_f32_16x16x32_bf16 v[36:39], a[228:231], a[196:199], 0
  v_mfma_f32_16x16x32_bf16 v[68:71], a[228:231], a[200:203], 0
  s_add_u32 m0, s46, 1088
  v_mfma_f32_16x16x32_bf16 v[100:103], a[228:231], a[204:207], 0
  buffer_load_dwordx4 v229, s[8:11], s31 offen lds
  v_mfma_f32_16x16x32_bf16 v[132:135], a[228:231], a[208:211], 0
  s_add_u32 s31, s31, s27
  v_mfma_f32_16x16x32_bf16 v[164:167], a[228:231], a[212:215], 0
  v_mfma_f32_16x16x32_bf16 v[196:199], a[228:231], a[216:219], 0
  ds_read_b64_tr_b16 a[228:229], v226 offset:8712
  v_mfma_f32_16x16x32_bf16 v[8:11], a[232:235], a[192:195], 0
  ds_read_b64_tr_b16 a[230:231], v226 offset:13064
  s_add_u32 m0, s46, 2176
  v_mfma_f32_16x16x32_bf16 v[40:43], a[232:235], a[196:199], 0
  buffer_load_dwordx4 v229, s[8:11], s31 offen lds
  v_mfma_f32_16x16x32_bf16 v[72:75], a[232:235], a[200:203], 0
  s_add_u32 s31, s31, s27
  v_mfma_f32_16x16x32_bf16 v[104:107], a[232:235], a[204:207], 0
  v_mfma_f32_16x16x32_bf16 v[136:139], a[232:235], a[208:211], 0
  v_mfma_f32_16x16x32_bf16 v[168:171], a[232:235], a[212:215], 0
  v_mfma_f32_16x16x32_bf16 v[200:203], a[232:235], a[216:219], 0
  ds_read_b64_tr_b16 a[232:233], v226 offset:8768
  v_mfma_f32_16x16x32_bf16 v[12:15], a[236:239], a[192:195], 0
  ds_read_b64_tr_b16 a[234:235], v226 offset:13120
  s_add_u32 m0, s46, 3264
  v_mfma_f32_16x16x32_bf16 v[44:47], a[236:239], a[196:199], 0
  buffer_load_dwordx4 v229, s[8:11], s31 offen lds
  v_mfma_f32_16x16x32_bf16 v[76:79], a[236:239], a[200:203], 0
  s_add_u32 s31, s31, s27
  v_mfma_f32_16x16x32_bf16 v[108:111], a[236:239], a[204:207], 0
  v_mfma_f32_16x16x32_bf16 v[140:143], a[236:239], a[208:211], 0
  v_mfma_f32_16x16x32_bf16 v[172:175], a[236:239], a[212:215], 0
  v_mfma_f32_16x16x32_bf16 v[204:207], a[236:239], a[216:219], 0
  ds_read_b64_tr_b16 a[236:237], v226 offset:8776
  v_mfma_f32_16x16x32_bf16 v[16:19], a[240:243], a[192:195], 0
  ds_read_b64_tr_b16 a[238:239], v226 offset:13128
  s_add_u32 m0, s46, 4352
  v_mfma_f32_16x16x32_bf16 v[48:51], a[240:243], a[196:199], 0
  buffer_load_dwordx4 v229, s[8:11], s31 offen lds
  v_mfma_f32_16x16x32_bf16 v[80:83], a[240:243], a[200:203], 0
  s_add_u32 s31, s31, s27
  v_mfma_f32_16x16x32_bf16 v[112:115], a[240:243], a[204:207], 0
  v_mfma_f32_16x16x32_bf16 v[144:147], a[240:243], a[208:211], 0
  v_mfma_f32_16x16x32_bf16 v[176:179], a[240:243], a[212:215], 0
  v_mfma_f32_16x16x32_bf16 v[208:211], a[240:243], a[216:219], 0
  ds_read_b64_tr_b16 a[240:241], v226 offset:8832
  v_mfma_f32_16x16x32_bf16 v[20:23], a[244:247], a[192:195], 0
  ds_read_b64_tr_b16 a[242:243], v226 offset:13184
  s_add_u32 m0, s46, 5440
  v_mfma_f32_16x16x32_bf16 v[52:55], a[244:247], a[196:199], 0
  buffer_load_dwordx4 v229, s[8:11], s31 offen lds
  v_mfma_f32_16x16x32_bf16 v[84:87], a[244:247], a[200:203], 0
  s_add_u32 s31, s31, s27
  v_mfma_f32_16x16x32_bf16 v[116:119], a[244:247], a[204:207], 0
  v_mfma_f32_16x16x32_bf16 v[148:151], a[244:247], a[208:211], 0
  v_mfma_f32_16x16x32_bf16 v[180:183], a[244:247], a[212:215], 0
  v_mfma_f32_16x16x32_bf16 v[212:215], a[244:247], a[216:219], 0
  ds_read_b64_tr_b16 a[244:245], v226 offset:8840
  v_mfma_f32_16x16x32_bf16 v[24:27], a[248:251], a[192:195], 0
  ds_read_b64_tr_b16 a[246:247], v226 offset:13192
  s_add_u32 m0, s46, 6528
  v_mfma_f32_16x16x32_bf16 v[56:59], a[248:251], a[196:199], 0
  buffer_load_dwordx4 v229, s[8:11], s31 offen lds
  v_mfma_f32_16x16x32_bf16 v[88:91], a[248:251], a[200:203], 0
  s_add_u32 s31, s31, s27
  v_mfma_f32_16x16x32_bf16 v[120:123], a[248:251], a[204:207], 0
  v_mfma_f32_16x16x32_bf16 v[152:155], a[248:251], a[208:211], 0
  v_mfma_f32_16x16x32_bf16 v[184:187], a[248:251], a[212:215], 0
  v_mfma_f32_16x16x32_bf16 v[216:219], a[248:251], a[216:219], 0
  ds_read_b64_tr_b16 a[248:249], v226 offset:8896
  v_mfma_f32_16x16x32_bf16 v[28:31], a[252:255], a[192:195], 0
  ds_read_b64_tr_b16 a[250:251], v226 offset:13248
  s_add_u32 m0, s46, 7616
  v_mfma_f32_16x16x32_bf16 v[60:63], a[252:255], a[196:199], 0
  buffer_load_dwordx4 v229, s[8:11], s31 offen lds
  v_mfma_f32_16x16x32_bf16 v[92:95], a[252:255], a[200:203], 0
  s_add_u32 s26, s26, s28
  s_mov_b32 s31, s26
  v_mfma_f32_16x16x32_bf16 v[124:127], a[252:255], a[204:207], 0
  v_mfma_f32_16x16x32_bf16 v[156:159], a[252:255], a[208:211], 0
  v_mfma_f32_16x16x32_bf16 v[188:191], a[252:255], a[212:215], 0
  s_waitcnt lgkmcnt(0)
  v_mfma_f32_16x16x32_bf16 v[220:223], a[252:255], a[216:219], 0
  ds_read_b64_tr_b16 a[252:253], v226 offset:8904
  s_cmp_eq_u32 s23, 1
  s_cbranch_scc1 A_WARM1
  s_waitcnt vmcnt(17)
A_WARM1:
  v_mfma_f32_16x16x32_bf16 v[0:3], a[224:227], a[160:163], v[0:3]
  ds_read_b64_tr_b16 a[254:255], v226 offset:13256
  v_mfma_f32_16x16x32_bf16 v[32:35], a[224:227], a[164:167], v[32:35]
  s_mul_i32 s46, s22, -8704
  v_mfma_f32_16x16x32_bf16 v[64:67], a[224:227], a[168:171], v[64:67]
  s_add_u32 s46, s46, s24
  v_mfma_f32_16x16x32_bf16 v[96:99], a[224:227], a[172:175], v[96:99]
  s_add_u32 s46, s46, 8704
  v_mfma_f32_16x16x32_bf16 v[128:131], a[224:227], a[176:179], v[128:131]
  s_waitcnt vmcnt(44) lgkmcnt(0)
  s_barrier
  s_add_u32 m0, s46, 0
  v_mfma_f32_16x16x32_bf16 v[160:163], a[224:227], a[180:183], v[160:163]
  buffer_load_dwordx4 v229, s[8:11], s31 offen lds
  v_mfma_f32_16x16x32_bf16 v[192:195], a[224:227], a[184:187], v[192:195]
  ds_read_b64_tr_b16 a[224:225], v226 offset:17408
  s_add_u32 s31, s31, s27
  v_mfma_f32_16x16x32_bf16 v[4:7], a[228:231], a[160:163], v[4:7]
  ds_read_b64_tr_b16 a[226:227], v226 offset:21760
  v_mfma_f32_16x16x32_bf16 v[36:39], a[228:231], a[164:167], v[36:39]
  ds_read_b128 a[192:195], v227 offset:8768
  v_mfma_f32_16x16x32_bf16 v[68:71], a[228:231], a[168:171], v[68:71]
  ds_read_b128 a[196:199], v227 offset:10944
  s_add_u32 m0, s46, 1088
  v_mfma_f32_16x16x32_bf16 v[100:103], a[228:231], a[172:175], v[100:103]
  buffer_load_dwordx4 v229, s[8:11], s31 offen lds
  v_mfma_f32_16x16x32_bf16 v[132:135], a[228:231], a[176:179], v[132:135]
  ds_read_b128 a[200:203], v227 offset:13120
  s_add_u32 s31, s31, s27
  v_mfma_f32_16x16x32_bf16 v[164:167], a[228:231], a[180:183], v[164:167]
  ds_read_b128 a[204:207], v227 offset:15296
  v_mfma_f32_16x16x32_bf16 v[196:199], a[228:231], a[184:187], v[196:199]
  ds_read_b64_tr_b16 a[228:229], v226 offset:17416
  v_mfma_f32_16x16x32_bf16 v[8:11], a[232:235], a[160:163], v[8:11]
  ds_read_b64_tr_b16 a[230:231], v226 offset:21768
  s_add_u32 m0, s46, 2176
  v_mfma_f32_16x16x32_bf16 v[40:43], a[232:235], a[164:167], v[40:43]
  buffer_load_dwordx4 v229, s[8:11], s31 offen lds
  v_mfma_f32_16x16x32_bf16 v[72:75], a[232:235], a[168:171], v[72:75]
  ds_read_b128 a[208:211], v227 offset:17472
  s_add_u32 s31, s31, s27
  v_mfma_f32_16x16x32_bf16 v[104:107], a[232:235], a[172:175], v[104:107]
  ds_read_b128 a[212:215], v227 offset:19648
  v_mfma_f32_16x16x32_bf16 v[136:139], a[232:235], a[176:179], v[136:139]
  ds_read_b128 a[216:219], v227 offset:21824
  v_mfma_f32_16x16x32_bf16 v[168:171], a[232:235], a[180:183], v[168:171]
  ds_read_b128 a[128:131], v227 offset:8704
  v_mfma_f32_16x16x32_bf16 v[200:203], a[232:235], a[184:187], v[200:203]
  ds_read_b64_tr_b16 a[232:233], v226 offset:17472
  v_mfma_f32_16x16x32_bf16 v[12:15], a[236:239], a[160:163], v[12:15]
  ds_read_b64_tr_b16 a[234:235], v226 offset:21824
  s_add_u32 m0, s46, 3264
  v_mfma_f32_16x16x32_bf16 v[44:47], a[236:239], a[164:167], v[44:47]
  buffer_load_dwordx4 v229, s[8:11], s31 offen lds
  v_mfma_f32_16x16x32_bf16 v[76:79], a[236:239], a[168:171], v[76:79]
  ds_read_b128 a[132:135], v227 offset:10880
  s_add_u32 s31, s31, s27
  v_mfma_f32_16x16x32_bf16 v[108:111], a[236:239], a[172:175], v[108:111]
  ds_read_b128 a[136:139], v227 offset:13056
  v_mfma_f32_16x16x32_bf16 v[140:143], a[236:239], a[176:179], v[140:143]
  ds_read_b128 a[140:143], v227 offset:15232
  v_mfma_f32_16x16x32_bf16 v[172:175], a[236:239], a[180:183], v[172:175]
  ds_read_b128 a[144:147], v227 offset:17408
  v_mfma_f32_16x16x32_bf16 v[204:207], a[236:239], a[184:187], v[204:207]
  ds_read_b64_tr_b16 a[236:237], v226 offset:17480
  v_mfma_f32_16x16x32_bf16 v[16:19], a[240:243], a[160:163], v[16:19]
  ds_read_b64_tr_b16 a[238:239], v226 offset:21832
  s_add_u32 m0, s46, 4352
  v_mfma_f32_16x16x32_bf16 v[48:51], a[240:243], a[164:167], v[48:51]
  buffer_load_dwordx4 v229, s[8:11], s31 offen lds
  v_mfma_f32_16x16x32_bf16 v[80:83], a[240:243], a[168:171], v[80:83]
  ds_read_b128 a[148:151], v227 offset:19584
  s_add_u32 s31, s31, s27
  v_mfma_f32_16x16x32_bf16 v[112:115], a[240:243], a[172:175], v[112:115]
  ds_read_b128 a[152:155], v227 offset:21760
  v_mfma_f32_16x16x32_bf16 v[144:147], a[240:243], a[176:179], v[144:147]
  v_mfma_f32_16x16x32_bf16 v[176:179], a[240:243], a[180:183], v[176:179]
  v_mfma_f32_16x16x32_bf16 v[208:211], a[240:243], a[184:187], v[208:211]
  ds_read_b64_tr_b16 a[240:241], v226 offset:17536
  v_mfma_f32_16x16x32_bf16 v[20:23], a[244:247], a[160:163], v[20:23]
  ds_read_b64_tr_b16 a[242:243], v226 offset:21888
  s_add_u32 m0, s46, 5440
  v_mfma_f32_16x16x32_bf16 v[52:55], a[244:247], a[164:167], v[52:55]
  buffer_load_dwordx4 v229, s[8:11], s31 offen lds
  v_mfma_f32_16x16x32_bf16 v[84:87], a[244:247], a[168:171], v[84:87]
  s_add_u32 s31, s31, s27
  v_mfma_f32_16x16x32_bf16 v[116:119], a[244:247], a[172:175], v[116:119]
  v_mfma_f32_16x16x32_bf16 v[148:151], a[244:247], a[176:179], v[148:151]
  v_mfma_f32_16x16x32_bf16 v[180:183], a[244:247], a[180:183], v[180:183]
  v_mfma_f32_16x16x32_bf16 v[212:215], a[244:247], a[184:187], v[212:215]
  ds_read_b64_tr_b16 a[244:245], v226 offset:17544
  v_mfma_f32_16x16x32_bf16 v[24:27], a[248:251], a[160:163], v[24:27]
  ds_read_b64_tr_b16 a[246:247], v226 offset:21896
  s_add_u32 m0, s46, 6528
  v_mfma_f32_16x16x32_bf16 v[56:59], a[248:251], a[164:167], v[56:59]
  buffer_load_dwordx4 v229, s[8:11], s31 offen lds
  v_mfma_f32_16x16x32_bf16 v[88:91], a[248:251], a[168:171], v[88:91]
  s_add_u32 s31, s31, s27
  v_mfma_f32_16x16x32_bf16 v[120:123], a[248:251], a[172:175], v[120:123]
  v_mfma_f32_16x16x32_bf16 v[152:155], a[248:251], a[176:179], v[152:155]
  v_mfma_f32_16x16x32_bf16 v[184:187], a[248:251], a[180:183], v[184:187]
  v_mfma_f32_16x16x32_bf16 v[216:219], a[248:251], a[184:187], v[216:219]
  ds_read_b64_tr_b16 a[248:249], v226 offset:17600
  v_mfma_f32_16x16x32_bf16 v[28:31], a[252:255], a[160:163], v[28:31]
  ds_read_b64_tr_b16 a[250:251], v226 offset:21952
  s_add_u32 m0, s46, 7616
  v_mfma_f32_16x16x32_bf16 v[60:63], a[252:255], a[164:167], v[60:63]
  buffer_load_dwordx4 v229, s[8:11], s31 offen lds
  v_mfma_f32_16x16x32_bf16 v[92:95], a[252:255], a[168:171], v[92:95]
  s_add_u32 s26, s26, s29
  s_mov_b32 s31, s26
  v_mfma_f32_16x16x32_bf16 v[124:127], a[252:255], a[172:175], v[124:127]
  v_mfma_f32_16x16x32_bf16 v[156:159], a[252:255], a[176:179], v[156:159]
  v_mfma_f32_16x16x32_bf16 v[188:191], a[252:255], a[180:183], v[188:191]
  s_waitcnt lgkmcnt(0)
  v_mfma_f32_16x16x32_bf16 v[220:223], a[252:255], a[184:187], v[220:223]
  ds_read_b64_tr_b16 a[252:253], v226 offset:17608
  s_cmp_eq_u32 s23, 1
  s_cbranch_scc1 A_WARM2
  s_waitcnt vmcnt(17)
A_WARM2:
  v_mfma_f32_16x16x32_bf16 v[0:3], a[224:227], a[128:131], v[0:3]
  ds_read_b64_tr_b16 a[254:255], v226 offset:21960
  v_mfma_f32_16x16x32_bf16 v[32:35], a[224:227], a[132:135], v[32:35]
  s_mul_i32 s46, s22, -8704
  v_mfma_f32_16x16x32_bf16 v[64:67], a[224:227], a[136:139], v[64:67]
  s_add_u32 s46, s46, s24
  v_mfma_f32_16x16x32_bf16 v[96:99], a[224:227], a[140:143], v[96:99]
  s_add_u32 s46, s46, 17408
  v_mfma_f32_16x16x32_bf16 v[128:131], a[224:227], a[144:147], v[128:131]
  s_waitcnt vmcnt(44) lgkmcnt(0)
  s_barrier
  s_add_u32 m0, s46, 0
  v_mfma_f32_16x16x32_bf16 v[160:163], a[224:227], a[148:151], v[160:163]
  buffer_load_dwordx4 v229, s[8:11], s31 offen lds
  v_mfma_f32_16x16x32_bf16 v[192:195], a[224:227], a[152:155], v[192:195]
  ds_read_b64_tr_b16 a[224:225], v226 offset:26112
  s_add_u32 s31, s31, s27
  v_mfma_f32_16x16x32_bf16 v[4:7], a[228:231], a[128:131], v[4:7]
  ds_read_b64_tr_b16 a[226:227], v226 offset:30464
  v_mfma_f32_16x16x32_bf16 v[36:39], a[228:231], a[132:135], v[36:39]
  v_mfma_f32_16x16x32_bf16 v[68:71], a[228:231], a[136:139], v[68:71]
  s_add_u32 m0, s46, 1088
  v_mfma_f32_16x16x32_bf16 v[100:103], a[228:231], a[140:143], v[100:103]
  buffer_load_dwordx4 v229, s[8:11], s31 offen lds
  v_mfma_f32_16x16x32_bf16 v[132:135], a[228:231], a[144:147], v[132:135]
  s_add_u32 s31, s31, s27
  v_mfma_f32_16x16x32_bf16 v[164:167], a[228:231], a[148:151], v[164:167]
  v_mfma_f32_16x16x32_bf16 v[196:199], a[228:231], a[152:155], v[196:199]
  ds_read_b64_tr_b16 a[228:229], v226 offset:26120
  v_mfma_f32_16x16x32_bf16 v[8:11], a[232:235], a[128:131], v[8:11]
  ds_read_b64_tr_b16 a[230:231], v226 offset:30472
  s_add_u32 m0, s46, 2176
  v_mfma_f32_16x16x32_bf16 v[40:43], a[232:235], a[132:135], v[40:43]
  buffer_load_dwordx4 v229, s[8:11], s31 offen lds
  v_mfma_f32_16x16x32_bf16 v[72:75], a[232:235], a[136:139], v[72:75]
  s_add_u32 s31, s31, s27
  v_mfma_f32_16x16x32_bf16 v[104:107], a[232:235], a[140:143], v[104:107]
  v_mfma_f32_16x16x32_bf16 v[136:139], a[232:235], a[144:147], v[136:139]
  v_mfma_f32_16x16x32_bf16 v[168:171], a[232:235], a[148:151], v[168:171]
  v_mfma_f32_16x16x32_bf16 v[200:203], a[232:235], a[152:155], v[200:203]
  ds_read_b64_tr_b16 a[232:233], v226 offset:26176
  v_mfma_f32_16x16x32_bf16 v[12:15], a[236:239], a[128:131], v[12:15]
  ds_read_b64_tr_b16 a[234:235], v226 offset:30528
  s_add_u32 m0, s46, 3264
  v_mfma_f32_16x16x32_bf16 v[44:47], a[236:239], a[132:135], v[44:47]
  buffer_load_dwordx4 v229, s[8:11], s31 offen lds
  v_mfma_f32_16x16x32_bf16 v[76:79], a[236:239], a[136:139], v[76:79]
  s_add_u32 s31, s31, s27
  v_mfma_f32_16x16x32_bf16 v[108:111], a[236:239], a[140:143], v[108:111]
  v_mfma_f32_16x16x32_bf16 v[140:143], a[236:239], a[144:147], v[140:143]
  v_mfma_f32_16x16x32_bf16 v[172:175], a[236:239], a[148:151], v[172:175]
  v_mfma_f32_16x16x32_bf16 v[204:207], a[236:239], a[152:155], v[204:207]
  ds_read_b64_tr_b16 a[236:237], v226 offset:26184
  v_mfma_f32_16x16x32_bf16 v[16:19], a[240:243], a[128:131], v[16:19]
  ds_read_b64_tr_b16 a[238:239], v226 offset:30536
  s_add_u32 m0, s46, 4352
  v_mfma_f32_16x16x32_bf16 v[48:51], a[240:243], a[132:135], v[48:51]
  buffer_load_dwordx4 v229, s[8:11], s31 offen lds
  v_mfma_f32_16x16x32_bf16 v[80:83], a[240:243], a[136:139], v[80:83]
  s_add_u32 s31, s31, s27
  v_mfma_f32_16x16x32_bf16 v[112:115], a[240:243], a[140:143], v[112:115]
  v_mfma_f32_16x16x32_bf16 v[144:147], a[240:243], a[144:147], v[144:147]
  v_mfma_f32_16x16x32_bf16 v[176:179], a[240:243], a[148:151], v[176:179]
  v_mfma_f32_16x16x32_bf16 v[208:211], a[240:243], a[152:155], v[208:211]
  ds_read_b64_tr_b16 a[240:241], v226 offset:26240
  v_mfma_f32_16x16x32_bf16 v[20:23], a[244:247], a[128:131], v[20:23]
  ds_read_b64_tr_b16 a[242:243], v226 offset:30592
  s_add_u32 m0, s46, 5440
  v_mfma_f32_16x16x32_bf16 v[52:55], a[244:247], a[132:135], v[52:55]
  buffer_load_dwordx4 v229, s[8:11], s31 offen lds
  v_mfma_f32_16x16x32_bf16 v[84:87], a[244:247], a[136:139], v[84:87]
  s_add_u32 s31, s31, s27
  v_mfma_f32_16x16x32_bf16 v[116:119], a[244:247], a[140:143], v[116:119]
  v_mfma_f32_16x16x32_bf16 v[148:151], a[244:247], a[144:147], v[148:151]
  v_mfma_f32_16x16x32_bf16 v[180:183], a[244:247], a[148:151], v[180:183]
  v_mfma_f32_16x16x32_bf16 v[212:215], a[244:247], a[152:155], v[212:215]
  ds_read_b64_tr_b16 a[244:245], v226 offset:26248
  v_mfma_f32_16x16x32_bf16 v[24:27], a[248:251], a[128:131], v[24:27]
  ds_read_b64_tr_b16 a[246:247], v226 offset:30600
  s_add_u32 m0, s46, 6528
  v_mfma_f32_16x16x32_bf16 v[56:59], a[248:251], a[132:135], v[56:59]
  buffer_load_dwordx4 v229, s[8:11], s31 offen lds
  v_mfma_f32_16x16x32_bf16 v[88:91], a[248:251], a[136:139], v[88:91]
  s_add_u32 s31, s31, s27
  v_mfma_f32_16x16x32_bf16 v[120:123], a[248:251], a[140:143], v[120:123]
  v_mfma_f32_16x16x32_bf16 v[152:155], a[248:251], a[144:147], v[152:155]
  v_mfma_f32_16x16x32_bf16 v[184:187], a[248:251], a[148:151], v[184:187]
  v_mfma_f32_16x16x32_bf16 v[216:219], a[248:251], a[152:155], v[216:219]
  ds_read_b64_tr_b16 a[248:249], v226 offset:26304
  v_mfma_f32_16x16x32_bf16 v[28:31], a[252:255], a[128:131], v[28:31]
  ds_read_b64_tr_b16 a[250:251], v226 offset:30656
  s_add_u32 m0, s46, 7616
  v_mfma_f32_16x16x32_bf16 v[60:63], a[252:255], a[132:135], v[60:63]
  buffer_load_dwordx4 v229, s[8:11], s31 offen lds
  v_mfma_f32_16x16x32_bf16 v[92:95], a[252:255], a[136:139], v[92:95]
  s_add_u32 s26, s26, s28
  s_mov_b32 s31, s26
  v_mfma_f32_16x16x32_bf16 v[124:127], a[252:255], a[140:143], v[124:127]
  v_mfma_f32_16x16x32_bf16 v[156:159], a[252:255], a[144:147], v[156:159]
  v_mfma_f32_16x16x32_bf16 v[188:191], a[252:255], a[148:151], v[188:191]
  s_waitcnt lgkmcnt(0)
  v_mfma_f32_16x16x32_bf16 v[220:223], a[252:255], a[152:155], v[220:223]
  ds_read_b64_tr_b16 a[252:253], v226 offset:26312
  v_mfma_f32_16x16x32_bf16 v[0:3], a[224:227], a[192:195], v[0:3]
  ds_read_b64_tr_b16 a[254:255], v226 offset:30664
  v_mfma_f32_16x16x32_bf16 v[32:35], a[224:227], a[196:199], v[32:35]
  s_mul_i32 s46, s22, -8704
  v_mfma_f32_16x16x32_bf16 v[64:67], a[224:227], a[200:203], v[64:67]
  s_add_u32 s46, s46, s24
  v_mfma_f32_16x16x32_bf16 v[96:99], a[224:227], a[204:207], v[96:99]
  s_add_u32 s46, s46, 26112
  v_mfma_f32_16x16x32_bf16 v[128:131], a[224:227], a[208:211], v[128:131]
  s_waitcnt vmcnt(16) lgkmcnt(0)
  s_barrier
  s_add_u32 m0, s46, 0
  v_mfma_f32_16x16x32_bf16 v[160:163], a[224:227], a[212:215], v[160:163]
  buffer_load_dwordx4 v229, s[8:11], s31 offen lds
  v_mfma_f32_16x16x32_bf16 v[192:195], a[224:227], a[216:219], v[192:195]
  ds_read_b64_tr_b16 a[224:225], v226 offset:0
  s_add_u32 s31, s31, s27
  v_mfma_f32_16x16x32_bf16 v[4:7], a[228:231], a[192:195], v[4:7]
  ds_read_b64_tr_b16 a[226:227], v226 offset:4352
  v_mfma_f32_16x16x32_bf16 v[36:39], a[228:231], a[196:199], v[36:39]
  ds_read_b128 a[128:131], v227 offset:26176
  v_mfma_f32_16x16x32_bf16 v[68:71], a[228:231], a[200:203], v[68:71]
  ds_read_b128 a[132:135], v227 offset:28352
  s_add_u32 m0, s46, 1088
  v_mfma_f32_16x16x32_bf16 v[100:103], a[228:231], a[204:207], v[100:103]
  buffer_load_dwordx4 v229, s[8:11], s31 offen lds
  v_mfma_f32_16x16x32_bf16 v[132:135], a[228:231], a[208:211], v[132:135]
  ds_read_b128 a[136:139], v227 offset:30528
  s_add_u32 s31, s31, s27
  v_mfma_f32_16x16x32_bf16 v[164:167], a[228:231], a[212:215], v[164:167]
  ds_read_b128 a[140:143], v227 offset:32704
  v_mfma_f32_16x16x32_bf16 v[196:199], a[228:231], a[216:219], v[196:199]
  ds_read_b64_tr_b16 a[228:229], v226 offset:8
  v_mfma_f32_16x16x32_bf16 v[8:11], a[232:235], a[192:195], v[8:11]
  ds_read_b64_tr_b16 a[230:231], v226 offset:4360
  s_add_u32 m0, s46, 2176
  v_mfma_f32_16x16x32_bf16 v[40:43], a[232:235], a[196:199], v[40:43]
  buffer_load_dwordx4 v229, s[8:11], s31 offen lds
  v_mfma_f32_16x16x32_bf16 v[72:75], a[232:235], a[200:203], v[72:75]
  ds_read_b128 a[144:147], v227 offset:34880
  s_add_u32 s31, s31, s27
  v_mfma_f32_16x16x32_bf16 v[104:107], a[232:235], a[204:207], v[104:107]
  ds_read_b128 a[148:151], v227 offset:37056
  v_mfma_f32_16x16x32_bf16 v[136:139], a[232:235], a[208:211], v[136:139]
  ds_read_b128 a[152:155], v227 offset:39232
  v_mfma_f32_16x16x32_bf16 v[168:171], a[232:235], a[212:215], v[168:171]
  ds_read_b128 a[160:163], v227 offset:26112
  v_mfma_f32_16x16x32_bf16 v[200:203], a[232:235], a[216:219], v[200:203]
  ds_read_b64_tr_b16 a[232:233], v226 offset:64
  v_mfma_f32_16x16x32_bf16 v[12:15], a[236:239], a[192:195], v[12:15]
  ds_read_b64_tr_b16 a[234:235], v226 offset:4416
  s_add_u32 m0, s46, 3264
  v_mfma_f32_16x16x32_bf16 v[44:47], a[236:239], a[196:199], v[44:47]
  buffer_load_dwordx4 v229, s[8:11], s31 offen lds
  v_mfma_f32_16x16x32_bf16 v[76:79], a[236:239], a[200:203], v[76:79]
  ds_read_b128 a[164:167], v227 offset:28288
  s_add_u32 s31, s31, s27
  v_mfma_f32_16x16x32_bf16 v[108:111], a[236:239], a[204:207], v[108:111]
  ds_read_b128 a[168:171], v227 offset:30464
  v_mfma_f32_16x16x32_bf16 v[140:143], a[236:239], a[208:211], v[140:143]
  ds_read_b128 a[172:175], v227 offset:32640
  v_mfma_f32_16x16x32_bf16 v[172:175], a[236:239], a[212:215], v[172:175]
  ds_read_b128 a[176:179], v227 offset:34816
  v_mfma_f32_16x16x32_bf16 v[204:207], a[236:239], a[216:219], v[204:207]
  ds_read_b64_tr_b16 a[236:237], v226 offset:72
  v_mfma_f32_16x16x32_bf16 v[16:19], a[240:243], a[192:195], v[16:19]
  ds_read_b64_tr_b16 a[238:239], v226 offset:4424
  s_add_u32 m0, s46, 4352
  v_mfma_f32_16x16x32_bf16 v[48:51], a[240:243], a[196:199], v[48:51]
  buffer_load_dwordx4 v229, s[8:11], s31 offen lds
  v_mfma_f32_16x16x32_bf16 v[80:83], a[240:243], a[200:203], v[80:83]
  ds_read_b128 a[180:183], v227 offset:36992
  s_add_u32 s31, s31, s27
  v_mfma_f32_16x16x32_bf16 v[112:115], a[240:243], a[204:207], v[112:115]
  ds_read_b128 a[184:187], v227 offset:39168
  v_mfma_f32_16x16x32_bf16 v[144:147], a[240:243], a[208:211], v[144:147]
  v_mfma_f32_16x16x32_bf16 v[176:179], a[240:243], a[212:215], v[176:179]
  v_mfma_f32_16x16x32_bf16 v[208:211], a[240:243], a[216:219], v[208:211]
  ds_read_b64_tr_b16 a[240:241], v226 offset:128
  v_mfma_f32_16x16x32_bf16 v[20:23], a[244:247], a[192:195], v[20:23]
  ds_read_b64_tr_b16 a[242:243], v226 offset:4480
  s_add_u32 m0, s46, 5440
  v_mfma_f32_16x16x32_bf16 v[52:55], a[244:247], a[196:199], v[52:55]
  buffer_load_dwordx4 v229, s[8:11], s31 offen lds
  v_mfma_f32_16x16x32_bf16 v[84:87], a[244:247], a[200:203], v[84:87]
  s_add_u32 s31, s31, s27
  v_mfma_f32_16x16x32_bf16 v[116:119], a[244:247], a[204:207], v[116:119]
  v_mfma_f32_16x16x32_bf16 v[148:151], a[244:247], a[208:211], v[148:151]
  v_mfma_f32_16x16x32_bf16 v[180:183], a[244:247], a[212:215], v[180:183]
  v_mfma_f32_16x16x32_bf16 v[212:215], a[244:247], a[216:219], v[212:215]
  ds_read_b64_tr_b16 a[244:245], v226 offset:136
  v_mfma_f32_16x16x32_bf16 v[24:27], a[248:251], a[192:195], v[24:27]
  ds_read_b64_tr_b16 a[246:247], v226 offset:4488
  s_add_u32 m0, s46, 6528
  v_mfma_f32_16x16x32_bf16 v[56:59], a[248:251], a[196:199], v[56:59]
  buffer_load_dwordx4 v229, s[8:11], s31 offen lds
  v_mfma_f32_16x16x32_bf16 v[88:91], a[248:251], a[200:203], v[88:91]
  s_add_u32 s31, s31, s27
  v_mfma_f32_16x16x32_bf16 v[120:123], a[248:251], a[204:207], v[120:123]
  v_mfma_f32_16x16x32_bf16 v[152:155], a[248:251], a[208:211], v[152:155]
  v_mfma_f32_16x16x32_bf16 v[184:187], a[248:251], a[212:215], v[184:187]
  v_mfma_f32_16x16x32_bf16 v[216:219], a[248:251], a[216:219], v[216:219]
  ds_read_b64_tr_b16 a[248:249], v226 offset:192
  v_mfma_f32_16x16x32_bf16 v[28:31], a[252:255], a[192:195], v[28:31]
  ds_read_b64_tr_b16 a[250:251], v226 offset:4544
  s_add_u32 m0, s46, 7616
  v_mfma_f32_16x16x32_bf16 v[60:63], a[252:255], a[196:199], v[60:63]
  buffer_load_dwordx4 v229, s[8:11], s31 offen lds
  v_mfma_f32_16x16x32_bf16 v[92:95], a[252:255], a[200:203], v[92:95]
  s_add_u32 s26, s26, s29
  s_mov_b32 s31, s26
  v_mfma_f32_16x16x32_bf16 v[124:127], a[252:255], a[204:207], v[124:127]
  v_mfma_f32_16x16x32_bf16 v[156:159], a[252:255], a[208:211], v[156:159]
  v_mfma_f32_16x16x32_bf16 v[188:191], a[252:255], a[212:215], v[188:191]
  s_waitcnt lgkmcnt(0)
  v_mfma_f32_16x16x32_bf16 v[220:223], a[252:255], a[216:219], v[220:223]
  ds_read_b64_tr_b16 a[252:253], v226 offset:200
  v_mfma_f32_16x16x32_bf16 v[0:3], a[224:227], a[160:163], v[0:3]
  ds_read_b64_tr_b16 a[254:255], v226 offset:4552
  v_mfma_f32_16x16x32_bf16 v[32:35], a[224:227], a[164:167], v[32:35]
  s_mul_i32 s46, s22, 26112
  v_mfma_f32_16x16x32_bf16 v[64:67], a[224:227], a[168:171], v[64:67]
  s_add_u32 s46, s46, s24
  v_mov_b32 v243, 1
  v_mfma_f32_16x16x32_bf16 v[96:99], a[224:227], a[172:175], v[96:99]
  s_add_u32 s46, s46, 0
  v_mfma_f32_16x16x32_bf16 v[128:131], a[224:227], a[176:179], v[128:131]
  s_waitcnt vmcnt(16) lgkmcnt(0)
  s_barrier
  s_add_u32 m0, s46, 0
  v_mfma_f32_16x16x32_bf16 v[160:163], a[224:227], a[180:183], v[160:163]
  buffer_load_dwordx4 v229, s[8:11], s31 offen lds
  v_mfma_f32_16x16x32_bf16 v[192:195], a[224:227], a[184:187], v[192:195]
  ds_read_b64_tr_b16 a[224:225], v226 offset:8704
  s_add_u32 s31, s31, s27
  v_mfma_f32_16x16x32_bf16 v[4:7], a[228:231], a[160:163], v[4:7]
  ds_read_b64_tr_b16 a[226:227], v226 offset:13056
  v_mfma_f32_16x16x32_bf16 v[36:39], a[228:231], a[164:167], v[36:39]
  v_mfma_f32_16x16x32_bf16 v[68:71], a[228:231], a[168:171], v[68:71]
  s_add_u32 m0, s46, 1088
  v_mfma_f32_16x16x32_bf16 v[100:103], a[228:231], a[172:175], v[100:103]
  buffer_load_dwordx4 v229, s[8:11], s31 offen lds
  v_mfma_f32_16x16x32_bf16 v[132:135], a[228:231], a[176:179], v[132:135]
  s_add_u32 s31, s31, s27
  v_mfma_f32_16x16x32_bf16 v[164:167], a[228:231], a[180:183], v[164:167]
  v_mfma_f32_16x16x32_bf16 v[196:199], a[228:231], a[184:187], v[196:199]
  ds_read_b64_tr_b16 a[228:229], v226 offset:8712
  v_mfma_f32_16x16x32_bf16 v[8:11], a[232:235], a[160:163], v[8:11]
  ds_read_b64_tr_b16 a[230:231], v226 offset:13064
  s_add_u32 m0, s46, 2176
  v_mfma_f32_16x16x32_bf16 v[40:43], a[232:235], a[164:167], v[40:43]
  buffer_load_dwordx4 v229, s[8:11], s31 offen lds
  v_mfma_f32_16x16x32_bf16 v[72:75], a[232:235], a[168:171], v[72:75]
  s_add_u32 s31, s31, s27
  v_mfma_f32_16x16x32_bf16 v[104:107], a[232:235], a[172:175], v[104:107]
  v_mfma_f32_16x16x32_bf16 v[136:139], a[232:235], a[176:179], v[136:139]
  v_mfma_f32_16x16x32_bf16 v[168:171], a[232:235], a[180:183], v[168:171]
  v_mfma_f32_16x16x32_bf16 v[200:203], a[232:235], a[184:187], v[200:203]
  ds_read_b64_tr_b16 a[232:233], v226 offset:8768
  v_mfma_f32_16x16x32_bf16 v[12:15], a[236:239], a[160:163], v[12:15]
  ds_read_b64_tr_b16 a[234:235], v226 offset:13120
  s_add_u32 m0, s46, 3264
  v_mfma_f32_16x16x32_bf16 v[44:47], a[236:239], a[164:167], v[44:47]
  buffer_load_dwordx4 v229, s[8:11], s31 offen lds
  v_mfma_f32_16x16x32_bf16 v[76:79], a[236:239], a[168:171], v[76:79]
  s_add_u32 s31, s31, s27
  v_mfma_f32_16x16x32_bf16 v[108:111], a[236:239], a[172:175], v[108:111]
  v_mfma_f32_16x16x32_bf16 v[140:143], a[236:239], a[176:179], v[140:143]
  v_mfma_f32_16x16x32_bf16 v[172:175], a[236:239], a[180:183], v[172:175]
  v_mfma_f32_16x16x32_bf16 v[204:207], a[236:239], a[184:187], v[204:207]
  ds_read_b64_tr_b16 a[236:237], v226 offset:8776
  v_mfma_f32_16x16x32_bf16 v[16:19], a[240:243], a[160:163], v[16:19]
  ds_read_b64_tr_b16 a[238:239], v226 offset:13128
  s_add_u32 m0, s46, 4352
  v_mfma_f32_16x16x32_bf16 v[48:51], a[240:243], a[164:167], v[48:51]
  buffer_load_dwordx4 v229, s[8:11], s31 offen lds
  v_mfma_f32_16x16x32_bf16 v[80:83], a[240:243], a[168:171], v[80:83]
  s_add_u32 s31, s31, s27
  v_mfma_f32_16x16x32_bf16 v[112:115], a[240:243], a[172:175], v[112:115]
  v_mfma_f32_16x16x32_bf16 v[144:147], a[240:243], a[176:179], v[144:147]
  v_mfma_f32_16x16x32_bf16 v[176:179], a[240:243], a[180:183], v[176:179]
  v_mfma_f32_16x16x32_bf16 v[208:211], a[240:243], a[184:187], v[208:211]
  ds_read_b64_tr_b16 a[240:241], v226 offset:8832
  v_mfma_f32_16x16x32_bf16 v[20:23], a[244:247], a[160:163], v[20:23]
  ds_read_b64_tr_b16 a[242:243], v226 offset:13184
  s_add_u32 m0, s46, 5440
  v_mfma_f32_16x16x32_bf16 v[52:55], a[244:247], a[164:167], v[52:55]
  buffer_load_dwordx4 v229, s[8:11], s31 offen lds
  v_mfma_f32_16x16x32_bf16 v[84:87], a[244:247], a[168:171], v[84:87]
  s_add_u32 s31, s31, s27
  v_mfma_f32_16x16x32_bf16 v[116:119], a[244:247], a[172:175], v[116:119]
  v_mfma_f32_16x16x32_bf16 v[148:151], a[244:247], a[176:179], v[148:151]
  v_mfma_f32_16x16x32_bf16 v[180:183], a[244:247], a[180:183], v[180:183]
  v_mfma_f32_16x16x32_bf16 v[212:215], a[244:247], a[184:187], v[212:215]
  ds_read_b64_tr_b16 a[244:245], v226 offset:8840
  v_mfma_f32_16x16x32_bf16 v[24:27], a[248:251], a[160:163], v[24:27]
  ds_read_b64_tr_b16 a[246:247], v226 offset:13192
  s_add_u32 m0, s46, 6528
  v_mfma_f32_16x16x32_bf16 v[56:59], a[248:251], a[164:167], v[56:59]
  buffer_load_dwordx4 v229, s[8:11], s31 offen lds
  v_mfma_f32_16x16x32_bf16 v[88:91], a[248:251], a[168:171], v[88:91]
  s_add_u32 s31, s31, s27
  v_mfma_f32_16x16x32_bf16 v[120:123], a[248:251], a[172:175], v[120:123]
  v_mfma_f32_16x16x32_bf16 v[152:155], a[248:251], a[176:179], v[152:155]
  v_mfma_f32_16x16x32_bf16 v[184:187], a[248:251], a[180:183], v[184:187]
  v_mfma_f32_16x16x32_bf16 v[216:219], a[248:251], a[184:187], v[216:219]
  ds_read_b64_tr_b16 a[248:249], v226 offset:8896
  v_mfma_f32_16x16x32_bf16 v[28:31], a[252:255], a[160:163], v[28:31]
  ds_read_b64_tr_b16 a[250:251], v226 offset:13248
  s_add_u32 m0, s46, 7616
  v_mfma_f32_16x16x32_bf16 v[60:63], a[252:255], a[164:167], v[60:63]
  buffer_load_dwordx4 v229, s[8:11], s31 offen lds
  v_mfma_f32_16x16x32_bf16 v[92:95], a[252:255], a[168:171], v[92:95]
  s_add_u32 s26, s26, s28
  s_mov_b32 s31, s26
  v_mfma_f32_16x16x32_bf16 v[124:127], a[252:255], a[172:175], v[124:127]
  v_mfma_f32_16x16x32_bf16 v[156:159], a[252:255], a[176:179], v[156:159]
  buffer_atomic_add v243, v228, s[96:99], s77 offen sc1
  v_mfma_f32_16x16x32_bf16 v[188:191], a[252:255], a[180:183], v[188:191]
  s_waitcnt lgkmcnt(0)
  s_mov_b32 s77, 2147418112
  v_mfma_f32_16x16x32_bf16 v[220:223], a[252:255], a[184:187], v[220:223]
  ds_read_b64_tr_b16 a[252:253], v226 offset:8904
  v_mfma_f32_16x16x32_bf16 v[0:3], a[224:227], a[128:131], v[0:3]
  ds_read_b64_tr_b16 a[254:255], v226 offset:13256
  v_mfma_f32_16x16x32_bf16 v[32:35], a[224:227], a[132:135], v[32:35]
  s_mul_i32 s46, s22, 26112
  v_mfma_f32_16x16x32_bf16 v[64:67], a[224:227], a[136:139], v[64:67]
  s_add_u32 s46, s46, s24
  v_mfma_f32_16x16x32_bf16 v[96:99], a[224:227], a[140:143], v[96:99]
  s_add_u32 s46, s46, 8704
  v_mfma_f32_16x16x32_bf16 v[128:131], a[224:227], a[144:147], v[128:131]
  s_waitcnt vmcnt(17) lgkmcnt(0)
  s_barrier
  s_add_u32 m0, s46, 0
  v_mfma_f32_16x16x32_bf16 v[160:163], a[224:227], a[148:151], v[160:163]
  buffer_load_dwordx4 v229, s[8:11], s31 offen lds
  v_mfma_f32_16x16x32_bf16 v[192:195], a[224:227], a[152:155], v[192:195]
  ds_read_b64_tr_b16 a[224:225], v226 offset:17408
  s_add_u32 s31, s31, s27
  v_mfma_f32_16x16x32_bf16 v[4:7], a[228:231], a[128:131], v[4:7]
  ds_read_b64_tr_b16 a[226:227], v226 offset:21760
  v_mfma_f32_16x16x32_bf16 v[36:39], a[228:231], a[132:135], v[36:39]
  ds_read_b128 a[160:163], v227 offset:64
  v_mfma_f32_16x16x32_bf16 v[68:71], a[228:231], a[136:139], v[68:71]
  ds_read_b128 a[164:167], v227 offset:2240
  s_add_u32 m0, s46, 1088
  v_mfma_f32_16x16x32_bf16 v[100:103], a[228:231], a[140:143], v[100:103]
  buffer_load_dwordx4 v229, s[8:11], s31 offen lds
  v_mfma_f32_16x16x32_bf16 v[132:135], a[228:231], a[144:147], v[132:135]
  ds_read_b128 a[168:171], v227 offset:4416
  s_add_u32 s31, s31, s27
  v_mfma_f32_16x16x32_bf16 v[164:167], a[228:231], a[148:151], v[164:167]
  ds_read_b128 a[172:175], v227 offset:6592
  v_mfma_f32_16x16x32_bf16 v[196:199], a[228:231], a[152:155], v[196:199]
  ds_read_b64_tr_b16 a[228:229], v226 offset:17416
  v_mfma_f32_16x16x32_bf16 v[8:11], a[232:235], a[128:131], v[8:11]
  ds_read_b64_tr_b16 a[230:231], v226 offset:21768
  s_add_u32 m0, s46, 2176
  v_mfma_f32_16x16x32_bf16 v[40:43], a[232:235], a[132:135], v[40:43]
  buffer_load_dwordx4 v229, s[8:11], s31 offen lds
  v_mfma_f32_16x16x32_bf16 v[72:75], a[232:235], a[136:139], v[72:75]
  ds_read_b128 a[176:179], v227 offset:8768
  s_add_u32 s31, s31, s27
  v_mfma_f32_16x16x32_bf16 v[104:107], a[232:235], a[140:143], v[104:107]
  ds_read_b128 a[180:183], v227 offset:10944
  v_mfma_f32_16x16x32_bf16 v[136:139], a[232:235], a[144:147], v[136:139]
  ds_read_b128 a[184:187], v227 offset:13120
  v_mfma_f32_16x16x32_bf16 v[168:171], a[232:235], a[148:151], v[168:171]
  ds_read_b128 a[192:195], v227 offset:0
  v_mfma_f32_16x16x32_bf16 v[200:203], a[232:235], a[152:155], v[200:203]
  ds_read_b64_tr_b16 a[232:233], v226 offset:17472
  v_mfma_f32_16x16x32_bf16 v[12:15], a[236:239], a[128:131], v[12:15]
  ds_read_b64_tr_b16 a[234:235], v226 offset:21824
  s_add_u32 m0, s46, 3264
  v_mfma_f32_16x16x32_bf16 v[44:47], a[236:239], a[132:135], v[44:47]
  buffer_load_dwordx4 v229, s[8:11], s31 offen lds
  v_mfma_f32_16x16x32_bf16 v[76:79], a[236:239], a[136:139], v[76:79]
  ds_read_b128 a[196:199], v227 offset:2176
  s_add_u32 s31, s31, s27
  v_mfma_f32_16x16x32_bf16 v[108:111], a[236:239], a[140:143], v[108:111]
  ds_read_b128 a[200:203], v227 offset:4352
  v_mfma_f32_16x16x32_bf16 v[140:143], a[236:239], a[144:147], v[140:143]
  ds_read_b128 a[204:207], v227 offset:6528
  v_mfma_f32_16x16x32_bf16 v[172:175], a[236:239], a[148:151], v[172:175]
  ds_read_b128 a[208:211], v227 offset:8704
  v_mfma_f32_16x16x32_bf16 v[204:207], a[236:239], a[152:155], v[204:207]
  ds_read_b64_tr_b16 a[236:237], v226 offset:17480
  v_mfma_f32_16x16x32_bf16 v[16:19], a[240:243], a[128:131], v[16:19]
  ds_read_b64_tr_b16 a[238:239], v226 offset:21832
  s_add_u32 m0, s46, 4352
  v_mfma_f32_16x16x32_bf16 v[48:51], a[240:243], a[132:135], v[48:51]
  buffer_load_dwordx4 v229, s[8:11], s31 offen lds
  v_mfma_f32_16x16x32_bf16 v[80:83], a[240:243], a[136:139], v[80:83]
  ds_read_b128 a[212:215], v227 offset:10880
  s_add_u32 s31, s31, s27
  v_mfma_f32_16x16x32_bf16 v[112:115], a[240:243], a[140:143], v[112:115]
  ds_read_b128 a[216:219], v227 offset:13056
  v_mfma_f32_16x16x32_bf16 v[144:147], a[240:243], a[144:147], v[144:147]
  v_mfma_f32_16x16x32_bf16 v[176:179], a[240:243], a[148:151], v[176:179]
  v_mfma_f32_16x16x32_bf16 v[208:211], a[240:243], a[152:155], v[208:211]
  ds_read_b64_tr_b16 a[240:241], v226 offset:17536
  v_mfma_f32_16x16x32_bf16 v[20:23], a[244:247], a[128:131], v[20:23]
  ds_read_b64_tr_b16 a[242:243], v226 offset:21888
  s_add_u32 m0, s46, 5440
  v_mfma_f32_16x16x32_bf16 v[52:55], a[244:247], a[132:135], v[52:55]
  buffer_load_dwordx4 v229, s[8:11], s31 offen lds
  v_mfma_f32_16x16x32_bf16 v[84:87], a[244:247], a[136:139], v[84:87]
  s_add_u32 s31, s31, s27
  v_mfma_f32_16x16x32_bf16 v[116:119], a[244:247], a[140:143], v[116:119]
  v_mfma_f32_16x16x32_bf16 v[148:151], a[244:247], a[144:147], v[148:151]
  v_mfma_f32_16x16x32_bf16 v[180:183], a[244:247], a[148:151], v[180:183]
  v_mfma_f32_16x16x32_bf16 v[212:215], a[244:247], a[152:155], v[212:215]
  ds_read_b64_tr_b16 a[244:245], v226 offset:17544
  v_mfma_f32_16x16x32_bf16 v[24:27], a[248:251], a[128:131], v[24:27]
  ds_read_b64_tr_b16 a[246:247], v226 offset:21896
  s_add_u32 m0, s46, 6528
  v_mfma_f32_16x16x32_bf16 v[56:59], a[248:251], a[132:135], v[56:59]
  buffer_load_dwordx4 v229, s[8:11], s31 offen lds
  v_mfma_f32_16x16x32_bf16 v[88:91], a[248:251], a[136:139], v[88:91]
  s_add_u32 s31, s31, s27
  v_mfma_f32_16x16x32_bf16 v[120:123], a[248:251], a[140:143], v[120:123]
  v_mfma_f32_16x16x32_bf16 v[152:155], a[248:251], a[144:147], v[152:155]
  v_mfma_f32_16x16x32_bf16 v[184:187], a[248:251], a[148:151], v[184:187]
  v_mfma_f32_16x16x32_bf16 v[216:219], a[248:251], a[152:155], v[216:219]
  ds_read_b64_tr_b16 a[248:249], v226 offset:17600
  v_mfma_f32_16x16x32_bf16 v[28:31], a[252:255], a[128:131], v[28:31]
  ds_read_b64_tr_b16 a[250:251], v226 offset:21952
  s_add_u32 m0, s46, 7616
  v_mfma_f32_16x16x32_bf16 v[60:63], a[252:255], a[132:135], v[60:63]
  buffer_load_dwordx4 v229, s[8:11], s31 offen lds
  v_mfma_f32_16x16x32_bf16 v[92:95], a[252:255], a[136:139], v[92:95]
  s_add_u32 s26, s26, s29
  s_mov_b32 s31, s26
  v_mfma_f32_16x16x32_bf16 v[124:127], a[252:255], a[140:143], v[124:127]
  v_mfma_f32_16x16x32_bf16 v[156:159], a[252:255], a[144:147], v[156:159]
  v_mfma_f32_16x16x32_bf16 v[188:191], a[252:255], a[148:151], v[188:191]
  s_waitcnt lgkmcnt(0)
  v_mfma_f32_16x16x32_bf16 v[220:223], a[252:255], a[152:155], v[220:223]
  ds_read_b64_tr_b16 a[252:253], v226 offset:17608
  v_mfma_f32_16x16x32_bf16 v[0:3], a[224:227], a[192:195], v[0:3]
  ds_read_b64_tr_b16 a[254:255], v226 offset:21960
  v_mfma_f32_16x16x32_bf16 v[32:35], a[224:227], a[196:199], v[32:35]
  s_mul_i32 s46, s22, -17408
  v_mfma_f32_16x16x32_bf16 v[64:67], a[224:227], a[200:203], v[64:67]
  s_add_u32 s46, s46, s24
  v_mfma_f32_16x16x32_bf16 v[96:99], a[224:227], a[204:207], v[96:99]
  s_add_u32 s46, s46, 17408
  v_mfma_f32_16x16x32_bf16 v[128:131], a[224:227], a[208:211], v[128:131]
  s_waitcnt vmcnt(17) lgkmcnt(0)
  s_barrier
  s_add_u32 m0, s46, 0
  v_mfma_f32_16x16x32_bf16 v[160:163], a[224:227], a[212:215], v[160:163]
  buffer_load_dwordx4 v229, s[8:11], s31 offen lds
  v_mfma_f32_16x16x32_bf16 v[192:195], a[224:227], a[216:219], v[192:195]
  ds_read_b64_tr_b16 a[224:225], v226 offset:26112
  s_add_u32 s31, s31, s27
  v_mfma_f32_16x16x32_bf16 v[4:7], a[228:231], a[192:195], v[4:7]
  ds_read_b64_tr_b16 a[226:227], v226 offset:30464
  v_mfma_f32_16x16x32_bf16 v[36:39], a[228:231], a[196:199], v[36:39]
  v_mfma_f32_16x16x32_bf16 v[68:71], a[228:231], a[200:203], v[68:71]
  s_add_u32 m0, s46, 1088
  v_mfma_f32_16x16x32_bf16 v[100:103], a[228:231], a[204:207], v[100:103]
  buffer_load_dwordx4 v229, s[8:11], s31 offen lds
  v_mfma_f32_16x16x32_bf16 v[132:135], a[228:231], a[208:211], v[132:135]
  s_add_u32 s31, s31, s27
  v_mfma_f32_16x16x32_bf16 v[164:167], a[228:231], a[212:215], v[164:167]
  v_mfma_f32_16x16x32_bf16 v[196:199], a[228:231], a[216:219], v[196:199]
  ds_read_b64_tr_b16 a[228:229], v226 offset:26120
  v_mfma_f32_16x16x32_bf16 v[8:11], a[232:235], a[192:195], v[8:11]
  ds_read_b64_tr_b16 a[230:231], v226 offset:30472
  s_add_u32 m0, s46, 2176
  v_mfma_f32_16x16x32_bf16 v[40:43], a[232:235], a[196:199], v[40:43]
  buffer_load_dwordx4 v229, s[8:11], s31 offen lds
  v_mfma_f32_16x16x32_bf16 v[72:75], a[232:235], a[200:203], v[72:75]
  s_add_u32 s31, s31, s27
  v_mfma_f32_16x16x32_bf16 v[104:107], a[232:235], a[204:207], v[104:107]
  v_mfma_f32_16x16x32_bf16 v[136:139], a[232:235], a[208:211], v[136:139]
  v_mfma_f32_16x16x32_bf16 v[168:171], a[232:235], a[212:215], v[168:171]
  v_mfma_f32_16x16x32_bf16 v[200:203], a[232:235], a[216:219], v[200:203]
  ds_read_b64_tr_b16 a[232:233], v226 offset:26176
  v_mfma_f32_16x16x32_bf16 v[12:15], a[236:239], a[192:195], v[12:15]
  ds_read_b64_tr_b16 a[234:235], v226 offset:30528
  s_add_u32 m0, s46, 3264
  v_mfma_f32_16x16x32_bf16 v[44:47], a[236:239], a[196:199], v[44:47]
  buffer_load_dwordx4 v229, s[8:11], s31 offen lds
  v_mfma_f32_16x16x32_bf16 v[76:79], a[236:239], a[200:203], v[76:79]
  s_add_u32 s31, s31, s27
  v_mfma_f32_16x16x32_bf16 v[108:111], a[236:239], a[204:207], v[108:111]
  v_mfma_f32_16x16x32_bf16 v[140:143], a[236:239], a[208:211], v[140:143]
  v_mfma_f32_16x16x32_bf16 v[172:175], a[236:239], a[212:215], v[172:175]
  v_mfma_f32_16x16x32_bf16 v[204:207], a[236:239], a[216:219], v[204:207]
  ds_read_b64_tr_b16 a[236:237], v226 offset:26184
  v_mfma_f32_16x16x32_bf16 v[16:19], a[240:243], a[192:195], v[16:19]
  ds_read_b64_tr_b16 a[238:239], v226 offset:30536
  s_add_u32 m0, s46, 4352
  v_mfma_f32_16x16x32_bf16 v[48:51], a[240:243], a[196:199], v[48:51]
  buffer_load_dwordx4 v229, s[8:11], s31 offen lds
  v_mfma_f32_16x16x32_bf16 v[80:83], a[240:243], a[200:203], v[80:83]
  s_add_u32 s31, s31, s27
  v_mfma_f32_16x16x32_bf16 v[112:115], a[240:243], a[204:207], v[112:115]
  v_mfma_f32_16x16x32_bf16 v[144:147], a[240:243], a[208:211], v[144:147]
  v_mfma_f32_16x16x32_bf16 v[176:179], a[240:243], a[212:215], v[176:179]
  v_mfma_f32_16x16x32_bf16 v[208:211], a[240:243], a[216:219], v[208:211]
  ds_read_b64_tr_b16 a[240:241], v226 offset:26240
  v_mfma_f32_16x16x32_bf16 v[20:23], a[244:247], a[192:195], v[20:23]
  ds_read_b64_tr_b16 a[242:243], v226 offset:30592
  s_add_u32 m0, s46, 5440
  v_mfma_f32_16x16x32_bf16 v[52:55], a[244:247], a[196:199], v[52:55]
  buffer_load_dwordx4 v229, s[8:11], s31 offen lds
  v_mfma_f32_16x16x32_bf16 v[84:87], a[244:247], a[200:203], v[84:87]
  s_add_u32 s31, s31, s27
  v_mfma_f32_16x16x32_bf16 v[116:119], a[244:247], a[204:207], v[116:119]
  v_mfma_f32_16x16x32_bf16 v[148:151], a[244:247], a[208:211], v[148:151]
  v_mfma_f32_16x16x32_bf16 v[180:183], a[244:247], a[212:215], v[180:183]
  v_mfma_f32_16x16x32_bf16 v[212:215], a[244:247], a[216:219], v[212:215]
  ds_read_b64_tr_b16 a[244:245], v226 offset:26248
  v_mfma_f32_16x16x32_bf16 v[24:27], a[248:251], a[192:195], v[24:27]
  ds_read_b64_tr_b16 a[246:247], v226 offset:30600
  s_add_u32 m0, s46, 6528
  v_mfma_f32_16x16x32_bf16 v[56:59], a[248:251], a[196:199], v[56:59]
  buffer_load_dwordx4 v229, s[8:11], s31 offen lds
  v_mfma_f32_16x16x32_bf16 v[88:91], a[248:251], a[200:203], v[88:91]
  s_add_u32 s31, s31, s27
  v_mfma_f32_16x16x32_bf16 v[120:123], a[248:251], a[204:207], v[120:123]
  v_mfma_f32_16x16x32_bf16 v[152:155], a[248:251], a[208:211], v[152:155]
  v_mfma_f32_16x16x32_bf16 v[184:187], a[248:251], a[212:215], v[184:187]
  s_lshl_b32 s41, s23, 4
  s_add_u32 s41, s41, s3
  v_mfma_f32_16x16x32_bf16 v[216:219], a[248:251], a[216:219], v[216:219]
  ds_read_b64_tr_b16 a[248:249], v226 offset:26304
  s_lshl_b32 s40, s32, 5
  s_add_u32 s40, s40, s41
  v_mfma_f32_16x16x32_bf16 v[28:31], a[252:255], a[192:195], v[28:31]
  ds_read_b64_tr_b16 a[250:251], v226 offset:30656
  s_add_u32 m0, s46, 7616
  s_lshl_b32 s40, s40, 18
  s_add_u32 s4, s48, s40
  v_mfma_f32_16x16x32_bf16 v[60:63], a[252:255], a[196:199], v[60:63]
  buffer_load_dwordx4 v229, s[8:11], s31 offen lds
  s_addc_u32 s5, s49, 0
  s_mul_i32 s39, s21, 0
  v_mfma_f32_16x16x32_bf16 v[92:95], a[252:255], a[200:203], v[92:95]
  s_add_u32 s26, s26, s28
  s_mov_b32 s31, s26
  s_mov_b32 s25, s39
  v_mfma_f32_16x16x32_bf16 v[124:127], a[252:255], a[204:207], v[124:127]
  v_mfma_f32_16x16x32_bf16 v[156:159], a[252:255], a[208:211], v[156:159]
  v_mfma_f32_16x16x32_bf16 v[188:191], a[252:255], a[212:215], v[188:191]
  s_waitcnt lgkmcnt(0)
  v_mfma_f32_16x16x32_bf16 v[220:223], a[252:255], a[216:219], v[220:223]
  ds_read_b64_tr_b16 a[252:253], v226 offset:26312
  v_mfma_f32_16x16x32_bf16 v[0:3], a[224:227], a[160:163], v[0:3]
  ds_read_b64_tr_b16 a[254:255], v226 offset:30664
  v_mfma_f32_16x16x32_bf16 v[32:35], a[224:227], a[164:167], v[32:35]
  s_mul_i32 s46, s22, -17408
  v_mfma_f32_16x16x32_bf16 v[64:67], a[224:227], a[168:171], v[64:67]
  s_add_u32 s46, s46, s24
  v_mfma_f32_16x16x32_bf16 v[96:99], a[224:227], a[172:175], v[96:99]
  s_add_u32 s46, s46, 26112
  v_mfma_f32_16x16x32_bf16 v[128:131], a[224:227], a[176:179], v[128:131]
  s_waitcnt vmcnt(17) lgkmcnt(0)
  s_barrier
  s_add_u32 m0, s46, 0
  v_mfma_f32_16x16x32_bf16 v[160:163], a[224:227], a[180:183], v[160:163]
  buffer_load_dwordx4 v229, s[8:11], s31 offen lds
  v_mfma_f32_16x16x32_bf16 v[192:195], a[224:227], a[184:187], v[192:195]
  ds_read_b64_tr_b16 a[224:225], v226 offset:0
  s_add_u32 s31, s31, s27
  v_mfma_f32_16x16x32_bf16 v[4:7], a[228:231], a[160:163], v[4:7]
  ds_read_b64_tr_b16 a[226:227], v226 offset:4352
  v_mfma_f32_16x16x32_bf16 v[36:39], a[228:231], a[164:167], v[36:39]
  ds_read_b128 a[192:195], v227 offset:17472
  v_mfma_f32_16x16x32_bf16 v[68:71], a[228:231], a[168:171], v[68:71]
  ds_read_b128 a[196:199], v227 offset:19648
  s_add_u32 m0, s46, 1088
  v_mfma_f32_16x16x32_bf16 v[100:103], a[228:231], a[172:175], v[100:103]
  buffer_load_dwordx4 v229, s[8:11], s31 offen lds
  v_mfma_f32_16x16x32_bf16 v[132:135], a[228:231], a[176:179], v[132:135]
  ds_read_b128 a[200:203], v227 offset:21824
  s_add_u32 s31, s31, s27
  v_mfma_f32_16x16x32_bf16 v[164:167], a[228:231], a[180:183], v[164:167]
  ds_read_b128 a[204:207], v227 offset:24000
  v_mfma_f32_16x16x32_bf16 v[196:199], a[228:231], a[184:187], v[196:199]
  ds_read_b64_tr_b16 a[228:229], v226 offset:8
  v_mfma_f32_16x16x32_bf16 v[8:11], a[232:235], a[160:163], v[8:11]
  ds_read_b64_tr_b16 a[230:231], v226 offset:4360
  s_add_u32 m0, s46, 2176
  v_mfma_f32_16x16x32_bf16 v[40:43], a[232:235], a[164:167], v[40:43]
  buffer_load_dwordx4 v229, s[8:11], s31 offen lds
  v_mfma_f32_16x16x32_bf16 v[72:75], a[232:235], a[168:171], v[72:75]
  ds_read_b128 a[208:211], v227 offset:26176
  s_add_u32 s31, s31, s27
  v_mfma_f32_16x16x32_bf16 v[104:107], a[232:235], a[172:175], v[104:107]
  ds_read_b128 a[212:215], v227 offset:28352
  v_mfma_f32_16x16x32_bf16 v[136:139], a[232:235], a[176:179], v[136:139]
  ds_read_b128 a[216:219], v227 offset:30528
  v_mfma_f32_16x16x32_bf16 v[168:171], a[232:235], a[180:183], v[168:171]
  ds_read_b128 a[128:131], v227 offset:17408
  v_mfma_f32_16x16x32_bf16 v[200:203], a[232:235], a[184:187], v[200:203]
  ds_read_b64_tr_b16 a[232:233], v226 offset:64
  v_mfma_f32_16x16x32_bf16 v[12:15], a[236:239], a[160:163], v[12:15]
  ds_read_b64_tr_b16 a[234:235], v226 offset:4416
  s_add_u32 m0, s46, 3264
  v_mfma_f32_16x16x32_bf16 v[44:47], a[236:239], a[164:167], v[44:47]
  buffer_load_dwordx4 v229, s[8:11], s31 offen lds
  v_mfma_f32_16x16x32_bf16 v[76:79], a[236:239], a[168:171], v[76:79]
  ds_read_b128 a[132:135], v227 offset:19584
  s_add_u32 s31, s31, s27
  v_mfma_f32_16x16x32_bf16 v[108:111], a[236:239], a[172:175], v[108:111]
  ds_read_b128 a[136:139], v227 offset:21760
  v_mfma_f32_16x16x32_bf16 v[140:143], a[236:239], a[176:179], v[140:143]
  ds_read_b128 a[140:143], v227 offset:23936
  v_mfma_f32_16x16x32_bf16 v[172:175], a[236:239], a[180:183], v[172:175]
  ds_read_b128 a[144:147], v227 offset:26112
  v_mfma_f32_16x16x32_bf16 v[204:207], a[236:239], a[184:187], v[204:207]
  ds_read_b64_tr_b16 a[236:237], v226 offset:72
  v_mfma_f32_16x16x32_bf16 v[16:19], a[240:243], a[160:163], v[16:19]
  ds_read_b64_tr_b16 a[238:239], v226 offset:4424
  s_add_u32 m0, s46, 4352
  v_mfma_f32_16x16x32_bf16 v[48:51], a[240:243], a[164:167], v[48:51]
  buffer_load_dwordx4 v229, s[8:11], s31 offen lds
  v_mfma_f32_16x16x32_bf16 v[80:83], a[240:243], a[168:171], v[80:83]
  ds_read_b128 a[148:151], v227 offset:28288
  s_add_u32 s31, s31, s27
  v_mfma_f32_16x16x32_bf16 v[112:115], a[240:243], a[172:175], v[112:115]
  ds_read_b128 a[152:155], v227 offset:30464
  v_mfma_f32_16x16x32_bf16 v[144:147], a[240:243], a[176:179], v[144:147]
  v_mfma_f32_16x16x32_bf16 v[176:179], a[240:243], a[180:183], v[176:179]
  v_mfma_f32_16x16x32_bf16 v[208:211], a[240:243], a[184:187], v[208:211]
  ds_read_b64_tr_b16 a[240:241], v226 offset:128
  v_mfma_f32_16x16x32_bf16 v[20:23], a[244:247], a[160:163], v[20:23]
  ds_read_b64_tr_b16 a[242:243], v226 offset:4480
  s_add_u32 m0, s46, 5440
  v_mfma_f32_16x16x32_bf16 v[52:55], a[244:247], a[164:167], v[52:55]
  buffer_load_dwordx4 v229, s[8:11], s31 offen lds
  v_mfma_f32_16x16x32_bf16 v[84:87], a[244:247], a[168:171], v[84:87]
  s_add_u32 s31, s31, s27
  v_mfma_f32_16x16x32_bf16 v[116:119], a[244:247], a[172:175], v[116:119]
  v_mfma_f32_16x16x32_bf16 v[148:151], a[244:247], a[176:179], v[148:151]
  v_mfma_f32_16x16x32_bf16 v[180:183], a[244:247], a[180:183], v[180:183]
  v_mfma_f32_16x16x32_bf16 v[212:215], a[244:247], a[184:187], v[212:215]
  ds_read_b64_tr_b16 a[244:245], v226 offset:136
  v_mfma_f32_16x16x32_bf16 v[24:27], a[248:251], a[160:163], v[24:27]
  ds_read_b64_tr_b16 a[246:247], v226 offset:4488
  s_add_u32 m0, s46, 6528
  v_mfma_f32_16x16x32_bf16 v[56:59], a[248:251], a[164:167], v[56:59]
  buffer_load_dwordx4 v229, s[8:11], s31 offen lds
  v_mfma_f32_16x16x32_bf16 v[88:91], a[248:251], a[168:171], v[88:91]
  s_add_u32 s31, s31, s27
  v_mfma_f32_16x16x32_bf16 v[120:123], a[248:251], a[172:175], v[120:123]
  v_mfma_f32_16x16x32_bf16 v[152:155], a[248:251], a[176:179], v[152:155]
  v_mfma_f32_16x16x32_bf16 v[184:187], a[248:251], a[180:183], v[184:187]
  v_mfma_f32_16x16x32_bf16 v[216:219], a[248:251], a[184:187], v[216:219]
  ds_read_b64_tr_b16 a[248:249], v226 offset:192
  v_mfma_f32_16x16x32_bf16 v[28:31], a[252:255], a[160:163], v[28:31]
  ds_read_b64_tr_b16 a[250:251], v226 offset:4544
  s_add_u32 m0, s46, 7616
  v_mfma_f32_16x16x32_bf16 v[60:63], a[252:255], a[164:167], v[60:63]
  buffer_load_dwordx4 v229, s[8:11], s31 offen lds
  v_mfma_f32_16x16x32_bf16 v[92:95], a[252:255], a[168:171], v[92:95]
  s_add_u32 s26, s26, s29
  s_mov_b32 s31, s26
  v_mfma_f32_16x16x32_bf16 v[124:127], a[252:255], a[172:175], v[124:127]
  v_mfma_f32_16x16x32_bf16 v[156:159], a[252:255], a[176:179], v[156:159]
  v_mfma_f32_16x16x32_bf16 v[188:191], a[252:255], a[180:183], v[188:191]
  s_waitcnt lgkmcnt(0)
  v_mfma_f32_16x16x32_bf16 v[220:223], a[252:255], a[184:187], v[220:223]
  ds_read_b64_tr_b16 a[252:253], v226 offset:200
  v_mfma_f32_16x16x32_bf16 v[0:3], a[224:227], a[128:131], v[0:3]
  ds_read_b64_tr_b16 a[254:255], v226 offset:4552
  v_mfma_f32_16x16x32_bf16 v[32:35], a[224:227], a[132:135], v[32:35]
  s_mul_i32 s46, s22, 17408
  v_mfma_f32_16x16x32_bf16 v[64:67], a[224:227], a[136:139], v[64:67]
  s_add_u32 s46, s46, s24
  v_mfma_f32_16x16x32_bf16 v[96:99], a[224:227], a[140:143], v[96:99]
  s_add_u32 s46, s46, 0
  v_mfma_f32_16x16x32_bf16 v[128:131], a[224:227], a[144:147], v[128:131]
  s_waitcnt vmcnt(16) lgkmcnt(0)
  s_barrier
  s_add_u32 m0, s46, 0
  v_mfma_f32_16x16x32_bf16 v[160:163], a[224:227], a[148:151], v[160:163]
  buffer_load_dwordx4 v229, s[8:11], s31 offen lds
  v_mfma_f32_16x16x32_bf16 v[192:195], a[224:227], a[152:155], v[192:195]
  ds_read_b64_tr_b16 a[224:225], v226 offset:8704
  s_add_u32 s31, s31, s27
  v_mfma_f32_16x16x32_bf16 v[4:7], a[228:231], a[128:131], v[4:7]
  ds_read_b64_tr_b16 a[226:227], v226 offset:13056
  v_mfma_f32_16x16x32_bf16 v[36:39], a[228:231], a[132:135], v[36:39]
  v_mfma_f32_16x16x32_bf16 v[68:71], a[228:231], a[136:139], v[68:71]
  s_add_u32 m0, s46, 1088
  v_mfma_f32_16x16x32_bf16 v[100:103], a[228:231], a[140:143], v[100:103]
  buffer_load_dwordx4 v229, s[8:11], s31 offen lds
  v_mfma_f32_16x16x32_bf16 v[132:135], a[228:231], a[144:147], v[132:135]
  s_add_u32 s31, s31, s27
  v_mfma_f32_16x16x32_bf16 v[164:167], a[228:231], a[148:151], v[164:167]
  v_mfma_f32_16x16x32_bf16 v[196:199], a[228:231], a[152:155], v[196:199]
  ds_read_b64_tr_b16 a[228:229], v226 offset:8712
  v_mfma_f32_16x16x32_bf16 v[8:11], a[232:235], a[128:131], v[8:11]
  ds_read_b64_tr_b16 a[230:231], v226 offset:13064
  s_add_u32 m0, s46, 2176
  v_mfma_f32_16x16x32_bf16 v[40:43], a[232:235], a[132:135], v[40:43]
  buffer_load_dwordx4 v229, s[8:11], s31 offen lds
  v_mfma_f32_16x16x32_bf16 v[72:75], a[232:235], a[136:139], v[72:75]
  s_add_u32 s31, s31, s27
  v_mfma_f32_16x16x32_bf16 v[104:107], a[232:235], a[140:143], v[104:107]
  v_mfma_f32_16x16x32_bf16 v[136:139], a[232:235], a[144:147], v[136:139]
  v_mfma_f32_16x16x32_bf16 v[168:171], a[232:235], a[148:151], v[168:171]
  v_mfma_f32_16x16x32_bf16 v[200:203], a[232:235], a[152:155], v[200:203]
  ds_read_b64_tr_b16 a[232:233], v226 offset:8768
  v_mfma_f32_16x16x32_bf16 v[12:15], a[236:239], a[128:131], v[12:15]
  ds_read_b64_tr_b16 a[234:235], v226 offset:13120
  s_add_u32 m0, s46, 3264
  v_mfma_f32_16x16x32_bf16 v[44:47], a[236:239], a[132:135], v[44:47]
  buffer_load_dwordx4 v229, s[8:11], s31 offen lds
  v_mfma_f32_16x16x32_bf16 v[76:79], a[236:239], a[136:139], v[76:79]
  s_add_u32 s31, s31, s27
  v_mfma_f32_16x16x32_bf16 v[108:111], a[236:239], a[140:143], v[108:111]
  v_mfma_f32_16x16x32_bf16 v[140:143], a[236:239], a[144:147], v[140:143]
  v_mfma_f32_16x16x32_bf16 v[172:175], a[236:239], a[148:151], v[172:175]
  v_mfma_f32_16x16x32_bf16 v[204:207], a[236:239], a[152:155], v[204:207]
  ds_read_b64_tr_b16 a[236:237], v226 offset:8776
  v_mfma_f32_16x16x32_bf16 v[16:19], a[240:243], a[128:131], v[16:19]
  ds_read_b64_tr_b16 a[238:239], v226 offset:13128
  s_add_u32 m0, s46, 4352
  v_mfma_f32_16x16x32_bf16 v[48:51], a[240:243], a[132:135], v[48:51]
  buffer_load_dwordx4 v229, s[8:11], s31 offen lds
  v_mfma_f32_16x16x32_bf16 v[80:83], a[240:243], a[136:139], v[80:83]
  s_add_u32 s31, s31, s27
  v_mfma_f32_16x16x32_bf16 v[112:115], a[240:243], a[140:143], v[112:115]
  v_mfma_f32_16x16x32_bf16 v[144:147], a[240:243], a[144:147], v[144:147]
  v_mfma_f32_16x16x32_bf16 v[176:179], a[240:243], a[148:151], v[176:179]
  v_mfma_f32_16x16x32_bf16 v[208:211], a[240:243], a[152:155], v[208:211]
  ds_read_b64_tr_b16 a[240:241], v226 offset:8832
  v_mfma_f32_16x16x32_bf16 v[20:23], a[244:247], a[128:131], v[20:23]
  ds_read_b64_tr_b16 a[242:243], v226 offset:13184
  s_add_u32 m0, s46, 5440
  v_mfma_f32_16x16x32_bf16 v[52:55], a[244:247], a[132:135], v[52:55]
  buffer_load_dwordx4 v229, s[8:11], s31 offen lds
  v_mfma_f32_16x16x32_bf16 v[84:87], a[244:247], a[136:139], v[84:87]
  s_add_u32 s31, s31, s27
  v_mfma_f32_16x16x32_bf16 v[116:119], a[244:247], a[140:143], v[116:119]
  v_mfma_f32_16x16x32_bf16 v[148:151], a[244:247], a[144:147], v[148:151]
  v_mfma_f32_16x16x32_bf16 v[180:183], a[244:247], a[148:151], v[180:183]
  v_mfma_f32_16x16x32_bf16 v[212:215], a[244:247], a[152:155], v[212:215]
  ds_read_b64_tr_b16 a[244:245], v226 offset:8840
  v_mfma_f32_16x16x32_bf16 v[24:27], a[248:251], a[128:131], v[24:27]
  ds_read_b64_tr_b16 a[246:247], v226 offset:13192
  s_add_u32 m0, s46, 6528
  v_mfma_f32_16x16x32_bf16 v[56:59], a[248:251], a[132:135], v[56:59]
  buffer_load_dwordx4 v229, s[8:11], s31 offen lds
  v_mfma_f32_16x16x32_bf16 v[88:91], a[248:251], a[136:139], v[88:91]
  s_add_u32 s31, s31, s27
  v_mfma_f32_16x16x32_bf16 v[120:123], a[248:251], a[140:143], v[120:123]
  v_mfma_f32_16x16x32_bf16 v[152:155], a[248:251], a[144:147], v[152:155]
  v_mfma_f32_16x16x32_bf16 v[184:187], a[248:251], a[148:151], v[184:187]
  s_lshl_b32 s40, s37, 4
  s_add_u32 s40, s40, s32
  v_mfma_f32_16x16x32_bf16 v[216:219], a[248:251], a[152:155], v[216:219]
  ds_read_b64_tr_b16 a[248:249], v226 offset:8896
  s_lshl_b32 s40, s40, 8
  s_lshr_b32 s41, s2, 2
  v_mfma_f32_16x16x32_bf16 v[28:31], a[252:255], a[128:131], v[28:31]
  ds_read_b64_tr_b16 a[250:251], v226 offset:13248
  s_add_u32 m0, s46, 7616
  s_lshl_b32 s41, s41, 1
  s_and_b32 s42, s2, 1
  v_mfma_f32_16x16x32_bf16 v[60:63], a[252:255], a[132:135], v[60:63]
  buffer_load_dwordx4 v229, s[8:11], s31 offen lds
  s_add_u32 s41, s41, s42
  s_lshl_b32 s41, s41, 2
  v_mfma_f32_16x16x32_bf16 v[92:95], a[252:255], a[136:139], v[92:95]
  s_add_u32 s26, s26, s28
  s_mov_b32 s31, s26
  s_add_u32 s41, s41, s20
  s_mul_i32 s41, s41, 10240
  v_mfma_f32_16x16x32_bf16 v[124:127], a[252:255], a[140:143], v[124:127]
  s_cmp_eq_u32 s23, 0
  s_cselect_b32 s63, 2147418112, s40
  v_mfma_f32_16x16x32_bf16 v[156:159], a[252:255], a[144:147], v[156:159]
  s_cselect_b32 s38, 2147418112, s41
  v_mfma_f32_16x16x32_bf16 v[188:191], a[252:255], a[148:151], v[188:191]
  s_waitcnt lgkmcnt(0)
  v_mfma_f32_16x16x32_bf16 v[220:223], a[252:255], a[152:155], v[220:223]
  ds_read_b64_tr_b16 a[252:253], v226 offset:8904
  v_mfma_f32_16x16x32_bf16 v[0:3], a[224:227], a[192:195], v[0:3]
  ds_read_b64_tr_b16 a[254:255], v226 offset:13256
  v_mfma_f32_16x16x32_bf16 v[32:35], a[224:227], a[196:199], v[32:35]
  s_mul_i32 s46, s22, 17408
  v_mfma_f32_16x16x32_bf16 v[64:67], a[224:227], a[200:203], v[64:67]
  s_add_u32 s46, s46, s24
  v_mfma_f32_16x16x32_bf16 v[96:99], a[224:227], a[204:207], v[96:99]
  s_add_u32 s46, s46, 8704
  v_mfma_f32_16x16x32_bf16 v[128:131], a[224:227], a[208:211], v[128:131]
  s_waitcnt vmcnt(16) lgkmcnt(0)
  s_barrier
  s_add_u32 m0, s46, 0
  v_mfma_f32_16x16x32_bf16 v[160:163], a[224:227], a[212:215], v[160:163]
  buffer_load_dwordx4 v229, s[8:11], s31 offen lds
  v_mfma_f32_16x16x32_bf16 v[192:195], a[224:227], a[216:219], v[192:195]
  ds_read_b64_tr_b16 a[224:225], v226 offset:17408
  s_add_u32 s31, s31, s27
  v_mfma_f32_16x16x32_bf16 v[4:7], a[228:231], a[192:195], v[4:7]
  ds_read_b64_tr_b16 a[226:227], v226 offset:21760
  v_mfma_f32_16x16x32_bf16 v[36:39], a[228:231], a[196:199], v[36:39]
  ds_read_b128 a[128:131], v227 offset:34880
  v_mfma_f32_16x16x32_bf16 v[68:71], a[228:231], a[200:203], v[68:71]
  ds_read_b128 a[132:135], v227 offset:37056
  s_add_u32 m0, s46, 1088
  v_mfma_f32_16x16x32_bf16 v[100:103], a[228:231], a[204:207], v[100:103]
  buffer_load_dwordx4 v229, s[8:11], s31 offen lds
  v_mfma_f32_16x16x32_bf16 v[132:135], a[228:231], a[208:211], v[132:135]
  ds_read_b128 a[136:139], v227 offset:39232
  s_add_u32 s31, s31, s27
  v_mfma_f32_16x16x32_bf16 v[164:167], a[228:231], a[212:215], v[164:167]
  ds_read_b128 a[140:143], v227 offset:41408
  v_mfma_f32_16x16x32_bf16 v[196:199], a[228:231], a[216:219], v[196:199]
  ds_read_b64_tr_b16 a[228:229], v226 offset:17416
  v_mfma_f32_16x16x32_bf16 v[8:11], a[232:235], a[192:195], v[8:11]
  ds_read_b64_tr_b16 a[230:231], v226 offset:21768
  s_add_u32 m0, s46, 2176
  v_mfma_f32_16x16x32_bf16 v[40:43], a[232:235], a[196:199], v[40:43]
  buffer_load_dwordx4 v229, s[8:11], s31 offen lds
  v_mfma_f32_16x16x32_bf16 v[72:75], a[232:235], a[200:203], v[72:75]
  ds_read_b128 a[144:147], v227 offset:64
  s_add_u32 s31, s31, s27
  v_mfma_f32_16x16x32_bf16 v[104:107], a[232:235], a[204:207], v[104:107]
  ds_read_b128 a[148:151], v227 offset:2240
  v_mfma_f32_16x16x32_bf16 v[136:139], a[232:235], a[208:211], v[136:139]
  ds_read_b128 a[152:155], v227 offset:4416
  v_mfma_f32_16x16x32_bf16 v[168:171], a[232:235], a[212:215], v[168:171]
  ds_read_b128 a[160:163], v227 offset:34816
  v_mfma_f32_16x16x32_bf16 v[200:203], a[232:235], a[216:219], v[200:203]
  ds_read_b64_tr_b16 a[232:233], v226 offset:17472
  v_mfma_f32_16x16x32_bf16 v[12:15], a[236:239], a[192:195], v[12:15]
  ds_read_b64_tr_b16 a[234:235], v226 offset:21824
  s_add_u32 m0, s46, 3264
  v_mfma_f32_16x16x32_bf16 v[44:47], a[236:239], a[196:199], v[44:47]
  buffer_load_dwordx4 v229, s[8:11], s31 offen lds
  v_mfma_f32_16x16x32_bf16 v[76:79], a[236:239], a[200:203], v[76:79]
  ds_read_b128 a[164:167], v227 offset:36992
  s_add_u32 s31, s31, s27
  v_mfma_f32_16x16x32_bf16 v[108:111], a[236:239], a[204:207], v[108:111]
  ds_read_b128 a[168:171], v227 offset:39168
  v_mfma_f32_16x16x32_bf16 v[140:143], a[236:239], a[208:211], v[140:143]
  ds_read_b128 a[172:175], v227 offset:41344
  v_mfma_f32_16x16x32_bf16 v[172:175], a[236:239], a[212:215], v[172:175]
  ds_read_b128 a[176:179], v227 offset:0
  v_mfma_f32_16x16x32_bf16 v[204:207], a[236:239], a[216:219], v[204:207]
  ds_read_b64_tr_b16 a[236:237], v226 offset:17480
  v_mfma_f32_16x16x32_bf16 v[16:19], a[240:243], a[192:195], v[16:19]
  ds_read_b64_tr_b16 a[238:239], v226 offset:21832
  s_add_u32 m0, s46, 4352
  v_mfma_f32_16x16x32_bf16 v[48:51], a[240:243], a[196:199], v[48:51]
  buffer_load_dwordx4 v229, s[8:11], s31 offen lds
  v_mfma_f32_16x16x32_bf16 v[80:83], a[240:243], a[200:203], v[80:83]
  ds_read_b128 a[180:183], v227 offset:2176
  s_add_u32 s31, s31, s27
  v_mfma_f32_16x16x32_bf16 v[112:115], a[240:243], a[204:207], v[112:115]
  ds_read_b128 a[184:187], v227 offset:4352
  v_mfma_f32_16x16x32_bf16 v[144:147], a[240:243], a[208:211], v[144:147]
  v_mfma_f32_16x16x32_bf16 v[176:179], a[240:243], a[212:215], v[176:179]
  v_mfma_f32_16x16x32_bf16 v[208:211], a[240:243], a[216:219], v[208:211]
  ds_read_b64_tr_b16 a[240:241], v226 offset:17536
  v_mfma_f32_16x16x32_bf16 v[20:23], a[244:247], a[192:195], v[20:23]
  ds_read_b64_tr_b16 a[242:243], v226 offset:21888
  s_add_u32 m0, s46, 5440
  v_mfma_f32_16x16x32_bf16 v[52:55], a[244:247], a[196:199], v[52:55]
  buffer_load_dwordx4 v229, s[8:11], s31 offen lds
  v_mfma_f32_16x16x32_bf16 v[84:87], a[244:247], a[200:203], v[84:87]
  s_add_u32 s31, s31, s27
  v_mfma_f32_16x16x32_bf16 v[116:119], a[244:247], a[204:207], v[116:119]
  v_mfma_f32_16x16x32_bf16 v[148:151], a[244:247], a[208:211], v[148:151]
  v_mfma_f32_16x16x32_bf16 v[180:183], a[244:247], a[212:215], v[180:183]
  v_mfma_f32_16x16x32_bf16 v[212:215], a[244:247], a[216:219], v[212:215]
  ds_read_b64_tr_b16 a[244:245], v226 offset:17544
  v_mfma_f32_16x16x32_bf16 v[24:27], a[248:251], a[192:195], v[24:27]
  ds_read_b64_tr_b16 a[246:247], v226 offset:21896
  s_add_u32 m0, s46, 6528
  v_mfma_f32_16x16x32_bf16 v[56:59], a[248:251], a[196:199], v[56:59]
  buffer_load_dwordx4 v229, s[8:11], s31 offen lds
  v_mfma_f32_16x16x32_bf16 v[88:91], a[248:251], a[200:203], v[88:91]
  s_add_u32 s31, s31, s27
  v_mfma_f32_16x16x32_bf16 v[120:123], a[248:251], a[204:207], v[120:123]
  v_mfma_f32_16x16x32_bf16 v[152:155], a[248:251], a[208:211], v[152:155]
  v_mfma_f32_16x16x32_bf16 v[184:187], a[248:251], a[212:215], v[184:187]
  v_mfma_f32_16x16x32_bf16 v[216:219], a[248:251], a[216:219], v[216:219]
  ds_read_b64_tr_b16 a[248:249], v226 offset:17600
  v_mfma_f32_16x16x32_bf16 v[28:31], a[252:255], a[192:195], v[28:31]
  ds_read_b64_tr_b16 a[250:251], v226 offset:21952
  s_add_u32 m0, s46, 7616
  v_mfma_f32_16x16x32_bf16 v[60:63], a[252:255], a[196:199], v[60:63]
  buffer_load_dwordx4 v229, s[8:11], s31 offen lds
  v_mfma_f32_16x16x32_bf16 v[92:95], a[252:255], a[200:203], v[92:95]
  s_add_u32 s26, s26, s29
  s_mov_b32 s31, s26
  v_mfma_f32_16x16x32_bf16 v[124:127], a[252:255], a[204:207], v[124:127]
  v_mfma_f32_16x16x32_bf16 v[156:159], a[252:255], a[208:211], v[156:159]
  v_mfma_f32_16x16x32_bf16 v[188:191], a[252:255], a[212:215], v[188:191]
  s_waitcnt lgkmcnt(0)
  v_mfma_f32_16x16x32_bf16 v[220:223], a[252:255], a[216:219], v[220:223]
  ds_read_b64_tr_b16 a[252:253], v226 offset:17608
  v_mfma_f32_16x16x32_bf16 v[0:3], a[224:227], a[160:163], v[0:3]
  ds_read_b64_tr_b16 a[254:255], v226 offset:21960
  v_mfma_f32_16x16x32_bf16 v[32:35], a[224:227], a[164:167], v[32:35]
  s_mul_i32 s46, s22, 17408
  v_mfma_f32_16x16x32_bf16 v[64:67], a[224:227], a[168:171], v[64:67]
  s_add_u32 s46, s46, s24
  v_mfma_f32_16x16x32_bf16 v[96:99], a[224:227], a[172:175], v[96:99]
  s_add_u32 s46, s46, 17408
  v_mfma_f32_16x16x32_bf16 v[128:131], a[224:227], a[176:179], v[128:131]
  s_waitcnt vmcnt(16) lgkmcnt(0)
  s_barrier
  s_add_u32 m0, s46, 0
  v_mfma_f32_16x16x32_bf16 v[160:163], a[224:227], a[180:183], v[160:163]
  buffer_load_dwordx4 v229, s[8:11], s31 offen lds
  v_mfma_f32_16x16x32_bf16 v[192:195], a[224:227], a[184:187], v[192:195]
  ds_read_b64_tr_b16 a[224:225], v226 offset:26112
  s_add_u32 s31, s31, s27
  v_mfma_f32_16x16x32_bf16 v[4:7], a[228:231], a[160:163], v[4:7]
  ds_read_b64_tr_b16 a[226:227], v226 offset:30464
  v_mfma_f32_16x16x32_bf16 v[36:39], a[228:231], a[164:167], v[36:39]
  v_mfma_f32_16x16x32_bf16 v[68:71], a[228:231], a[168:171], v[68:71]
  s_add_u32 m0, s46, 1088
  v_mfma_f32_16x16x32_bf16 v[100:103], a[228:231], a[172:175], v[100:103]
  buffer_load_dwordx4 v229, s[8:11], s31 offen lds
  v_mfma_f32_16x16x32_bf16 v[132:135], a[228:231], a[176:179], v[132:135]
  s_add_u32 s31, s31, s27
  v_mfma_f32_16x16x32_bf16 v[164:167], a[228:231], a[180:183], v[164:167]
  v_mfma_f32_16x16x32_bf16 v[196:199], a[228:231], a[184:187], v[196:199]
  ds_read_b64_tr_b16 a[228:229], v226 offset:26120
  v_mfma_f32_16x16x32_bf16 v[8:11], a[232:235], a[160:163], v[8:11]
  ds_read_b64_tr_b16 a[230:231], v226 offset:30472
  s_add_u32 m0, s46, 2176
  v_mfma_f32_16x16x32_bf16 v[40:43], a[232:235], a[164:167], v[40:43]
  buffer_load_dwordx4 v229, s[8:11], s31 offen lds
  v_mfma_f32_16x16x32_bf16 v[72:75], a[232:235], a[168:171], v[72:75]
  s_add_u32 s31, s31, s27
  v_mfma_f32_16x16x32_bf16 v[104:107], a[232:235], a[172:175], v[104:107]
  v_mfma_f32_16x16x32_bf16 v[136:139], a[232:235], a[176:179], v[136:139]
  v_mfma_f32_16x16x32_bf16 v[168:171], a[232:235], a[180:183], v[168:171]
  v_mfma_f32_16x16x32_bf16 v[200:203], a[232:235], a[184:187], v[200:203]
  ds_read_b64_tr_b16 a[232:233], v226 offset:26176
  v_mfma_f32_16x16x32_bf16 v[12:15], a[236:239], a[160:163], v[12:15]
  ds_read_b64_tr_b16 a[234:235], v226 offset:30528
  s_add_u32 m0, s46, 3264
  v_mfma_f32_16x16x32_bf16 v[44:47], a[236:239], a[164:167], v[44:47]
  buffer_load_dwordx4 v229, s[8:11], s31 offen lds
  v_mfma_f32_16x16x32_bf16 v[76:79], a[236:239], a[168:171], v[76:79]
  s_add_u32 s31, s31, s27
  v_mfma_f32_16x16x32_bf16 v[108:111], a[236:239], a[172:175], v[108:111]
  v_mfma_f32_16x16x32_bf16 v[140:143], a[236:239], a[176:179], v[140:143]
  v_mfma_f32_16x16x32_bf16 v[172:175], a[236:239], a[180:183], v[172:175]
  v_mfma_f32_16x16x32_bf16 v[204:207], a[236:239], a[184:187], v[204:207]
  ds_read_b64_tr_b16 a[236:237], v226 offset:26184
  v_mfma_f32_16x16x32_bf16 v[16:19], a[240:243], a[160:163], v[16:19]
  ds_read_b64_tr_b16 a[238:239], v226 offset:30536
  s_add_u32 m0, s46, 4352
  v_mfma_f32_16x16x32_bf16 v[48:51], a[240:243], a[164:167], v[48:51]
  buffer_load_dwordx4 v229, s[8:11], s31 offen lds
  v_mfma_f32_16x16x32_bf16 v[80:83], a[240:243], a[168:171], v[80:83]
  s_add_u32 s31, s31, s27
  v_mfma_f32_16x16x32_bf16 v[112:115], a[240:243], a[172:175], v[112:115]
  v_mfma_f32_16x16x32_bf16 v[144:147], a[240:243], a[176:179], v[144:147]
  v_mfma_f32_16x16x32_bf16 v[176:179], a[240:243], a[180:183], v[176:179]
  v_mfma_f32_16x16x32_bf16 v[208:211], a[240:243], a[184:187], v[208:211]
  ds_read_b64_tr_b16 a[240:241], v226 offset:26240
  v_mfma_f32_16x16x32_bf16 v[20:23], a[244:247], a[160:163], v[20:23]
  ds_read_b64_tr_b16 a[242:243], v226 offset:30592
  s_add_u32 m0, s46, 5440
  v_mfma_f32_16x16x32_bf16 v[52:55], a[244:247], a[164:167], v[52:55]
  buffer_load_dwordx4 v229, s[8:11], s31 offen lds
  v_mfma_f32_16x16x32_bf16 v[84:87], a[244:247], a[168:171], v[84:87]
  s_add_u32 s31, s31, s27
  v_mfma_f32_16x16x32_bf16 v[116:119], a[244:247], a[172:175], v[116:119]
  v_mfma_f32_16x16x32_bf16 v[148:151], a[244:247], a[176:179], v[148:151]
  v_mfma_f32_16x16x32_bf16 v[180:183], a[244:247], a[180:183], v[180:183]
  v_mfma_f32_16x16x32_bf16 v[212:215], a[244:247], a[184:187], v[212:215]
  ds_read_b64_tr_b16 a[244:245], v226 offset:26248
  v_mfma_f32_16x16x32_bf16 v[24:27], a[248:251], a[160:163], v[24:27]
  ds_read_b64_tr_b16 a[246:247], v226 offset:30600
  s_add_u32 m0, s46, 6528
  v_mfma_f32_16x16x32_bf16 v[56:59], a[248:251], a[164:167], v[56:59]
  buffer_load_dwordx4 v229, s[8:11], s31 offen lds
  v_mfma_f32_16x16x32_bf16 v[88:91], a[248:251], a[168:171], v[88:91]
  s_add_u32 s31, s31, s27
  v_mfma_f32_16x16x32_bf16 v[120:123], a[248:251], a[172:175], v[120:123]
  v_mfma_f32_16x16x32_bf16 v[152:155], a[248:251], a[176:179], v[152:155]
  v_mfma_f32_16x16x32_bf16 v[184:187], a[248:251], a[180:183], v[184:187]
  v_mfma_f32_16x16x32_bf16 v[216:219], a[248:251], a[184:187], v[216:219]
  ds_read_b64_tr_b16 a[248:249], v226 offset:26304
  v_mfma_f32_16x16x32_bf16 v[28:31], a[252:255], a[160:163], v[28:31]
  ds_read_b64_tr_b16 a[250:251], v226 offset:30656
  s_add_u32 m0, s46, 7616
  v_mfma_f32_16x16x32_bf16 v[60:63], a[252:255], a[164:167], v[60:63]
  buffer_load_dwordx4 v229, s[8:11], s31 offen lds
  v_mfma_f32_16x16x32_bf16 v[92:95], a[252:255], a[168:171], v[92:95]
  s_add_u32 s26, s26, s28
  s_mov_b32 s31, s26
  v_mfma_f32_16x16x32_bf16 v[124:127], a[252:255], a[172:175], v[124:127]
  v_mfma_f32_16x16x32_bf16 v[156:159], a[252:255], a[176:179], v[156:159]
  v_mfma_f32_16x16x32_bf16 v[188:191], a[252:255], a[180:183], v[188:191]
  s_waitcnt lgkmcnt(0)
  v_mfma_f32_16x16x32_bf16 v[220:223], a[252:255], a[184:187], v[220:223]
  ds_read_b64_tr_b16 a[252:253], v226 offset:26312
  v_mfma_f32_16x16x32_bf16 v[0:3], a[224:227], a[128:131], v[0:3]
  ds_read_b64_tr_b16 a[254:255], v226 offset:30664
  v_mfma_f32_16x16x32_bf16 v[32:35], a[224:227], a[132:135], v[32:35]
  s_mul_i32 s46, s22, -26112
  v_mfma_f32_16x16x32_bf16 v[64:67], a[224:227], a[136:139], v[64:67]
  s_add_u32 s46, s46, s24
  v_mfma_f32_16x16x32_bf16 v[96:99], a[224:227], a[140:143], v[96:99]
  s_add_u32 s46, s46, 26112
  v_mfma_f32_16x16x32_bf16 v[128:131], a[224:227], a[144:147], v[128:131]
  s_waitcnt vmcnt(16) lgkmcnt(0)
  s_barrier
  s_add_u32 m0, s46, 0
  v_mfma_f32_16x16x32_bf16 v[160:163], a[224:227], a[148:151], v[160:163]
  buffer_load_dwordx4 v229, s[8:11], s31 offen lds
  v_mfma_f32_16x16x32_bf16 v[192:195], a[224:227], a[152:155], v[192:195]
  ds_read_b64_tr_b16 a[224:225], v226 offset:0
  s_add_u32 s31, s31, s27
  v_mfma_f32_16x16x32_bf16 v[4:7], a[228:231], a[128:131], v[4:7]
  ds_read_b64_tr_b16 a[226:227], v226 offset:4352
  v_mfma_f32_16x16x32_bf16 v[36:39], a[228:231], a[132:135], v[36:39]
  ds_read_b128 a[160:163], v227 offset:8768
  v_mfma_f32_16x16x32_bf16 v[68:71], a[228:231], a[136:139], v[68:71]
  ds_read_b128 a[164:167], v227 offset:10944
  s_add_u32 m0, s46, 1088
  v_mfma_f32_16x16x32_bf16 v[100:103], a[228:231], a[140:143], v[100:103]
  buffer_load_dwordx4 v229, s[8:11], s31 offen lds
  v_mfma_f32_16x16x32_bf16 v[132:135], a[228:231], a[144:147], v[132:135]
  ds_read_b128 a[168:171], v227 offset:13120
  s_add_u32 s31, s31, s27
  v_mfma_f32_16x16x32_bf16 v[164:167], a[228:231], a[148:151], v[164:167]
  ds_read_b128 a[172:175], v227 offset:15296
  v_mfma_f32_16x16x32_bf16 v[196:199], a[228:231], a[152:155], v[196:199]
  ds_read_b64_tr_b16 a[228:229], v226 offset:8
  v_mfma_f32_16x16x32_bf16 v[8:11], a[232:235], a[128:131], v[8:11]
  ds_read_b64_tr_b16 a[230:231], v226 offset:4360
  s_add_u32 m0, s46, 2176
  v_mfma_f32_16x16x32_bf16 v[40:43], a[232:235], a[132:135], v[40:43]
  buffer_load_dwordx4 v229, s[8:11], s31 offen lds
  v_mfma_f32_16x16x32_bf16 v[72:75], a[232:235], a[136:139], v[72:75]
  ds_read_b128 a[176:179], v227 offset:17472
  s_add_u32 s31, s31, s27
  v_mfma_f32_16x16x32_bf16 v[104:107], a[232:235], a[140:143], v[104:107]
  ds_read_b128 a[180:183], v227 offset:19648
  v_mfma_f32_16x16x32_bf16 v[136:139], a[232:235], a[144:147], v[136:139]
  ds_read_b128 a[184:187], v227 offset:21824
  v_mfma_f32_16x16x32_bf16 v[168:171], a[232:235], a[148:151], v[168:171]
  ds_read_b128 a[192:195], v227 offset:8704
  v_mfma_f32_16x16x32_bf16 v[200:203], a[232:235], a[152:155], v[200:203]
  ds_read_b64_tr_b16 a[232:233], v226 offset:64
  v_mfma_f32_16x16x32_bf16 v[12:15], a[236:239], a[128:131], v[12:15]
  ds_read_b64_tr_b16 a[234:235], v226 offset:4416
  s_add_u32 m0, s46, 3264
  v_mfma_f32_16x16x32_bf16 v[44:47], a[236:239], a[132:135], v[44:47]
  buffer_load_dwordx4 v229, s[8:11], s31 offen lds
  v_mfma_f32_16x16x32_bf16 v[76:79], a[236:239], a[136:139], v[76:79]
  ds_read_b128 a[196:199], v227 offset:10880
  s_add_u32 s31, s31, s27
  v_mfma_f32_16x16x32_bf16 v[108:111], a[236:239], a[140:143], v[108:111]
  ds_read_b128 a[200:203], v227 offset:13056
  v_mfma_f32_16x16x32_bf16 v[140:143], a[236:239], a[144:147], v[140:143]
  ds_read_b128 a[204:207], v227 offset:15232
  v_mfma_f32_16x16x32_bf16 v[172:175], a[236:239], a[148:151], v[172:175]
  ds_read_b128 a[208:211], v227 offset:17408
  v_mfma_f32_16x16x32_bf16 v[204:207], a[236:239], a[152:155], v[204:207]
  ds_read_b64_tr_b16 a[236:237], v226 offset:72
  v_mfma_f32_16x16x32_bf16 v[16:19], a[240:243], a[128:131], v[16:19]
  ds_read_b64_tr_b16 a[238:239], v226 offset:4424
  s_add_u32 m0, s46, 4352
  v_mfma_f32_16x16x32_bf16 v[48:51], a[240:243], a[132:135], v[48:51]
  buffer_load_dwordx4 v229, s[8:11], s31 offen lds
  v_mfma_f32_16x16x32_bf16 v[80:83], a[240:243], a[136:139], v[80:83]
  ds_read_b128 a[212:215], v227 offset:19584
  s_add_u32 s31, s31, s27
  v_mfma_f32_16x16x32_bf16 v[112:115], a[240:243], a[140:143], v[112:115]
  ds_read_b128 a[216:219], v227 offset:21760
  v_mfma_f32_16x16x32_bf16 v[144:147], a[240:243], a[144:147], v[144:147]
  v_mfma_f32_16x16x32_bf16 v[176:179], a[240:243], a[148:151], v[176:179]
  v_mfma_f32_16x16x32_bf16 v[208:211], a[240:243], a[152:155], v[208:211]
  ds_read_b64_tr_b16 a[240:241], v226 offset:128
  v_mfma_f32_16x16x32_bf16 v[20:23], a[244:247], a[128:131], v[20:23]
  ds_read_b64_tr_b16 a[242:243], v226 offset:4480
  s_add_u32 m0, s46, 5440
  v_mfma_f32_16x16x32_bf16 v[52:55], a[244:247], a[132:135], v[52:55]
  buffer_load_dwordx4 v229, s[8:11], s31 offen lds
  v_mfma_f32_16x16x32_bf16 v[84:87], a[244:247], a[136:139], v[84:87]
  s_add_u32 s31, s31, s27
  v_mfma_f32_16x16x32_bf16 v[116:119], a[244:247], a[140:143], v[116:119]
  v_mfma_f32_16x16x32_bf16 v[148:151], a[244:247], a[144:147], v[148:151]
  v_mfma_f32_16x16x32_bf16 v[180:183], a[244:247], a[148:151], v[180:183]
  v_mfma_f32_16x16x32_bf16 v[212:215], a[244:247], a[152:155], v[212:215]
  ds_read_b64_tr_b16 a[244:245], v226 offset:136
  v_mfma_f32_16x16x32_bf16 v[24:27], a[248:251], a[128:131], v[24:27]
  ds_read_b64_tr_b16 a[246:247], v226 offset:4488
  s_add_u32 m0, s46, 6528
  v_mfma_f32_16x16x32_bf16 v[56:59], a[248:251], a[132:135], v[56:59]
  buffer_load_dwordx4 v229, s[8:11], s31 offen lds
  v_mfma_f32_16x16x32_bf16 v[88:91], a[248:251], a[136:139], v[88:91]
  s_add_u32 s31, s31, s27
  v_mfma_f32_16x16x32_bf16 v[120:123], a[248:251], a[140:143], v[120:123]
  v_mfma_f32_16x16x32_bf16 v[152:155], a[248:251], a[144:147], v[152:155]
  v_mfma_f32_16x16x32_bf16 v[184:187], a[248:251], a[148:151], v[184:187]
  v_mfma_f32_16x16x32_bf16 v[216:219], a[248:251], a[152:155], v[216:219]
  ds_read_b64_tr_b16 a[248:249], v226 offset:192
  v_mfma_f32_16x16x32_bf16 v[28:31], a[252:255], a[128:131], v[28:31]
  ds_read_b64_tr_b16 a[250:251], v226 offset:4544
  s_add_u32 m0, s46, 7616
  v_mfma_f32_16x16x32_bf16 v[60:63], a[252:255], a[132:135], v[60:63]
  buffer_load_dwordx4 v229, s[8:11], s31 offen lds
  v_mfma_f32_16x16x32_bf16 v[92:95], a[252:255], a[136:139], v[92:95]
  s_add_u32 s26, s26, s29
  s_mov_b32 s31, s26
  v_mfma_f32_16x16x32_bf16 v[124:127], a[252:255], a[140:143], v[124:127]
  v_mfma_f32_16x16x32_bf16 v[156:159], a[252:255], a[144:147], v[156:159]
  v_mfma_f32_16x16x32_bf16 v[188:191], a[252:255], a[148:151], v[188:191]
  s_waitcnt lgkmcnt(0)
  v_mfma_f32_16x16x32_bf16 v[220:223], a[252:255], a[152:155], v[220:223]
  ds_read_b64_tr_b16 a[252:253], v226 offset:200
  v_mfma_f32_16x16x32_bf16 v[0:3], a[224:227], a[192:195], v[0:3]
  ds_read_b64_tr_b16 a[254:255], v226 offset:4552
  v_mfma_f32_16x16x32_bf16 v[32:35], a[224:227], a[196:199], v[32:35]
  s_mul_i32 s46, s22, 8704
  v_mfma_f32_16x16x32_bf16 v[64:67], a[224:227], a[200:203], v[64:67]
  s_add_u32 s46, s46, s24
  v_mfma_f32_16x16x32_bf16 v[96:99], a[224:227], a[204:207], v[96:99]
  s_add_u32 s46, s46, 0
  v_mfma_f32_16x16x32_bf16 v[128:131], a[224:227], a[208:211], v[128:131]
  s_waitcnt vmcnt(16) lgkmcnt(0)
  s_barrier
  s_add_u32 m0, s46, 0
  v_mfma_f32_16x16x32_bf16 v[160:163], a[224:227], a[212:215], v[160:163]
  buffer_load_dwordx4 v229, s[8:11], s31 offen lds
  v_mfma_f32_16x16x32_bf16 v[192:195], a[224:227], a[216:219], v[192:195]
  ds_read_b64_tr_b16 a[224:225], v226 offset:8704
  s_add_u32 s31, s31, s27
  v_mfma_f32_16x16x32_bf16 v[4:7], a[228:231], a[192:195], v[4:7]
  ds_read_b64_tr_b16 a[226:227], v226 offset:13056
  v_mfma_f32_16x16x32_bf16 v[36:39], a[228:231], a[196:199], v[36:39]
  v_mfma_f32_16x16x32_bf16 v[68:71], a[228:231], a[200:203], v[68:71]
  s_add_u32 m0, s46, 1088
  v_mfma_f32_16x16x32_bf16 v[100:103], a[228:231], a[204:207], v[100:103]
  buffer_load_dwordx4 v229, s[8:11], s31 offen lds
  v_mfma_f32_16x16x32_bf16 v[132:135], a[228:231], a[208:211], v[132:135]
  s_add_u32 s31, s31, s27
  v_mfma_f32_16x16x32_bf16 v[164:167], a[228:231], a[212:215], v[164:167]
  v_mfma_f32_16x16x32_bf16 v[196:199], a[228:231], a[216:219], v[196:199]
  ds_read_b64_tr_b16 a[228:229], v226 offset:8712
  v_mfma_f32_16x16x32_bf16 v[8:11], a[232:235], a[192:195], v[8:11]
  ds_read_b64_tr_b16 a[230:231], v226 offset:13064
  s_add_u32 m0, s46, 2176
  v_mfma_f32_16x16x32_bf16 v[40:43], a[232:235], a[196:199], v[40:43]
  buffer_load_dwordx4 v229, s[8:11], s31 offen lds
  v_mfma_f32_16x16x32_bf16 v[72:75], a[232:235], a[200:203], v[72:75]
  s_add_u32 s31, s31, s27
  v_mfma_f32_16x16x32_bf16 v[104:107], a[232:235], a[204:207], v[104:107]
  v_mfma_f32_16x16x32_bf16 v[136:139], a[232:235], a[208:211], v[136:139]
  v_mfma_f32_16x16x32_bf16 v[168:171], a[232:235], a[212:215], v[168:171]
  v_mfma_f32_16x16x32_bf16 v[200:203], a[232:235], a[216:219], v[200:203]
  ds_read_b64_tr_b16 a[232:233], v226 offset:8768
  v_mfma_f32_16x16x32_bf16 v[12:15], a[236:239], a[192:195], v[12:15]
  ds_read_b64_tr_b16 a[234:235], v226 offset:13120
  s_add_u32 m0, s46, 3264
  v_mfma_f32_16x16x32_bf16 v[44:47], a[236:239], a[196:199], v[44:47]
  buffer_load_dwordx4 v229, s[8:11], s31 offen lds
  v_mfma_f32_16x16x32_bf16 v[76:79], a[236:239], a[200:203], v[76:79]
  s_add_u32 s31, s31, s27
  v_mfma_f32_16x16x32_bf16 v[108:111], a[236:239], a[204:207], v[108:111]
  v_mfma_f32_16x16x32_bf16 v[140:143], a[236:239], a[208:211], v[140:143]
  v_mfma_f32_16x16x32_bf16 v[172:175], a[236:239], a[212:215], v[172:175]
  v_mfma_f32_16x16x32_bf16 v[204:207], a[236:239], a[216:219], v[204:207]
  ds_read_b64_tr_b16 a[236:237], v226 offset:8776
  v_mfma_f32_16x16x32_bf16 v[16:19], a[240:243], a[192:195], v[16:19]
  ds_read_b64_tr_b16 a[238:239], v226 offset:13128
  s_add_u32 m0, s46, 4352
  v_mfma_f32_16x16x32_bf16 v[48:51], a[240:243], a[196:199], v[48:51]
  buffer_load_dwordx4 v229, s[8:11], s31 offen lds
  v_mfma_f32_16x16x32_bf16 v[80:83], a[240:243], a[200:203], v[80:83]
  s_add_u32 s31, s31, s27
  v_mfma_f32_16x16x32_bf16 v[112:115], a[240:243], a[204:207], v[112:115]
  v_mfma_f32_16x16x32_bf16 v[144:147], a[240:243], a[208:211], v[144:147]
  v_mfma_f32_16x16x32_bf16 v[176:179], a[240:243], a[212:215], v[176:179]
  v_mfma_f32_16x16x32_bf16 v[208:211], a[240:243], a[216:219], v[208:211]
  ds_read_b64_tr_b16 a[240:241], v226 offset:8832
  v_mfma_f32_16x16x32_bf16 v[20:23], a[244:247], a[192:195], v[20:23]
  ds_read_b64_tr_b16 a[242:243], v226 offset:13184
  s_add_u32 m0, s46, 5440
  v_mfma_f32_16x16x32_bf16 v[52:55], a[244:247], a[196:199], v[52:55]
  buffer_load_dwordx4 v229, s[8:11], s31 offen lds
  v_mfma_f32_16x16x32_bf16 v[84:87], a[244:247], a[200:203], v[84:87]
  s_add_u32 s31, s31, s27
  v_mfma_f32_16x16x32_bf16 v[116:119], a[244:247], a[204:207], v[116:119]
  v_mfma_f32_16x16x32_bf16 v[148:151], a[244:247], a[208:211], v[148:151]
  v_mfma_f32_16x16x32_bf16 v[180:183], a[244:247], a[212:215], v[180:183]
  v_mfma_f32_16x16x32_bf16 v[212:215], a[244:247], a[216:219], v[212:215]
  ds_read_b64_tr_b16 a[244:245], v226 offset:8840
  v_mfma_f32_16x16x32_bf16 v[24:27], a[248:251], a[192:195], v[24:27]
  ds_read_b64_tr_b16 a[246:247], v226 offset:13192
  s_add_u32 m0, s46, 6528
  v_mfma_f32_16x16x32_bf16 v[56:59], a[248:251], a[196:199], v[56:59]
  buffer_load_dwordx4 v229, s[8:11], s31 offen lds
  v_mfma_f32_16x16x32_bf16 v[88:91], a[248:251], a[200:203], v[88:91]
  s_add_u32 s31, s31, s27
  v_mfma_f32_16x16x32_bf16 v[120:123], a[248:251], a[204:207], v[120:123]
  v_mfma_f32_16x16x32_bf16 v[152:155], a[248:251], a[208:211], v[152:155]
  v_mfma_f32_16x16x32_bf16 v[184:187], a[248:251], a[212:215], v[184:187]
  v_mfma_f32_16x16x32_bf16 v[216:219], a[248:251], a[216:219], v[216:219]
  ds_read_b64_tr_b16 a[248:249], v226 offset:8896
  v_mfma_f32_16x16x32_bf16 v[28:31], a[252:255], a[192:195], v[28:31]
  ds_read_b64_tr_b16 a[250:251], v226 offset:13248
  s_add_u32 m0, s46, 7616
  v_mfma_f32_16x16x32_bf16 v[60:63], a[252:255], a[196:199], v[60:63]
  buffer_load_dwordx4 v229, s[8:11], s31 offen lds
  v_mfma_f32_16x16x32_bf16 v[92:95], a[252:255], a[200:203], v[92:95]
  s_add_u32 s26, s26, s28
  s_mov_b32 s31, s26
  v_mfma_f32_16x16x32_bf16 v[124:127], a[252:255], a[204:207], v[124:127]
  v_mfma_f32_16x16x32_bf16 v[156:159], a[252:255], a[208:211], v[156:159]
  v_mfma_f32_16x16x32_bf16 v[188:191], a[252:255], a[212:215], v[188:191]
  s_waitcnt lgkmcnt(0)
  v_mfma_f32_16x16x32_bf16 v[220:223], a[252:255], a[216:219], v[220:223]
  ds_read_b64_tr_b16 a[252:253], v226 offset:8904
  v_mfma_f32_16x16x32_bf16 v[0:3], a[224:227], a[160:163], v[0:3]
  ds_read_b64_tr_b16 a[254:255], v226 offset:13256
  v_mfma_f32_16x16x32_bf16 v[32:35], a[224:227], a[164:167], v[32:35]
  s_mul_i32 s46, s22, 8704
  v_mfma_f32_16x16x32_bf16 v[64:67], a[224:227], a[168:171], v[64:67]
  s_add_u32 s46, s46, s24
  v_mfma_f32_16x16x32_bf16 v[96:99], a[224:227], a[172:175], v[96:99]
  s_add_u32 s46, s46, 8704
  v_mfma_f32_16x16x32_bf16 v[128:131], a[224:227], a[176:179], v[128:131]
  s_waitcnt vmcnt(16) lgkmcnt(0)
  s_barrier
  s_add_u32 m0, s46, 0
  v_mfma_f32_16x16x32_bf16 v[160:163], a[224:227], a[180:183], v[160:163]
  buffer_load_dwordx4 v229, s[8:11], s31 offen lds
  v_mfma_f32_16x16x32_bf16 v[192:195], a[224:227], a[184:187], v[192:195]
  ds_read_b64_tr_b16 a[224:225], v226 offset:17408
  s_add_u32 s31, s31, s27
  v_mfma_f32_16x16x32_bf16 v[4:7], a[228:231], a[160:163], v[4:7]
  ds_read_b64_tr_b16 a[226:227], v226 offset:21760
  v_mfma_f32_16x16x32_bf16 v[36:39], a[228:231], a[164:167], v[36:39]
  ds_read_b128 a[192:195], v227 offset:26176
  v_mfma_f32_16x16x32_bf16 v[68:71], a[228:231], a[168:171], v[68:71]
  ds_read_b128 a[196:199], v227 offset:28352
  s_add_u32 m0, s46, 1088
  v_mfma_f32_16x16x32_bf16 v[100:103], a[228:231], a[172:175], v[100:103]
  buffer_load_dwordx4 v229, s[8:11], s31 offen lds
  v_mfma_f32_16x16x32_bf16 v[132:135], a[228:231], a[176:179], v[132:135]
  ds_read_b128 a[200:203], v227 offset:30528
  s_add_u32 s31, s31, s27
  v_mfma_f32_16x16x32_bf16 v[164:167], a[228:231], a[180:183], v[164:167]
  ds_read_b128 a[204:207], v227 offset:32704
  v_mfma_f32_16x16x32_bf16 v[196:199], a[228:231], a[184:187], v[196:199]
  ds_read_b64_tr_b16 a[228:229], v226 offset:17416
  v_mfma_f32_16x16x32_bf16 v[8:11], a[232:235], a[160:163], v[8:11]
  ds_read_b64_tr_b16 a[230:231], v226 offset:21768
  s_add_u32 m0, s46, 2176
  v_mfma_f32_16x16x32_bf16 v[40:43], a[232:235], a[164:167], v[40:43]
  buffer_load_dwordx4 v229, s[8:11], s31 offen lds
  v_mfma_f32_16x16x32_bf16 v[72:75], a[232:235], a[168:171], v[72:75]
  ds_read_b128 a[208:211], v227 offset:34880
  s_add_u32 s31, s31, s27
  v_mfma_f32_16x16x32_bf16 v[104:107], a[232:235], a[172:175], v[104:107]
  ds_read_b128 a[212:215], v227 offset:37056
  v_mfma_f32_16x16x32_bf16 v[136:139], a[232:235], a[176:179], v[136:139]
  ds_read_b128 a[216:219], v227 offset:39232
  v_mfma_f32_16x16x32_bf16 v[168:171], a[232:235], a[180:183], v[168:171]
  ds_read_b128 a[128:131], v227 offset:26112
  v_mfma_f32_16x16x32_bf16 v[200:203], a[232:235], a[184:187], v[200:203]
  ds_read_b64_tr_b16 a[232:233], v226 offset:17472
  v_mfma_f32_16x16x32_bf16 v[12:15], a[236:239], a[160:163], v[12:15]
  ds_read_b64_tr_b16 a[234:235], v226 offset:21824
  s_add_u32 m0, s46, 3264
  v_mfma_f32_16x16x32_bf16 v[44:47], a[236:239], a[164:167], v[44:47]
  buffer_load_dwordx4 v229, s[8:11], s31 offen lds
  v_mfma_f32_16x16x32_bf16 v[76:79], a[236:239], a[168:171], v[76:79]
  ds_read_b128 a[132:135], v227 offset:28288
  s_add_u32 s31, s31, s27
  v_mfma_f32_16x16x32_bf16 v[108:111], a[236:239], a[172:175], v[108:111]
  ds_read_b128 a[136:139], v227 offset:30464
  v_mfma_f32_16x16x32_bf16 v[140:143], a[236:239], a[176:179], v[140:143]
  ds_read_b128 a[140:143], v227 offset:32640
  v_mfma_f32_16x16x32_bf16 v[172:175], a[236:239], a[180:183], v[172:175]
  ds_read_b128 a[144:147], v227 offset:34816
  v_mfma_f32_16x16x32_bf16 v[204:207], a[236:239], a[184:187], v[204:207]
  ds_read_b64_tr_b16 a[236:237], v226 offset:17480
  v_mfma_f32_16x16x32_bf16 v[16:19], a[240:243], a[160:163], v[16:19]
  ds_read_b64_tr_b16 a[238:239], v226 offset:21832
  s_add_u32 m0, s46, 4352
  v_mfma_f32_16x16x32_bf16 v[48:51], a[240:243], a[164:167], v[48:51]
  buffer_load_dwordx4 v229, s[8:11], s31 offen lds
  v_mfma_f32_16x16x32_bf16 v[80:83], a[240:243], a[168:171], v[80:83]
  ds_read_b128 a[148:151], v227 offset:36992
  s_add_u32 s31, s31, s27
  v_mfma_f32_16x16x32_bf16 v[112:115], a[240:243], a[172:175], v[112:115]
  ds_read_b128 a[152:155], v227 offset:39168
  v_mfma_f32_16x16x32_bf16 v[144:147], a[240:243], a[176:179], v[144:147]
  v_mfma_f32_16x16x32_bf16 v[176:179], a[240:243], a[180:183], v[176:179]
  v_mfma_f32_16x16x32_bf16 v[208:211], a[240:243], a[184:187], v[208:211]
  ds_read_b64_tr_b16 a[240:241], v226 offset:17536
  v_mfma_f32_16x16x32_bf16 v[20:23], a[244:247], a[160:163], v[20:23]
  ds_read_b64_tr_b16 a[242:243], v226 offset:21888
  s_add_u32 m0, s46, 5440
  v_mfma_f32_16x16x32_bf16 v[52:55], a[244:247], a[164:167], v[52:55]
  buffer_load_dwordx4 v229, s[8:11], s31 offen lds
  v_mfma_f32_16x16x32_bf16 v[84:87], a[244:247], a[168:171], v[84:87]
  s_add_u32 s31, s31, s27
  v_mfma_f32_16x16x32_bf16 v[116:119], a[244:247], a[172:175], v[116:119]
  v_mfma_f32_16x16x32_bf16 v[148:151], a[244:247], a[176:179], v[148:151]
  v_mfma_f32_16x16x32_bf16 v[180:183], a[244:247], a[180:183], v[180:183]
  v_mfma_f32_16x16x32_bf16 v[212:215], a[244:247], a[184:187], v[212:215]
  ds_read_b64_tr_b16 a[244:245], v226 offset:17544
  v_mfma_f32_16x16x32_bf16 v[24:27], a[248:251], a[160:163], v[24:27]
  ds_read_b64_tr_b16 a[246:247], v226 offset:21896
  s_add_u32 m0, s46, 6528
  v_mfma_f32_16x16x32_bf16 v[56:59], a[248:251], a[164:167], v[56:59]
  buffer_load_dwordx4 v229, s[8:11], s31 offen lds
  v_mfma_f32_16x16x32_bf16 v[88:91], a[248:251], a[168:171], v[88:91]
  s_add_u32 s31, s31, s27
  v_mfma_f32_16x16x32_bf16 v[120:123], a[248:251], a[172:175], v[120:123]
  v_mfma_f32_16x16x32_bf16 v[152:155], a[248:251], a[176:179], v[152:155]
  v_mfma_f32_16x16x32_bf16 v[184:187], a[248:251], a[180:183], v[184:187]
  v_mfma_f32_16x16x32_bf16 v[216:219], a[248:251], a[184:187], v[216:219]
  ds_read_b64_tr_b16 a[248:249], v226 offset:17600
  v_mfma_f32_16x16x32_bf16 v[28:31], a[252:255], a[160:163], v[28:31]
  ds_read_b64_tr_b16 a[250:251], v226 offset:21952
  s_add_u32 m0, s46, 7616
  v_mfma_f32_16x16x32_bf16 v[60:63], a[252:255], a[164:167], v[60:63]
  buffer_load_dwordx4 v229, s[8:11], s31 offen lds
  v_mfma_f32_16x16x32_bf16 v[92:95], a[252:255], a[168:171], v[92:95]
  s_add_u32 s26, s26, s29
  s_mov_b32 s31, s26
  v_mfma_f32_16x16x32_bf16 v[124:127], a[252:255], a[172:175], v[124:127]
  v_mfma_f32_16x16x32_bf16 v[156:159], a[252:255], a[176:179], v[156:159]
  v_mfma_f32_16x16x32_bf16 v[188:191], a[252:255], a[180:183], v[188:191]
  s_waitcnt lgkmcnt(0)
  v_mfma_f32_16x16x32_bf16 v[220:223], a[252:255], a[184:187], v[220:223]
  ds_read_b64_tr_b16 a[252:253], v226 offset:17608
  v_mfma_f32_16x16x32_bf16 v[0:3], a[224:227], a[128:131], v[0:3]
  ds_read_b64_tr_b16 a[254:255], v226 offset:21960
  v_mfma_f32_16x16x32_bf16 v[32:35], a[224:227], a[132:135], v[32:35]
  s_mul_i32 s46, s22, 8704
  v_mfma_f32_16x16x32_bf16 v[64:67], a[224:227], a[136:139], v[64:67]
  s_add_u32 s46, s46, s24
  v_mfma_f32_16x16x32_bf16 v[96:99], a[224:227], a[140:143], v[96:99]
  s_add_u32 s46, s46, 17408
  v_mfma_f32_16x16x32_bf16 v[128:131], a[224:227], a[144:147], v[128:131]
  s_waitcnt vmcnt(16) lgkmcnt(0)
  s_barrier
  s_add_u32 m0, s46, 0
  v_mfma_f32_16x16x32_bf16 v[160:163], a[224:227], a[148:151], v[160:163]
  buffer_load_dwordx4 v229, s[8:11], s31 offen lds
  v_mfma_f32_16x16x32_bf16 v[192:195], a[224:227], a[152:155], v[192:195]
  ds_read_b64_tr_b16 a[224:225], v226 offset:26112
  s_add_u32 s31, s31, s27
  v_mfma_f32_16x16x32_bf16 v[4:7], a[228:231], a[128:131], v[4:7]
  ds_read_b64_tr_b16 a[226:227], v226 offset:30464
  v_mfma_f32_16x16x32_bf16 v[36:39], a[228:231], a[132:135], v[36:39]
  v_mfma_f32_16x16x32_bf16 v[68:71], a[228:231], a[136:139], v[68:71]
  s_add_u32 m0, s46, 1088
  v_mfma_f32_16x16x32_bf16 v[100:103], a[228:231], a[140:143], v[100:103]
  buffer_load_dwordx4 v229, s[8:11], s31 offen lds
  v_mfma_f32_16x16x32_bf16 v[132:135], a[228:231], a[144:147], v[132:135]
  s_add_u32 s31, s31, s27
  v_mfma_f32_16x16x32_bf16 v[164:167], a[228:231], a[148:151], v[164:167]
  v_mfma_f32_16x16x32_bf16 v[196:199], a[228:231], a[152:155], v[196:199]
  ds_read_b64_tr_b16 a[228:229], v226 offset:26120
  v_mfma_f32_16x16x32_bf16 v[8:11], a[232:235], a[128:131], v[8:11]
  ds_read_b64_tr_b16 a[230:231], v226 offset:30472
  s_add_u32 m0, s46, 2176
  v_mfma_f32_16x16x32_bf16 v[40:43], a[232:235], a[132:135], v[40:43]
  buffer_load_dwordx4 v229, s[8:11], s31 offen lds
  v_mfma_f32_16x16x32_bf16 v[72:75], a[232:235], a[136:139], v[72:75]
  s_add_u32 s31, s31, s27
  v_mfma_f32_16x16x32_bf16 v[104:107], a[232:235], a[140:143], v[104:107]
  v_mfma_f32_16x16x32_bf16 v[136:139], a[232:235], a[144:147], v[136:139]
  v_mfma_f32_16x16x32_bf16 v[168:171], a[232:235], a[148:151], v[168:171]
  v_mfma_f32_16x16x32_bf16 v[200:203], a[232:235], a[152:155], v[200:203]
  ds_read_b64_tr_b16 a[232:233], v226 offset:26176
  v_mfma_f32_16x16x32_bf16 v[12:15], a[236:239], a[128:131], v[12:15]
  ds_read_b64_tr_b16 a[234:235], v226 offset:30528
  s_add_u32 m0, s46, 3264
  v_mfma_f32_16x16x32_bf16 v[44:47], a[236:239], a[132:135], v[44:47]
  buffer_load_dwordx4 v229, s[8:11], s31 offen lds
  v_mfma_f32_16x16x32_bf16 v[76:79], a[236:239], a[136:139], v[76:79]
  s_add_u32 s31, s31, s27
  v_mfma_f32_16x16x32_bf16 v[108:111], a[236:239], a[140:143], v[108:111]
  v_mfma_f32_16x16x32_bf16 v[140:143], a[236:239], a[144:147], v[140:143]
  v_mfma_f32_16x16x32_bf16 v[172:175], a[236:239], a[148:151], v[172:175]
  v_mfma_f32_16x16x32_bf16 v[204:207], a[236:239], a[152:155], v[204:207]
  ds_read_b64_tr_b16 a[236:237], v226 offset:26184
  v_mfma_f32_16x16x32_bf16 v[16:19], a[240:243], a[128:131], v[16:19]
  ds_read_b64_tr_b16 a[238:239], v226 offset:30536
  s_add_u32 m0, s46, 4352
  v_mfma_f32_16x16x32_bf16 v[48:51], a[240:243], a[132:135], v[48:51]
  buffer_load_dwordx4 v229, s[8:11], s31 offen lds
  v_mfma_f32_16x16x32_bf16 v[80:83], a[240:243], a[136:139], v[80:83]
  s_add_u32 s31, s31, s27
  v_mfma_f32_16x16x32_bf16 v[112:115], a[240:243], a[140:143], v[112:115]
  v_mfma_f32_16x16x32_bf16 v[144:147], a[240:243], a[144:147], v[144:147]
  v_mfma_f32_16x16x32_bf16 v[176:179], a[240:243], a[148:151], v[176:179]
  v_mfma_f32_16x16x32_bf16 v[208:211], a[240:243], a[152:155], v[208:211]
  ds_read_b64_tr_b16 a[240:241], v226 offset:26240
  v_mfma_f32_16x16x32_bf16 v[20:23], a[244:247], a[128:131], v[20:23]
  ds_read_b64_tr_b16 a[242:243], v226 offset:30592
  s_add_u32 m0, s46, 5440
  v_mfma_f32_16x16x32_bf16 v[52:55], a[244:247], a[132:135], v[52:55]
  buffer_load_dwordx4 v229, s[8:11], s31 offen lds
  v_mfma_f32_16x16x32_bf16 v[84:87], a[244:247], a[136:139], v[84:87]
  s_add_u32 s31, s31, s27
  v_mfma_f32_16x16x32_bf16 v[116:119], a[244:247], a[140:143], v[116:119]
  v_mfma_f32_16x16x32_bf16 v[148:151], a[244:247], a[144:147], v[148:151]
  v_mfma_f32_16x16x32_bf16 v[180:183], a[244:247], a[148:151], v[180:183]
  v_mfma_f32_16x16x32_bf16 v[212:215], a[244:247], a[152:155], v[212:215]
  ds_read_b64_tr_b16 a[244:245], v226 offset:26248
  v_mfma_f32_16x16x32_bf16 v[24:27], a[248:251], a[128:131], v[24:27]
  ds_read_b64_tr_b16 a[246:247], v226 offset:30600
  s_add_u32 m0, s46, 6528
  v_mfma_f32_16x16x32_bf16 v[56:59], a[248:251], a[132:135], v[56:59]
  buffer_load_dwordx4 v229, s[8:11], s31 offen lds
  v_mfma_f32_16x16x32_bf16 v[88:91], a[248:251], a[136:139], v[88:91]
  s_add_u32 s31, s31, s27
  v_mfma_f32_16x16x32_bf16 v[120:123], a[248:251], a[140:143], v[120:123]
  v_mfma_f32_16x16x32_bf16 v[152:155], a[248:251], a[144:147], v[152:155]
  v_mfma_f32_16x16x32_bf16 v[184:187], a[248:251], a[148:151], v[184:187]
  v_mfma_f32_16x16x32_bf16 v[216:219], a[248:251], a[152:155], v[216:219]
  ds_read_b64_tr_b16 a[248:249], v226 offset:26304
  v_mfma_f32_16x16x32_bf16 v[28:31], a[252:255], a[128:131], v[28:31]
  ds_read_b64_tr_b16 a[250:251], v226 offset:30656
  s_add_u32 m0, s46, 7616
  v_mfma_f32_16x16x32_bf16 v[60:63], a[252:255], a[132:135], v[60:63]
  buffer_load_dwordx4 v229, s[8:11], s31 offen lds
  v_mfma_f32_16x16x32_bf16 v[92:95], a[252:255], a[136:139], v[92:95]
  s_add_u32 s26, s26, s28
  s_mov_b32 s31, s26
  v_mfma_f32_16x16x32_bf16 v[124:127], a[252:255], a[140:143], v[124:127]
  v_mfma_f32_16x16x32_bf16 v[156:159], a[252:255], a[144:147], v[156:159]
  v_mfma_f32_16x16x32_bf16 v[188:191], a[252:255], a[148:151], v[188:191]
  s_waitcnt lgkmcnt(0)
  v_mfma_f32_16x16x32_bf16 v[220:223], a[252:255], a[152:155], v[220:223]
  ds_read_b64_tr_b16 a[252:253], v226 offset:26312
  v_mfma_f32_16x16x32_bf16 v[0:3], a[224:227], a[192:195], v[0:3]
  ds_read_b64_tr_b16 a[254:255], v226 offset:30664
  v_mfma_f32_16x16x32_bf16 v[32:35], a[224:227], a[196:199], v[32:35]
  s_mul_i32 s46, s22, 8704
  v_mfma_f32_16x16x32_bf16 v[64:67], a[224:227], a[200:203], v[64:67]
  s_add_u32 s46, s46, s24
  v_mfma_f32_16x16x32_bf16 v[96:99], a[224:227], a[204:207], v[96:99]
  s_add_u32 s46, s46, 26112
  v_mfma_f32_16x16x32_bf16 v[128:131], a[224:227], a[208:211], v[128:131]
  s_waitcnt vmcnt(16) lgkmcnt(0)
  s_barrier
  s_add_u32 m0, s46, 0
  v_mfma_f32_16x16x32_bf16 v[160:163], a[224:227], a[212:215], v[160:163]
  buffer_load_dwordx4 v229, s[8:11], s31 offen lds
  v_mfma_f32_16x16x32_bf16 v[192:195], a[224:227], a[216:219], v[192:195]
  ds_read_b64_tr_b16 a[224:225], v226 offset:0
  s_add_u32 s31, s31, s27
  v_mfma_f32_16x16x32_bf16 v[4:7], a[228:231], a[192:195], v[4:7]
  ds_read_b64_tr_b16 a[226:227], v226 offset:4352
  v_mfma_f32_16x16x32_bf16 v[36:39], a[228:231], a[196:199], v[36:39]
  ds_read_b128 a[128:131], v227 offset:64
  v_mfma_f32_16x16x32_bf16 v[68:71], a[228:231], a[200:203], v[68:71]
  ds_read_b128 a[132:135], v227 offset:2240
  s_add_u32 m0, s46, 1088
  v_mfma_f32_16x16x32_bf16 v[100:103], a[228:231], a[204:207], v[100:103]
  buffer_load_dwordx4 v229, s[8:11], s31 offen lds
  v_mfma_f32_16x16x32_bf16 v[132:135], a[228:231], a[208:211], v[132:135]
  ds_read_b128 a[136:139], v227 offset:4416
  s_add_u32 s31, s31, s27
  v_mfma_f32_16x16x32_bf16 v[164:167], a[228:231], a[212:215], v[164:167]
  ds_read_b128 a[140:143], v227 offset:6592
  v_mfma_f32_16x16x32_bf16 v[196:199], a[228:231], a[216:219], v[196:199]
  ds_read_b64_tr_b16 a[228:229], v226 offset:8
  v_mfma_f32_16x16x32_bf16 v[8:11], a[232:235], a[192:195], v[8:11]
  ds_read_b64_tr_b16 a[230:231], v226 offset:4360
  s_add_u32 m0, s46, 2176
  v_mfma_f32_16x16x32_bf16 v[40:43], a[232:235], a[196:199], v[40:43]
  buffer_load_dwordx4 v229, s[8:11], s31 offen lds
  v_mfma_f32_16x16x32_bf16 v[72:75], a[232:235], a[200:203], v[72:75]
  ds_read_b128 a[144:147], v227 offset:8768
  s_add_u32 s31, s31, s27
  v_mfma_f32_16x16x32_bf16 v[104:107], a[232:235], a[204:207], v[104:107]
  ds_read_b128 a[148:151], v227 offset:10944
  v_mfma_f32_16x16x32_bf16 v[136:139], a[232:235], a[208:211], v[136:139]
  ds_read_b128 a[152:155], v227 offset:13120
  v_mfma_f32_16x16x32_bf16 v[168:171], a[232:235], a[212:215], v[168:171]
  ds_read_b128 a[160:163], v227 offset:0
  v_mfma_f32_16x16x32_bf16 v[200:203], a[232:235], a[216:219], v[200:203]
  ds_read_b64_tr_b16 a[232:233], v226 offset:64
  v_mfma_f32_16x16x32_bf16 v[12:15], a[236:239], a[192:195], v[12:15]
  ds_read_b64_tr_b16 a[234:235], v226 offset:4416
  s_add_u32 m0, s46, 3264
  v_mfma_f32_16x16x32_bf16 v[44:47], a[236:239], a[196:199], v[44:47]
  buffer_load_dwordx4 v229, s[8:11], s31 offen lds
  v_mfma_f32_16x16x32_bf16 v[76:79], a[236:239], a[200:203], v[76:79]
  ds_read_b128 a[164:167], v227 offset:2176
  s_add_u32 s31, s31, s27
  v_mfma_f32_16x16x32_bf16 v[108:111], a[236:239], a[204:207], v[108:111]
  ds_read_b128 a[168:171], v227 offset:4352
  v_mfma_f32_16x16x32_bf16 v[140:143], a[236:239], a[208:211], v[140:143]
  ds_read_b128 a[172:175], v227 offset:6528
  v_mfma_f32_16x16x32_bf16 v[172:175], a[236:239], a[212:215], v[172:175]
  ds_read_b128 a[176:179], v227 offset:8704
  v_mfma_f32_16x16x32_bf16 v[204:207], a[236:239], a[216:219], v[204:207]
  ds_read_b64_tr_b16 a[236:237], v226 offset:72
  v_mfma_f32_16x16x32_bf16 v[16:19], a[240:243], a[192:195], v[16:19]
  ds_read_b64_tr_b16 a[238:239], v226 offset:4424
  s_add_u32 m0, s46, 4352
  v_mfma_f32_16x16x32_bf16 v[48:51], a[240:243], a[196:199], v[48:51]
  buffer_load_dwordx4 v229, s[8:11], s31 offen lds
  v_mfma_f32_16x16x32_bf16 v[80:83], a[240:243], a[200:203], v[80:83]
  ds_read_b128 a[180:183], v227 offset:10880
  s_add_u32 s31, s31, s27
  v_mfma_f32_16x16x32_bf16 v[112:115], a[240:243], a[204:207], v[112:115]
  ds_read_b128 a[184:187], v227 offset:13056
  v_mfma_f32_16x16x32_bf16 v[144:147], a[240:243], a[208:211], v[144:147]
  v_mfma_f32_16x16x32_bf16 v[176:179], a[240:243], a[212:215], v[176:179]
  v_mfma_f32_16x16x32_bf16 v[208:211], a[240:243], a[216:219], v[208:211]
  ds_read_b64_tr_b16 a[240:241], v226 offset:128
  v_mfma_f32_16x16x32_bf16 v[20:23], a[244:247], a[192:195], v[20:23]
  ds_read_b64_tr_b16 a[242:243], v226 offset:4480
  s_add_u32 m0, s46, 5440
  v_mfma_f32_16x16x32_bf16 v[52:55], a[244:247], a[196:199], v[52:55]
  buffer_load_dwordx4 v229, s[8:11], s31 offen lds
  v_mfma_f32_16x16x32_bf16 v[84:87], a[244:247], a[200:203], v[84:87]
  s_add_u32 s31, s31, s27
  v_mfma_f32_16x16x32_bf16 v[116:119], a[244:247], a[204:207], v[116:119]
  v_mfma_f32_16x16x32_bf16 v[148:151], a[244:247], a[208:211], v[148:151]
  v_mfma_f32_16x16x32_bf16 v[180:183], a[244:247], a[212:215], v[180:183]
  v_mfma_f32_16x16x32_bf16 v[212:215], a[244:247], a[216:219], v[212:215]
  ds_read_b64_tr_b16 a[244:245], v226 offset:136
  v_mfma_f32_16x16x32_bf16 v[24:27], a[248:251], a[192:195], v[24:27]
  ds_read_b64_tr_b16 a[246:247], v226 offset:4488
  s_add_u32 m0, s46, 6528
  v_mfma_f32_16x16x32_bf16 v[56:59], a[248:251], a[196:199], v[56:59]
  buffer_load_dwordx4 v229, s[8:11], s31 offen lds
  v_mfma_f32_16x16x32_bf16 v[88:91], a[248:251], a[200:203], v[88:91]
  s_add_u32 s31, s31, s27
  v_mfma_f32_16x16x32_bf16 v[120:123], a[248:251], a[204:207], v[120:123]
  v_mfma_f32_16x16x32_bf16 v[152:155], a[248:251], a[208:211], v[152:155]
  v_mfma_f32_16x16x32_bf16 v[184:187], a[248:251], a[212:215], v[184:187]
  v_mfma_f32_16x16x32_bf16 v[216:219], a[248:251], a[216:219], v[216:219]
  ds_read_b64_tr_b16 a[248:249], v226 offset:192
  v_mfma_f32_16x16x32_bf16 v[28:31], a[252:255], a[192:195], v[28:31]
  ds_read_b64_tr_b16 a[250:251], v226 offset:4544
  s_add_u32 m0, s46, 7616
  v_mfma_f32_16x16x32_bf16 v[60:63], a[252:255], a[196:199], v[60:63]
  buffer_load_dwordx4 v229, s[8:11], s31 offen lds
  v_mfma_f32_16x16x32_bf16 v[92:95], a[252:255], a[200:203], v[92:95]
  s_add_u32 s26, s26, s29
  s_mov_b32 s31, s26
  v_mfma_f32_16x16x32_bf16 v[124:127], a[252:255], a[204:207], v[124:127]
  v_mfma_f32_16x16x32_bf16 v[156:159], a[252:255], a[208:211], v[156:159]
  v_mfma_f32_16x16x32_bf16 v[188:191], a[252:255], a[212:215], v[188:191]
  s_waitcnt lgkmcnt(0)
  v_mfma_f32_16x16x32_bf16 v[220:223], a[252:255], a[216:219], v[220:223]
  ds_read_b64_tr_b16 a[252:253], v226 offset:200
  v_mfma_f32_16x16x32_bf16 v[0:3], a[224:227], a[160:163], v[0:3]
  ds_read_b64_tr_b16 a[254:255], v226 offset:4552
  v_mfma_f32_16x16x32_bf16 v[32:35], a[224:227], a[164:167], v[32:35]
  v_mfma_f32_16x16x32_bf16 v[64:67], a[224:227], a[168:171], v[64:67]
  v_mfma_f32_16x16x32_bf16 v[96:99], a[224:227], a[172:175], v[96:99]
  v_mfma_f32_16x16x32_bf16 v[128:131], a[224:227], a[176:179], v[128:131]
  s_waitcnt vmcnt(16) lgkmcnt(0)
  s_barrier
  s_add_u32 m0, s24, 0
  v_mfma_f32_16x16x32_bf16 v[160:163], a[224:227], a[180:183], v[160:163]
  buffer_load_dwordx4 v230, s[4:7], s25 offen offset:0 nt lds
  v_mfma_f32_16x16x32_bf16 v[192:195], a[224:227], a[184:187], v[192:195]
  ds_read_b64_tr_b16 a[224:225], v226 offset:8704
  v_mfma_f32_16x16x32_bf16 v[4:7], a[228:231], a[160:163], v[4:7]
  ds_read_b64_tr_b16 a[226:227], v226 offset:13056
  v_mfma_f32_16x16x32_bf16 v[36:39], a[228:231], a[164:167], v[36:39]
  v_mfma_f32_16x16x32_bf16 v[68:71], a[228:231], a[168:171], v[68:71]
  s_add_u32 m0, s24, 32
  v_mfma_f32_16x16x32_bf16 v[100:103], a[228:231], a[172:175], v[100:103]
  buffer_load_dwordx4 v230, s[4:7], s25 offen offset:1024 nt lds
  v_mfma_f32_16x16x32_bf16 v[132:135], a[228:231], a[176:179], v[132:135]
  v_mfma_f32_16x16x32_bf16 v[164:167], a[228:231], a[180:183], v[164:167]
  v_mfma_f32_16x16x32_bf16 v[196:199], a[228:231], a[184:187], v[196:199]
  ds_read_b64_tr_b16 a[228:229], v226 offset:8712
  v_mfma_f32_16x16x32_bf16 v[8:11], a[232:235], a[160:163], v[8:11]
  ds_read_b64_tr_b16 a[230:231], v226 offset:13064
  s_add_u32 m0, s24, 64
  v_mfma_f32_16x16x32_bf16 v[40:43], a[232:235], a[164:167], v[40:43]
  buffer_load_dwordx4 v230, s[4:7], s25 offen offset:2048 nt lds
  v_mfma_f32_16x16x32_bf16 v[72:75], a[232:235], a[168:171], v[72:75]
  v_mfma_f32_16x16x32_bf16 v[104:107], a[232:235], a[172:175], v[104:107]
  v_mfma_f32_16x16x32_bf16 v[136:139], a[232:235], a[176:179], v[136:139]
  v_mfma_f32_16x16x32_bf16 v[168:171], a[232:235], a[180:183], v[168:171]
  v_mfma_f32_16x16x32_bf16 v[200:203], a[232:235], a[184:187], v[200:203]
  ds_read_b64_tr_b16 a[232:233], v226 offset:8768
  v_mfma_f32_16x16x32_bf16 v[12:15], a[236:239], a[160:163], v[12:15]
  ds_read_b64_tr_b16 a[234:235], v226 offset:13120
  s_add_u32 m0, s24, 96
  v_mfma_f32_16x16x32_bf16 v[44:47], a[236:239], a[164:167], v[44:47]
  buffer_load_dwordx4 v230, s[4:7], s25 offen offset:3072 nt lds
  v_mfma_f32_16x16x32_bf16 v[76:79], a[236:239], a[168:171], v[76:79]
  s_add_u32 s25, s25, 4096
  v_mfma_f32_16x16x32_bf16 v[108:111], a[236:239], a[172:175], v[108:111]
  v_mfma_f32_16x16x32_bf16 v[140:143], a[236:239], a[176:179], v[140:143]
  v_mfma_f32_16x16x32_bf16 v[172:175], a[236:239], a[180:183], v[172:175]
  v_mfma_f32_16x16x32_bf16 v[204:207], a[236:239], a[184:187], v[204:207]
  ds_read_b64_tr_b16 a[236:237], v226 offset:8776
  v_mfma_f32_16x16x32_bf16 v[16:19], a[240:243], a[160:163], v[16:19]
  ds_read_b64_tr_b16 a[238:239], v226 offset:13128
  s_add_u32 m0, s24, 4224
  v_mfma_f32_16x16x32_bf16 v[48:51], a[240:243], a[164:167], v[48:51]
  buffer_load_dwordx4 v230, s[4:7], s25 offen offset:0 nt lds
  v_mfma_f32_16x16x32_bf16 v[80:83], a[240:243], a[168:171], v[80:83]
  v_mfma_f32_16x16x32_bf16 v[112:115], a[240:243], a[172:175], v[112:115]
  v_mfma_f32_16x16x32_bf16 v[144:147], a[240:243], a[176:179], v[144:147]
  v_mfma_f32_16x16x32_bf16 v[176:179], a[240:243], a[180:183], v[176:179]
  v_mfma_f32_16x16x32_bf16 v[208:211], a[240:243], a[184:187], v[208:211]
  ds_read_b64_tr_b16 a[240:241], v226 offset:8832
  v_mfma_f32_16x16x32_bf16 v[20:23], a[244:247], a[160:163], v[20:23]
  ds_read_b64_tr_b16 a[242:243], v226 offset:13184
  s_add_u32 m0, s24, 4256
  v_mfma_f32_16x16x32_bf16 v[52:55], a[244:247], a[164:167], v[52:55]
  buffer_load_dwordx4 v230, s[4:7], s25 offen offset:1024 nt lds
  v_mfma_f32_16x16x32_bf16 v[84:87], a[244:247], a[168:171], v[84:87]
  v_mfma_f32_16x16x32_bf16 v[116:119], a[244:247], a[172:175], v[116:119]
  v_mfma_f32_16x16x32_bf16 v[148:151], a[244:247], a[176:179], v[148:151]
  v_mfma_f32_16x16x32_bf16 v[180:183], a[244:247], a[180:183], v[180:183]
  v_mfma_f32_16x16x32_bf16 v[212:215], a[244:247], a[184:187], v[212:215]
  ds_read_b64_tr_b16 a[244:245], v226 offset:8840
  v_mfma_f32_16x16x32_bf16 v[24:27], a[248:251], a[160:163], v[24:27]
  ds_read_b64_tr_b16 a[246:247], v226 offset:13192
  s_add_u32 m0, s24, 4288
  v_mfma_f32_16x16x32_bf16 v[56:59], a[248:251], a[164:167], v[56:59]
  buffer_load_dwordx4 v230, s[4:7], s25 offen offset:2048 nt lds
  v_mfma_f32_16x16x32_bf16 v[88:91], a[248:251], a[168:171], v[88:91]
  v_mfma_f32_16x16x32_bf16 v[120:123], a[248:251], a[172:175], v[120:123]
  v_mfma_f32_16x16x32_bf16 v[152:155], a[248:251], a[176:179], v[152:155]
  v_mfma_f32_16x16x32_bf16 v[184:187], a[248:251], a[180:183], v[184:187]
  v_mfma_f32_16x16x32_bf16 v[216:219], a[248:251], a[184:187], v[216:219]
  ds_read_b64_tr_b16 a[248:249], v226 offset:8896
  v_mfma_f32_16x16x32_bf16 v[28:31], a[252:255], a[160:163], v[28:31]
  ds_read_b64_tr_b16 a[250:251], v226 offset:13248
  s_add_u32 m0, s24, 4320
  v_mfma_f32_16x16x32_bf16 v[60:63], a[252:255], a[164:167], v[60:63]
  buffer_load_dwordx4 v230, s[4:7], s25 offen offset:3072 nt lds
  v_mfma_f32_16x16x32_bf16 v[92:95], a[252:255], a[168:171], v[92:95]
  s_add_u32 s25, s25, 4096
  s_and_b32 s25, s25, 0x3ffff
  v_mfma_f32_16x16x32_bf16 v[124:127], a[252:255], a[172:175], v[124:127]
  v_mfma_f32_16x16x32_bf16 v[156:159], a[252:255], a[176:179], v[156:159]
  v_mfma_f32_16x16x32_bf16 v[188:191], a[252:255], a[180:183], v[188:191]
  s_waitcnt lgkmcnt(0)
  v_mfma_f32_16x16x32_bf16 v[220:223], a[252:255], a[184:187], v[220:223]
  ds_read_b64_tr_b16 a[252:253], v226 offset:8904
  v_mfma_f32_16x16x32_bf16 v[0:3], a[224:227], a[128:131], v[0:3]
  ds_read_b64_tr_b16 a[254:255], v226 offset:13256
  v_mfma_f32_16x16x32_bf16 v[32:35], a[224:227], a[132:135], v[32:35]
  v_mfma_f32_16x16x32_bf16 v[64:67], a[224:227], a[136:139], v[64:67]
  v_mfma_f32_16x16x32_bf16 v[96:99], a[224:227], a[140:143], v[96:99]
  v_mfma_f32_16x16x32_bf16 v[128:131], a[224:227], a[144:147], v[128:131]
  s_waitcnt vmcnt(16) lgkmcnt(0)
  s_barrier
  s_add_u32 m0, s24, 8704
  v_mfma_f32_16x16x32_bf16 v[160:163], a[224:227], a[148:151], v[160:163]
  buffer_load_dwordx4 v230, s[4:7], s25 offen offset:0 nt lds
  v_mfma_f32_16x16x32_bf16 v[192:195], a[224:227], a[152:155], v[192:195]
  ds_read_b64_tr_b16 a[224:225], v226 offset:17408
  v_mfma_f32_16x16x32_bf16 v[4:7], a[228:231], a[128:131], v[4:7]
  ds_read_b64_tr_b16 a[226:227], v226 offset:21760
  v_mfma_f32_16x16x32_bf16 v[36:39], a[228:231], a[132:135], v[36:39]
  ds_read_b128 a[160:163], v227 offset:17472
  v_mfma_f32_16x16x32_bf16 v[68:71], a[228:231], a[136:139], v[68:71]
  ds_read_b128 a[164:167], v227 offset:19648
  s_add_u32 m0, s24, 8736
  v_mfma_f32_16x16x32_bf16 v[100:103], a[228:231], a[140:143], v[100:103]
  buffer_load_dwordx4 v230, s[4:7], s25 offen offset:1024 nt lds
  v_mfma_f32_16x16x32_bf16 v[132:135], a[228:231], a[144:147], v[132:135]
  ds_read_b128 a[168:171], v227 offset:21824
  v_mfma_f32_16x16x32_bf16 v[164:167], a[228:231], a[148:151], v[164:167]
  ds_read_b128 a[172:175], v227 offset:24000
  v_mfma_f32_16x16x32_bf16 v[196:199], a[228:231], a[152:155], v[196:199]
  ds_read_b64_tr_b16 a[228:229], v226 offset:17416
  v_mfma_f32_16x16x32_bf16 v[8:11], a[232:235], a[128:131], v[8:11]
  ds_read_b64_tr_b16 a[230:231], v226 offset:21768
  s_add_u32 m0, s24, 8768
  v_mfma_f32_16x16x32_bf16 v[40:43], a[232:235], a[132:135], v[40:43]
  buffer_load_dwordx4 v230, s[4:7], s25 offen offset:2048 nt lds
  v_mfma_f32_16x16x32_bf16 v[72:75], a[232:235], a[136:139], v[72:75]
  ds_read_b128 a[176:179], v227 offset:26176
  v_mfma_f32_16x16x32_bf16 v[104:107], a[232:235], a[140:143], v[104:107]
  ds_read_b128 a[180:183], v227 offset:28352
  v_mfma_f32_16x16x32_bf16 v[136:139], a[232:235], a[144:147], v[136:139]
  ds_read_b128 a[184:187], v227 offset:30528
  v_mfma_f32_16x16x32_bf16 v[168:171], a[232:235], a[148:151], v[168:171]
  ds_read_b128 a[192:195], v227 offset:17408
  v_mfma_f32_16x16x32_bf16 v[200:203], a[232:235], a[152:155], v[200:203]
  ds_read_b64_tr_b16 a[232:233], v226 offset:17472
  v_mfma_f32_16x16x32_bf16 v[12:15], a[236:239], a[128:131], v[12:15]
  ds_read_b64_tr_b16 a[234:235], v226 offset:21824
  s_add_u32 m0, s24, 8800
  v_mfma_f32_16x16x32_bf16 v[44:47], a[236:239], a[132:135], v[44:47]
  buffer_load_dwordx4 v230, s[4:7], s25 offen offset:3072 nt lds
  v_mfma_f32_16x16x32_bf16 v[76:79], a[236:239], a[136:139], v[76:79]
  ds_read_b128 a[196:199], v227 offset:19584
  s_add_u32 s25, s25, 4096
  v_mfma_f32_16x16x32_bf16 v[108:111], a[236:239], a[140:143], v[108:111]
  ds_read_b128 a[200:203], v227 offset:21760
  v_mfma_f32_16x16x32_bf16 v[140:143], a[236:239], a[144:147], v[140:143]
  ds_read_b128 a[204:207], v227 offset:23936
  v_mfma_f32_16x16x32_bf16 v[172:175], a[236:239], a[148:151], v[172:175]
  ds_read_b128 a[208:211], v227 offset:26112
  v_mfma_f32_16x16x32_bf16 v[204:207], a[236:239], a[152:155], v[204:207]
  ds_read_b64_tr_b16 a[236:237], v226 offset:17480
  v_mfma_f32_16x16x32_bf16 v[16:19], a[240:243], a[128:131], v[16:19]
  ds_read_b64_tr_b16 a[238:239], v226 offset:21832
  s_add_u32 m0, s24, 12928
  v_mfma_f32_16x16x32_bf16 v[48:51], a[240:243], a[132:135], v[48:51]
  buffer_load_dwordx4 v230, s[4:7], s25 offen offset:0 nt lds
  v_mfma_f32_16x16x32_bf16 v[80:83], a[240:243], a[136:139], v[80:83]
  ds_read_b128 a[212:215], v227 offset:28288
  v_mfma_f32_16x16x32_bf16 v[112:115], a[240:243], a[140:143], v[112:115]
  ds_read_b128 a[216:219], v227 offset:30464
  v_mfma_f32_16x16x32_bf16 v[144:147], a[240:243], a[144:147], v[144:147]
  v_mfma_f32_16x16x32_bf16 v[176:179], a[240:243], a[148:151], v[176:179]
  v_mfma_f32_16x16x32_bf16 v[208:211], a[240:243], a[152:155], v[208:211]
  ds_read_b64_tr_b16 a[240:241], v226 offset:17536
  v_mfma_f32_16x16x32_bf16 v[20:23], a[244:247], a[128:131], v[20:23]
  ds_read_b64_tr_b16 a[242:243], v226 offset:21888
  s_add_u32 m0, s24, 12960
  v_mfma_f32_16x16x32_bf16 v[52:55], a[244:247], a[132:135], v[52:55]
  buffer_load_dwordx4 v230, s[4:7], s25 offen offset:1024 nt lds
  v_mfma_f32_16x16x32_bf16 v[84:87], a[244:247], a[136:139], v[84:87]
  v_mfma_f32_16x16x32_bf16 v[116:119], a[244:247], a[140:143], v[116:119]
  v_mfma_f32_16x16x32_bf16 v[148:151], a[244:247], a[144:147], v[148:151]
  v_mfma_f32_16x16x32_bf16 v[180:183], a[244:247], a[148:151], v[180:183]
  v_mfma_f32_16x16x32_bf16 v[212:215], a[244:247], a[152:155], v[212:215]
  ds_read_b64_tr_b16 a[244:245], v226 offset:17544
  v_mfma_f32_16x16x32_bf16 v[24:27], a[248:251], a[128:131], v[24:27]
  ds_read_b64_tr_b16 a[246:247], v226 offset:21896
  s_add_u32 m0, s24, 12992
  v_mfma_f32_16x16x32_bf16 v[56:59], a[248:251], a[132:135], v[56:59]
  buffer_load_dwordx4 v230, s[4:7], s25 offen offset:2048 nt lds
  v_mfma_f32_16x16x32_bf16 v[88:91], a[248:251], a[136:139], v[88:91]
  v_mfma_f32_16x16x32_bf16 v[120:123], a[248:251], a[140:143], v[120:123]
  v_mfma_f32_16x16x32_bf16 v[152:155], a[248:251], a[144:147], v[152:155]
  v_mfma_f32_16x16x32_bf16 v[184:187], a[248:251], a[148:151], v[184:187]
  v_mfma_f32_16x16x32_bf16 v[216:219], a[248:251], a[152:155], v[216:219]
  ds_read_b64_tr_b16 a[248:249], v226 offset:17600
  v_mfma_f32_16x16x32_bf16 v[28:31], a[252:255], a[128:131], v[28:31]
  ds_read_b64_tr_b16 a[250:251], v226 offset:21952
  s_add_u32 m0, s24, 13024
  v_mfma_f32_16x16x32_bf16 v[60:63], a[252:255], a[132:135], v[60:63]
  buffer_load_dwordx4 v230, s[4:7], s25 offen offset:3072 nt lds
  v_mfma_f32_16x16x32_bf16 v[92:95], a[252:255], a[136:139], v[92:95]
  s_add_u32 s25, s25, 4096
  s_and_b32 s25, s25, 0x3ffff
  v_mfma_f32_16x16x32_bf16 v[124:127], a[252:255], a[140:143], v[124:127]
  v_mfma_f32_16x16x32_bf16 v[156:159], a[252:255], a[144:147], v[156:159]
  v_mfma_f32_16x16x32_bf16 v[188:191], a[252:255], a[148:151], v[188:191]
  s_waitcnt lgkmcnt(0)
  v_mfma_f32_16x16x32_bf16 v[220:223], a[252:255], a[152:155], v[220:223]
  ds_read_b64_tr_b16 a[252:253], v226 offset:17608
  v_mfma_f32_16x16x32_bf16 v[0:3], a[224:227], a[192:195], v[0:3]
  ds_read_b64_tr_b16 a[254:255], v226 offset:21960
  v_mfma_f32_16x16x32_bf16 v[32:35], a[224:227], a[196:199], v[32:35]
  v_mfma_f32_16x16x32_bf16 v[64:67], a[224:227], a[200:203], v[64:67]
  v_mfma_f32_16x16x32_bf16 v[96:99], a[224:227], a[204:207], v[96:99]
  v_mfma_f32_16x16x32_bf16 v[128:131], a[224:227], a[208:211], v[128:131]
  s_waitcnt vmcnt(16) lgkmcnt(0)
  s_barrier
  s_add_u32 m0, s24, 17408
  v_mfma_f32_16x16x32_bf16 v[160:163], a[224:227], a[212:215], v[160:163]
  buffer_load_dwordx4 v230, s[4:7], s25 offen offset:0 nt lds
  v_mfma_f32_16x16x32_bf16 v[192:195], a[224:227], a[216:219], v[192:195]
  ds_read_b64_tr_b16 a[0:1], v226 offset:26112
  v_mfma_f32_16x16x32_bf16 v[4:7], a[228:231], a[192:195], v[4:7]
  ds_read_b64_tr_b16 a[2:3], v226 offset:30464
  v_mfma_f32_16x16x32_bf16 v[36:39], a[228:231], a[196:199], v[36:39]
  v_mfma_f32_16x16x32_bf16 v[68:71], a[228:231], a[200:203], v[68:71]
  s_add_u32 m0, s24, 17440
  v_mfma_f32_16x16x32_bf16 v[100:103], a[228:231], a[204:207], v[100:103]
  buffer_load_dwordx4 v230, s[4:7], s25 offen offset:1024 nt lds
  v_mfma_f32_16x16x32_bf16 v[132:135], a[228:231], a[208:211], v[132:135]
  v_mfma_f32_16x16x32_bf16 v[164:167], a[228:231], a[212:215], v[164:167]
  v_mfma_f32_16x16x32_bf16 v[196:199], a[228:231], a[216:219], v[196:199]
  ds_read_b64_tr_b16 a[4:5], v226 offset:26120
  v_mfma_f32_16x16x32_bf16 v[8:11], a[232:235], a[192:195], v[8:11]
  ds_read_b64_tr_b16 a[6:7], v226 offset:30472
  s_add_u32 m0, s24, 17472
  v_mfma_f32_16x16x32_bf16 v[40:43], a[232:235], a[196:199], v[40:43]
  buffer_load_dwordx4 v230, s[4:7], s25 offen offset:2048 nt lds
  v_mfma_f32_16x16x32_bf16 v[72:75], a[232:235], a[200:203], v[72:75]
  v_mfma_f32_16x16x32_bf16 v[104:107], a[232:235], a[204:207], v[104:107]
  v_mfma_f32_16x16x32_bf16 v[136:139], a[232:235], a[208:211], v[136:139]
  v_mfma_f32_16x16x32_bf16 v[168:171], a[232:235], a[212:215], v[168:171]
  v_mfma_f32_16x16x32_bf16 v[200:203], a[232:235], a[216:219], v[200:203]
  ds_read_b64_tr_b16 a[8:9], v226 offset:26176
  v_mfma_f32_16x16x32_bf16 v[12:15], a[236:239], a[192:195], v[12:15]
  ds_read_b64_tr_b16 a[10:11], v226 offset:30528
  s_add_u32 m0, s24, 17504
  v_mfma_f32_16x16x32_bf16 v[44:47], a[236:239], a[196:199], v[44:47]
  buffer_load_dwordx4 v230, s[4:7], s25 offen offset:3072 nt lds
  v_mfma_f32_16x16x32_bf16 v[76:79], a[236:239], a[200:203], v[76:79]
  s_add_u32 s25, s25, 4096
  v_mfma_f32_16x16x32_bf16 v[108:111], a[236:239], a[204:207], v[108:111]
  v_mfma_f32_16x16x32_bf16 v[140:143], a[236:239], a[208:211], v[140:143]
  v_mfma_f32_16x16x32_bf16 v[172:175], a[236:239], a[212:215], v[172:175]
  v_mfma_f32_16x16x32_bf16 v[204:207], a[236:239], a[216:219], v[204:207]
  ds_read_b64_tr_b16 a[12:13], v226 offset:26184
  v_mfma_f32_16x16x32_bf16 v[16:19], a[240:243], a[192:195], v[16:19]
  ds_read_b64_tr_b16 a[14:15], v226 offset:30536
  s_add_u32 m0, s24, 21632
  v_mfma_f32_16x16x32_bf16 v[48:51], a[240:243], a[196:199], v[48:51]
  buffer_load_dwordx4 v230, s[4:7], s25 offen offset:0 nt lds
  v_mfma_f32_16x16x32_bf16 v[80:83], a[240:243], a[200:203], v[80:83]
  v_mfma_f32_16x16x32_bf16 v[112:115], a[240:243], a[204:207], v[112:115]
  v_mfma_f32_16x16x32_bf16 v[144:147], a[240:243], a[208:211], v[144:147]
  v_mfma_f32_16x16x32_bf16 v[176:179], a[240:243], a[212:215], v[176:179]
  v_mfma_f32_16x16x32_bf16 v[208:211], a[240:243], a[216:219], v[208:211]
  ds_read_b64_tr_b16 a[16:17], v226 offset:26240
  v_mfma_f32_16x16x32_bf16 v[20:23], a[244:247], a[192:195], v[20:23]
  ds_read_b64_tr_b16 a[18:19], v226 offset:30592
  s_add_u32 m0, s24, 21664
  v_mfma_f32_16x16x32_bf16 v[52:55], a[244:247], a[196:199], v[52:55]
  buffer_load_dwordx4 v230, s[4:7], s25 offen offset:1024 nt lds
  v_mfma_f32_16x16x32_bf16 v[84:87], a[244:247], a[200:203], v[84:87]
  v_mfma_f32_16x16x32_bf16 v[116:119], a[244:247], a[204:207], v[116:119]
  v_mfma_f32_16x16x32_bf16 v[148:151], a[244:247], a[208:211], v[148:151]
  v_mfma_f32_16x16x32_bf16 v[180:183], a[244:247], a[212:215], v[180:183]
  v_mfma_f32_16x16x32_bf16 v[212:215], a[244:247], a[216:219], v[212:215]
  ds_read_b64_tr_b16 a[20:21], v226 offset:26248
  v_mfma_f32_16x16x32_bf16 v[24:27], a[248:251], a[192:195], v[24:27]
  ds_read_b64_tr_b16 a[22:23], v226 offset:30600
  s_add_u32 m0, s24, 21696
  v_mfma_f32_16x16x32_bf16 v[56:59], a[248:251], a[196:199], v[56:59]
  buffer_load_dwordx4 v230, s[4:7], s25 offen offset:2048 nt lds
  v_mfma_f32_16x16x32_bf16 v[88:91], a[248:251], a[200:203], v[88:91]
  v_mfma_f32_16x16x32_bf16 v[120:123], a[248:251], a[204:207], v[120:123]
  v_mfma_f32_16x16x32_bf16 v[152:155], a[248:251], a[208:211], v[152:155]
  v_mfma_f32_16x16x32_bf16 v[184:187], a[248:251], a[212:215], v[184:187]
  v_mfma_f32_16x16x32_bf16 v[216:219], a[248:251], a[216:219], v[216:219]
  ds_read_b64_tr_b16 a[24:25], v226 offset:26304
  v_mfma_f32_16x16x32_bf16 v[28:31], a[252:255], a[192:195], v[28:31]
  ds_read_b64_tr_b16 a[26:27], v226 offset:30656
  s_add_u32 m0, s24, 21728
  v_mfma_f32_16x16x32_bf16 v[60:63], a[252:255], a[196:199], v[60:63]
  buffer_load_dwordx4 v230, s[4:7], s25 offen offset:3072 nt lds
  v_mfma_f32_16x16x32_bf16 v[92:95], a[252:255], a[200:203], v[92:95]
  s_add_u32 s25, s25, 4096
  s_and_b32 s25, s25, 0x3ffff
  v_mfma_f32_16x16x32_bf16 v[124:127], a[252:255], a[204:207], v[124:127]
  v_mfma_f32_16x16x32_bf16 v[156:159], a[252:255], a[208:211], v[156:159]
  v_mfma_f32_16x16x32_bf16 v[188:191], a[252:255], a[212:215], v[188:191]
  s_waitcnt lgkmcnt(0)
  v_mfma_f32_16x16x32_bf16 v[220:223], a[252:255], a[216:219], v[220:223]
  ds_read_b64_tr_b16 a[28:29], v226 offset:26312
  v_mfma_f32_16x16x32_bf16 v[0:3], a[0:3], a[160:163], v[0:3]
  ds_read_b64_tr_b16 a[30:31], v226 offset:30664
  v_mfma_f32_16x16x32_bf16 v[4:7], a[4:7], a[160:163], v[4:7]
  v_mfma_f32_16x16x32_bf16 v[8:11], a[8:11], a[160:163], v[8:11]
  s_mul_i32 s40, s21, 78336
  v_lshrrev_b32 v232, 8, v230
  v_mfma_f32_16x16x32_bf16 v[12:15], a[12:15], a[160:163], v[12:15]
  v_lshl_add_u32 v232, v232, 4, s40
  v_mfma_f32_16x16x32_bf16 v[16:19], a[16:19], a[160:163], v[16:19]
  s_waitcnt vmcnt(16) lgkmcnt(0)
  s_barrier
  v_mfma_f32_16x16x32_bf16 v[20:23], a[20:23], a[160:163], v[20:23]
  ds_read_b128 v[240:243], v232 offset:0
  v_mfma_f32_16x16x32_bf16 v[24:27], a[24:27], a[160:163], v[24:27]
  ds_read_b128 v[244:247], v232 offset:64
  v_mfma_f32_16x16x32_bf16 v[28:31], a[28:31], a[160:163], v[28:31]
  ds_read_b128 v[248:251], v232 offset:128
  v_mfma_f32_16x16x32_bf16 v[32:35], a[0:3], a[164:167], v[32:35]
  ds_read_b128 v[252:255], v232 offset:192
  v_mfma_f32_16x16x32_bf16 v[36:39], a[4:7], a[164:167], v[36:39]
  ds_read_b128 a[224:227], v224 offset:0
  v_mfma_f32_16x16x32_bf16 v[40:43], a[8:11], a[164:167], v[40:43]
  ds_read_b128 a[228:231], v224 offset:64
  v_mul_f32 v0, s60, v0
  v_mfma_f32_16x16x32_bf16 v[44:47], a[12:15], a[164:167], v[44:47]
  ds_read_b128 a[232:235], v224 offset:128
  v_mul_f32 v1, s60, v1
  v_mfma_f32_16x16x32_bf16 v[48:51], a[16:19], a[164:167], v[48:51]
  ds_read_b128 a[236:239], v224 offset:192
  v_mul_f32 v2, s60, v2
  v_mfma_f32_16x16x32_bf16 v[52:55], a[20:23], a[164:167], v[52:55]
  ds_read_b128 a[240:243], v224 offset:512
  v_mul_f32 v3, s60, v3
  v_mfma_f32_16x16x32_bf16 v[56:59], a[24:27], a[164:167], v[56:59]
  ds_read_b128 a[244:247], v224 offset:576
  v_mul_f32 v4, s60, v4
  v_mfma_f32_16x16x32_bf16 v[60:63], a[28:31], a[164:167], v[60:63]
  ds_read_b128 a[248:251], v224 offset:640
  v_mul_f32 v5, s60, v5
  v_mfma_f32_16x16x32_bf16 v[64:67], a[0:3], a[168:171], v[64:67]
  ds_read_b128 a[252:255], v224 offset:704
  v_mul_f32 v6, s60, v6
  v_mfma_f32_16x16x32_bf16 v[68:71], a[4:7], a[168:171], v[68:71]
  s_add_u32 m0, s24, 26112
  v_mul_f32 v7, s60, v7
  v_cvt_pk_bf16_f32 v0, v0, v1
  v_mfma_f32_16x16x32_bf16 v[72:75], a[8:11], a[168:171], v[72:75]
  buffer_load_dwordx4 v230, s[4:7], s25 offen offset:0 nt lds
  v_mfma_f32_16x16x32_bf16 v[76:79], a[12:15], a[168:171], v[76:79]
  v_cvt_pk_bf16_f32 v1, v2, v3
  v_cvt_pk_bf16_f32 v2, v4, v5
  v_mfma_f32_16x16x32_bf16 v[80:83], a[16:19], a[168:171], v[80:83]
  s_waitcnt lgkmcnt(0)
  v_cvt_pk_bf16_f32 v3, v6, v7
  v_mul_f32 v8, s60, v8
  v_mfma_f32_16x16x32_bf16 v[84:87], a[20:23], a[168:171], v[84:87]
  s_add_u32 m0, s24, 26144
  v_xor_b32 v240, 0x80008000, v240
  v_xor_b32 v241, 0x80008000, v241
  v_mfma_f32_16x16x32_bf16 v[88:91], a[24:27], a[168:171], v[88:91]
  buffer_load_dwordx4 v230, s[4:7], s25 offen offset:1024 nt lds
  v_mfma_f32_16x16x32_bf16 v[92:95], a[28:31], a[168:171], v[92:95]
  v_xor_b32 v242, 0x80008000, v242
  v_xor_b32 v243, 0x80008000, v243
  v_mfma_f32_16x16x32_bf16 v[96:99], a[0:3], a[172:175], v[96:99]
  v_xor_b32 v244, 0x80008000, v244
  v_xor_b32 v245, 0x80008000, v245
  v_mfma_f32_16x16x32_bf16 v[100:103], a[4:7], a[172:175], v[100:103]
  s_add_u32 m0, s24, 26176
  v_xor_b32 v246, 0x80008000, v246
  v_xor_b32 v247, 0x80008000, v247
  v_mfma_f32_16x16x32_bf16 v[104:107], a[8:11], a[172:175], v[104:107]
  buffer_load_dwordx4 v230, s[4:7], s25 offen offset:2048 nt lds
  v_mfma_f32_16x16x32_bf16 v[108:111], a[12:15], a[172:175], v[108:111]
  v_xor_b32 v248, 0x80008000, v248
  v_xor_b32 v249, 0x80008000, v249
  v_mfma_f32_16x16x32_bf16 v[112:115], a[16:19], a[172:175], v[112:115]
  v_xor_b32 v250, 0x80008000, v250
  v_xor_b32 v251, 0x80008000, v251
  v_mfma_f32_16x16x32_bf16 v[116:119], a[20:23], a[172:175], v[116:119]
  s_add_u32 m0, s24, 26208
  v_xor_b32 v252, 0x80008000, v252
  v_xor_b32 v253, 0x80008000, v253
  v_mfma_f32_16x16x32_bf16 v[120:123], a[24:27], a[172:175], v[120:123]
  buffer_load_dwordx4 v230, s[4:7], s25 offen offset:3072 nt lds
  v_mfma_f32_16x16x32_bf16 v[124:127], a[28:31], a[172:175], v[124:127]
  s_add_u32 s25, s25, 4096
  v_xor_b32 v254, 0x80008000, v254
  v_xor_b32 v255, 0x80008000, v255
  v_mfma_f32_16x16x32_bf16 v[128:131], a[0:3], a[176:179], v[128:131]
  v_mov_b32 v236, 3248488448
  v_mov_b32 v237, 3248488448
  v_mfma_f32_16x16x32_bf16 v[132:135], a[4:7], a[176:179], v[132:135]
  s_add_u32 m0, s24, 30336
  v_mov_b32 v238, 3248488448
  v_mov_b32 v239, 3248488448
  v_mfma_f32_16x16x32_bf16 v[136:139], a[8:11], a[176:179], v[136:139]
  buffer_load_dwordx4 v230, s[4:7], s25 offen offset:0 nt lds
  v_mfma_f32_16x16x32_bf16 v[140:143], a[12:15], a[176:179], v[140:143]
  v_mul_f32 v9, s60, v9
  v_mul_f32 v10, s60, v10
  v_mfma_f32_16x16x32_bf16 v[144:147], a[16:19], a[176:179], v[144:147]
  v_mul_f32 v11, s60, v11
  v_mul_f32 v12, s60, v12
  v_mfma_f32_16x16x32_bf16 v[148:151], a[20:23], a[176:179], v[148:151]
  s_add_u32 m0, s24, 30368
  v_mul_f32 v13, s60, v13
  v_mul_f32 v14, s60, v14
  v_mfma_f32_16x16x32_bf16 v[152:155], a[24:27], a[176:179], v[152:155]
  buffer_load_dwordx4 v230, s[4:7], s25 offen offset:1024 nt lds
  v_mfma_f32_16x16x32_bf16 v[156:159], a[28:31], a[176:179], v[156:159]
  v_mul_f32 v15, s60, v15
  v_cvt_pk_bf16_f32 v4, v8, v9
  v_mfma_f32_16x16x32_bf16 v[160:163], a[0:3], a[180:183], v[160:163]
  v_cvt_pk_bf16_f32 v5, v10, v11
  v_cvt_pk_bf16_f32 v6, v12, v13
  v_mfma_f32_16x16x32_bf16 v[164:167], a[4:7], a[180:183], v[164:167]
  s_add_u32 m0, s24, 30400
  v_cvt_pk_bf16_f32 v7, v14, v15
  v_mul_f32 v16, s60, v16
  v_mfma_f32_16x16x32_bf16 v[168:171], a[8:11], a[180:183], v[168:171]
  buffer_load_dwordx4 v230, s[4:7], s25 offen offset:2048 nt lds
  v_mfma_f32_16x16x32_bf16 v[172:175], a[12:15], a[180:183], v[172:175]
  v_mul_f32 v17, s60, v17
  v_mul_f32 v18, s60, v18
  v_mfma_f32_16x16x32_bf16 v[176:179], a[16:19], a[180:183], v[176:179]
  v_mul_f32 v19, s60, v19
  v_mul_f32 v20, s60, v20
  v_mfma_f32_16x16x32_bf16 v[180:183], a[20:23], a[180:183], v[180:183]
  s_add_u32 m0, s24, 30432
  v_mul_f32 v21, s60, v21
  v_mul_f32 v22, s60, v22
  v_mfma_f32_16x16x32_bf16 v[184:187], a[24:27], a[180:183], v[184:187]
  buffer_load_dwordx4 v230, s[4:7], s25 offen offset:3072 nt lds
  v_mfma_f32_16x16x32_bf16 v[188:191], a[28:31], a[180:183], v[188:191]
  s_add_u32 s25, s25, 4096
  s_and_b32 s25, s25, 0x3ffff
  v_mul_f32 v23, s60, v23
  v_cvt_pk_bf16_f32 v8, v16, v17
  v_mfma_f32_16x16x32_bf16 v[192:195], a[0:3], a[184:187], v[192:195]
  v_cvt_pk_bf16_f32 v9, v18, v19
  v_cvt_pk_bf16_f32 v10, v20, v21
  v_mfma_f32_16x16x32_bf16 v[196:199], a[4:7], a[184:187], v[196:199]
  v_cvt_pk_bf16_f32 v11, v22, v23
  v_mul_f32 v24, s60, v24
  v_mfma_f32_16x16x32_bf16 v[200:203], a[8:11], a[184:187], v[200:203]
  v_mul_f32 v25, s60, v25
  v_mul_f32 v26, s60, v26
  v_mfma_f32_16x16x32_bf16 v[204:207], a[12:15], a[184:187], v[204:207]
  v_mul_f32 v27, s60, v27
  v_mul_f32 v28, s60, v28
  v_mfma_f32_16x16x32_bf16 v[208:211], a[16:19], a[184:187], v[208:211]
  v_mul_f32 v29, s60, v29
  v_mul_f32 v30, s60, v30
  v_mfma_f32_16x16x32_bf16 v[212:215], a[20:23], a[184:187], v[212:215]
  v_mul_f32 v31, s60, v31
  v_cvt_pk_bf16_f32 v12, v24, v25
  v_mfma_f32_16x16x32_bf16 v[216:219], a[24:27], a[184:187], v[216:219]
  v_cvt_pk_bf16_f32 v13, v26, v27
  v_cvt_pk_bf16_f32 v14, v28, v29
  v_mfma_f32_16x16x32_bf16 v[220:223], a[28:31], a[184:187], v[220:223]
  v_cvt_pk_bf16_f32 v15, v30, v31
  v_mul_f32 v32, s60, v32
  s_nop 3
  v_mul_f32 v33, s60, v33
  v_mul_f32 v34, s60, v34
  v_mul_f32 v35, s60, v35
  v_mul_f32 v36, s60, v36
  v_mul_f32 v37, s60, v37
  v_mul_f32 v38, s60, v38
  v_mul_f32 v39, s60, v39
  v_cvt_pk_bf16_f32 v16, v32, v33
  v_cvt_pk_bf16_f32 v17, v34, v35
  v_cvt_pk_bf16_f32 v18, v36, v37
  v_cvt_pk_bf16_f32 v19, v38, v39
  v_mul_f32 v40, s60, v40
  v_mul_f32 v41, s60, v41
  v_mul_f32 v42, s60, v42
  v_mul_f32 v43, s60, v43
  v_mul_f32 v44, s60, v44
  v_mul_f32 v45, s60, v45
  v_mul_f32 v46, s60, v46
  v_mul_f32 v47, s60, v47
  v_cvt_pk_bf16_f32 v20, v40, v41
  v_cvt_pk_bf16_f32 v21, v42, v43
  v_cvt_pk_bf16_f32 v22, v44, v45
  v_cvt_pk_bf16_f32 v23, v46, v47
  v_mul_f32 v48, s60, v48
  v_mul_f32 v49, s60, v49
  v_mul_f32 v50, s60, v50
  v_mul_f32 v51, s60, v51
  v_mul_f32 v52, s60, v52
  v_mul_f32 v53, s60, v53
  v_mul_f32 v54, s60, v54
  v_mul_f32 v55, s60, v55
  v_cvt_pk_bf16_f32 v24, v48, v49
  v_cvt_pk_bf16_f32 v25, v50, v51
  v_cvt_pk_bf16_f32 v26, v52, v53
  v_cvt_pk_bf16_f32 v27, v54, v55
  v_mul_f32 v56, s60, v56
  v_mul_f32 v57, s60, v57
  v_mul_f32 v58, s60, v58
  v_mul_f32 v59, s60, v59
  v_mul_f32 v60, s60, v60
  v_mul_f32 v61, s60, v61
  v_mul_f32 v62, s60, v62
  v_mul_f32 v63, s60, v63
  v_cvt_pk_bf16_f32 v28, v56, v57
  v_cvt_pk_bf16_f32 v29, v58, v59
  v_cvt_pk_bf16_f32 v30, v60, v61
  v_cvt_pk_bf16_f32 v31, v62, v63
  v_mul_f32 v64, s60, v64
  v_mul_f32 v65, s60, v65
  v_mul_f32 v66, s60, v66
  v_mul_f32 v67, s60, v67
  v_mul_f32 v68, s60, v68
  v_mul_f32 v69, s60, v69
  v_mul_f32 v70, s60, v70
  v_mul_f32 v71, s60, v71
  v_cvt_pk_bf16_f32 v32, v64, v65
  v_cvt_pk_bf16_f32 v33, v66, v67
  v_cvt_pk_bf16_f32 v34, v68, v69
  v_cvt_pk_bf16_f32 v35, v70, v71
  v_mul_f32 v72, s60, v72
  v_mul_f32 v73, s60, v73
  v_mul_f32 v74, s60, v74
  v_mul_f32 v75, s60, v75
  v_mul_f32 v76, s60, v76
  v_mul_f32 v77, s60, v77
  v_mul_f32 v78, s60, v78
  v_mul_f32 v79, s60, v79
  v_cvt_pk_bf16_f32 v36, v72, v73
  v_cvt_pk_bf16_f32 v37, v74, v75
  v_cvt_pk_bf16_f32 v38, v76, v77
  v_cvt_pk_bf16_f32 v39, v78, v79
  v_mul_f32 v80, s60, v80
  v_mul_f32 v81, s60, v81
  v_mul_f32 v82, s60, v82
  v_mul_f32 v83, s60, v83
  v_mul_f32 v84, s60, v84
  v_mul_f32 v85, s60, v85
  v_mul_f32 v86, s60, v86
  v_mul_f32 v87, s60, v87
  v_cvt_pk_bf16_f32 v40, v80, v81
  v_cvt_pk_bf16_f32 v41, v82, v83
  v_cvt_pk_bf16_f32 v42, v84, v85
  v_cvt_pk_bf16_f32 v43, v86, v87
  v_mul_f32 v88, s60, v88
  v_mul_f32 v89, s60, v89
  v_mul_f32 v90, s60, v90
  v_mul_f32 v91, s60, v91
  v_mul_f32 v92, s60, v92
  v_mul_f32 v93, s60, v93
  v_mul_f32 v94, s60, v94
  v_mul_f32 v95, s60, v95
  v_cvt_pk_bf16_f32 v44, v88, v89
  v_cvt_pk_bf16_f32 v45, v90, v91
  v_cvt_pk_bf16_f32 v46, v92, v93
  v_cvt_pk_bf16_f32 v47, v94, v95
  v_mul_f32 v96, s60, v96
  v_mul_f32 v97, s60, v97
  v_mul_f32 v98, s60, v98
  v_mul_f32 v99, s60, v99
  v_mul_f32 v100, s60, v100
  v_mul_f32 v101, s60, v101
  v_mul_f32 v102, s60, v102
  v_mul_f32 v103, s60, v103
  v_cvt_pk_bf16_f32 v48, v96, v97
  v_cvt_pk_bf16_f32 v49, v98, v99
  v_cvt_pk_bf16_f32 v50, v100, v101
  v_cvt_pk_bf16_f32 v51, v102, v103
  v_mul_f32 v104, s60, v104
  v_mul_f32 v105, s60, v105
  v_mul_f32 v106, s60, v106
  v_mul_f32 v107, s60, v107
  v_mul_f32 v108, s60, v108
  v_mul_f32 v109, s60, v109
  v_mul_f32 v110, s60, v110
  v_mul_f32 v111, s60, v111
  v_cvt_pk_bf16_f32 v52, v104, v105
  v_cvt_pk_bf16_f32 v53, v106, v107
  v_cvt_pk_bf16_f32 v54, v108, v109
  v_cvt_pk_bf16_f32 v55, v110, v111
  v_mul_f32 v112, s60, v112
  v_mul_f32 v113, s60, v113
  v_mul_f32 v114, s60, v114
  v_mul_f32 v115, s60, v115
  v_mul_f32 v116, s60, v116
  v_mul_f32 v117, s60, v117
  v_mul_f32 v118, s60, v118
  v_mul_f32 v119, s60, v119
  v_cvt_pk_bf16_f32 v56, v112, v113
  v_cvt_pk_bf16_f32 v57, v114, v115
  v_cvt_pk_bf16_f32 v58, v116, v117
  v_cvt_pk_bf16_f32 v59, v118, v119
  v_mul_f32 v120, s60, v120
  v_mul_f32 v121, s60, v121
  v_mul_f32 v122, s60, v122
  v_mul_f32 v123, s60, v123
  v_mul_f32 v124, s60, v124
  v_mul_f32 v125, s60, v125
  v_mul_f32 v126, s60, v126
  v_mul_f32 v127, s60, v127
  v_cvt_pk_bf16_f32 v60, v120, v121
  v_cvt_pk_bf16_f32 v61, v122, v123
  v_cvt_pk_bf16_f32 v62, v124, v125
  v_cvt_pk_bf16_f32 v63, v126, v127
  v_mul_f32 v128, s60, v128
  v_mul_f32 v129, s60, v129
  v_mul_f32 v130, s60, v130
  v_mul_f32 v131, s60, v131
  v_mul_f32 v132, s60, v132
  v_mul_f32 v133, s60, v133
  v_mul_f32 v134, s60, v134
  v_mul_f32 v135, s60, v135
  v_cvt_pk_bf16_f32 v64, v128, v129
  v_cvt_pk_bf16_f32 v65, v130, v131
  v_cvt_pk_bf16_f32 v66, v132, v133
  v_cvt_pk_bf16_f32 v67, v134, v135
  v_mul_f32 v136, s60, v136
  v_mul_f32 v137, s60, v137
  v_mul_f32 v138, s60, v138
  v_mul_f32 v139, s60, v139
  v_mul_f32 v140, s60, v140
  v_mul_f32 v141, s60, v141
  v_mul_f32 v142, s60, v142
  v_mul_f32 v143, s60, v143
  v_cvt_pk_bf16_f32 v68, v136, v137
  v_cvt_pk_bf16_f32 v69, v138, v139
  v_cvt_pk_bf16_f32 v70, v140, v141
  v_cvt_pk_bf16_f32 v71, v142, v143
  v_mul_f32 v144, s60, v144
  v_mul_f32 v145, s60, v145
  v_mul_f32 v146, s60, v146
  v_mul_f32 v147, s60, v147
  v_mul_f32 v148, s60, v148
  v_mul_f32 v149, s60, v149
  v_mul_f32 v150, s60, v150
  v_mul_f32 v151, s60, v151
  v_cvt_pk_bf16_f32 v72, v144, v145
  v_cvt_pk_bf16_f32 v73, v146, v147
  v_cvt_pk_bf16_f32 v74, v148, v149
  v_cvt_pk_bf16_f32 v75, v150, v151
  v_mul_f32 v152, s60, v152
  v_mul_f32 v153, s60, v153
  v_mul_f32 v154, s60, v154
  v_mul_f32 v155, s60, v155
  v_mul_f32 v156, s60, v156
  v_mul_f32 v157, s60, v157
  v_mul_f32 v158, s60, v158
  v_mul_f32 v159, s60, v159
  v_cvt_pk_bf16_f32 v76, v152, v153
  v_cvt_pk_bf16_f32 v77, v154, v155
  v_cvt_pk_bf16_f32 v78, v156, v157
  v_cvt_pk_bf16_f32 v79, v158, v159
  v_mul_f32 v160, s60, v160
  v_mul_f32 v161, s60, v161
  v_mul_f32 v162, s60, v162
  v_mul_f32 v163, s60, v163
  v_mul_f32 v164, s60, v164
  v_mul_f32 v165, s60, v165
  v_mul_f32 v166, s60, v166
  v_mul_f32 v167, s60, v167
  v_cvt_pk_bf16_f32 v80, v160, v161
  v_cvt_pk_bf16_f32 v81, v162, v163
  v_cvt_pk_bf16_f32 v82, v164, v165
  v_cvt_pk_bf16_f32 v83, v166, v167
  v_mul_f32 v168, s60, v168
  v_mul_f32 v169, s60, v169
  v_mul_f32 v170, s60, v170
  v_mul_f32 v171, s60, v171
  v_mul_f32 v172, s60, v172
  v_mul_f32 v173, s60, v173
  v_mul_f32 v174, s60, v174
  v_mul_f32 v175, s60, v175
  v_cvt_pk_bf16_f32 v84, v168, v169
  v_cvt_pk_bf16_f32 v85, v170, v171
  v_cvt_pk_bf16_f32 v86, v172, v173
  v_cvt_pk_bf16_f32 v87, v174, v175
  v_mul_f32 v176, s60, v176
  v_mul_f32 v177, s60, v177
  v_mul_f32 v178, s60, v178
  v_mul_f32 v179, s60, v179
  v_mul_f32 v180, s60, v180
  v_mul_f32 v181, s60, v181
  v_mul_f32 v182, s60, v182
  v_mul_f32 v183, s60, v183
  v_cvt_pk_bf16_f32 v88, v176, v177
  v_cvt_pk_bf16_f32 v89, v178, v179
  v_cvt_pk_bf16_f32 v90, v180, v181
  v_cvt_pk_bf16_f32 v91, v182, v183
  v_mul_f32 v184, s60, v184
  v_mul_f32 v185, s60, v185
  v_mul_f32 v186, s60, v186
  v_mul_f32 v187, s60, v187
  v_mul_f32 v188, s60, v188
  v_mul_f32 v189, s60, v189
  v_mul_f32 v190, s60, v190
  v_mul_f32 v191, s60, v191
  v_cvt_pk_bf16_f32 v92, v184, v185
  v_cvt_pk_bf16_f32 v93, v186, v187
  v_cvt_pk_bf16_f32 v94, v188, v189
  v_cvt_pk_bf16_f32 v95, v190, v191
  v_mul_f32 v192, s60, v192
  v_mfma_f32_16x16x32_bf16 v[176:179], v[240:243], v[0:3], v[236:239]
  s_mov_b32 s40, s37
  v_mul_f32 v193, s60, v193
  v_mul_f32 v194, s60, v194
  v_mfma_f32_16x16x32_bf16 v[176:179], v[244:247], v[4:7], v[176:179]
  s_mul_i32 s40, s40, 224
  v_mul_f32 v195, s60, v195
  v_mul_f32 v196, s60, v196
  v_mfma_f32_16x16x32_bf16 v[176:179], v[248:251], v[8:11], v[176:179]
  s_mul_i32 s41, s32, 14
  v_mul_f32 v197, s60, v197
  v_mul_f32 v198, s60, v198
  v_mfma_f32_16x16x32_bf16 v[176:179], v[252:255], v[12:15], v[176:179]
  s_add_u32 s40, s40, s41
  v_mul_f32 v199, s60, v199
  v_cvt_pk_bf16_f32 v96, v192, v193
  v_mfma_f32_16x16x32_bf16 v[180:183], v[240:243], v[16:19], v[236:239]
  s_mul_i32 s41, s22, 7
  v_cvt_pk_bf16_f32 v97, v194, v195
  v_cvt_pk_bf16_f32 v98, v196, v197
  v_mfma_f32_16x16x32_bf16 v[180:183], v[244:247], v[20:23], v[180:183]
  s_add_u32 s40, s40, s41
  v_cvt_pk_bf16_f32 v99, v198, v199
  v_mul_f32 v200, s60, v200
  v_mfma_f32_16x16x32_bf16 v[180:183], v[248:251], v[24:27], v[180:183]
  s_lshl_b32 s40, s40, 17
  v_mul_f32 v201, s60, v201
  v_mul_f32 v202, s60, v202
  v_mfma_f32_16x16x32_bf16 v[180:183], v[252:255], v[28:31], v[180:183]
  s_lshl_b32 s41, s23, 4
  v_mul_f32 v203, s60, v203
  v_mul_f32 v204, s60, v204
  v_mfma_f32_16x16x32_bf16 v[184:187], v[240:243], v[32:35], v[236:239]
  s_add_u32 s41, s41, s3
  v_mul_f32 v205, s60, v205
  v_mul_f32 v206, s60, v206
  v_mfma_f32_16x16x32_bf16 v[184:187], v[244:247], v[36:39], v[184:187]
  s_lshl_b32 s41, s41, 12
  v_mul_f32 v207, s60, v207
  v_cvt_pk_bf16_f32 v100, v200, v201
  v_mfma_f32_16x16x32_bf16 v[184:187], v[248:251], v[40:43], v[184:187]
  s_add_u32 s40, s40, s41
  v_cvt_pk_bf16_f32 v101, v202, v203
  v_cvt_pk_bf16_f32 v102, v204, v205
  v_mfma_f32_16x16x32_bf16 v[184:187], v[252:255], v[44:47], v[184:187]
  s_add_u32 s12, s52, s40
  v_cvt_pk_bf16_f32 v103, v206, v207
  v_mul_f32 v208, s60, v208
  v_mfma_f32_16x16x32_bf16 v[188:191], v[240:243], v[48:51], v[236:239]
  s_addc_u32 s13, s53, 0
  v_mul_f32 v209, s60, v209
  v_mul_f32 v210, s60, v210
  v_mfma_f32_16x16x32_bf16 v[188:191], v[244:247], v[52:55], v[188:191]
  s_mov_b32 s14, 790528
  v_mul_f32 v211, s60, v211
  v_mul_f32 v212, s60, v212
  v_mfma_f32_16x16x32_bf16 v[188:191], v[248:251], v[56:59], v[188:191]
  s_add_u32 s40, s3, 16
  v_mul_f32 v213, s60, v213
  v_mul_f32 v214, s60, v214
  v_mfma_f32_16x16x32_bf16 v[188:191], v[252:255], v[60:63], v[188:191]
  s_lshl_b32 s40, s40, 8
  v_mul_f32 v215, s60, v215
  v_cvt_pk_bf16_f32 v104, v208, v209
  v_cvt_pk_bf16_f32 v105, v210, v211
  v_cvt_pk_bf16_f32 v106, v212, v213
  v_cvt_pk_bf16_f32 v107, v214, v215
  v_mul_f32 v216, s60, v216
  v_mul_f32 v217, s60, v217
  v_mul_f32 v218, s60, v218
  v_mul_f32 v219, s60, v219
  v_mul_f32 v220, s60, v220
  v_mul_f32 v221, s60, v221
  v_mul_f32 v222, s60, v222
  v_mul_f32 v223, s60, v223
  v_cvt_pk_bf16_f32 v108, v216, v217
  v_cvt_pk_bf16_f32 v109, v218, v219
  v_cvt_pk_bf16_f32 v110, v220, v221
  v_cvt_pk_bf16_f32 v111, v222, v223
  v_mfma_f32_16x16x32_bf16 v[192:195], v[240:243], v[64:67], v[236:239]
  s_sub_u32 s41, 5242880, s40
  s_cmp_eq_u32 s22, 0
  s_cselect_b32 s40, s40, s36
  v_mfma_f32_16x16x32_bf16 v[192:195], v[244:247], v[68:71], v[192:195]
  s_cselect_b32 s10, s41, 143360
  s_add_u32 s8, s34, s40
  s_addc_u32 s9, s35, 0
  v_mfma_f32_16x16x32_bf16 v[192:195], v[248:251], v[72:75], v[192:195]
  s_mul_i32 s26, s22, 81920
  s_mov_b32 s31, s26
  s_lshl_b32 s40, s93, 8
  v_mfma_f32_16x16x32_bf16 v[192:195], v[252:255], v[76:79], v[192:195]
  s_add_u32 s41, s54, s40
  s_addc_u32 s42, s55, 0
  s_sub_u32 s43, 5242880, s40
  v_mfma_f32_16x16x32_bf16 v[196:199], v[240:243], v[80:83], v[236:239]
  s_mul_i32 s44, s20, 40960
  s_lshl_b32 s40, s20, 6
  v_lshrrev_b32 v233, 8, v230
  v_mfma_f32_16x16x32_bf16 v[196:199], v[244:247], v[84:87], v[196:199]
  v_mul_u32_u24 v233, 10240, v233
  v_and_b32 v234, 0xf0, v230
  v_xor_b32 v234, s40, v234
  v_mfma_f32_16x16x32_bf16 v[196:199], v[248:251], v[88:91], v[196:199]
  v_add_u32 v233, v233, v234
  s_cmp_eq_u32 s23, 0
  s_cselect_b32 s8, s8, s41
  v_mfma_f32_16x16x32_bf16 v[196:199], v[252:255], v[92:95], v[196:199]
  s_cselect_b32 s9, s9, s42
  s_cselect_b32 s10, s10, s43
  s_cselect_b32 s26, s26, s44
  s_nop 1
  v_mfma_f32_16x16x32_bf16 v[200:203], v[240:243], v[96:99], v[236:239]
  s_cselect_b32 s27, s27, 1280
  s_cselect_b32 s28, s28, 163840
  s_cselect_b32 s29, s29, 163840
  v_mfma_f32_16x16x32_bf16 v[200:203], v[244:247], v[100:103], v[200:203]
  s_cselect_b64 vcc, -1, 0
  s_mov_b32 s31, s26
  v_cndmask_b32 v229, v233, v229, vcc
  v_mfma_f32_16x16x32_bf16 v[200:203], v[248:251], v[104:107], v[200:203]
  v_mfma_f32_16x16x32_bf16 v[200:203], v[252:255], v[108:111], v[200:203]
.p2align 3
A_START:
  v_lshlrev_b32 v247, 3, v230
  v_mov_b32 v242, 0
  v_mov_b32 v241, 0
  v_mov_b32 v240, 0
  v_mov_b32 v239, 0
  v_mov_b32 v238, 0
  v_mov_b32 v237, 0
  v_mov_b32 v236, 0
  v_mfma_f32_16x16x32_bf16 v[204:207], a[224:227], v[0:3], v[176:179]
  ds_read_b64_tr_b16 v[112:113], v225 offset:0
  v_mfma_f32_16x16x32_bf16 v[204:207], a[228:231], v[4:7], v[204:207]
  ds_read_b64_tr_b16 v[114:115], v225 offset:512
  v_mfma_f32_16x16x32_bf16 v[204:207], a[232:235], v[8:11], v[204:207]
  ds_read_b64_tr_b16 v[116:117], v225 offset:32
  v_mfma_f32_16x16x32_bf16 v[204:207], a[236:239], v[12:15], v[204:207]
  ds_read_b64_tr_b16 v[118:119], v225 offset:544
  v_mfma_f32_16x16x32_bf16 v[208:211], a[240:243], v[0:3], v[176:179]
  ds_read_b64_tr_b16 v[120:121], v225 offset:64
  v_mfma_f32_16x16x32_bf16 v[208:211], a[244:247], v[4:7], v[208:211]
  ds_read_b64_tr_b16 v[122:123], v225 offset:576
  v_mfma_f32_16x16x32_bf16 v[208:211], a[248:251], v[8:11], v[208:211]
  ds_read_b64_tr_b16 v[124:125], v225 offset:96
  s_nop 0
  v_exp_f32 v204, v204
  v_mfma_f32_16x16x32_bf16 v[208:211], a[252:255], v[12:15], v[208:211]
  ds_read_b64_tr_b16 v[126:127], v225 offset:608
  v_add_f32 v236, v236, v204
  ds_read_b64_tr_b16 v[128:129], v225 offset:128
  v_exp_f32 v205, v205
  ds_read_b64_tr_b16 v[130:131], v225 offset:640
  v_add_f32 v236, v236, v205
  v_cvt_pk_bf16_f32 v220, v204, v205
  ds_read_b64_tr_b16 v[132:133], v225 offset:160
  v_exp_f32 v206, v206
  ds_read_b64_tr_b16 v[134:135], v225 offset:672
  v_add_f32 v236, v236, v206
  ds_read_b64_tr_b16 v[136:137], v225 offset:192
  v_exp_f32 v207, v207
  ds_read_b64_tr_b16 v[138:139], v225 offset:704
  v_add_f32 v236, v236, v207
  v_cvt_pk_bf16_f32 v221, v206, v207
  ds_read_b64_tr_b16 v[140:141], v225 offset:224
  v_exp_f32 v208, v208
  ds_read_b64_tr_b16 v[142:143], v225 offset:736
  v_mfma_f32_16x16x32_bf16 v[212:215], a[224:227], v[16:19], v[180:183]
  s_waitcnt vmcnt(16) lgkmcnt(0)
  s_barrier
  v_exp_f32 v209, v209
  v_mfma_f32_16x16x32_bf16 v[212:215], a[228:231], v[20:23], v[212:215]
  v_mov_b32 v243, 1
  v_add_f32 v236, v236, v208
  v_add_f32 v236, v236, v209
  v_cvt_pk_bf16_f32 v222, v208, v209
  v_mfma_f32_16x16x32_bf16 v[212:215], a[232:235], v[24:27], v[212:215]
  v_exp_f32 v210, v210
  v_mfma_f32_16x16x32_bf16 v[212:215], a[236:239], v[28:31], v[212:215]
  ds_read_b64_tr_b16 v[144:145], v225 offset:8704
  v_add_f32 v236, v236, v210
  v_mfma_f32_16x16x32_bf16 v[216:219], a[240:243], v[16:19], v[180:183]
  v_exp_f32 v211, v211
  v_mfma_f32_16x16x32_bf16 v[216:219], a[244:247], v[20:23], v[216:219]
  buffer_atomic_add v243, v228, s[16:19], s63 offen sc1
  v_add_f32 v236, v236, v211
  v_cvt_pk_bf16_f32 v223, v210, v211
  v_mfma_f32_16x16x32_bf16 v[216:219], a[248:251], v[24:27], v[216:219]
  s_add_u32 m0, s24, 0
  v_exp_f32 v212, v212
  v_mfma_f32_16x16x32_bf16 v[216:219], a[252:255], v[28:31], v[216:219]
  buffer_load_dwordx4 v230, s[4:7], s25 offen offset:0 nt lds
  v_mfma_f32_16x16x32_bf16 a[0:3], v[112:115], v[220:223], 0
  s_mov_b32 s63, 2147418112
  v_exp_f32 v213, v213
  v_mfma_f32_16x16x32_bf16 a[4:7], v[116:119], v[220:223], 0
  v_add_f32 v237, v237, v212
  v_add_f32 v237, v237, v213
  v_cvt_pk_bf16_f32 v232, v212, v213
  v_mfma_f32_16x16x32_bf16 a[8:11], v[120:123], v[220:223], 0
  s_add_u32 m0, s24, 32
  v_exp_f32 v214, v214
  v_mfma_f32_16x16x32_bf16 a[12:15], v[124:127], v[220:223], 0
  buffer_load_dwordx4 v230, s[4:7], s25 offen offset:1024 nt lds
  v_mfma_f32_16x16x32_bf16 a[16:19], v[128:131], v[220:223], 0
  v_exp_f32 v215, v215
  v_mfma_f32_16x16x32_bf16 a[20:23], v[132:135], v[220:223], 0
  v_add_f32 v237, v237, v214
  v_add_f32 v237, v237, v215
  v_cvt_pk_bf16_f32 v233, v214, v215
  v_mfma_f32_16x16x32_bf16 a[24:27], v[136:139], v[220:223], 0
  s_add_u32 m0, s24, 64
  v_exp_f32 v216, v216
  v_mfma_f32_16x16x32_bf16 a[28:31], v[140:143], v[220:223], 0
  buffer_load_dwordx4 v230, s[4:7], s25 offen offset:2048 nt lds
  v_mfma_f32_16x16x32_bf16 v[204:207], a[224:227], v[32:35], v[184:187]
  v_exp_f32 v217, v217
  v_mfma_f32_16x16x32_bf16 v[204:207], a[228:231], v[36:39], v[204:207]
  v_add_f32 v237, v237, v216
  v_add_f32 v237, v237, v217
  v_cvt_pk_bf16_f32 v234, v216, v217
  v_mfma_f32_16x16x32_bf16 v[204:207], a[232:235], v[40:43], v[204:207]
  s_add_u32 m0, s24, 96
  v_exp_f32 v218, v218
  v_mfma_f32_16x16x32_bf16 v[204:207], a[236:239], v[44:47], v[204:207]
  buffer_load_dwordx4 v230, s[4:7], s25 offen offset:3072 nt lds
  v_mfma_f32_16x16x32_bf16 v[208:211], a[240:243], v[32:35], v[184:187]
  s_add_u32 s25, s25, 4096
  v_exp_f32 v219, v219
  v_mfma_f32_16x16x32_bf16 v[208:211], a[244:247], v[36:39], v[208:211]
  v_add_f32 v237, v237, v218
  v_add_f32 v237, v237, v219
  v_cvt_pk_bf16_f32 v235, v218, v219
  v_mfma_f32_16x16x32_bf16 v[208:211], a[248:251], v[40:43], v[208:211]
  s_add_u32 m0, s24, 4224
  v_exp_f32 v204, v204
  v_mfma_f32_16x16x32_bf16 v[208:211], a[252:255], v[44:47], v[208:211]
  buffer_load_dwordx4 v230, s[4:7], s25 offen offset:0 nt lds
  v_mfma_f32_16x16x32_bf16 a[32:35], v[112:115], v[232:235], 0
  v_exp_f32 v205, v205
  v_mfma_f32_16x16x32_bf16 a[36:39], v[116:119], v[232:235], 0
  v_add_f32 v238, v238, v204
  v_add_f32 v238, v238, v205
  v_cvt_pk_bf16_f32 v220, v204, v205
  v_mfma_f32_16x16x32_bf16 a[40:43], v[120:123], v[232:235], 0
  s_add_u32 m0, s24, 4256
  v_exp_f32 v206, v206
  v_mfma_f32_16x16x32_bf16 a[44:47], v[124:127], v[232:235], 0
  buffer_load_dwordx4 v230, s[4:7], s25 offen offset:1024 nt lds
  v_mfma_f32_16x16x32_bf16 a[48:51], v[128:131], v[232:235], 0
  v_exp_f32 v207, v207
  v_mfma_f32_16x16x32_bf16 a[52:55], v[132:135], v[232:235], 0
  v_add_f32 v238, v238, v206
  v_add_f32 v238, v238, v207
  v_cvt_pk_bf16_f32 v221, v206, v207
  v_mfma_f32_16x16x32_bf16 a[56:59], v[136:139], v[232:235], 0
  s_add_u32 m0, s24, 4288
  v_exp_f32 v208, v208
  v_mfma_f32_16x16x32_bf16 a[60:63], v[140:143], v[232:235], 0
  buffer_load_dwordx4 v230, s[4:7], s25 offen offset:2048 nt lds
  v_mfma_f32_16x16x32_bf16 v[212:215], a[224:227], v[48:51], v[188:191]
  v_exp_f32 v209, v209
  v_mfma_f32_16x16x32_bf16 v[212:215], a[228:231], v[52:55], v[212:215]
  v_add_f32 v238, v238, v208
  v_add_f32 v238, v238, v209
  v_cvt_pk_bf16_f32 v222, v208, v209
  v_mfma_f32_16x16x32_bf16 v[212:215], a[232:235], v[56:59], v[212:215]
  s_add_u32 m0, s24, 4320
  v_exp_f32 v210, v210
  v_mfma_f32_16x16x32_bf16 v[212:215], a[236:239], v[60:63], v[212:215]
  buffer_load_dwordx4 v230, s[4:7], s25 offen offset:3072 nt lds
  v_mfma_f32_16x16x32_bf16 v[216:219], a[240:243], v[48:51], v[188:191]
  s_add_u32 s25, s25, 4096
  s_and_b32 s25, s25, 0x3ffff
  v_exp_f32 v211, v211
  v_mfma_f32_16x16x32_bf16 v[216:219], a[244:247], v[52:55], v[216:219]
  v_add_f32 v238, v238, v210
  v_add_f32 v238, v238, v211
  v_cvt_pk_bf16_f32 v223, v210, v211
  v_mfma_f32_16x16x32_bf16 v[216:219], a[248:251], v[56:59], v[216:219]
  v_exp_f32 v212, v212
  v_mfma_f32_16x16x32_bf16 v[216:219], a[252:255], v[60:63], v[216:219]
  ds_read_b64_tr_b16 v[146:147], v225 offset:9216
  v_add_f32 v239, v239, v212
  v_mfma_f32_16x16x32_bf16 a[64:67], v[112:115], v[220:223], 0
  v_exp_f32 v213, v213
  v_mfma_f32_16x16x32_bf16 a[68:71], v[116:119], v[220:223], 0
  v_add_f32 v239, v239, v213
  v_cvt_pk_bf16_f32 v232, v212, v213
  v_mfma_f32_16x16x32_bf16 a[72:75], v[120:123], v[220:223], 0
  v_exp_f32 v214, v214
  v_mfma_f32_16x16x32_bf16 a[76:79], v[124:127], v[220:223], 0
  ds_read_b64_tr_b16 v[148:149], v225 offset:8736
  v_add_f32 v239, v239, v214
  v_mfma_f32_16x16x32_bf16 a[80:83], v[128:131], v[220:223], 0
  v_exp_f32 v215, v215
  v_mfma_f32_16x16x32_bf16 a[84:87], v[132:135], v[220:223], 0
  v_add_f32 v239, v239, v215
  v_cvt_pk_bf16_f32 v233, v214, v215
  v_mfma_f32_16x16x32_bf16 a[88:91], v[136:139], v[220:223], 0
  v_exp_f32 v216, v216
  v_mfma_f32_16x16x32_bf16 a[92:95], v[140:143], v[220:223], 0
  ds_read_b64_tr_b16 v[150:151], v225 offset:9248
  v_add_f32 v239, v239, v216
  v_mfma_f32_16x16x32_bf16 v[204:207], a[224:227], v[64:67], v[192:195]
  v_exp_f32 v217, v217
  v_mfma_f32_16x16x32_bf16 v[204:207], a[228:231], v[68:71], v[204:207]
  v_add_f32 v239, v239, v217
  v_cvt_pk_bf16_f32 v234, v216, v217
  v_mfma_f32_16x16x32_bf16 v[204:207], a[232:235], v[72:75], v[204:207]
  v_exp_f32 v218, v218
  v_mfma_f32_16x16x32_bf16 v[204:207], a[236:239], v[76:79], v[204:207]
  ds_read_b64_tr_b16 v[152:153], v225 offset:8768
  v_add_f32 v239, v239, v218
  v_mfma_f32_16x16x32_bf16 v[208:211], a[240:243], v[64:67], v[192:195]
  v_exp_f32 v219, v219
  v_mfma_f32_16x16x32_bf16 v[208:211], a[244:247], v[68:71], v[208:211]
  v_add_f32 v239, v239, v219
  v_cvt_pk_bf16_f32 v235, v218, v219
  v_mfma_f32_16x16x32_bf16 v[208:211], a[248:251], v[72:75], v[208:211]
  v_exp_f32 v204, v204
  v_mfma_f32_16x16x32_bf16 v[208:211], a[252:255], v[76:79], v[208:211]
  ds_read_b64_tr_b16 v[154:155], v225 offset:9280
  v_add_f32 v240, v240, v204
  v_mfma_f32_16x16x32_bf16 a[96:99], v[112:115], v[232:235], 0
  v_exp_f32 v205, v205
  v_mfma_f32_16x16x32_bf16 a[100:103], v[116:119], v[232:235], 0
  v_add_f32 v240, v240, v205
  v_cvt_pk_bf16_f32 v220, v204, v205
  v_mfma_f32_16x16x32_bf16 a[104:107], v[120:123], v[232:235], 0
  v_exp_f32 v206, v206
  v_mfma_f32_16x16x32_bf16 a[108:111], v[124:127], v[232:235], 0
  ds_read_b64_tr_b16 v[156:157], v225 offset:8800
  v_add_f32 v240, v240, v206
  v_mfma_f32_16x16x32_bf16 a[112:115], v[128:131], v[232:235], 0
  v_exp_f32 v207, v207
  v_mfma_f32_16x16x32_bf16 a[116:119], v[132:135], v[232:235], 0
  v_add_f32 v240, v240, v207
  v_cvt_pk_bf16_f32 v221, v206, v207
  v_mfma_f32_16x16x32_bf16 a[120:123], v[136:139], v[232:235], 0
  v_exp_f32 v208, v208
  v_mfma_f32_16x16x32_bf16 a[124:127], v[140:143], v[232:235], 0
  ds_read_b64_tr_b16 v[158:159], v225 offset:9312
  v_add_f32 v240, v240, v208
  v_mfma_f32_16x16x32_bf16 v[212:215], a[224:227], v[80:83], v[196:199]
  v_exp_f32 v209, v209
  v_mfma_f32_16x16x32_bf16 v[212:215], a[228:231], v[84:87], v[212:215]
  v_add_f32 v240, v240, v209
  v_cvt_pk_bf16_f32 v222, v208, v209
  v_mfma_f32_16x16x32_bf16 v[212:215], a[232:235], v[88:91], v[212:215]
  v_exp_f32 v210, v210
  v_mfma_f32_16x16x32_bf16 v[212:215], a[236:239], v[92:95], v[212:215]
  ds_read_b64_tr_b16 v[160:161], v225 offset:8832
  v_add_f32 v240, v240, v210
  v_mfma_f32_16x16x32_bf16 v[216:219], a[240:243], v[80:83], v[196:199]
  v_exp_f32 v211, v211
  v_mfma_f32_16x16x32_bf16 v[216:219], a[244:247], v[84:87], v[216:219]
  v_add_f32 v240, v240, v211
  v_cvt_pk_bf16_f32 v223, v210, v211
  v_mfma_f32_16x16x32_bf16 v[216:219], a[248:251], v[88:91], v[216:219]
  v_exp_f32 v212, v212
  v_mfma_f32_16x16x32_bf16 v[216:219], a[252:255], v[92:95], v[216:219]
  ds_read_b64_tr_b16 v[162:163], v225 offset:9344
  v_add_f32 v241, v241, v212
  v_mfma_f32_16x16x32_bf16 a[128:131], v[112:115], v[220:223], 0
  v_exp_f32 v213, v213
  v_mfma_f32_16x16x32_bf16 a[132:135], v[116:119], v[220:223], 0
  ds_read_b64_tr_b16 v[164:165], v225 offset:8864
  v_add_f32 v241, v241, v213
  v_cvt_pk_bf16_f32 v232, v212, v213
  v_mfma_f32_16x16x32_bf16 a[136:139], v[120:123], v[220:223], 0
  v_exp_f32 v214, v214
  v_mfma_f32_16x16x32_bf16 a[140:143], v[124:127], v[220:223], 0
  ds_read_b64_tr_b16 v[166:167], v225 offset:9376
  v_add_f32 v241, v241, v214
  v_mfma_f32_16x16x32_bf16 a[144:147], v[128:131], v[220:223], 0
  v_exp_f32 v215, v215
  v_mfma_f32_16x16x32_bf16 a[148:151], v[132:135], v[220:223], 0
  ds_read_b64_tr_b16 v[168:169], v225 offset:8896
  v_add_f32 v241, v241, v215
  v_cvt_pk_bf16_f32 v233, v214, v215
  v_mfma_f32_16x16x32_bf16 a[152:155], v[136:139], v[220:223], 0
  v_exp_f32 v216, v216
  v_mfma_f32_16x16x32_bf16 a[156:159], v[140:143], v[220:223], 0
  ds_read_b64_tr_b16 v[170:171], v225 offset:9408
  v_add_f32 v241, v241, v216
  v_mfma_f32_16x16x32_bf16 v[204:207], a[224:227], v[96:99], v[200:203]
  v_exp_f32 v217, v217
  v_mfma_f32_16x16x32_bf16 v[204:207], a[228:231], v[100:103], v[204:207]
  ds_read_b128 a[224:227], v224 offset:8704
  v_add_f32 v241, v241, v217
  v_cvt_pk_bf16_f32 v234, v216, v217
  v_mfma_f32_16x16x32_bf16 v[204:207], a[232:235], v[104:107], v[204:207]
  v_exp_f32 v218, v218
  v_mfma_f32_16x16x32_bf16 v[204:207], a[236:239], v[108:111], v[204:207]
  ds_read_b128 a[228:231], v224 offset:8768
  v_add_f32 v241, v241, v218
  v_mfma_f32_16x16x32_bf16 v[208:211], a[240:243], v[96:99], v[200:203]
  v_exp_f32 v219, v219
  v_mfma_f32_16x16x32_bf16 v[208:211], a[244:247], v[100:103], v[208:211]
  ds_read_b128 a[232:235], v224 offset:8832
  v_add_f32 v241, v241, v219
  v_cvt_pk_bf16_f32 v235, v218, v219
  v_mfma_f32_16x16x32_bf16 v[208:211], a[248:251], v[104:107], v[208:211]
  v_exp_f32 v204, v204
  v_mfma_f32_16x16x32_bf16 v[208:211], a[252:255], v[108:111], v[208:211]
  ds_read_b128 a[236:239], v224 offset:8896
  v_add_f32 v242, v242, v204
  v_mfma_f32_16x16x32_bf16 a[160:163], v[112:115], v[232:235], 0
  v_exp_f32 v205, v205
  v_mfma_f32_16x16x32_bf16 a[164:167], v[116:119], v[232:235], 0
  ds_read_b128 a[240:243], v224 offset:9216
  v_add_f32 v242, v242, v205
  v_cvt_pk_bf16_f32 v220, v204, v205
  v_mfma_f32_16x16x32_bf16 a[168:171], v[120:123], v[232:235], 0
  v_exp_f32 v206, v206
  v_mfma_f32_16x16x32_bf16 a[172:175], v[124:127], v[232:235], 0
  ds_read_b128 a[244:247], v224 offset:9280
  v_add_f32 v242, v242, v206
  v_mfma_f32_16x16x32_bf16 a[176:179], v[128:131], v[232:235], 0
  v_exp_f32 v207, v207
  v_mfma_f32_16x16x32_bf16 a[180:183], v[132:135], v[232:235], 0
  ds_read_b128 a[248:251], v224 offset:9344
  v_add_f32 v242, v242, v207
  v_cvt_pk_bf16_f32 v221, v206, v207
  v_mfma_f32_16x16x32_bf16 a[184:187], v[136:139], v[232:235], 0
  s_waitcnt lgkmcnt(3)
  v_exp_f32 v208, v208
  v_mfma_f32_16x16x32_bf16 a[188:191], v[140:143], v[232:235], 0
  ds_read_b128 a[252:255], v224 offset:9408
  v_add_f32 v242, v242, v208
  v_mfma_f32_16x16x32_bf16 v[212:215], a[224:227], v[0:3], v[176:179]
  v_exp_f32 v209, v209
  v_mfma_f32_16x16x32_bf16 v[212:215], a[228:231], v[4:7], v[212:215]
  v_add_f32 v242, v242, v209
  v_cvt_pk_bf16_f32 v222, v208, v209
  v_mfma_f32_16x16x32_bf16 v[212:215], a[232:235], v[8:11], v[212:215]
  s_waitcnt lgkmcnt(2)
  v_exp_f32 v210, v210
  v_mfma_f32_16x16x32_bf16 v[212:215], a[236:239], v[12:15], v[212:215]
  ds_read_b64_tr_b16 v[172:173], v225 offset:8928
  v_add_f32 v242, v242, v210
  v_mfma_f32_16x16x32_bf16 v[216:219], a[240:243], v[0:3], v[176:179]
  s_waitcnt lgkmcnt(1)
  v_exp_f32 v211, v211
  v_mfma_f32_16x16x32_bf16 v[216:219], a[244:247], v[4:7], v[216:219]
  v_add_f32 v242, v242, v211
  v_cvt_pk_bf16_f32 v223, v210, v211
  v_mfma_f32_16x16x32_bf16 v[216:219], a[248:251], v[8:11], v[216:219]
  v_exp_f32 v212, v212
  v_mfma_f32_16x16x32_bf16 v[216:219], a[252:255], v[12:15], v[216:219]
  ds_read_b64_tr_b16 v[174:175], v225 offset:9440
  v_add_f32 v236, v236, v212
  v_mfma_f32_16x16x32_bf16 a[192:195], v[112:115], v[220:223], 0
  v_exp_f32 v213, v213
  v_mfma_f32_16x16x32_bf16 a[196:199], v[116:119], v[220:223], 0
  v_add_f32 v236, v236, v213
  v_cvt_pk_bf16_f32 v232, v212, v213
  v_mfma_f32_16x16x32_bf16 a[200:203], v[120:123], v[220:223], 0
  v_exp_f32 v214, v214
  v_mfma_f32_16x16x32_bf16 a[204:207], v[124:127], v[220:223], 0
  v_add_f32 v236, v236, v214
  v_mfma_f32_16x16x32_bf16 a[208:211], v[128:131], v[220:223], 0
  v_exp_f32 v215, v215
  v_mfma_f32_16x16x32_bf16 a[212:215], v[132:135], v[220:223], 0
  v_add_f32 v236, v236, v215
  v_cvt_pk_bf16_f32 v233, v214, v215
  v_mfma_f32_16x16x32_bf16 a[216:219], v[136:139], v[220:223], 0
  v_exp_f32 v216, v216
  v_mfma_f32_16x16x32_bf16 a[220:223], v[140:143], v[220:223], 0
  v_mfma_f32_16x16x32_bf16 v[204:207], a[224:227], v[16:19], v[180:183]
  s_waitcnt vmcnt(1) lgkmcnt(0)
  s_barrier
  v_exp_f32 v217, v217
  v_mfma_f32_16x16x32_bf16 v[204:207], a[228:231], v[20:23], v[204:207]
  v_add_f32 v236, v236, v216
  v_add_f32 v236, v236, v217
  v_cvt_pk_bf16_f32 v234, v216, v217
  v_mfma_f32_16x16x32_bf16 v[204:207], a[232:235], v[24:27], v[204:207]
  v_exp_f32 v218, v218
  v_mfma_f32_16x16x32_bf16 v[204:207], a[236:239], v[28:31], v[204:207]
  ds_read_b64_tr_b16 v[112:113], v225 offset:17408
  v_add_f32 v236, v236, v218
  v_mfma_f32_16x16x32_bf16 v[208:211], a[240:243], v[16:19], v[180:183]
  v_exp_f32 v219, v219
  v_mfma_f32_16x16x32_bf16 v[208:211], a[244:247], v[20:23], v[208:211]
  v_add_f32 v236, v236, v219
  v_cvt_pk_bf16_f32 v235, v218, v219
  v_mfma_f32_16x16x32_bf16 v[208:211], a[248:251], v[24:27], v[208:211]
  s_add_u32 m0, s24, 8704
  v_exp_f32 v204, v204
  v_mfma_f32_16x16x32_bf16 v[208:211], a[252:255], v[28:31], v[208:211]
  buffer_load_dwordx4 v230, s[4:7], s25 offen offset:0 nt lds
  v_mfma_f32_16x16x32_bf16 a[0:3], v[144:147], v[232:235], a[0:3]
  v_exp_f32 v205, v205
  v_mfma_f32_16x16x32_bf16 a[4:7], v[148:151], v[232:235], a[4:7]
  v_add_f32 v237, v237, v204
  v_add_f32 v237, v237, v205
  v_cvt_pk_bf16_f32 v220, v204, v205
  v_mfma_f32_16x16x32_bf16 a[8:11], v[152:155], v[232:235], a[8:11]
  s_add_u32 m0, s24, 8736
  v_exp_f32 v206, v206
  v_mfma_f32_16x16x32_bf16 a[12:15], v[156:159], v[232:235], a[12:15]
  buffer_load_dwordx4 v230, s[4:7], s25 offen offset:1024 nt lds
  v_mfma_f32_16x16x32_bf16 a[16:19], v[160:163], v[232:235], a[16:19]
  v_exp_f32 v207, v207
  v_mfma_f32_16x16x32_bf16 a[20:23], v[164:167], v[232:235], a[20:23]
  v_add_f32 v237, v237, v206
  v_add_f32 v237, v237, v207
  v_cvt_pk_bf16_f32 v221, v206, v207
  v_mfma_f32_16x16x32_bf16 a[24:27], v[168:171], v[232:235], a[24:27]
  s_add_u32 m0, s24, 8768
  v_exp_f32 v208, v208
  v_mfma_f32_16x16x32_bf16 a[28:31], v[172:175], v[232:235], a[28:31]
  buffer_load_dwordx4 v230, s[4:7], s25 offen offset:2048 nt lds
  v_mfma_f32_16x16x32_bf16 v[212:215], a[224:227], v[32:35], v[184:187]
  v_exp_f32 v209, v209
  v_mfma_f32_16x16x32_bf16 v[212:215], a[228:231], v[36:39], v[212:215]
  v_add_f32 v237, v237, v208
  v_add_f32 v237, v237, v209
  v_cvt_pk_bf16_f32 v222, v208, v209
  v_mfma_f32_16x16x32_bf16 v[212:215], a[232:235], v[40:43], v[212:215]
  s_add_u32 m0, s24, 8800
  v_exp_f32 v210, v210
  v_mfma_f32_16x16x32_bf16 v[212:215], a[236:239], v[44:47], v[212:215]
  buffer_load_dwordx4 v230, s[4:7], s25 offen offset:3072 nt lds
  v_mfma_f32_16x16x32_bf16 v[216:219], a[240:243], v[32:35], v[184:187]
  s_add_u32 s25, s25, 4096
  v_exp_f32 v211, v211
  v_mfma_f32_16x16x32_bf16 v[216:219], a[244:247], v[36:39], v[216:219]
  v_add_f32 v237, v237, v210
  v_add_f32 v237, v237, v211
  v_cvt_pk_bf16_f32 v223, v210, v211
  v_mfma_f32_16x16x32_bf16 v[216:219], a[248:251], v[40:43], v[216:219]
  s_add_u32 m0, s24, 12928
  v_exp_f32 v212, v212
  v_mfma_f32_16x16x32_bf16 v[216:219], a[252:255], v[44:47], v[216:219]
  buffer_load_dwordx4 v230, s[4:7], s25 offen offset:0 nt lds
  v_mfma_f32_16x16x32_bf16 a[32:35], v[144:147], v[220:223], a[32:35]
  v_exp_f32 v213, v213
  v_mfma_f32_16x16x32_bf16 a[36:39], v[148:151], v[220:223], a[36:39]
  v_add_f32 v238, v238, v212
  v_add_f32 v238, v238, v213
  v_cvt_pk_bf16_f32 v232, v212, v213
  v_mfma_f32_16x16x32_bf16 a[40:43], v[152:155], v[220:223], a[40:43]
  s_add_u32 m0, s24, 12960
  v_exp_f32 v214, v214
  v_mfma_f32_16x16x32_bf16 a[44:47], v[156:159], v[220:223], a[44:47]
  buffer_load_dwordx4 v230, s[4:7], s25 offen offset:1024 nt lds
  v_mfma_f32_16x16x32_bf16 a[48:51], v[160:163], v[220:223], a[48:51]
  v_exp_f32 v215, v215
  v_mfma_f32_16x16x32_bf16 a[52:55], v[164:167], v[220:223], a[52:55]
  v_add_f32 v238, v238, v214
  v_add_f32 v238, v238, v215
  v_cvt_pk_bf16_f32 v233, v214, v215
  v_mfma_f32_16x16x32_bf16 a[56:59], v[168:171], v[220:223], a[56:59]
  s_add_u32 m0, s24, 12992
  v_exp_f32 v216, v216
  v_mfma_f32_16x16x32_bf16 a[60:63], v[172:175], v[220:223], a[60:63]
  buffer_load_dwordx4 v230, s[4:7], s25 offen offset:2048 nt lds
  v_mfma_f32_16x16x32_bf16 v[204:207], a[224:227], v[48:51], v[188:191]
  v_exp_f32 v217, v217
  v_mfma_f32_16x16x32_bf16 v[204:207], a[228:231], v[52:55], v[204:207]
  v_add_f32 v238, v238, v216
  v_add_f32 v238, v238, v217
  v_cvt_pk_bf16_f32 v234, v216, v217
  v_mfma_f32_16x16x32_bf16 v[204:207], a[232:235], v[56:59], v[204:207]
  s_add_u32 m0, s24, 13024
  v_exp_f32 v218, v218
  v_mfma_f32_16x16x32_bf16 v[204:207], a[236:239], v[60:63], v[204:207]
  buffer_load_dwordx4 v230, s[4:7], s25 offen offset:3072 nt lds
  v_mfma_f32_16x16x32_bf16 v[208:211], a[240:243], v[48:51], v[188:191]
  s_add_u32 s25, s25, 4096
  s_and_b32 s25, s25, 0x3ffff
  v_exp_f32 v219, v219
  v_mfma_f32_16x16x32_bf16 v[208:211], a[244:247], v[52:55], v[208:211]
  v_add_f32 v238, v238, v218
  v_add_f32 v238, v238, v219
  v_cvt_pk_bf16_f32 v235, v218, v219
  v_mfma_f32_16x16x32_bf16 v[208:211], a[248:251], v[56:59], v[208:211]
  v_exp_f32 v204, v204
  v_mfma_f32_16x16x32_bf16 v[208:211], a[252:255], v[60:63], v[208:211]
  ds_read_b64_tr_b16 v[114:115], v225 offset:17920
  v_add_f32 v239, v239, v204
  v_mfma_f32_16x16x32_bf16 a[64:67], v[144:147], v[232:235], a[64:67]
  v_exp_f32 v205, v205
  v_mfma_f32_16x16x32_bf16 a[68:71], v[148:151], v[232:235], a[68:71]
  v_add_f32 v239, v239, v205
  v_cvt_pk_bf16_f32 v220, v204, v205
  v_mfma_f32_16x16x32_bf16 a[72:75], v[152:155], v[232:235], a[72:75]
  v_exp_f32 v206, v206
  v_mfma_f32_16x16x32_bf16 a[76:79], v[156:159], v[232:235], a[76:79]
  ds_read_b64_tr_b16 v[116:117], v225 offset:17440
  v_add_f32 v239, v239, v206
  v_mfma_f32_16x16x32_bf16 a[80:83], v[160:163], v[232:235], a[80:83]
  v_exp_f32 v207, v207
  v_mfma_f32_16x16x32_bf16 a[84:87], v[164:167], v[232:235], a[84:87]
  v_add_f32 v239, v239, v207
  v_cvt_pk_bf16_f32 v221, v206, v207
  v_mfma_f32_16x16x32_bf16 a[88:91], v[168:171], v[232:235], a[88:91]
  v_exp_f32 v208, v208
  v_mfma_f32_16x16x32_bf16 a[92:95], v[172:175], v[232:235], a[92:95]
  ds_read_b64_tr_b16 v[118:119], v225 offset:17952
  v_add_f32 v239, v239, v208
  v_mfma_f32_16x16x32_bf16 v[212:215], a[224:227], v[64:67], v[192:195]
  v_exp_f32 v209, v209
  v_mfma_f32_16x16x32_bf16 v[212:215], a[228:231], v[68:71], v[212:215]
  v_add_f32 v239, v239, v209
  v_cvt_pk_bf16_f32 v222, v208, v209
  v_mfma_f32_16x16x32_bf16 v[212:215], a[232:235], v[72:75], v[212:215]
  v_exp_f32 v210, v210
  v_mfma_f32_16x16x32_bf16 v[212:215], a[236:239], v[76:79], v[212:215]
  ds_read_b64_tr_b16 v[120:121], v225 offset:17472
  v_add_f32 v239, v239, v210
  v_mfma_f32_16x16x32_bf16 v[216:219], a[240:243], v[64:67], v[192:195]
  v_exp_f32 v211, v211
  v_mfma_f32_16x16x32_bf16 v[216:219], a[244:247], v[68:71], v[216:219]
  v_add_f32 v239, v239, v211
  v_cvt_pk_bf16_f32 v223, v210, v211
  v_mfma_f32_16x16x32_bf16 v[216:219], a[248:251], v[72:75], v[216:219]
  v_exp_f32 v212, v212
  v_mfma_f32_16x16x32_bf16 v[216:219], a[252:255], v[76:79], v[216:219]
  ds_read_b64_tr_b16 v[122:123], v225 offset:17984
  v_add_f32 v240, v240, v212
  v_mfma_f32_16x16x32_bf16 a[96:99], v[144:147], v[220:223], a[96:99]
  v_exp_f32 v213, v213
  v_mfma_f32_16x16x32_bf16 a[100:103], v[148:151], v[220:223], a[100:103]
  v_add_f32 v240, v240, v213
  v_cvt_pk_bf16_f32 v232, v212, v213
  v_mfma_f32_16x16x32_bf16 a[104:107], v[152:155], v[220:223], a[104:107]
  v_exp_f32 v214, v214
  v_mfma_f32_16x16x32_bf16 a[108:111], v[156:159], v[220:223], a[108:111]
  ds_read_b64_tr_b16 v[124:125], v225 offset:17504
  v_add_f32 v240, v240, v214
  v_mfma_f32_16x16x32_bf16 a[112:115], v[160:163], v[220:223], a[112:115]
  v_exp_f32 v215, v215
  v_mfma_f32_16x16x32_bf16 a[116:119], v[164:167], v[220:223], a[116:119]
  v_add_f32 v240, v240, v215
  v_cvt_pk_bf16_f32 v233, v214, v215
  v_mfma_f32_16x16x32_bf16 a[120:123], v[168:171], v[220:223], a[120:123]
  v_exp_f32 v216, v216
  v_mfma_f32_16x16x32_bf16 a[124:127], v[172:175], v[220:223], a[124:127]
  ds_read_b64_tr_b16 v[126:127], v225 offset:18016
  v_add_f32 v240, v240, v216
  v_mfma_f32_16x16x32_bf16 v[204:207], a[224:227], v[80:83], v[196:199]
  v_exp_f32 v217, v217
  v_mfma_f32_16x16x32_bf16 v[204:207], a[228:231], v[84:87], v[204:207]
  v_add_f32 v240, v240, v217
  v_cvt_pk_bf16_f32 v234, v216, v217
  v_mfma_f32_16x16x32_bf16 v[204:207], a[232:235], v[88:91], v[204:207]
  v_exp_f32 v218, v218
  v_mfma_f32_16x16x32_bf16 v[204:207], a[236:239], v[92:95], v[204:207]
  ds_read_b64_tr_b16 v[128:129], v225 offset:17536
  v_add_f32 v240, v240, v218
  v_mfma_f32_16x16x32_bf16 v[208:211], a[240:243], v[80:83], v[196:199]
  v_exp_f32 v219, v219
  v_mfma_f32_16x16x32_bf16 v[208:211], a[244:247], v[84:87], v[208:211]
  v_add_f32 v240, v240, v219
  v_cvt_pk_bf16_f32 v235, v218, v219
  v_mfma_f32_16x16x32_bf16 v[208:211], a[248:251], v[88:91], v[208:211]
  v_exp_f32 v204, v204
  v_mfma_f32_16x16x32_bf16 v[208:211], a[252:255], v[92:95], v[208:211]
  ds_read_b64_tr_b16 v[130:131], v225 offset:18048
  v_add_f32 v241, v241, v204
  v_mfma_f32_16x16x32_bf16 a[128:131], v[144:147], v[232:235], a[128:131]
  v_exp_f32 v205, v205
  v_mfma_f32_16x16x32_bf16 a[132:135], v[148:151], v[232:235], a[132:135]
  ds_read_b64_tr_b16 v[132:133], v225 offset:17568
  v_add_f32 v241, v241, v205
  v_cvt_pk_bf16_f32 v220, v204, v205
  v_mfma_f32_16x16x32_bf16 a[136:139], v[152:155], v[232:235], a[136:139]
  v_exp_f32 v206, v206
  v_mfma_f32_16x16x32_bf16 a[140:143], v[156:159], v[232:235], a[140:143]
  ds_read_b64_tr_b16 v[134:135], v225 offset:18080
  v_add_f32 v241, v241, v206
  v_mfma_f32_16x16x32_bf16 a[144:147], v[160:163], v[232:235], a[144:147]
  v_exp_f32 v207, v207
  v_mfma_f32_16x16x32_bf16 a[148:151], v[164:167], v[232:235], a[148:151]
  ds_read_b64_tr_b16 v[136:137], v225 offset:17600
  v_add_f32 v241, v241, v207
  v_cvt_pk_bf16_f32 v221, v206, v207
  v_mfma_f32_16x16x32_bf16 a[152:155], v[168:171], v[232:235], a[152:155]
  v_exp_f32 v208, v208
  v_mfma_f32_16x16x32_bf16 a[156:159], v[172:175], v[232:235], a[156:159]
  ds_read_b64_tr_b16 v[138:139], v225 offset:18112
  v_add_f32 v241, v241, v208
  v_mfma_f32_16x16x32_bf16 v[212:215], a[224:227], v[96:99], v[200:203]
  v_exp_f32 v209, v209
  v_mfma_f32_16x16x32_bf16 v[212:215], a[228:231], v[100:103], v[212:215]
  ds_read_b128 a[224:227], v224 offset:17408
  v_add_f32 v241, v241, v209
  v_cvt_pk_bf16_f32 v222, v208, v209
  v_mfma_f32_16x16x32_bf16 v[212:215], a[232:235], v[104:107], v[212:215]
  v_exp_f32 v210, v210
  v_mfma_f32_16x16x32_bf16 v[212:215], a[236:239], v[108:111], v[212:215]
  ds_read_b128 a[228:231], v224 offset:17472
  v_add_f32 v241, v241, v210
  v_mfma_f32_16x16x32_bf16 v[216:219], a[240:243], v[96:99], v[200:203]
  v_exp_f32 v211, v211
  v_mfma_f32_16x16x32_bf16 v[216:219], a[244:247], v[100:103], v[216:219]
  ds_read_b128 a[232:235], v224 offset:17536
  v_add_f32 v241, v241, v211
  v_cvt_pk_bf16_f32 v223, v210, v211
  v_mfma_f32_16x16x32_bf16 v[216:219], a[248:251], v[104:107], v[216:219]
  v_exp_f32 v212, v212
  v_mfma_f32_16x16x32_bf16 v[216:219], a[252:255], v[108:111], v[216:219]
  ds_read_b128 a[236:239], v224 offset:17600
  v_add_f32 v242, v242, v212
  v_mfma_f32_16x16x32_bf16 a[160:163], v[144:147], v[220:223], a[160:163]
  v_exp_f32 v213, v213
  v_mfma_f32_16x16x32_bf16 a[164:167], v[148:151], v[220:223], a[164:167]
  ds_read_b128 a[240:243], v224 offset:17920
  v_add_f32 v242, v242, v213
  v_cvt_pk_bf16_f32 v232, v212, v213
  v_mfma_f32_16x16x32_bf16 a[168:171], v[152:155], v[220:223], a[168:171]
  v_exp_f32 v214, v214
  v_mfma_f32_16x16x32_bf16 a[172:175], v[156:159], v[220:223], a[172:175]
  ds_read_b128 a[244:247], v224 offset:17984
  v_add_f32 v242, v242, v214
  v_mfma_f32_16x16x32_bf16 a[176:179], v[160:163], v[220:223], a[176:179]
  v_exp_f32 v215, v215
  v_mfma_f32_16x16x32_bf16 a[180:183], v[164:167], v[220:223], a[180:183]
  ds_read_b128 a[248:251], v224 offset:18048
  v_add_f32 v242, v242, v215
  v_cvt_pk_bf16_f32 v233, v214, v215
  v_mfma_f32_16x16x32_bf16 a[184:187], v[168:171], v[220:223], a[184:187]
  s_waitcnt lgkmcnt(3)
  v_exp_f32 v216, v216
  v_mfma_f32_16x16x32_bf16 a[188:191], v[172:175], v[220:223], a[188:191]
  ds_read_b128 a[252:255], v224 offset:18112
  v_add_f32 v242, v242, v216
  v_mfma_f32_16x16x32_bf16 v[204:207], a[224:227], v[0:3], v[176:179]
  v_exp_f32 v217, v217
  v_mfma_f32_16x16x32_bf16 v[204:207], a[228:231], v[4:7], v[204:207]
  v_add_f32 v242, v242, v217
  v_cvt_pk_bf16_f32 v234, v216, v217
  v_mfma_f32_16x16x32_bf16 v[204:207], a[232:235], v[8:11], v[204:207]
  s_waitcnt lgkmcnt(2)
  v_exp_f32 v218, v218
  v_mfma_f32_16x16x32_bf16 v[204:207], a[236:239], v[12:15], v[204:207]
  ds_read_b64_tr_b16 v[140:141], v225 offset:17632
  v_add_f32 v242, v242, v218
  v_mfma_f32_16x16x32_bf16 v[208:211], a[240:243], v[0:3], v[176:179]
  s_waitcnt lgkmcnt(1)
  v_exp_f32 v219, v219
  v_mfma_f32_16x16x32_bf16 v[208:211], a[244:247], v[4:7], v[208:211]
  v_add_f32 v242, v242, v219
  v_cvt_pk_bf16_f32 v235, v218, v219
  v_mfma_f32_16x16x32_bf16 v[208:211], a[248:251], v[8:11], v[208:211]
  v_exp_f32 v204, v204
  v_mfma_f32_16x16x32_bf16 v[208:211], a[252:255], v[12:15], v[208:211]
  ds_read_b64_tr_b16 v[142:143], v225 offset:18144
  v_add_f32 v236, v236, v204
  v_mfma_f32_16x16x32_bf16 a[192:195], v[144:147], v[232:235], a[192:195]
  v_exp_f32 v205, v205
  v_mfma_f32_16x16x32_bf16 a[196:199], v[148:151], v[232:235], a[196:199]
  v_add_f32 v236, v236, v205
  v_cvt_pk_bf16_f32 v220, v204, v205
  v_mfma_f32_16x16x32_bf16 a[200:203], v[152:155], v[232:235], a[200:203]
  v_exp_f32 v206, v206
  v_mfma_f32_16x16x32_bf16 a[204:207], v[156:159], v[232:235], a[204:207]
  v_add_f32 v236, v236, v206
  v_mfma_f32_16x16x32_bf16 a[208:211], v[160:163], v[232:235], a[208:211]
  v_exp_f32 v207, v207
  v_mfma_f32_16x16x32_bf16 a[212:215], v[164:167], v[232:235], a[212:215]
  v_add_f32 v236, v236, v207
  v_cvt_pk_bf16_f32 v221, v206, v207
  v_mfma_f32_16x16x32_bf16 a[216:219], v[168:171], v[232:235], a[216:219]
  v_exp_f32 v208, v208
  v_mfma_f32_16x16x32_bf16 a[220:223], v[172:175], v[232:235], a[220:223]
  v_mfma_f32_16x16x32_bf16 v[212:215], a[224:227], v[16:19], v[180:183]
  s_waitcnt vmcnt(1) lgkmcnt(0)
  s_barrier
  v_exp_f32 v209, v209
  v_mfma_f32_16x16x32_bf16 v[212:215], a[228:231], v[20:23], v[212:215]
  v_add_f32 v236, v236, v208
  v_add_f32 v236, v236, v209
  v_cvt_pk_bf16_f32 v222, v208, v209
  v_mfma_f32_16x16x32_bf16 v[212:215], a[232:235], v[24:27], v[212:215]
  v_exp_f32 v210, v210
  v_mfma_f32_16x16x32_bf16 v[212:215], a[236:239], v[28:31], v[212:215]
  ds_read_b64_tr_b16 v[144:145], v225 offset:26112
  v_add_f32 v236, v236, v210
  v_mfma_f32_16x16x32_bf16 v[216:219], a[240:243], v[16:19], v[180:183]
  v_exp_f32 v211, v211
  v_mfma_f32_16x16x32_bf16 v[216:219], a[244:247], v[20:23], v[216:219]
  v_add_f32 v236, v236, v211
  v_cvt_pk_bf16_f32 v223, v210, v211
  v_mfma_f32_16x16x32_bf16 v[216:219], a[248:251], v[24:27], v[216:219]
  s_add_u32 m0, s24, 17408
  v_exp_f32 v212, v212
  v_mfma_f32_16x16x32_bf16 v[216:219], a[252:255], v[28:31], v[216:219]
  buffer_load_dwordx4 v230, s[4:7], s25 offen offset:0 nt lds
  v_mfma_f32_16x16x32_bf16 a[0:3], v[112:115], v[220:223], a[0:3]
  v_exp_f32 v213, v213
  v_mfma_f32_16x16x32_bf16 a[4:7], v[116:119], v[220:223], a[4:7]
  v_add_f32 v237, v237, v212
  v_add_f32 v237, v237, v213
  v_cvt_pk_bf16_f32 v232, v212, v213
  v_mfma_f32_16x16x32_bf16 a[8:11], v[120:123], v[220:223], a[8:11]
  s_add_u32 m0, s24, 17440
  v_exp_f32 v214, v214
  v_mfma_f32_16x16x32_bf16 a[12:15], v[124:127], v[220:223], a[12:15]
  buffer_load_dwordx4 v230, s[4:7], s25 offen offset:1024 nt lds
  v_mfma_f32_16x16x32_bf16 a[16:19], v[128:131], v[220:223], a[16:19]
  v_exp_f32 v215, v215
  v_mfma_f32_16x16x32_bf16 a[20:23], v[132:135], v[220:223], a[20:23]
  v_add_f32 v237, v237, v214
  v_add_f32 v237, v237, v215
  v_cvt_pk_bf16_f32 v233, v214, v215
  v_mfma_f32_16x16x32_bf16 a[24:27], v[136:139], v[220:223], a[24:27]
  s_add_u32 m0, s24, 17472
  v_exp_f32 v216, v216
  v_mfma_f32_16x16x32_bf16 a[28:31], v[140:143], v[220:223], a[28:31]
  buffer_load_dwordx4 v230, s[4:7], s25 offen offset:2048 nt lds
  v_mfma_f32_16x16x32_bf16 v[204:207], a[224:227], v[32:35], v[184:187]
  v_exp_f32 v217, v217
  v_mfma_f32_16x16x32_bf16 v[204:207], a[228:231], v[36:39], v[204:207]
  v_add_f32 v237, v237, v216
  v_add_f32 v237, v237, v217
  v_cvt_pk_bf16_f32 v234, v216, v217
  v_mfma_f32_16x16x32_bf16 v[204:207], a[232:235], v[40:43], v[204:207]
  s_add_u32 m0, s24, 17504
  v_exp_f32 v218, v218
  v_mfma_f32_16x16x32_bf16 v[204:207], a[236:239], v[44:47], v[204:207]
  buffer_load_dwordx4 v230, s[4:7], s25 offen offset:3072 nt lds
  v_mfma_f32_16x16x32_bf16 v[208:211], a[240:243], v[32:35], v[184:187]
  s_add_u32 s25, s25, 4096
  v_exp_f32 v219, v219
  v_mfma_f32_16x16x32_bf16 v[208:211], a[244:247], v[36:39], v[208:211]
  v_add_f32 v237, v237, v218
  v_add_f32 v237, v237, v219
  v_cvt_pk_bf16_f32 v235, v218, v219
  v_mfma_f32_16x16x32_bf16 v[208:211], a[248:251], v[40:43], v[208:211]
  s_add_u32 m0, s24, 21632
  v_exp_f32 v204, v204
  v_mfma_f32_16x16x32_bf16 v[208:211], a[252:255], v[44:47], v[208:211]
  buffer_load_dwordx4 v230, s[4:7], s25 offen offset:0 nt lds
  v_mfma_f32_16x16x32_bf16 a[32:35], v[112:115], v[232:235], a[32:35]
  v_exp_f32 v205, v205
  v_mfma_f32_16x16x32_bf16 a[36:39], v[116:119], v[232:235], a[36:39]
  v_add_f32 v238, v238, v204
  v_add_f32 v238, v238, v205
  v_cvt_pk_bf16_f32 v220, v204, v205
  v_mfma_f32_16x16x32_bf16 a[40:43], v[120:123], v[232:235], a[40:43]
  s_add_u32 m0, s24, 21664
  v_exp_f32 v206, v206
  v_mfma_f32_16x16x32_bf16 a[44:47], v[124:127], v[232:235], a[44:47]
  buffer_load_dwordx4 v230, s[4:7], s25 offen offset:1024 nt lds
  v_mfma_f32_16x16x32_bf16 a[48:51], v[128:131], v[232:235], a[48:51]
  v_exp_f32 v207, v207
  v_mfma_f32_16x16x32_bf16 a[52:55], v[132:135], v[232:235], a[52:55]
  v_add_f32 v238, v238, v206
  v_add_f32 v238, v238, v207
  v_cvt_pk_bf16_f32 v221, v206, v207
  v_mfma_f32_16x16x32_bf16 a[56:59], v[136:139], v[232:235], a[56:59]
  s_add_u32 m0, s24, 21696
  v_exp_f32 v208, v208
  v_mfma_f32_16x16x32_bf16 a[60:63], v[140:143], v[232:235], a[60:63]
  buffer_load_dwordx4 v230, s[4:7], s25 offen offset:2048 nt lds
  v_mfma_f32_16x16x32_bf16 v[212:215], a[224:227], v[48:51], v[188:191]
  v_exp_f32 v209, v209
  v_mfma_f32_16x16x32_bf16 v[212:215], a[228:231], v[52:55], v[212:215]
  v_add_f32 v238, v238, v208
  v_add_f32 v238, v238, v209
  v_cvt_pk_bf16_f32 v222, v208, v209
  v_mfma_f32_16x16x32_bf16 v[212:215], a[232:235], v[56:59], v[212:215]
  s_add_u32 m0, s24, 21728
  v_exp_f32 v210, v210
  v_mfma_f32_16x16x32_bf16 v[212:215], a[236:239], v[60:63], v[212:215]
  buffer_load_dwordx4 v230, s[4:7], s25 offen offset:3072 nt lds
  v_mfma_f32_16x16x32_bf16 v[216:219], a[240:243], v[48:51], v[188:191]
  s_add_u32 s25, s25, 4096
  s_and_b32 s25, s25, 0x3ffff
  v_exp_f32 v211, v211
  v_mfma_f32_16x16x32_bf16 v[216:219], a[244:247], v[52:55], v[216:219]
  v_add_f32 v238, v238, v210
  v_add_f32 v238, v238, v211
  v_cvt_pk_bf16_f32 v223, v210, v211
  v_mfma_f32_16x16x32_bf16 v[216:219], a[248:251], v[56:59], v[216:219]
  v_exp_f32 v212, v212
  v_mfma_f32_16x16x32_bf16 v[216:219], a[252:255], v[60:63], v[216:219]
  ds_read_b64_tr_b16 v[146:147], v225 offset:26624
  v_add_f32 v239, v239, v212
  v_mfma_f32_16x16x32_bf16 a[64:67], v[112:115], v[220:223], a[64:67]
  v_exp_f32 v213, v213
  v_mfma_f32_16x16x32_bf16 a[68:71], v[116:119], v[220:223], a[68:71]
  v_add_f32 v239, v239, v213
  v_cvt_pk_bf16_f32 v232, v212, v213
  v_mfma_f32_16x16x32_bf16 a[72:75], v[120:123], v[220:223], a[72:75]
  v_exp_f32 v214, v214
  v_mfma_f32_16x16x32_bf16 a[76:79], v[124:127], v[220:223], a[76:79]
  ds_read_b64_tr_b16 v[148:149], v225 offset:26144
  v_add_f32 v239, v239, v214
  v_mfma_f32_16x16x32_bf16 a[80:83], v[128:131], v[220:223], a[80:83]
  v_exp_f32 v215, v215
  v_mfma_f32_16x16x32_bf16 a[84:87], v[132:135], v[220:223], a[84:87]
  v_add_f32 v239, v239, v215
  v_cvt_pk_bf16_f32 v233, v214, v215
  v_mfma_f32_16x16x32_bf16 a[88:91], v[136:139], v[220:223], a[88:91]
  v_exp_f32 v216, v216
  v_mfma_f32_16x16x32_bf16 a[92:95], v[140:143], v[220:223], a[92:95]
  ds_read_b64_tr_b16 v[150:151], v225 offset:26656
  v_add_f32 v239, v239, v216
  v_mfma_f32_16x16x32_bf16 v[204:207], a[224:227], v[64:67], v[192:195]
  v_exp_f32 v217, v217
  v_mfma_f32_16x16x32_bf16 v[204:207], a[228:231], v[68:71], v[204:207]
  v_add_f32 v239, v239, v217
  v_cvt_pk_bf16_f32 v234, v216, v217
  v_mfma_f32_16x16x32_bf16 v[204:207], a[232:235], v[72:75], v[204:207]
  v_exp_f32 v218, v218
  v_mfma_f32_16x16x32_bf16 v[204:207], a[236:239], v[76:79], v[204:207]
  ds_read_b64_tr_b16 v[152:153], v225 offset:26176
  v_add_f32 v239, v239, v218
  v_mfma_f32_16x16x32_bf16 v[208:211], a[240:243], v[64:67], v[192:195]
  v_exp_f32 v219, v219
  v_mfma_f32_16x16x32_bf16 v[208:211], a[244:247], v[68:71], v[208:211]
  v_add_f32 v239, v239, v219
  v_cvt_pk_bf16_f32 v235, v218, v219
  v_mfma_f32_16x16x32_bf16 v[208:211], a[248:251], v[72:75], v[208:211]
  v_exp_f32 v204, v204
  v_mfma_f32_16x16x32_bf16 v[208:211], a[252:255], v[76:79], v[208:211]
  ds_read_b64_tr_b16 v[154:155], v225 offset:26688
  v_add_f32 v240, v240, v204
  v_mfma_f32_16x16x32_bf16 a[96:99], v[112:115], v[232:235], a[96:99]
  v_exp_f32 v205, v205
  v_mfma_f32_16x16x32_bf16 a[100:103], v[116:119], v[232:235], a[100:103]
  v_add_f32 v240, v240, v205
  v_cvt_pk_bf16_f32 v220, v204, v205
  v_mfma_f32_16x16x32_bf16 a[104:107], v[120:123], v[232:235], a[104:107]
  v_exp_f32 v206, v206
  v_mfma_f32_16x16x32_bf16 a[108:111], v[124:127], v[232:235], a[108:111]
  ds_read_b64_tr_b16 v[156:157], v225 offset:26208
  v_add_f32 v240, v240, v206
  v_mfma_f32_16x16x32_bf16 a[112:115], v[128:131], v[232:235], a[112:115]
  v_exp_f32 v207, v207
  v_mfma_f32_16x16x32_bf16 a[116:119], v[132:135], v[232:235], a[116:119]
  v_add_f32 v240, v240, v207
  v_cvt_pk_bf16_f32 v221, v206, v207
  v_mfma_f32_16x16x32_bf16 a[120:123], v[136:139], v[232:235], a[120:123]
  v_exp_f32 v208, v208
  v_mfma_f32_16x16x32_bf16 a[124:127], v[140:143], v[232:235], a[124:127]
  ds_read_b64_tr_b16 v[158:159], v225 offset:26720
  v_add_f32 v240, v240, v208
  v_mfma_f32_16x16x32_bf16 v[212:215], a[224:227], v[80:83], v[196:199]
  v_exp_f32 v209, v209
  v_mfma_f32_16x16x32_bf16 v[212:215], a[228:231], v[84:87], v[212:215]
  v_add_f32 v240, v240, v209
  v_cvt_pk_bf16_f32 v222, v208, v209
  v_mfma_f32_16x16x32_bf16 v[212:215], a[232:235], v[88:91], v[212:215]
  v_exp_f32 v210, v210
  v_mfma_f32_16x16x32_bf16 v[212:215], a[236:239], v[92:95], v[212:215]
  ds_read_b64_tr_b16 v[160:161], v225 offset:26240
  v_add_f32 v240, v240, v210
  v_mfma_f32_16x16x32_bf16 v[216:219], a[240:243], v[80:83], v[196:199]
  v_exp_f32 v211, v211
  v_mfma_f32_16x16x32_bf16 v[216:219], a[244:247], v[84:87], v[216:219]
  v_add_f32 v240, v240, v211
  v_cvt_pk_bf16_f32 v223, v210, v211
  v_mfma_f32_16x16x32_bf16 v[216:219], a[248:251], v[88:91], v[216:219]
  v_exp_f32 v212, v212
  v_mfma_f32_16x16x32_bf16 v[216:219], a[252:255], v[92:95], v[216:219]
  ds_read_b64_tr_b16 v[162:163], v225 offset:26752
  v_add_f32 v241, v241, v212
  v_mfma_f32_16x16x32_bf16 a[128:131], v[112:115], v[220:223], a[128:131]
  v_exp_f32 v213, v213
  v_mfma_f32_16x16x32_bf16 a[132:135], v[116:119], v[220:223], a[132:135]
  ds_read_b64_tr_b16 v[164:165], v225 offset:26272
  v_add_f32 v241, v241, v213
  v_cvt_pk_bf16_f32 v232, v212, v213
  v_mfma_f32_16x16x32_bf16 a[136:139], v[120:123], v[220:223], a[136:139]
  v_exp_f32 v214, v214
  v_mfma_f32_16x16x32_bf16 a[140:143], v[124:127], v[220:223], a[140:143]
  ds_read_b64_tr_b16 v[166:167], v225 offset:26784
  v_add_f32 v241, v241, v214
  v_mfma_f32_16x16x32_bf16 a[144:147], v[128:131], v[220:223], a[144:147]
  v_exp_f32 v215, v215
  v_mfma_f32_16x16x32_bf16 a[148:151], v[132:135], v[220:223], a[148:151]
  ds_read_b64_tr_b16 v[168:169], v225 offset:26304
  v_add_f32 v241, v241, v215
  v_cvt_pk_bf16_f32 v233, v214, v215
  v_mfma_f32_16x16x32_bf16 a[152:155], v[136:139], v[220:223], a[152:155]
  v_exp_f32 v216, v216
  v_mfma_f32_16x16x32_bf16 a[156:159], v[140:143], v[220:223], a[156:159]
  ds_read_b64_tr_b16 v[170:171], v225 offset:26816
  v_add_f32 v241, v241, v216
  v_mfma_f32_16x16x32_bf16 v[204:207], a[224:227], v[96:99], v[200:203]
  v_exp_f32 v217, v217
  v_mfma_f32_16x16x32_bf16 v[204:207], a[228:231], v[100:103], v[204:207]
  ds_read_b128 a[224:227], v224 offset:26112
  v_add_f32 v241, v241, v217
  v_cvt_pk_bf16_f32 v234, v216, v217
  v_mfma_f32_16x16x32_bf16 v[204:207], a[232:235], v[104:107], v[204:207]
  v_exp_f32 v218, v218
  v_mfma_f32_16x16x32_bf16 v[204:207], a[236:239], v[108:111], v[204:207]
  ds_read_b128 a[228:231], v224 offset:26176
  v_add_f32 v241, v241, v218
  v_mfma_f32_16x16x32_bf16 v[208:211], a[240:243], v[96:99], v[200:203]
  v_exp_f32 v219, v219
  v_mfma_f32_16x16x32_bf16 v[208:211], a[244:247], v[100:103], v[208:211]
  ds_read_b128 a[232:235], v224 offset:26240
  v_add_f32 v241, v241, v219
  v_cvt_pk_bf16_f32 v235, v218, v219
  v_mfma_f32_16x16x32_bf16 v[208:211], a[248:251], v[104:107], v[208:211]
  v_exp_f32 v204, v204
  v_mfma_f32_16x16x32_bf16 v[208:211], a[252:255], v[108:111], v[208:211]
  ds_read_b128 a[236:239], v224 offset:26304
  v_add_f32 v242, v242, v204
  v_mfma_f32_16x16x32_bf16 a[160:163], v[112:115], v[232:235], a[160:163]
  v_exp_f32 v205, v205
  v_mfma_f32_16x16x32_bf16 a[164:167], v[116:119], v[232:235], a[164:167]
  ds_read_b128 a[240:243], v224 offset:26624
  v_add_f32 v242, v242, v205
  v_cvt_pk_bf16_f32 v220, v204, v205
  v_mfma_f32_16x16x32_bf16 a[168:171], v[120:123], v[232:235], a[168:171]
  v_exp_f32 v206, v206
  v_mfma_f32_16x16x32_bf16 a[172:175], v[124:127], v[232:235], a[172:175]
  ds_read_b128 a[244:247], v224 offset:26688
  v_add_f32 v242, v242, v206
  v_mfma_f32_16x16x32_bf16 a[176:179], v[128:131], v[232:235], a[176:179]
  v_exp_f32 v207, v207
  v_mfma_f32_16x16x32_bf16 a[180:183], v[132:135], v[232:235], a[180:183]
  ds_read_b128 a[248:251], v224 offset:26752
  v_add_f32 v242, v242, v207
  v_cvt_pk_bf16_f32 v221, v206, v207
  v_mfma_f32_16x16x32_bf16 a[184:187], v[136:139], v[232:235], a[184:187]
  s_waitcnt lgkmcnt(3)
  v_exp_f32 v208, v208
  v_mfma_f32_16x16x32_bf16 a[188:191], v[140:143], v[232:235], a[188:191]
  ds_read_b128 a[252:255], v224 offset:26816
  v_add_f32 v242, v242, v208
  v_mfma_f32_16x16x32_bf16 v[212:215], a[224:227], v[0:3], v[176:179]
  v_exp_f32 v209, v209
  v_mfma_f32_16x16x32_bf16 v[212:215], a[228:231], v[4:7], v[212:215]
  v_add_f32 v242, v242, v209
  v_cvt_pk_bf16_f32 v222, v208, v209
  v_mfma_f32_16x16x32_bf16 v[212:215], a[232:235], v[8:11], v[212:215]
  s_waitcnt lgkmcnt(2)
  v_exp_f32 v210, v210
  v_mfma_f32_16x16x32_bf16 v[212:215], a[236:239], v[12:15], v[212:215]
  ds_read_b64_tr_b16 v[172:173], v225 offset:26336
  v_add_f32 v242, v242, v210
  v_mfma_f32_16x16x32_bf16 v[216:219], a[240:243], v[0:3], v[176:179]
  s_waitcnt lgkmcnt(1)
  v_exp_f32 v211, v211
  v_mfma_f32_16x16x32_bf16 v[216:219], a[244:247], v[4:7], v[216:219]
  v_add_f32 v242, v242, v211
  v_cvt_pk_bf16_f32 v223, v210, v211
  v_mfma_f32_16x16x32_bf16 v[216:219], a[248:251], v[8:11], v[216:219]
  v_exp_f32 v212, v212
  v_mfma_f32_16x16x32_bf16 v[216:219], a[252:255], v[12:15], v[216:219]
  ds_read_b64_tr_b16 v[174:175], v225 offset:26848
  v_add_f32 v236, v236, v212
  v_mfma_f32_16x16x32_bf16 a[192:195], v[112:115], v[220:223], a[192:195]
  v_exp_f32 v213, v213
  v_mfma_f32_16x16x32_bf16 a[196:199], v[116:119], v[220:223], a[196:199]
  v_add_f32 v236, v236, v213
  v_cvt_pk_bf16_f32 v232, v212, v213
  v_mfma_f32_16x16x32_bf16 a[200:203], v[120:123], v[220:223], a[200:203]
  v_exp_f32 v214, v214
  v_mfma_f32_16x16x32_bf16 a[204:207], v[124:127], v[220:223], a[204:207]
  v_add_f32 v236, v236, v214
  v_mfma_f32_16x16x32_bf16 a[208:211], v[128:131], v[220:223], a[208:211]
  v_exp_f32 v215, v215
  v_mfma_f32_16x16x32_bf16 a[212:215], v[132:135], v[220:223], a[212:215]
  v_add_f32 v236, v236, v215
  v_cvt_pk_bf16_f32 v233, v214, v215
  v_mfma_f32_16x16x32_bf16 a[216:219], v[136:139], v[220:223], a[216:219]
  v_exp_f32 v216, v216
  v_mfma_f32_16x16x32_bf16 a[220:223], v[140:143], v[220:223], a[220:223]
  v_mfma_f32_16x16x32_bf16 v[204:207], a[224:227], v[16:19], v[180:183]
  s_waitcnt vmcnt(1) lgkmcnt(0)
  s_barrier
  v_exp_f32 v217, v217
  v_mfma_f32_16x16x32_bf16 v[204:207], a[228:231], v[20:23], v[204:207]
  v_add_f32 v236, v236, v216
  v_add_f32 v236, v236, v217
  v_cvt_pk_bf16_f32 v234, v216, v217
  v_mfma_f32_16x16x32_bf16 v[204:207], a[232:235], v[24:27], v[204:207]
  v_exp_f32 v218, v218
  v_mfma_f32_16x16x32_bf16 v[204:207], a[236:239], v[28:31], v[204:207]
  ds_read_b64_tr_b16 v[112:113], v225 offset:0
  v_add_f32 v236, v236, v218
  v_mfma_f32_16x16x32_bf16 v[208:211], a[240:243], v[16:19], v[180:183]
  v_exp_f32 v219, v219
  v_mfma_f32_16x16x32_bf16 v[208:211], a[244:247], v[20:23], v[208:211]
  v_add_f32 v236, v236, v219
  v_cvt_pk_bf16_f32 v235, v218, v219
  v_mfma_f32_16x16x32_bf16 v[208:211], a[248:251], v[24:27], v[208:211]
  s_add_u32 m0, s24, 26112
  v_exp_f32 v204, v204
  v_mfma_f32_16x16x32_bf16 v[208:211], a[252:255], v[28:31], v[208:211]
  buffer_load_dwordx4 v230, s[4:7], s25 offen offset:0 nt lds
  v_mfma_f32_16x16x32_bf16 a[0:3], v[144:147], v[232:235], a[0:3]
  v_exp_f32 v205, v205
  v_mfma_f32_16x16x32_bf16 a[4:7], v[148:151], v[232:235], a[4:7]
  v_add_f32 v237, v237, v204
  v_add_f32 v237, v237, v205
  v_cvt_pk_bf16_f32 v220, v204, v205
  v_mfma_f32_16x16x32_bf16 a[8:11], v[152:155], v[232:235], a[8:11]
  s_add_u32 m0, s24, 26144
  v_exp_f32 v206, v206
  v_mfma_f32_16x16x32_bf16 a[12:15], v[156:159], v[232:235], a[12:15]
  buffer_load_dwordx4 v230, s[4:7], s25 offen offset:1024 nt lds
  v_mfma_f32_16x16x32_bf16 a[16:19], v[160:163], v[232:235], a[16:19]
  v_exp_f32 v207, v207
  v_mfma_f32_16x16x32_bf16 a[20:23], v[164:167], v[232:235], a[20:23]
  v_add_f32 v237, v237, v206
  v_add_f32 v237, v237, v207
  v_cvt_pk_bf16_f32 v221, v206, v207
  v_mfma_f32_16x16x32_bf16 a[24:27], v[168:171], v[232:235], a[24:27]
  s_add_u32 m0, s24, 26176
  v_exp_f32 v208, v208
  v_mfma_f32_16x16x32_bf16 a[28:31], v[172:175], v[232:235], a[28:31]
  buffer_load_dwordx4 v230, s[4:7], s25 offen offset:2048 nt lds
  v_mfma_f32_16x16x32_bf16 v[212:215], a[224:227], v[32:35], v[184:187]
  v_exp_f32 v209, v209
  v_mfma_f32_16x16x32_bf16 v[212:215], a[228:231], v[36:39], v[212:215]
  v_add_f32 v237, v237, v208
  v_add_f32 v237, v237, v209
  v_cvt_pk_bf16_f32 v222, v208, v209
  v_mfma_f32_16x16x32_bf16 v[212:215], a[232:235], v[40:43], v[212:215]
  s_add_u32 m0, s24, 26208
  v_exp_f32 v210, v210
  v_mfma_f32_16x16x32_bf16 v[212:215], a[236:239], v[44:47], v[212:215]
  buffer_load_dwordx4 v230, s[4:7], s25 offen offset:3072 nt lds
  v_mfma_f32_16x16x32_bf16 v[216:219], a[240:243], v[32:35], v[184:187]
  s_add_u32 s25, s25, 4096
  v_exp_f32 v211, v211
  v_mfma_f32_16x16x32_bf16 v[216:219], a[244:247], v[36:39], v[216:219]
  v_add_f32 v237, v237, v210
  v_add_f32 v237, v237, v211
  v_cvt_pk_bf16_f32 v223, v210, v211
  v_mfma_f32_16x16x32_bf16 v[216:219], a[248:251], v[40:43], v[216:219]
  s_add_u32 m0, s24, 30336
  v_exp_f32 v212, v212
  v_mfma_f32_16x16x32_bf16 v[216:219], a[252:255], v[44:47], v[216:219]
  buffer_load_dwordx4 v230, s[4:7], s25 offen offset:0 nt lds
  v_mfma_f32_16x16x32_bf16 a[32:35], v[144:147], v[220:223], a[32:35]
  v_exp_f32 v213, v213
  v_mfma_f32_16x16x32_bf16 a[36:39], v[148:151], v[220:223], a[36:39]
  v_add_f32 v238, v238, v212
  v_add_f32 v238, v238, v213
  v_cvt_pk_bf16_f32 v232, v212, v213
  v_mfma_f32_16x16x32_bf16 a[40:43], v[152:155], v[220:223], a[40:43]
  s_add_u32 m0, s24, 30368
  v_exp_f32 v214, v214
  v_mfma_f32_16x16x32_bf16 a[44:47], v[156:159], v[220:223], a[44:47]
  buffer_load_dwordx4 v230, s[4:7], s25 offen offset:1024 nt lds
  v_mfma_f32_16x16x32_bf16 a[48:51], v[160:163], v[220:223], a[48:51]
  v_exp_f32 v215, v215
  v_mfma_f32_16x16x32_bf16 a[52:55], v[164:167], v[220:223], a[52:55]
  v_add_f32 v238, v238, v214
  v_add_f32 v238, v238, v215
  v_cvt_pk_bf16_f32 v233, v214, v215
  v_mfma_f32_16x16x32_bf16 a[56:59], v[168:171], v[220:223], a[56:59]
  s_add_u32 m0, s24, 30400
  v_exp_f32 v216, v216
  v_mfma_f32_16x16x32_bf16 a[60:63], v[172:175], v[220:223], a[60:63]
  buffer_load_dwordx4 v230, s[4:7], s25 offen offset:2048 nt lds
  v_mfma_f32_16x16x32_bf16 v[204:207], a[224:227], v[48:51], v[188:191]
  v_exp_f32 v217, v217
  v_mfma_f32_16x16x32_bf16 v[204:207], a[228:231], v[52:55], v[204:207]
  v_add_f32 v238, v238, v216
  v_add_f32 v238, v238, v217
  v_cvt_pk_bf16_f32 v234, v216, v217
  v_mfma_f32_16x16x32_bf16 v[204:207], a[232:235], v[56:59], v[204:207]
  s_add_u32 m0, s24, 30432
  v_exp_f32 v218, v218
  v_mfma_f32_16x16x32_bf16 v[204:207], a[236:239], v[60:63], v[204:207]
  buffer_load_dwordx4 v230, s[4:7], s25 offen offset:3072 nt lds
  v_mfma_f32_16x16x32_bf16 v[208:211], a[240:243], v[48:51], v[188:191]
  s_add_u32 s25, s25, 4096
  s_and_b32 s25, s25, 0x3ffff
  v_exp_f32 v219, v219
  v_mfma_f32_16x16x32_bf16 v[208:211], a[244:247], v[52:55], v[208:211]
  v_add_f32 v238, v238, v218
  v_add_f32 v238, v238, v219
  v_cvt_pk_bf16_f32 v235, v218, v219
  v_mfma_f32_16x16x32_bf16 v[208:211], a[248:251], v[56:59], v[208:211]
  v_exp_f32 v204, v204
  v_mfma_f32_16x16x32_bf16 v[208:211], a[252:255], v[60:63], v[208:211]
  ds_read_b64_tr_b16 v[114:115], v225 offset:512
  v_add_f32 v239, v239, v204
  v_mfma_f32_16x16x32_bf16 a[64:67], v[144:147], v[232:235], a[64:67]
  v_exp_f32 v205, v205
  v_mfma_f32_16x16x32_bf16 a[68:71], v[148:151], v[232:235], a[68:71]
  v_add_f32 v239, v239, v205
  v_cvt_pk_bf16_f32 v220, v204, v205
  v_mfma_f32_16x16x32_bf16 a[72:75], v[152:155], v[232:235], a[72:75]
  v_exp_f32 v206, v206
  v_mfma_f32_16x16x32_bf16 a[76:79], v[156:159], v[232:235], a[76:79]
  ds_read_b64_tr_b16 v[116:117], v225 offset:32
  v_add_f32 v239, v239, v206
  v_mfma_f32_16x16x32_bf16 a[80:83], v[160:163], v[232:235], a[80:83]
  v_exp_f32 v207, v207
  v_mfma_f32_16x16x32_bf16 a[84:87], v[164:167], v[232:235], a[84:87]
  v_add_f32 v239, v239, v207
  v_cvt_pk_bf16_f32 v221, v206, v207
  v_mfma_f32_16x16x32_bf16 a[88:91], v[168:171], v[232:235], a[88:91]
  v_exp_f32 v208, v208
  v_mfma_f32_16x16x32_bf16 a[92:95], v[172:175], v[232:235], a[92:95]
  ds_read_b64_tr_b16 v[118:119], v225 offset:544
  v_add_f32 v239, v239, v208
  v_mfma_f32_16x16x32_bf16 v[212:215], a[224:227], v[64:67], v[192:195]
  v_exp_f32 v209, v209
  v_mfma_f32_16x16x32_bf16 v[212:215], a[228:231], v[68:71], v[212:215]
  v_add_f32 v239, v239, v209
  v_cvt_pk_bf16_f32 v222, v208, v209
  v_mfma_f32_16x16x32_bf16 v[212:215], a[232:235], v[72:75], v[212:215]
  v_exp_f32 v210, v210
  v_mfma_f32_16x16x32_bf16 v[212:215], a[236:239], v[76:79], v[212:215]
  ds_read_b64_tr_b16 v[120:121], v225 offset:64
  v_add_f32 v239, v239, v210
  v_mfma_f32_16x16x32_bf16 v[216:219], a[240:243], v[64:67], v[192:195]
  v_exp_f32 v211, v211
  v_mfma_f32_16x16x32_bf16 v[216:219], a[244:247], v[68:71], v[216:219]
  v_add_f32 v239, v239, v211
  v_cvt_pk_bf16_f32 v223, v210, v211
  v_mfma_f32_16x16x32_bf16 v[216:219], a[248:251], v[72:75], v[216:219]
  v_exp_f32 v212, v212
  v_mfma_f32_16x16x32_bf16 v[216:219], a[252:255], v[76:79], v[216:219]
  ds_read_b64_tr_b16 v[122:123], v225 offset:576
  v_add_f32 v240, v240, v212
  v_mfma_f32_16x16x32_bf16 a[96:99], v[144:147], v[220:223], a[96:99]
  v_exp_f32 v213, v213
  v_mfma_f32_16x16x32_bf16 a[100:103], v[148:151], v[220:223], a[100:103]
  v_add_f32 v240, v240, v213
  v_cvt_pk_bf16_f32 v232, v212, v213
  v_mfma_f32_16x16x32_bf16 a[104:107], v[152:155], v[220:223], a[104:107]
  v_exp_f32 v214, v214
  v_mfma_f32_16x16x32_bf16 a[108:111], v[156:159], v[220:223], a[108:111]
  ds_read_b64_tr_b16 v[124:125], v225 offset:96
  v_add_f32 v240, v240, v214
  v_mfma_f32_16x16x32_bf16 a[112:115], v[160:163], v[220:223], a[112:115]
  v_exp_f32 v215, v215
  v_mfma_f32_16x16x32_bf16 a[116:119], v[164:167], v[220:223], a[116:119]
  v_add_f32 v240, v240, v215
  v_cvt_pk_bf16_f32 v233, v214, v215
  v_mfma_f32_16x16x32_bf16 a[120:123], v[168:171], v[220:223], a[120:123]
  v_exp_f32 v216, v216
  v_mfma_f32_16x16x32_bf16 a[124:127], v[172:175], v[220:223], a[124:127]
  ds_read_b64_tr_b16 v[126:127], v225 offset:608
  v_add_f32 v240, v240, v216
  v_mfma_f32_16x16x32_bf16 v[204:207], a[224:227], v[80:83], v[196:199]
  v_exp_f32 v217, v217
  v_mfma_f32_16x16x32_bf16 v[204:207], a[228:231], v[84:87], v[204:207]
  v_add_f32 v240, v240, v217
  v_cvt_pk_bf16_f32 v234, v216, v217
  v_mfma_f32_16x16x32_bf16 v[204:207], a[232:235], v[88:91], v[204:207]
  v_exp_f32 v218, v218
  v_mfma_f32_16x16x32_bf16 v[204:207], a[236:239], v[92:95], v[204:207]
  ds_read_b64_tr_b16 v[128:129], v225 offset:128
  v_add_f32 v240, v240, v218
  v_mfma_f32_16x16x32_bf16 v[208:211], a[240:243], v[80:83], v[196:199]
  v_exp_f32 v219, v219
  v_mfma_f32_16x16x32_bf16 v[208:211], a[244:247], v[84:87], v[208:211]
  v_add_f32 v240, v240, v219
  v_cvt_pk_bf16_f32 v235, v218, v219
  v_mfma_f32_16x16x32_bf16 v[208:211], a[248:251], v[88:91], v[208:211]
  v_exp_f32 v204, v204
  v_mfma_f32_16x16x32_bf16 v[208:211], a[252:255], v[92:95], v[208:211]
  ds_read_b64_tr_b16 v[130:131], v225 offset:640
  v_add_f32 v241, v241, v204
  v_mfma_f32_16x16x32_bf16 a[128:131], v[144:147], v[232:235], a[128:131]
  v_exp_f32 v205, v205
  v_mfma_f32_16x16x32_bf16 a[132:135], v[148:151], v[232:235], a[132:135]
  ds_read_b64_tr_b16 v[132:133], v225 offset:160
  v_add_f32 v241, v241, v205
  v_cvt_pk_bf16_f32 v220, v204, v205
  v_mfma_f32_16x16x32_bf16 a[136:139], v[152:155], v[232:235], a[136:139]
  v_exp_f32 v206, v206
  v_mfma_f32_16x16x32_bf16 a[140:143], v[156:159], v[232:235], a[140:143]
  ds_read_b64_tr_b16 v[134:135], v225 offset:672
  v_add_f32 v241, v241, v206
  v_mfma_f32_16x16x32_bf16 a[144:147], v[160:163], v[232:235], a[144:147]
  v_exp_f32 v207, v207
  v_mfma_f32_16x16x32_bf16 a[148:151], v[164:167], v[232:235], a[148:151]
  ds_read_b64_tr_b16 v[136:137], v225 offset:192
  v_add_f32 v241, v241, v207
  v_cvt_pk_bf16_f32 v221, v206, v207
  v_mfma_f32_16x16x32_bf16 a[152:155], v[168:171], v[232:235], a[152:155]
  v_exp_f32 v208, v208
  v_mfma_f32_16x16x32_bf16 a[156:159], v[172:175], v[232:235], a[156:159]
  ds_read_b64_tr_b16 v[138:139], v225 offset:704
  v_add_f32 v241, v241, v208
  v_mfma_f32_16x16x32_bf16 v[212:215], a[224:227], v[96:99], v[200:203]
  v_exp_f32 v209, v209
  v_mfma_f32_16x16x32_bf16 v[212:215], a[228:231], v[100:103], v[212:215]
  ds_read_b128 a[224:227], v224 offset:0
  v_add_f32 v241, v241, v209
  v_cvt_pk_bf16_f32 v222, v208, v209
  v_mfma_f32_16x16x32_bf16 v[212:215], a[232:235], v[104:107], v[212:215]
  v_exp_f32 v210, v210
  v_mfma_f32_16x16x32_bf16 v[212:215], a[236:239], v[108:111], v[212:215]
  ds_read_b128 a[228:231], v224 offset:64
  v_add_f32 v241, v241, v210
  v_mfma_f32_16x16x32_bf16 v[216:219], a[240:243], v[96:99], v[200:203]
  v_exp_f32 v211, v211
  v_mfma_f32_16x16x32_bf16 v[216:219], a[244:247], v[100:103], v[216:219]
  ds_read_b128 a[232:235], v224 offset:128
  v_add_f32 v241, v241, v211
  v_cvt_pk_bf16_f32 v223, v210, v211
  v_mfma_f32_16x16x32_bf16 v[216:219], a[248:251], v[104:107], v[216:219]
  v_exp_f32 v212, v212
  v_mfma_f32_16x16x32_bf16 v[216:219], a[252:255], v[108:111], v[216:219]
  ds_read_b128 a[236:239], v224 offset:192
  v_add_f32 v242, v242, v212
  v_mfma_f32_16x16x32_bf16 a[160:163], v[144:147], v[220:223], a[160:163]
  v_exp_f32 v213, v213
  v_mfma_f32_16x16x32_bf16 a[164:167], v[148:151], v[220:223], a[164:167]
  ds_read_b128 a[240:243], v224 offset:512
  v_add_f32 v242, v242, v213
  v_cvt_pk_bf16_f32 v232, v212, v213
  v_mfma_f32_16x16x32_bf16 a[168:171], v[152:155], v[220:223], a[168:171]
  v_exp_f32 v214, v214
  v_mfma_f32_16x16x32_bf16 a[172:175], v[156:159], v[220:223], a[172:175]
  ds_read_b128 a[244:247], v224 offset:576
  v_add_f32 v242, v242, v214
  v_mfma_f32_16x16x32_bf16 a[176:179], v[160:163], v[220:223], a[176:179]
  v_exp_f32 v215, v215
  v_mfma_f32_16x16x32_bf16 a[180:183], v[164:167], v[220:223], a[180:183]
  ds_read_b128 a[248:251], v224 offset:640
  v_add_f32 v242, v242, v215
  v_cvt_pk_bf16_f32 v233, v214, v215
  v_mfma_f32_16x16x32_bf16 a[184:187], v[168:171], v[220:223], a[184:187]
  s_waitcnt lgkmcnt(3)
  v_exp_f32 v216, v216
  v_mfma_f32_16x16x32_bf16 a[188:191], v[172:175], v[220:223], a[188:191]
  ds_read_b128 a[252:255], v224 offset:704
  v_add_f32 v242, v242, v216
  v_mfma_f32_16x16x32_bf16 v[204:207], a[224:227], v[0:3], v[176:179]
  v_exp_f32 v217, v217
  v_mfma_f32_16x16x32_bf16 v[204:207], a[228:231], v[4:7], v[204:207]
  v_add_f32 v242, v242, v217
  v_cvt_pk_bf16_f32 v234, v216, v217
  v_mfma_f32_16x16x32_bf16 v[204:207], a[232:235], v[8:11], v[204:207]
  s_waitcnt lgkmcnt(2)
  v_exp_f32 v218, v218
  v_mfma_f32_16x16x32_bf16 v[204:207], a[236:239], v[12:15], v[204:207]
  ds_read_b64_tr_b16 v[140:141], v225 offset:224
  v_add_f32 v242, v242, v218
  v_mfma_f32_16x16x32_bf16 v[208:211], a[240:243], v[0:3], v[176:179]
  s_waitcnt lgkmcnt(1)
  v_exp_f32 v219, v219
  v_mfma_f32_16x16x32_bf16 v[208:211], a[244:247], v[4:7], v[208:211]
  v_add_f32 v242, v242, v219
  v_cvt_pk_bf16_f32 v235, v218, v219
  v_mfma_f32_16x16x32_bf16 v[208:211], a[248:251], v[8:11], v[208:211]
  v_exp_f32 v204, v204
  v_mfma_f32_16x16x32_bf16 v[208:211], a[252:255], v[12:15], v[208:211]
  ds_read_b64_tr_b16 v[142:143], v225 offset:736
  v_add_f32 v236, v236, v204
  v_mfma_f32_16x16x32_bf16 a[192:195], v[144:147], v[232:235], a[192:195]
  v_exp_f32 v205, v205
  v_mfma_f32_16x16x32_bf16 a[196:199], v[148:151], v[232:235], a[196:199]
  v_add_f32 v236, v236, v205
  v_cvt_pk_bf16_f32 v220, v204, v205
  v_mfma_f32_16x16x32_bf16 a[200:203], v[152:155], v[232:235], a[200:203]
  v_exp_f32 v206, v206
  v_mfma_f32_16x16x32_bf16 a[204:207], v[156:159], v[232:235], a[204:207]
  v_add_f32 v236, v236, v206
  v_mfma_f32_16x16x32_bf16 a[208:211], v[160:163], v[232:235], a[208:211]
  s_mov_b32 s30, 6
  v_exp_f32 v207, v207
  v_mfma_f32_16x16x32_bf16 a[212:215], v[164:167], v[232:235], a[212:215]
  v_add_f32 v236, v236, v207
  v_cvt_pk_bf16_f32 v221, v206, v207
  v_mfma_f32_16x16x32_bf16 a[216:219], v[168:171], v[232:235], a[216:219]
  v_exp_f32 v208, v208
  v_mfma_f32_16x16x32_bf16 a[220:223], v[172:175], v[232:235], a[220:223]
.p2align 3
A_AL:
  v_mfma_f32_16x16x32_bf16 v[212:215], a[224:227], v[16:19], v[180:183]
  s_waitcnt vmcnt(1) lgkmcnt(0)
  s_barrier
  v_exp_f32 v209, v209
  v_mfma_f32_16x16x32_bf16 v[212:215], a[228:231], v[20:23], v[212:215]
  v_add_f32 v236, v236, v208
  v_add_f32 v236, v236, v209
  v_cvt_pk_bf16_f32 v222, v208, v209
  v_mfma_f32_16x16x32_bf16 v[212:215], a[232:235], v[24:27], v[212:215]
  v_exp_f32 v210, v210
  v_mfma_f32_16x16x32_bf16 v[212:215], a[236:239], v[28:31], v[212:215]
  ds_read_b64_tr_b16 v[144:145], v225 offset:8704
  v_add_f32 v236, v236, v210
  v_mfma_f32_16x16x32_bf16 v[216:219], a[240:243], v[16:19], v[180:183]
  v_exp_f32 v211, v211
  v_mfma_f32_16x16x32_bf16 v[216:219], a[244:247], v[20:23], v[216:219]
  v_add_f32 v236, v236, v211
  v_cvt_pk_bf16_f32 v223, v210, v211
  v_mfma_f32_16x16x32_bf16 v[216:219], a[248:251], v[24:27], v[216:219]
  s_add_u32 m0, s24, 0
  v_exp_f32 v212, v212
  v_mfma_f32_16x16x32_bf16 v[216:219], a[252:255], v[28:31], v[216:219]
  buffer_load_dwordx4 v230, s[4:7], s25 offen offset:0 nt lds
  v_mfma_f32_16x16x32_bf16 a[0:3], v[112:115], v[220:223], a[0:3]
  v_exp_f32 v213, v213
  v_mfma_f32_16x16x32_bf16 a[4:7], v[116:119], v[220:223], a[4:7]
  v_add_f32 v237, v237, v212
  v_add_f32 v237, v237, v213
  v_cvt_pk_bf16_f32 v232, v212, v213
  v_mfma_f32_16x16x32_bf16 a[8:11], v[120:123], v[220:223], a[8:11]
  s_add_u32 m0, s24, 32
  v_exp_f32 v214, v214
  v_mfma_f32_16x16x32_bf16 a[12:15], v[124:127], v[220:223], a[12:15]
  buffer_load_dwordx4 v230, s[4:7], s25 offen offset:1024 nt lds
  v_mfma_f32_16x16x32_bf16 a[16:19], v[128:131], v[220:223], a[16:19]
  v_exp_f32 v215, v215
  v_mfma_f32_16x16x32_bf16 a[20:23], v[132:135], v[220:223], a[20:23]
  v_add_f32 v237, v237, v214
  v_add_f32 v237, v237, v215
  v_cvt_pk_bf16_f32 v233, v214, v215
  v_mfma_f32_16x16x32_bf16 a[24:27], v[136:139], v[220:223], a[24:27]
  s_add_u32 m0, s24, 64
  v_exp_f32 v216, v216
  v_mfma_f32_16x16x32_bf16 a[28:31], v[140:143], v[220:223], a[28:31]
  buffer_load_dwordx4 v230, s[4:7], s25 offen offset:2048 nt lds
  v_mfma_f32_16x16x32_bf16 v[204:207], a[224:227], v[32:35], v[184:187]
  v_exp_f32 v217, v217
  v_mfma_f32_16x16x32_bf16 v[204:207], a[228:231], v[36:39], v[204:207]
  v_add_f32 v237, v237, v216
  v_add_f32 v237, v237, v217
  v_cvt_pk_bf16_f32 v234, v216, v217
  v_mfma_f32_16x16x32_bf16 v[204:207], a[232:235], v[40:43], v[204:207]
  s_add_u32 m0, s24, 96
  v_exp_f32 v218, v218
  v_mfma_f32_16x16x32_bf16 v[204:207], a[236:239], v[44:47], v[204:207]
  buffer_load_dwordx4 v230, s[4:7], s25 offen offset:3072 nt lds
  v_mfma_f32_16x16x32_bf16 v[208:211], a[240:243], v[32:35], v[184:187]
  s_add_u32 s25, s25, 4096
  v_exp_f32 v219, v219
  v_mfma_f32_16x16x32_bf16 v[208:211], a[244:247], v[36:39], v[208:211]
  v_add_f32 v237, v237, v218
  v_add_f32 v237, v237, v219
  v_cvt_pk_bf16_f32 v235, v218, v219
  v_mfma_f32_16x16x32_bf16 v[208:211], a[248:251], v[40:43], v[208:211]
  s_add_u32 m0, s24, 4224
  v_exp_f32 v204, v204
  v_mfma_f32_16x16x32_bf16 v[208:211], a[252:255], v[44:47], v[208:211]
  buffer_load_dwordx4 v230, s[4:7], s25 offen offset:0 nt lds
  v_mfma_f32_16x16x32_bf16 a[32:35], v[112:115], v[232:235], a[32:35]
  v_exp_f32 v205, v205
  v_mfma_f32_16x16x32_bf16 a[36:39], v[116:119], v[232:235], a[36:39]
  v_add_f32 v238, v238, v204
  v_add_f32 v238, v238, v205
  v_cvt_pk_bf16_f32 v220, v204, v205
  v_mfma_f32_16x16x32_bf16 a[40:43], v[120:123], v[232:235], a[40:43]
  s_add_u32 m0, s24, 4256
  v_exp_f32 v206, v206
  v_mfma_f32_16x16x32_bf16 a[44:47], v[124:127], v[232:235], a[44:47]
  buffer_load_dwordx4 v230, s[4:7], s25 offen offset:1024 nt lds
  v_mfma_f32_16x16x32_bf16 a[48:51], v[128:131], v[232:235], a[48:51]
  v_exp_f32 v207, v207
  v_mfma_f32_16x16x32_bf16 a[52:55], v[132:135], v[232:235], a[52:55]
  v_add_f32 v238, v238, v206
  v_add_f32 v238, v238, v207
  v_cvt_pk_bf16_f32 v221, v206, v207
  v_mfma_f32_16x16x32_bf16 a[56:59], v[136:139], v[232:235], a[56:59]
  s_add_u32 m0, s24, 4288
  v_exp_f32 v208, v208
  v_mfma_f32_16x16x32_bf16 a[60:63], v[140:143], v[232:235], a[60:63]
  buffer_load_dwordx4 v230, s[4:7], s25 offen offset:2048 nt lds
  v_mfma_f32_16x16x32_bf16 v[212:215], a[224:227], v[48:51], v[188:191]
  v_exp_f32 v209, v209
  v_mfma_f32_16x16x32_bf16 v[212:215], a[228:231], v[52:55], v[212:215]
  v_add_f32 v238, v238, v208
  v_add_f32 v238, v238, v209
  v_cvt_pk_bf16_f32 v222, v208, v209
  v_mfma_f32_16x16x32_bf16 v[212:215], a[232:235], v[56:59], v[212:215]
  s_add_u32 m0, s24, 4320
  v_exp_f32 v210, v210
  v_mfma_f32_16x16x32_bf16 v[212:215], a[236:239], v[60:63], v[212:215]
  buffer_load_dwordx4 v230, s[4:7], s25 offen offset:3072 nt lds
  v_mfma_f32_16x16x32_bf16 v[216:219], a[240:243], v[48:51], v[188:191]
  s_add_u32 s25, s25, 4096
  s_and_b32 s25, s25, 0x3ffff
  v_exp_f32 v211, v211
  v_mfma_f32_16x16x32_bf16 v[216:219], a[244:247], v[52:55], v[216:219]
  v_add_f32 v238, v238, v210
  v_add_f32 v238, v238, v211
  v_cvt_pk_bf16_f32 v223, v210, v211
  v_mfma_f32_16x16x32_bf16 v[216:219], a[248:251], v[56:59], v[216:219]
  v_exp_f32 v212, v212
  v_mfma_f32_16x16x32_bf16 v[216:219], a[252:255], v[60:63], v[216:219]
  ds_read_b64_tr_b16 v[146:147], v225 offset:9216
  v_add_f32 v239, v239, v212
  v_mfma_f32_16x16x32_bf16 a[64:67], v[112:115], v[220:223], a[64:67]
  v_exp_f32 v213, v213
  v_mfma_f32_16x16x32_bf16 a[68:71], v[116:119], v[220:223], a[68:71]
  v_add_f32 v239, v239, v213
  v_cvt_pk_bf16_f32 v232, v212, v213
  v_mfma_f32_16x16x32_bf16 a[72:75], v[120:123], v[220:223], a[72:75]
  v_exp_f32 v214, v214
  v_mfma_f32_16x16x32_bf16 a[76:79], v[124:127], v[220:223], a[76:79]
  ds_read_b64_tr_b16 v[148:149], v225 offset:8736
  v_add_f32 v239, v239, v214
  v_mfma_f32_16x16x32_bf16 a[80:83], v[128:131], v[220:223], a[80:83]
  v_exp_f32 v215, v215
  v_mfma_f32_16x16x32_bf16 a[84:87], v[132:135], v[220:223], a[84:87]
  v_add_f32 v239, v239, v215
  v_cvt_pk_bf16_f32 v233, v214, v215
  v_mfma_f32_16x16x32_bf16 a[88:91], v[136:139], v[220:223], a[88:91]
  v_exp_f32 v216, v216
  v_mfma_f32_16x16x32_bf16 a[92:95], v[140:143], v[220:223], a[92:95]
  ds_read_b64_tr_b16 v[150:151], v225 offset:9248
  v_add_f32 v239, v239, v216
  v_mfma_f32_16x16x32_bf16 v[204:207], a[224:227], v[64:67], v[192:195]
  v_exp_f32 v217, v217
  v_mfma_f32_16x16x32_bf16 v[204:207], a[228:231], v[68:71], v[204:207]
  v_add_f32 v239, v239, v217
  v_cvt_pk_bf16_f32 v234, v216, v217
  v_mfma_f32_16x16x32_bf16 v[204:207], a[232:235], v[72:75], v[204:207]
  v_exp_f32 v218, v218
  v_mfma_f32_16x16x32_bf16 v[204:207], a[236:239], v[76:79], v[204:207]
  ds_read_b64_tr_b16 v[152:153], v225 offset:8768
  v_add_f32 v239, v239, v218
  v_mfma_f32_16x16x32_bf16 v[208:211], a[240:243], v[64:67], v[192:195]
  v_exp_f32 v219, v219
  v_mfma_f32_16x16x32_bf16 v[208:211], a[244:247], v[68:71], v[208:211]
  v_add_f32 v239, v239, v219
  v_cvt_pk_bf16_f32 v235, v218, v219
  v_mfma_f32_16x16x32_bf16 v[208:211], a[248:251], v[72:75], v[208:211]
  v_exp_f32 v204, v204
  v_mfma_f32_16x16x32_bf16 v[208:211], a[252:255], v[76:79], v[208:211]
  ds_read_b64_tr_b16 v[154:155], v225 offset:9280
  v_add_f32 v240, v240, v204
  v_mfma_f32_16x16x32_bf16 a[96:99], v[112:115], v[232:235], a[96:99]
  v_exp_f32 v205, v205
  v_mfma_f32_16x16x32_bf16 a[100:103], v[116:119], v[232:235], a[100:103]
  v_add_f32 v240, v240, v205
  v_cvt_pk_bf16_f32 v220, v204, v205
  v_mfma_f32_16x16x32_bf16 a[104:107], v[120:123], v[232:235], a[104:107]
  v_exp_f32 v206, v206
  v_mfma_f32_16x16x32_bf16 a[108:111], v[124:127], v[232:235], a[108:111]
  ds_read_b64_tr_b16 v[156:157], v225 offset:8800
  v_add_f32 v240, v240, v206
  v_mfma_f32_16x16x32_bf16 a[112:115], v[128:131], v[232:235], a[112:115]
  v_exp_f32 v207, v207
  v_mfma_f32_16x16x32_bf16 a[116:119], v[132:135], v[232:235], a[116:119]
  v_add_f32 v240, v240, v207
  v_cvt_pk_bf16_f32 v221, v206, v207
  v_mfma_f32_16x16x32_bf16 a[120:123], v[136:139], v[232:235], a[120:123]
  v_exp_f32 v208, v208
  v_mfma_f32_16x16x32_bf16 a[124:127], v[140:143], v[232:235], a[124:127]
  ds_read_b64_tr_b16 v[158:159], v225 offset:9312
  v_add_f32 v240, v240, v208
  v_mfma_f32_16x16x32_bf16 v[212:215], a[224:227], v[80:83], v[196:199]
  v_exp_f32 v209, v209
  v_mfma_f32_16x16x32_bf16 v[212:215], a[228:231], v[84:87], v[212:215]
  v_add_f32 v240, v240, v209
  v_cvt_pk_bf16_f32 v222, v208, v209
  v_mfma_f32_16x16x32_bf16 v[212:215], a[232:235], v[88:91], v[212:215]
  v_exp_f32 v210, v210
  v_mfma_f32_16x16x32_bf16 v[212:215], a[236:239], v[92:95], v[212:215]
  ds_read_b64_tr_b16 v[160:161], v225 offset:8832
  v_add_f32 v240, v240, v210
  v_mfma_f32_16x16x32_bf16 v[216:219], a[240:243], v[80:83], v[196:199]
  v_exp_f32 v211, v211
  v_mfma_f32_16x16x32_bf16 v[216:219], a[244:247], v[84:87], v[216:219]
  v_add_f32 v240, v240, v211
  v_cvt_pk_bf16_f32 v223, v210, v211
  v_mfma_f32_16x16x32_bf16 v[216:219], a[248:251], v[88:91], v[216:219]
  v_exp_f32 v212, v212
  v_mfma_f32_16x16x32_bf16 v[216:219], a[252:255], v[92:95], v[216:219]
  ds_read_b64_tr_b16 v[162:163], v225 offset:9344
  v_add_f32 v241, v241, v212
  v_mfma_f32_16x16x32_bf16 a[128:131], v[112:115], v[220:223], a[128:131]
  v_exp_f32 v213, v213
  v_mfma_f32_16x16x32_bf16 a[132:135], v[116:119], v[220:223], a[132:135]
  ds_read_b64_tr_b16 v[164:165], v225 offset:8864
  v_add_f32 v241, v241, v213
  v_cvt_pk_bf16_f32 v232, v212, v213
  v_mfma_f32_16x16x32_bf16 a[136:139], v[120:123], v[220:223], a[136:139]
  v_exp_f32 v214, v214
  v_mfma_f32_16x16x32_bf16 a[140:143], v[124:127], v[220:223], a[140:143]
  ds_read_b64_tr_b16 v[166:167], v225 offset:9376
  v_add_f32 v241, v241, v214
  v_mfma_f32_16x16x32_bf16 a[144:147], v[128:131], v[220:223], a[144:147]
  v_exp_f32 v215, v215
  v_mfma_f32_16x16x32_bf16 a[148:151], v[132:135], v[220:223], a[148:151]
  ds_read_b64_tr_b16 v[168:169], v225 offset:8896
  v_add_f32 v241, v241, v215
  v_cvt_pk_bf16_f32 v233, v214, v215
  v_mfma_f32_16x16x32_bf16 a[152:155], v[136:139], v[220:223], a[152:155]
  v_exp_f32 v216, v216
  v_mfma_f32_16x16x32_bf16 a[156:159], v[140:143], v[220:223], a[156:159]
  ds_read_b64_tr_b16 v[170:171], v225 offset:9408
  v_add_f32 v241, v241, v216
  v_mfma_f32_16x16x32_bf16 v[204:207], a[224:227], v[96:99], v[200:203]
  v_exp_f32 v217, v217
  v_mfma_f32_16x16x32_bf16 v[204:207], a[228:231], v[100:103], v[204:207]
  ds_read_b128 a[224:227], v224 offset:8704
  v_add_f32 v241, v241, v217
  v_cvt_pk_bf16_f32 v234, v216, v217
  v_mfma_f32_16x16x32_bf16 v[204:207], a[232:235], v[104:107], v[204:207]
  v_exp_f32 v218, v218
  v_mfma_f32_16x16x32_bf16 v[204:207], a[236:239], v[108:111], v[204:207]
  ds_read_b128 a[228:231], v224 offset:8768
  v_add_f32 v241, v241, v218
  v_mfma_f32_16x16x32_bf16 v[208:211], a[240:243], v[96:99], v[200:203]
  v_exp_f32 v219, v219
  v_mfma_f32_16x16x32_bf16 v[208:211], a[244:247], v[100:103], v[208:211]
  ds_read_b128 a[232:235], v224 offset:8832
  v_add_f32 v241, v241, v219
  v_cvt_pk_bf16_f32 v235, v218, v219
  v_mfma_f32_16x16x32_bf16 v[208:211], a[248:251], v[104:107], v[208:211]
  v_exp_f32 v204, v204
  v_mfma_f32_16x16x32_bf16 v[208:211], a[252:255], v[108:111], v[208:211]
  ds_read_b128 a[236:239], v224 offset:8896
  v_add_f32 v242, v242, v204
  v_mfma_f32_16x16x32_bf16 a[160:163], v[112:115], v[232:235], a[160:163]
  v_exp_f32 v205, v205
  v_mfma_f32_16x16x32_bf16 a[164:167], v[116:119], v[232:235], a[164:167]
  ds_read_b128 a[240:243], v224 offset:9216
  v_add_f32 v242, v242, v205
  v_cvt_pk_bf16_f32 v220, v204, v205
  v_mfma_f32_16x16x32_bf16 a[168:171], v[120:123], v[232:235], a[168:171]
  v_exp_f32 v206, v206
  v_mfma_f32_16x16x32_bf16 a[172:175], v[124:127], v[232:235], a[172:175]
  ds_read_b128 a[244:247], v224 offset:9280
  v_add_f32 v242, v242, v206
  v_mfma_f32_16x16x32_bf16 a[176:179], v[128:131], v[232:235], a[176:179]
  v_exp_f32 v207, v207
  v_mfma_f32_16x16x32_bf16 a[180:183], v[132:135], v[232:235], a[180:183]
  ds_read_b128 a[248:251], v224 offset:9344
  v_add_f32 v242, v242, v207
  v_cvt_pk_bf16_f32 v221, v206, v207
  v_mfma_f32_16x16x32_bf16 a[184:187], v[136:139], v[232:235], a[184:187]
  s_waitcnt lgkmcnt(3)
  v_exp_f32 v208, v208
  v_mfma_f32_16x16x32_bf16 a[188:191], v[140:143], v[232:235], a[188:191]
  ds_read_b128 a[252:255], v224 offset:9408
  v_add_f32 v242, v242, v208
  v_mfma_f32_16x16x32_bf16 v[212:215], a[224:227], v[0:3], v[176:179]
  v_exp_f32 v209, v209
  v_mfma_f32_16x16x32_bf16 v[212:215], a[228:231], v[4:7], v[212:215]
  v_add_f32 v242, v242, v209
  v_cvt_pk_bf16_f32 v222, v208, v209
  v_mfma_f32_16x16x32_bf16 v[212:215], a[232:235], v[8:11], v[212:215]
  s_waitcnt lgkmcnt(2)
  v_exp_f32 v210, v210
  v_mfma_f32_16x16x32_bf16 v[212:215], a[236:239], v[12:15], v[212:215]
  ds_read_b64_tr_b16 v[172:173], v225 offset:8928
  v_add_f32 v242, v242, v210
  v_mfma_f32_16x16x32_bf16 v[216:219], a[240:243], v[0:3], v[176:179]
  s_waitcnt lgkmcnt(1)
  v_exp_f32 v211, v211
  v_mfma_f32_16x16x32_bf16 v[216:219], a[244:247], v[4:7], v[216:219]
  v_add_f32 v242, v242, v211
  v_cvt_pk_bf16_f32 v223, v210, v211
  v_mfma_f32_16x16x32_bf16 v[216:219], a[248:251], v[8:11], v[216:219]
  v_exp_f32 v212, v212
  v_mfma_f32_16x16x32_bf16 v[216:219], a[252:255], v[12:15], v[216:219]
  ds_read_b64_tr_b16 v[174:175], v225 offset:9440
  v_add_f32 v236, v236, v212
  v_mfma_f32_16x16x32_bf16 a[192:195], v[112:115], v[220:223], a[192:195]
  v_exp_f32 v213, v213
  v_mfma_f32_16x16x32_bf16 a[196:199], v[116:119], v[220:223], a[196:199]
  v_add_f32 v236, v236, v213
  v_cvt_pk_bf16_f32 v232, v212, v213
  v_mfma_f32_16x16x32_bf16 a[200:203], v[120:123], v[220:223], a[200:203]
  v_exp_f32 v214, v214
  v_mfma_f32_16x16x32_bf16 a[204:207], v[124:127], v[220:223], a[204:207]
  v_add_f32 v236, v236, v214
  v_mfma_f32_16x16x32_bf16 a[208:211], v[128:131], v[220:223], a[208:211]
  v_exp_f32 v215, v215
  v_mfma_f32_16x16x32_bf16 a[212:215], v[132:135], v[220:223], a[212:215]
  v_add_f32 v236, v236, v215
  v_cvt_pk_bf16_f32 v233, v214, v215
  v_mfma_f32_16x16x32_bf16 a[216:219], v[136:139], v[220:223], a[216:219]
  v_exp_f32 v216, v216
  v_mfma_f32_16x16x32_bf16 a[220:223], v[140:143], v[220:223], a[220:223]
  v_mfma_f32_16x16x32_bf16 v[204:207], a[224:227], v[16:19], v[180:183]
  s_waitcnt vmcnt(1) lgkmcnt(0)
  s_barrier
  v_exp_f32 v217, v217
  v_mfma_f32_16x16x32_bf16 v[204:207], a[228:231], v[20:23], v[204:207]
  v_add_f32 v236, v236, v216
  v_add_f32 v236, v236, v217
  v_cvt_pk_bf16_f32 v234, v216, v217
  v_mfma_f32_16x16x32_bf16 v[204:207], a[232:235], v[24:27], v[204:207]
  v_exp_f32 v218, v218
  v_mfma_f32_16x16x32_bf16 v[204:207], a[236:239], v[28:31], v[204:207]
  ds_read_b64_tr_b16 v[112:113], v225 offset:17408
  v_add_f32 v236, v236, v218
  v_mfma_f32_16x16x32_bf16 v[208:211], a[240:243], v[16:19], v[180:183]
  v_exp_f32 v219, v219
  v_mfma_f32_16x16x32_bf16 v[208:211], a[244:247], v[20:23], v[208:211]
  v_add_f32 v236, v236, v219
  v_cvt_pk_bf16_f32 v235, v218, v219
  v_mfma_f32_16x16x32_bf16 v[208:211], a[248:251], v[24:27], v[208:211]
  s_add_u32 m0, s24, 8704
  v_exp_f32 v204, v204
  v_mfma_f32_16x16x32_bf16 v[208:211], a[252:255], v[28:31], v[208:211]
  buffer_load_dwordx4 v230, s[4:7], s25 offen offset:0 nt lds
  v_mfma_f32_16x16x32_bf16 a[0:3], v[144:147], v[232:235], a[0:3]
  v_exp_f32 v205, v205
  v_mfma_f32_16x16x32_bf16 a[4:7], v[148:151], v[232:235], a[4:7]
  v_add_f32 v237, v237, v204
  v_add_f32 v237, v237, v205
  v_cvt_pk_bf16_f32 v220, v204, v205
  v_mfma_f32_16x16x32_bf16 a[8:11], v[152:155], v[232:235], a[8:11]
  s_add_u32 m0, s24, 8736
  v_exp_f32 v206, v206
  v_mfma_f32_16x16x32_bf16 a[12:15], v[156:159], v[232:235], a[12:15]
  buffer_load_dwordx4 v230, s[4:7], s25 offen offset:1024 nt lds
  v_mfma_f32_16x16x32_bf16 a[16:19], v[160:163], v[232:235], a[16:19]
  v_exp_f32 v207, v207
  v_mfma_f32_16x16x32_bf16 a[20:23], v[164:167], v[232:235], a[20:23]
  v_add_f32 v237, v237, v206
  v_add_f32 v237, v237, v207
  v_cvt_pk_bf16_f32 v221, v206, v207
  v_mfma_f32_16x16x32_bf16 a[24:27], v[168:171], v[232:235], a[24:27]
  s_add_u32 m0, s24, 8768
  v_exp_f32 v208, v208
  v_mfma_f32_16x16x32_bf16 a[28:31], v[172:175], v[232:235], a[28:31]
  buffer_load_dwordx4 v230, s[4:7], s25 offen offset:2048 nt lds
  v_mfma_f32_16x16x32_bf16 v[212:215], a[224:227], v[32:35], v[184:187]
  v_exp_f32 v209, v209
  v_mfma_f32_16x16x32_bf16 v[212:215], a[228:231], v[36:39], v[212:215]
  v_add_f32 v237, v237, v208
  v_add_f32 v237, v237, v209
  v_cvt_pk_bf16_f32 v222, v208, v209
  v_mfma_f32_16x16x32_bf16 v[212:215], a[232:235], v[40:43], v[212:215]
  s_add_u32 m0, s24, 8800
  v_exp_f32 v210, v210
  v_mfma_f32_16x16x32_bf16 v[212:215], a[236:239], v[44:47], v[212:215]
  buffer_load_dwordx4 v230, s[4:7], s25 offen offset:3072 nt lds
  v_mfma_f32_16x16x32_bf16 v[216:219], a[240:243], v[32:35], v[184:187]
  s_add_u32 s25, s25, 4096
  v_exp_f32 v211, v211
  v_mfma_f32_16x16x32_bf16 v[216:219], a[244:247], v[36:39], v[216:219]
  v_add_f32 v237, v237, v210
  v_add_f32 v237, v237, v211
  v_cvt_pk_bf16_f32 v223, v210, v211
  v_mfma_f32_16x16x32_bf16 v[216:219], a[248:251], v[40:43], v[216:219]
  s_add_u32 m0, s24, 12928
  v_exp_f32 v212, v212
  v_mfma_f32_16x16x32_bf16 v[216:219], a[252:255], v[44:47], v[216:219]
  buffer_load_dwordx4 v230, s[4:7], s25 offen offset:0 nt lds
  v_mfma_f32_16x16x32_bf16 a[32:35], v[144:147], v[220:223], a[32:35]
  v_exp_f32 v213, v213
  v_mfma_f32_16x16x32_bf16 a[36:39], v[148:151], v[220:223], a[36:39]
  v_add_f32 v238, v238, v212
  v_add_f32 v238, v238, v213
  v_cvt_pk_bf16_f32 v232, v212, v213
  v_mfma_f32_16x16x32_bf16 a[40:43], v[152:155], v[220:223], a[40:43]
  s_add_u32 m0, s24, 12960
  v_exp_f32 v214, v214
  v_mfma_f32_16x16x32_bf16 a[44:47], v[156:159], v[220:223], a[44:47]
  buffer_load_dwordx4 v230, s[4:7], s25 offen offset:1024 nt lds
  v_mfma_f32_16x16x32_bf16 a[48:51], v[160:163], v[220:223], a[48:51]
  v_exp_f32 v215, v215
  v_mfma_f32_16x16x32_bf16 a[52:55], v[164:167], v[220:223], a[52:55]
  v_add_f32 v238, v238, v214
  v_add_f32 v238, v238, v215
  v_cvt_pk_bf16_f32 v233, v214, v215
  v_mfma_f32_16x16x32_bf16 a[56:59], v[168:171], v[220:223], a[56:59]
  s_add_u32 m0, s24, 12992
  v_exp_f32 v216, v216
  v_mfma_f32_16x16x32_bf16 a[60:63], v[172:175], v[220:223], a[60:63]
  buffer_load_dwordx4 v230, s[4:7], s25 offen offset:2048 nt lds
  v_mfma_f32_16x16x32_bf16 v[204:207], a[224:227], v[48:51], v[188:191]
  v_exp_f32 v217, v217
  v_mfma_f32_16x16x32_bf16 v[204:207], a[228:231], v[52:55], v[204:207]
  v_add_f32 v238, v238, v216
  v_add_f32 v238, v238, v217
  v_cvt_pk_bf16_f32 v234, v216, v217
  v_mfma_f32_16x16x32_bf16 v[204:207], a[232:235], v[56:59], v[204:207]
  s_add_u32 m0, s24, 13024
  v_exp_f32 v218, v218
  v_mfma_f32_16x16x32_bf16 v[204:207], a[236:239], v[60:63], v[204:207]
  buffer_load_dwordx4 v230, s[4:7], s25 offen offset:3072 nt lds
  v_mfma_f32_16x16x32_bf16 v[208:211], a[240:243], v[48:51], v[188:191]
  s_add_u32 s25, s25, 4096
  s_and_b32 s25, s25, 0x3ffff
  v_exp_f32 v219, v219
  v_mfma_f32_16x16x32_bf16 v[208:211], a[244:247], v[52:55], v[208:211]
  v_add_f32 v238, v238, v218
  v_add_f32 v238, v238, v219
  v_cvt_pk_bf16_f32 v235, v218, v219
  v_mfma_f32_16x16x32_bf16 v[208:211], a[248:251], v[56:59], v[208:211]
  v_exp_f32 v204, v204
  v_mfma_f32_16x16x32_bf16 v[208:211], a[252:255], v[60:63], v[208:211]
  ds_read_b64_tr_b16 v[114:115], v225 offset:17920
  v_add_f32 v239, v239, v204
  v_mfma_f32_16x16x32_bf16 a[64:67], v[144:147], v[232:235], a[64:67]
  v_exp_f32 v205, v205
  v_mfma_f32_16x16x32_bf16 a[68:71], v[148:151], v[232:235], a[68:71]
  v_add_f32 v239, v239, v205
  v_cvt_pk_bf16_f32 v220, v204, v205
  v_mfma_f32_16x16x32_bf16 a[72:75], v[152:155], v[232:235], a[72:75]
  v_exp_f32 v206, v206
  v_mfma_f32_16x16x32_bf16 a[76:79], v[156:159], v[232:235], a[76:79]
  ds_read_b64_tr_b16 v[116:117], v225 offset:17440
  v_add_f32 v239, v239, v206
  v_mfma_f32_16x16x32_bf16 a[80:83], v[160:163], v[232:235], a[80:83]
  v_exp_f32 v207, v207
  v_mfma_f32_16x16x32_bf16 a[84:87], v[164:167], v[232:235], a[84:87]
  v_add_f32 v239, v239, v207
  v_cvt_pk_bf16_f32 v221, v206, v207
  v_mfma_f32_16x16x32_bf16 a[88:91], v[168:171], v[232:235], a[88:91]
  v_exp_f32 v208, v208
  v_mfma_f32_16x16x32_bf16 a[92:95], v[172:175], v[232:235], a[92:95]
  ds_read_b64_tr_b16 v[118:119], v225 offset:17952
  v_add_f32 v239, v239, v208
  v_mfma_f32_16x16x32_bf16 v[212:215], a[224:227], v[64:67], v[192:195]
  v_exp_f32 v209, v209
  v_mfma_f32_16x16x32_bf16 v[212:215], a[228:231], v[68:71], v[212:215]
  v_add_f32 v239, v239, v209
  v_cvt_pk_bf16_f32 v222, v208, v209
  v_mfma_f32_16x16x32_bf16 v[212:215], a[232:235], v[72:75], v[212:215]
  v_exp_f32 v210, v210
  v_mfma_f32_16x16x32_bf16 v[212:215], a[236:239], v[76:79], v[212:215]
  ds_read_b64_tr_b16 v[120:121], v225 offset:17472
  v_add_f32 v239, v239, v210
  v_mfma_f32_16x16x32_bf16 v[216:219], a[240:243], v[64:67], v[192:195]
  v_exp_f32 v211, v211
  v_mfma_f32_16x16x32_bf16 v[216:219], a[244:247], v[68:71], v[216:219]
  v_add_f32 v239, v239, v211
  v_cvt_pk_bf16_f32 v223, v210, v211
  v_mfma_f32_16x16x32_bf16 v[216:219], a[248:251], v[72:75], v[216:219]
  v_exp_f32 v212, v212
  v_mfma_f32_16x16x32_bf16 v[216:219], a[252:255], v[76:79], v[216:219]
  ds_read_b64_tr_b16 v[122:123], v225 offset:17984
  v_add_f32 v240, v240, v212
  v_mfma_f32_16x16x32_bf16 a[96:99], v[144:147], v[220:223], a[96:99]
  v_exp_f32 v213, v213
  v_mfma_f32_16x16x32_bf16 a[100:103], v[148:151], v[220:223], a[100:103]
  v_add_f32 v240, v240, v213
  v_cvt_pk_bf16_f32 v232, v212, v213
  v_mfma_f32_16x16x32_bf16 a[104:107], v[152:155], v[220:223], a[104:107]
  v_exp_f32 v214, v214
  v_mfma_f32_16x16x32_bf16 a[108:111], v[156:159], v[220:223], a[108:111]
  ds_read_b64_tr_b16 v[124:125], v225 offset:17504
  v_add_f32 v240, v240, v214
  v_mfma_f32_16x16x32_bf16 a[112:115], v[160:163], v[220:223], a[112:115]
  v_exp_f32 v215, v215
  v_mfma_f32_16x16x32_bf16 a[116:119], v[164:167], v[220:223], a[116:119]
  v_add_f32 v240, v240, v215
  v_cvt_pk_bf16_f32 v233, v214, v215
  v_mfma_f32_16x16x32_bf16 a[120:123], v[168:171], v[220:223], a[120:123]
  v_exp_f32 v216, v216
  v_mfma_f32_16x16x32_bf16 a[124:127], v[172:175], v[220:223], a[124:127]
  ds_read_b64_tr_b16 v[126:127], v225 offset:18016
  v_add_f32 v240, v240, v216
  v_mfma_f32_16x16x32_bf16 v[204:207], a[224:227], v[80:83], v[196:199]
  v_exp_f32 v217, v217
  v_mfma_f32_16x16x32_bf16 v[204:207], a[228:231], v[84:87], v[204:207]
  v_add_f32 v240, v240, v217
  v_cvt_pk_bf16_f32 v234, v216, v217
  v_mfma_f32_16x16x32_bf16 v[204:207], a[232:235], v[88:91], v[204:207]
  v_exp_f32 v218, v218
  v_mfma_f32_16x16x32_bf16 v[204:207], a[236:239], v[92:95], v[204:207]
  ds_read_b64_tr_b16 v[128:129], v225 offset:17536
  v_add_f32 v240, v240, v218
  v_mfma_f32_16x16x32_bf16 v[208:211], a[240:243], v[80:83], v[196:199]
  v_exp_f32 v219, v219
  v_mfma_f32_16x16x32_bf16 v[208:211], a[244:247], v[84:87], v[208:211]
  v_add_f32 v240, v240, v219
  v_cvt_pk_bf16_f32 v235, v218, v219
  v_mfma_f32_16x16x32_bf16 v[208:211], a[248:251], v[88:91], v[208:211]
  v_exp_f32 v204, v204
  v_mfma_f32_16x16x32_bf16 v[208:211], a[252:255], v[92:95], v[208:211]
  ds_read_b64_tr_b16 v[130:131], v225 offset:18048
  v_add_f32 v241, v241, v204
  v_mfma_f32_16x16x32_bf16 a[128:131], v[144:147], v[232:235], a[128:131]
  v_exp_f32 v205, v205
  v_mfma_f32_16x16x32_bf16 a[132:135], v[148:151], v[232:235], a[132:135]
  ds_read_b64_tr_b16 v[132:133], v225 offset:17568
  v_add_f32 v241, v241, v205
  v_cvt_pk_bf16_f32 v220, v204, v205
  v_mfma_f32_16x16x32_bf16 a[136:139], v[152:155], v[232:235], a[136:139]
  v_exp_f32 v206, v206
  v_mfma_f32_16x16x32_bf16 a[140:143], v[156:159], v[232:235], a[140:143]
  ds_read_b64_tr_b16 v[134:135], v225 offset:18080
  v_add_f32 v241, v241, v206
  v_mfma_f32_16x16x32_bf16 a[144:147], v[160:163], v[232:235], a[144:147]
  v_exp_f32 v207, v207
  v_mfma_f32_16x16x32_bf16 a[148:151], v[164:167], v[232:235], a[148:151]
  ds_read_b64_tr_b16 v[136:137], v225 offset:17600
  v_add_f32 v241, v241, v207
  v_cvt_pk_bf16_f32 v221, v206, v207
  v_mfma_f32_16x16x32_bf16 a[152:155], v[168:171], v[232:235], a[152:155]
  v_exp_f32 v208, v208
  v_mfma_f32_16x16x32_bf16 a[156:159], v[172:175], v[232:235], a[156:159]
  ds_read_b64_tr_b16 v[138:139], v225 offset:18112
  v_add_f32 v241, v241, v208
  v_mfma_f32_16x16x32_bf16 v[212:215], a[224:227], v[96:99], v[200:203]
  v_exp_f32 v209, v209
  v_mfma_f32_16x16x32_bf16 v[212:215], a[228:231], v[100:103], v[212:215]
  ds_read_b128 a[224:227], v224 offset:17408
  v_add_f32 v241, v241, v209
  v_cvt_pk_bf16_f32 v222, v208, v209
  v_mfma_f32_16x16x32_bf16 v[212:215], a[232:235], v[104:107], v[212:215]
  v_exp_f32 v210, v210
  v_mfma_f32_16x16x32_bf16 v[212:215], a[236:239], v[108:111], v[212:215]
  ds_read_b128 a[228:231], v224 offset:17472
  v_add_f32 v241, v241, v210
  v_mfma_f32_16x16x32_bf16 v[216:219], a[240:243], v[96:99], v[200:203]
  v_exp_f32 v211, v211
  v_mfma_f32_16x16x32_bf16 v[216:219], a[244:247], v[100:103], v[216:219]
  ds_read_b128 a[232:235], v224 offset:17536
  v_add_f32 v241, v241, v211
  v_cvt_pk_bf16_f32 v223, v210, v211
  v_mfma_f32_16x16x32_bf16 v[216:219], a[248:251], v[104:107], v[216:219]
  v_exp_f32 v212, v212
  v_mfma_f32_16x16x32_bf16 v[216:219], a[252:255], v[108:111], v[216:219]
  ds_read_b128 a[236:239], v224 offset:17600
  v_add_f32 v242, v242, v212
  v_mfma_f32_16x16x32_bf16 a[160:163], v[144:147], v[220:223], a[160:163]
  v_exp_f32 v213, v213
  v_mfma_f32_16x16x32_bf16 a[164:167], v[148:151], v[220:223], a[164:167]
  ds_read_b128 a[240:243], v224 offset:17920
  v_add_f32 v242, v242, v213
  v_cvt_pk_bf16_f32 v232, v212, v213
  v_mfma_f32_16x16x32_bf16 a[168:171], v[152:155], v[220:223], a[168:171]
  v_exp_f32 v214, v214
  v_mfma_f32_16x16x32_bf16 a[172:175], v[156:159], v[220:223], a[172:175]
  ds_read_b128 a[244:247], v224 offset:17984
  v_add_f32 v242, v242, v214
  v_mfma_f32_16x16x32_bf16 a[176:179], v[160:163], v[220:223], a[176:179]
  v_exp_f32 v215, v215
  v_mfma_f32_16x16x32_bf16 a[180:183], v[164:167], v[220:223], a[180:183]
  ds_read_b128 a[248:251], v224 offset:18048
  v_add_f32 v242, v242, v215
  v_cvt_pk_bf16_f32 v233, v214, v215
  v_mfma_f32_16x16x32_bf16 a[184:187], v[168:171], v[220:223], a[184:187]
  s_waitcnt lgkmcnt(3)
  v_exp_f32 v216, v216
  v_mfma_f32_16x16x32_bf16 a[188:191], v[172:175], v[220:223], a[188:191]
  ds_read_b128 a[252:255], v224 offset:18112
  v_add_f32 v242, v242, v216
  v_mfma_f32_16x16x32_bf16 v[204:207], a[224:227], v[0:3], v[176:179]
  v_exp_f32 v217, v217
  v_mfma_f32_16x16x32_bf16 v[204:207], a[228:231], v[4:7], v[204:207]
  v_add_f32 v242, v242, v217
  v_cvt_pk_bf16_f32 v234, v216, v217
  v_mfma_f32_16x16x32_bf16 v[204:207], a[232:235], v[8:11], v[204:207]
  s_waitcnt lgkmcnt(2)
  v_exp_f32 v218, v218
  v_mfma_f32_16x16x32_bf16 v[204:207], a[236:239], v[12:15], v[204:207]
  ds_read_b64_tr_b16 v[140:141], v225 offset:17632
  v_add_f32 v242, v242, v218
  v_mfma_f32_16x16x32_bf16 v[208:211], a[240:243], v[0:3], v[176:179]
  s_waitcnt lgkmcnt(1)
  v_exp_f32 v219, v219
  v_mfma_f32_16x16x32_bf16 v[208:211], a[244:247], v[4:7], v[208:211]
  v_add_f32 v242, v242, v219
  v_cvt_pk_bf16_f32 v235, v218, v219
  v_mfma_f32_16x16x32_bf16 v[208:211], a[248:251], v[8:11], v[208:211]
  v_exp_f32 v204, v204
  v_mfma_f32_16x16x32_bf16 v[208:211], a[252:255], v[12:15], v[208:211]
  ds_read_b64_tr_b16 v[142:143], v225 offset:18144
  v_add_f32 v236, v236, v204
  v_mfma_f32_16x16x32_bf16 a[192:195], v[144:147], v[232:235], a[192:195]
  v_exp_f32 v205, v205
  v_mfma_f32_16x16x32_bf16 a[196:199], v[148:151], v[232:235], a[196:199]
  v_add_f32 v236, v236, v205
  v_cvt_pk_bf16_f32 v220, v204, v205
  v_mfma_f32_16x16x32_bf16 a[200:203], v[152:155], v[232:235], a[200:203]
  v_exp_f32 v206, v206
  v_mfma_f32_16x16x32_bf16 a[204:207], v[156:159], v[232:235], a[204:207]
  v_add_f32 v236, v236, v206
  v_mfma_f32_16x16x32_bf16 a[208:211], v[160:163], v[232:235], a[208:211]
  v_exp_f32 v207, v207
  v_mfma_f32_16x16x32_bf16 a[212:215], v[164:167], v[232:235], a[212:215]
  v_add_f32 v236, v236, v207
  v_cvt_pk_bf16_f32 v221, v206, v207
  v_mfma_f32_16x16x32_bf16 a[216:219], v[168:171], v[232:235], a[216:219]
  v_exp_f32 v208, v208
  v_mfma_f32_16x16x32_bf16 a[220:223], v[172:175], v[232:235], a[220:223]
  v_mfma_f32_16x16x32_bf16 v[212:215], a[224:227], v[16:19], v[180:183]
  s_waitcnt vmcnt(1) lgkmcnt(0)
  s_barrier
  v_exp_f32 v209, v209
  v_mfma_f32_16x16x32_bf16 v[212:215], a[228:231], v[20:23], v[212:215]
  v_add_f32 v236, v236, v208
  v_add_f32 v236, v236, v209
  v_cvt_pk_bf16_f32 v222, v208, v209
  v_mfma_f32_16x16x32_bf16 v[212:215], a[232:235], v[24:27], v[212:215]
  v_exp_f32 v210, v210
  v_mfma_f32_16x16x32_bf16 v[212:215], a[236:239], v[28:31], v[212:215]
  ds_read_b64_tr_b16 v[144:145], v225 offset:26112
  v_add_f32 v236, v236, v210
  v_mfma_f32_16x16x32_bf16 v[216:219], a[240:243], v[16:19], v[180:183]
  v_exp_f32 v211, v211
  v_mfma_f32_16x16x32_bf16 v[216:219], a[244:247], v[20:23], v[216:219]
  v_add_f32 v236, v236, v211
  v_cvt_pk_bf16_f32 v223, v210, v211
  v_mfma_f32_16x16x32_bf16 v[216:219], a[248:251], v[24:27], v[216:219]
  s_add_u32 m0, s24, 17408
  v_exp_f32 v212, v212
  v_mfma_f32_16x16x32_bf16 v[216:219], a[252:255], v[28:31], v[216:219]
  buffer_load_dwordx4 v230, s[4:7], s25 offen offset:0 nt lds
  v_mfma_f32_16x16x32_bf16 a[0:3], v[112:115], v[220:223], a[0:3]
  v_exp_f32 v213, v213
  v_mfma_f32_16x16x32_bf16 a[4:7], v[116:119], v[220:223], a[4:7]
  v_add_f32 v237, v237, v212
  v_add_f32 v237, v237, v213
  v_cvt_pk_bf16_f32 v232, v212, v213
  v_mfma_f32_16x16x32_bf16 a[8:11], v[120:123], v[220:223], a[8:11]
  s_add_u32 m0, s24, 17440
  v_exp_f32 v214, v214
  v_mfma_f32_16x16x32_bf16 a[12:15], v[124:127], v[220:223], a[12:15]
  buffer_load_dwordx4 v230, s[4:7], s25 offen offset:1024 nt lds
  v_mfma_f32_16x16x32_bf16 a[16:19], v[128:131], v[220:223], a[16:19]
  v_exp_f32 v215, v215
  v_mfma_f32_16x16x32_bf16 a[20:23], v[132:135], v[220:223], a[20:23]
  v_add_f32 v237, v237, v214
  v_add_f32 v237, v237, v215
  v_cvt_pk_bf16_f32 v233, v214, v215
  v_mfma_f32_16x16x32_bf16 a[24:27], v[136:139], v[220:223], a[24:27]
  s_add_u32 m0, s24, 17472
  v_exp_f32 v216, v216
  v_mfma_f32_16x16x32_bf16 a[28:31], v[140:143], v[220:223], a[28:31]
  buffer_load_dwordx4 v230, s[4:7], s25 offen offset:2048 nt lds
  v_mfma_f32_16x16x32_bf16 v[204:207], a[224:227], v[32:35], v[184:187]
  v_exp_f32 v217, v217
  v_mfma_f32_16x16x32_bf16 v[204:207], a[228:231], v[36:39], v[204:207]
  v_add_f32 v237, v237, v216
  v_add_f32 v237, v237, v217
  v_cvt_pk_bf16_f32 v234, v216, v217
  v_mfma_f32_16x16x32_bf16 v[204:207], a[232:235], v[40:43], v[204:207]
  s_add_u32 m0, s24, 17504
  v_exp_f32 v218, v218
  v_mfma_f32_16x16x32_bf16 v[204:207], a[236:239], v[44:47], v[204:207]
  buffer_load_dwordx4 v230, s[4:7], s25 offen offset:3072 nt lds
  v_mfma_f32_16x16x32_bf16 v[208:211], a[240:243], v[32:35], v[184:187]
  s_add_u32 s25, s25, 4096
  v_exp_f32 v219, v219
  v_mfma_f32_16x16x32_bf16 v[208:211], a[244:247], v[36:39], v[208:211]
  v_add_f32 v237, v237, v218
  v_add_f32 v237, v237, v219
  v_cvt_pk_bf16_f32 v235, v218, v219
  v_mfma_f32_16x16x32_bf16 v[208:211], a[248:251], v[40:43], v[208:211]
  s_add_u32 m0, s24, 21632
  v_exp_f32 v204, v204
  v_mfma_f32_16x16x32_bf16 v[208:211], a[252:255], v[44:47], v[208:211]
  buffer_load_dwordx4 v230, s[4:7], s25 offen offset:0 nt lds
  v_mfma_f32_16x16x32_bf16 a[32:35], v[112:115], v[232:235], a[32:35]
  v_exp_f32 v205, v205
  v_mfma_f32_16x16x32_bf16 a[36:39], v[116:119], v[232:235], a[36:39]
  v_add_f32 v238, v238, v204
  v_add_f32 v238, v238, v205
  v_cvt_pk_bf16_f32 v220, v204, v205
  v_mfma_f32_16x16x32_bf16 a[40:43], v[120:123], v[232:235], a[40:43]
  s_add_u32 m0, s24, 21664
  v_exp_f32 v206, v206
  v_mfma_f32_16x16x32_bf16 a[44:47], v[124:127], v[232:235], a[44:47]
  buffer_load_dwordx4 v230, s[4:7], s25 offen offset:1024 nt lds
  v_mfma_f32_16x16x32_bf16 a[48:51], v[128:131], v[232:235], a[48:51]
  v_exp_f32 v207, v207
  v_mfma_f32_16x16x32_bf16 a[52:55], v[132:135], v[232:235], a[52:55]
  v_add_f32 v238, v238, v206
  v_add_f32 v238, v238, v207
  v_cvt_pk_bf16_f32 v221, v206, v207
  v_mfma_f32_16x16x32_bf16 a[56:59], v[136:139], v[232:235], a[56:59]
  s_add_u32 m0, s24, 21696
  v_exp_f32 v208, v208
  v_mfma_f32_16x16x32_bf16 a[60:63], v[140:143], v[232:235], a[60:63]
  buffer_load_dwordx4 v230, s[4:7], s25 offen offset:2048 nt lds
  v_mfma_f32_16x16x32_bf16 v[212:215], a[224:227], v[48:51], v[188:191]
  v_exp_f32 v209, v209
  v_mfma_f32_16x16x32_bf16 v[212:215], a[228:231], v[52:55], v[212:215]
  v_add_f32 v238, v238, v208
  v_add_f32 v238, v238, v209
  v_cvt_pk_bf16_f32 v222, v208, v209
  v_mfma_f32_16x16x32_bf16 v[212:215], a[232:235], v[56:59], v[212:215]
  s_add_u32 m0, s24, 21728
  v_exp_f32 v210, v210
  v_mfma_f32_16x16x32_bf16 v[212:215], a[236:239], v[60:63], v[212:215]
  buffer_load_dwordx4 v230, s[4:7], s25 offen offset:3072 nt lds
  v_mfma_f32_16x16x32_bf16 v[216:219], a[240:243], v[48:51], v[188:191]
  s_add_u32 s25, s25, 4096
  s_and_b32 s25, s25, 0x3ffff
  v_exp_f32 v211, v211
  v_mfma_f32_16x16x32_bf16 v[216:219], a[244:247], v[52:55], v[216:219]
  v_add_f32 v238, v238, v210
  v_add_f32 v238, v238, v211
  v_cvt_pk_bf16_f32 v223, v210, v211
  v_mfma_f32_16x16x32_bf16 v[216:219], a[248:251], v[56:59], v[216:219]
  v_exp_f32 v212, v212
  v_mfma_f32_16x16x32_bf16 v[216:219], a[252:255], v[60:63], v[216:219]
  ds_read_b64_tr_b16 v[146:147], v225 offset:26624
  v_add_f32 v239, v239, v212
  v_mfma_f32_16x16x32_bf16 a[64:67], v[112:115], v[220:223], a[64:67]
  v_exp_f32 v213, v213
  v_mfma_f32_16x16x32_bf16 a[68:71], v[116:119], v[220:223], a[68:71]
  v_add_f32 v239, v239, v213
  v_cvt_pk_bf16_f32 v232, v212, v213
  v_mfma_f32_16x16x32_bf16 a[72:75], v[120:123], v[220:223], a[72:75]
  v_exp_f32 v214, v214
  v_mfma_f32_16x16x32_bf16 a[76:79], v[124:127], v[220:223], a[76:79]
  ds_read_b64_tr_b16 v[148:149], v225 offset:26144
  v_add_f32 v239, v239, v214
  v_mfma_f32_16x16x32_bf16 a[80:83], v[128:131], v[220:223], a[80:83]
  v_exp_f32 v215, v215
  v_mfma_f32_16x16x32_bf16 a[84:87], v[132:135], v[220:223], a[84:87]
  v_add_f32 v239, v239, v215
  v_cvt_pk_bf16_f32 v233, v214, v215
  v_mfma_f32_16x16x32_bf16 a[88:91], v[136:139], v[220:223], a[88:91]
  v_exp_f32 v216, v216
  v_mfma_f32_16x16x32_bf16 a[92:95], v[140:143], v[220:223], a[92:95]
  ds_read_b64_tr_b16 v[150:151], v225 offset:26656
  v_add_f32 v239, v239, v216
  v_mfma_f32_16x16x32_bf16 v[204:207], a[224:227], v[64:67], v[192:195]
  v_exp_f32 v217, v217
  v_mfma_f32_16x16x32_bf16 v[204:207], a[228:231], v[68:71], v[204:207]
  v_add_f32 v239, v239, v217
  v_cvt_pk_bf16_f32 v234, v216, v217
  v_mfma_f32_16x16x32_bf16 v[204:207], a[232:235], v[72:75], v[204:207]
  v_exp_f32 v218, v218
  v_mfma_f32_16x16x32_bf16 v[204:207], a[236:239], v[76:79], v[204:207]
  ds_read_b64_tr_b16 v[152:153], v225 offset:26176
  v_add_f32 v239, v239, v218
  v_mfma_f32_16x16x32_bf16 v[208:211], a[240:243], v[64:67], v[192:195]
  v_exp_f32 v219, v219
  v_mfma_f32_16x16x32_bf16 v[208:211], a[244:247], v[68:71], v[208:211]
  v_add_f32 v239, v239, v219
  v_cvt_pk_bf16_f32 v235, v218, v219
  v_mfma_f32_16x16x32_bf16 v[208:211], a[248:251], v[72:75], v[208:211]
  v_exp_f32 v204, v204
  v_mfma_f32_16x16x32_bf16 v[208:211], a[252:255], v[76:79], v[208:211]
  ds_read_b64_tr_b16 v[154:155], v225 offset:26688
  v_add_f32 v240, v240, v204
  v_mfma_f32_16x16x32_bf16 a[96:99], v[112:115], v[232:235], a[96:99]
  v_exp_f32 v205, v205
  v_mfma_f32_16x16x32_bf16 a[100:103], v[116:119], v[232:235], a[100:103]
  v_add_f32 v240, v240, v205
  v_cvt_pk_bf16_f32 v220, v204, v205
  v_mfma_f32_16x16x32_bf16 a[104:107], v[120:123], v[232:235], a[104:107]
  v_exp_f32 v206, v206
  v_mfma_f32_16x16x32_bf16 a[108:111], v[124:127], v[232:235], a[108:111]
  ds_read_b64_tr_b16 v[156:157], v225 offset:26208
  v_add_f32 v240, v240, v206
  v_mfma_f32_16x16x32_bf16 a[112:115], v[128:131], v[232:235], a[112:115]
  v_exp_f32 v207, v207
  v_mfma_f32_16x16x32_bf16 a[116:119], v[132:135], v[232:235], a[116:119]
  v_add_f32 v240, v240, v207
  v_cvt_pk_bf16_f32 v221, v206, v207
  v_mfma_f32_16x16x32_bf16 a[120:123], v[136:139], v[232:235], a[120:123]
  v_exp_f32 v208, v208
  v_mfma_f32_16x16x32_bf16 a[124:127], v[140:143], v[232:235], a[124:127]
  ds_read_b64_tr_b16 v[158:159], v225 offset:26720
  v_add_f32 v240, v240, v208
  v_mfma_f32_16x16x32_bf16 v[212:215], a[224:227], v[80:83], v[196:199]
  v_exp_f32 v209, v209
  v_mfma_f32_16x16x32_bf16 v[212:215], a[228:231], v[84:87], v[212:215]
  v_add_f32 v240, v240, v209
  v_cvt_pk_bf16_f32 v222, v208, v209
  v_mfma_f32_16x16x32_bf16 v[212:215], a[232:235], v[88:91], v[212:215]
  v_exp_f32 v210, v210
  v_mfma_f32_16x16x32_bf16 v[212:215], a[236:239], v[92:95], v[212:215]
  ds_read_b64_tr_b16 v[160:161], v225 offset:26240
  v_add_f32 v240, v240, v210
  v_mfma_f32_16x16x32_bf16 v[216:219], a[240:243], v[80:83], v[196:199]
  v_exp_f32 v211, v211
  v_mfma_f32_16x16x32_bf16 v[216:219], a[244:247], v[84:87], v[216:219]
  v_add_f32 v240, v240, v211
  v_cvt_pk_bf16_f32 v223, v210, v211
  v_mfma_f32_16x16x32_bf16 v[216:219], a[248:251], v[88:91], v[216:219]
  v_exp_f32 v212, v212
  v_mfma_f32_16x16x32_bf16 v[216:219], a[252:255], v[92:95], v[216:219]
  ds_read_b64_tr_b16 v[162:163], v225 offset:26752
  v_add_f32 v241, v241, v212
  v_mfma_f32_16x16x32_bf16 a[128:131], v[112:115], v[220:223], a[128:131]
  v_exp_f32 v213, v213
  v_mfma_f32_16x16x32_bf16 a[132:135], v[116:119], v[220:223], a[132:135]
  ds_read_b64_tr_b16 v[164:165], v225 offset:26272
  v_add_f32 v241, v241, v213
  v_cvt_pk_bf16_f32 v232, v212, v213
  v_mfma_f32_16x16x32_bf16 a[136:139], v[120:123], v[220:223], a[136:139]
  v_exp_f32 v214, v214
  v_mfma_f32_16x16x32_bf16 a[140:143], v[124:127], v[220:223], a[140:143]
  ds_read_b64_tr_b16 v[166:167], v225 offset:26784
  v_add_f32 v241, v241, v214
  v_mfma_f32_16x16x32_bf16 a[144:147], v[128:131], v[220:223], a[144:147]
  v_exp_f32 v215, v215
  v_mfma_f32_16x16x32_bf16 a[148:151], v[132:135], v[220:223], a[148:151]
  ds_read_b64_tr_b16 v[168:169], v225 offset:26304
  v_add_f32 v241, v241, v215
  v_cvt_pk_bf16_f32 v233, v214, v215
  v_mfma_f32_16x16x32_bf16 a[152:155], v[136:139], v[220:223], a[152:155]
  v_exp_f32 v216, v216
  v_mfma_f32_16x16x32_bf16 a[156:159], v[140:143], v[220:223], a[156:159]
  ds_read_b64_tr_b16 v[170:171], v225 offset:26816
  v_add_f32 v241, v241, v216
  v_mfma_f32_16x16x32_bf16 v[204:207], a[224:227], v[96:99], v[200:203]
  v_exp_f32 v217, v217
  v_mfma_f32_16x16x32_bf16 v[204:207], a[228:231], v[100:103], v[204:207]
  ds_read_b128 a[224:227], v224 offset:26112
  v_add_f32 v241, v241, v217
  v_cvt_pk_bf16_f32 v234, v216, v217
  v_mfma_f32_16x16x32_bf16 v[204:207], a[232:235], v[104:107], v[204:207]
  v_exp_f32 v218, v218
  v_mfma_f32_16x16x32_bf16 v[204:207], a[236:239], v[108:111], v[204:207]
  ds_read_b128 a[228:231], v224 offset:26176
  v_add_f32 v241, v241, v218
  v_mfma_f32_16x16x32_bf16 v[208:211], a[240:243], v[96:99], v[200:203]
  v_exp_f32 v219, v219
  v_mfma_f32_16x16x32_bf16 v[208:211], a[244:247], v[100:103], v[208:211]
  ds_read_b128 a[232:235], v224 offset:26240
  v_add_f32 v241, v241, v219
  v_cvt_pk_bf16_f32 v235, v218, v219
  v_mfma_f32_16x16x32_bf16 v[208:211], a[248:251], v[104:107], v[208:211]
  v_exp_f32 v204, v204
  v_mfma_f32_16x16x32_bf16 v[208:211], a[252:255], v[108:111], v[208:211]
  ds_read_b128 a[236:239], v224 offset:26304
  v_add_f32 v242, v242, v204
  v_mfma_f32_16x16x32_bf16 a[160:163], v[112:115], v[232:235], a[160:163]
  v_exp_f32 v205, v205
  v_mfma_f32_16x16x32_bf16 a[164:167], v[116:119], v[232:235], a[164:167]
  ds_read_b128 a[240:243], v224 offset:26624
  v_add_f32 v242, v242, v205
  v_cvt_pk_bf16_f32 v220, v204, v205
  v_mfma_f32_16x16x32_bf16 a[168:171], v[120:123], v[232:235], a[168:171]
  v_exp_f32 v206, v206
  v_mfma_f32_16x16x32_bf16 a[172:175], v[124:127], v[232:235], a[172:175]
  ds_read_b128 a[244:247], v224 offset:26688
  v_add_f32 v242, v242, v206
  v_mfma_f32_16x16x32_bf16 a[176:179], v[128:131], v[232:235], a[176:179]
  v_exp_f32 v207, v207
  v_mfma_f32_16x16x32_bf16 a[180:183], v[132:135], v[232:235], a[180:183]
  ds_read_b128 a[248:251], v224 offset:26752
  v_add_f32 v242, v242, v207
  v_cvt_pk_bf16_f32 v221, v206, v207
  v_mfma_f32_16x16x32_bf16 a[184:187], v[136:139], v[232:235], a[184:187]
  s_waitcnt lgkmcnt(3)
  v_exp_f32 v208, v208
  v_mfma_f32_16x16x32_bf16 a[188:191], v[140:143], v[232:235], a[188:191]
  ds_read_b128 a[252:255], v224 offset:26816
  v_add_f32 v242, v242, v208
  v_mfma_f32_16x16x32_bf16 v[212:215], a[224:227], v[0:3], v[176:179]
  v_exp_f32 v209, v209
  v_mfma_f32_16x16x32_bf16 v[212:215], a[228:231], v[4:7], v[212:215]
  v_add_f32 v242, v242, v209
  v_cvt_pk_bf16_f32 v222, v208, v209
  v_mfma_f32_16x16x32_bf16 v[212:215], a[232:235], v[8:11], v[212:215]
  s_waitcnt lgkmcnt(2)
  v_exp_f32 v210, v210
  v_mfma_f32_16x16x32_bf16 v[212:215], a[236:239], v[12:15], v[212:215]
  ds_read_b64_tr_b16 v[172:173], v225 offset:26336
  v_add_f32 v242, v242, v210
  v_mfma_f32_16x16x32_bf16 v[216:219], a[240:243], v[0:3], v[176:179]
  s_waitcnt lgkmcnt(1)
  v_exp_f32 v211, v211
  v_mfma_f32_16x16x32_bf16 v[216:219], a[244:247], v[4:7], v[216:219]
  v_add_f32 v242, v242, v211
  v_cvt_pk_bf16_f32 v223, v210, v211
  v_mfma_f32_16x16x32_bf16 v[216:219], a[248:251], v[8:11], v[216:219]
  v_exp_f32 v212, v212
  v_mfma_f32_16x16x32_bf16 v[216:219], a[252:255], v[12:15], v[216:219]
  ds_read_b64_tr_b16 v[174:175], v225 offset:26848
  v_add_f32 v236, v236, v212
  v_mfma_f32_16x16x32_bf16 a[192:195], v[112:115], v[220:223], a[192:195]
  v_exp_f32 v213, v213
  v_mfma_f32_16x16x32_bf16 a[196:199], v[116:119], v[220:223], a[196:199]
  v_add_f32 v236, v236, v213
  v_cvt_pk_bf16_f32 v232, v212, v213
  v_mfma_f32_16x16x32_bf16 a[200:203], v[120:123], v[220:223], a[200:203]
  v_exp_f32 v214, v214
  v_mfma_f32_16x16x32_bf16 a[204:207], v[124:127], v[220:223], a[204:207]
  v_add_f32 v236, v236, v214
  v_mfma_f32_16x16x32_bf16 a[208:211], v[128:131], v[220:223], a[208:211]
  v_exp_f32 v215, v215
  v_mfma_f32_16x16x32_bf16 a[212:215], v[132:135], v[220:223], a[212:215]
  v_add_f32 v236, v236, v215
  v_cvt_pk_bf16_f32 v233, v214, v215
  v_mfma_f32_16x16x32_bf16 a[216:219], v[136:139], v[220:223], a[216:219]
  v_exp_f32 v216, v216
  v_mfma_f32_16x16x32_bf16 a[220:223], v[140:143], v[220:223], a[220:223]
  v_mfma_f32_16x16x32_bf16 v[204:207], a[224:227], v[16:19], v[180:183]
  s_waitcnt vmcnt(1) lgkmcnt(0)
  s_barrier
  v_exp_f32 v217, v217
  v_mfma_f32_16x16x32_bf16 v[204:207], a[228:231], v[20:23], v[204:207]
  v_add_f32 v236, v236, v216
  v_add_f32 v236, v236, v217
  v_cvt_pk_bf16_f32 v234, v216, v217
  v_mfma_f32_16x16x32_bf16 v[204:207], a[232:235], v[24:27], v[204:207]
  v_exp_f32 v218, v218
  v_mfma_f32_16x16x32_bf16 v[204:207], a[236:239], v[28:31], v[204:207]
  ds_read_b64_tr_b16 v[112:113], v225 offset:0
  v_add_f32 v236, v236, v218
  v_mfma_f32_16x16x32_bf16 v[208:211], a[240:243], v[16:19], v[180:183]
  v_exp_f32 v219, v219
  v_mfma_f32_16x16x32_bf16 v[208:211], a[244:247], v[20:23], v[208:211]
  v_add_f32 v236, v236, v219
  v_cvt_pk_bf16_f32 v235, v218, v219
  v_mfma_f32_16x16x32_bf16 v[208:211], a[248:251], v[24:27], v[208:211]
  s_add_u32 m0, s24, 26112
  v_exp_f32 v204, v204
  v_mfma_f32_16x16x32_bf16 v[208:211], a[252:255], v[28:31], v[208:211]
  buffer_load_dwordx4 v230, s[4:7], s25 offen offset:0 nt lds
  v_mfma_f32_16x16x32_bf16 a[0:3], v[144:147], v[232:235], a[0:3]
  v_exp_f32 v205, v205
  v_mfma_f32_16x16x32_bf16 a[4:7], v[148:151], v[232:235], a[4:7]
  v_add_f32 v237, v237, v204
  v_add_f32 v237, v237, v205
  v_cvt_pk_bf16_f32 v220, v204, v205
  v_mfma_f32_16x16x32_bf16 a[8:11], v[152:155], v[232:235], a[8:11]
  s_add_u32 m0, s24, 26144
  v_exp_f32 v206, v206
  v_mfma_f32_16x16x32_bf16 a[12:15], v[156:159], v[232:235], a[12:15]
  buffer_load_dwordx4 v230, s[4:7], s25 offen offset:1024 nt lds
  v_mfma_f32_16x16x32_bf16 a[16:19], v[160:163], v[232:235], a[16:19]
  v_exp_f32 v207, v207
  v_mfma_f32_16x16x32_bf16 a[20:23], v[164:167], v[232:235], a[20:23]
  v_add_f32 v237, v237, v206
  v_add_f32 v237, v237, v207
  v_cvt_pk_bf16_f32 v221, v206, v207
  v_mfma_f32_16x16x32_bf16 a[24:27], v[168:171], v[232:235], a[24:27]
  s_add_u32 m0, s24, 26176
  v_exp_f32 v208, v208
  v_mfma_f32_16x16x32_bf16 a[28:31], v[172:175], v[232:235], a[28:31]
  buffer_load_dwordx4 v230, s[4:7], s25 offen offset:2048 nt lds
  v_mfma_f32_16x16x32_bf16 v[212:215], a[224:227], v[32:35], v[184:187]
  v_exp_f32 v209, v209
  v_mfma_f32_16x16x32_bf16 v[212:215], a[228:231], v[36:39], v[212:215]
  v_add_f32 v237, v237, v208
  v_add_f32 v237, v237, v209
  v_cvt_pk_bf16_f32 v222, v208, v209
  v_mfma_f32_16x16x32_bf16 v[212:215], a[232:235], v[40:43], v[212:215]
  s_add_u32 m0, s24, 26208
  v_exp_f32 v210, v210
  v_mfma_f32_16x16x32_bf16 v[212:215], a[236:239], v[44:47], v[212:215]
  buffer_load_dwordx4 v230, s[4:7], s25 offen offset:3072 nt lds
  v_mfma_f32_16x16x32_bf16 v[216:219], a[240:243], v[32:35], v[184:187]
  s_add_u32 s25, s25, 4096
  v_exp_f32 v211, v211
  v_mfma_f32_16x16x32_bf16 v[216:219], a[244:247], v[36:39], v[216:219]
  v_add_f32 v237, v237, v210
  v_add_f32 v237, v237, v211
  v_cvt_pk_bf16_f32 v223, v210, v211
  v_mfma_f32_16x16x32_bf16 v[216:219], a[248:251], v[40:43], v[216:219]
  s_add_u32 m0, s24, 30336
  v_exp_f32 v212, v212
  v_mfma_f32_16x16x32_bf16 v[216:219], a[252:255], v[44:47], v[216:219]
  buffer_load_dwordx4 v230, s[4:7], s25 offen offset:0 nt lds
  v_mfma_f32_16x16x32_bf16 a[32:35], v[144:147], v[220:223], a[32:35]
  v_exp_f32 v213, v213
  v_mfma_f32_16x16x32_bf16 a[36:39], v[148:151], v[220:223], a[36:39]
  v_add_f32 v238, v238, v212
  v_add_f32 v238, v238, v213
  v_cvt_pk_bf16_f32 v232, v212, v213
  v_mfma_f32_16x16x32_bf16 a[40:43], v[152:155], v[220:223], a[40:43]
  s_add_u32 m0, s24, 30368
  v_exp_f32 v214, v214
  v_mfma_f32_16x16x32_bf16 a[44:47], v[156:159], v[220:223], a[44:47]
  buffer_load_dwordx4 v230, s[4:7], s25 offen offset:1024 nt lds
  v_mfma_f32_16x16x32_bf16 a[48:51], v[160:163], v[220:223], a[48:51]
  v_exp_f32 v215, v215
  v_mfma_f32_16x16x32_bf16 a[52:55], v[164:167], v[220:223], a[52:55]
  v_add_f32 v238, v238, v214
  v_add_f32 v238, v238, v215
  v_cvt_pk_bf16_f32 v233, v214, v215
  v_mfma_f32_16x16x32_bf16 a[56:59], v[168:171], v[220:223], a[56:59]
  s_add_u32 m0, s24, 30400
  v_exp_f32 v216, v216
  v_mfma_f32_16x16x32_bf16 a[60:63], v[172:175], v[220:223], a[60:63]
  buffer_load_dwordx4 v230, s[4:7], s25 offen offset:2048 nt lds
  v_mfma_f32_16x16x32_bf16 v[204:207], a[224:227], v[48:51], v[188:191]
  v_exp_f32 v217, v217
  v_mfma_f32_16x16x32_bf16 v[204:207], a[228:231], v[52:55], v[204:207]
  v_add_f32 v238, v238, v216
  v_add_f32 v238, v238, v217
  v_cvt_pk_bf16_f32 v234, v216, v217
  v_mfma_f32_16x16x32_bf16 v[204:207], a[232:235], v[56:59], v[204:207]
  s_add_u32 m0, s24, 30432
  v_exp_f32 v218, v218
  v_mfma_f32_16x16x32_bf16 v[204:207], a[236:239], v[60:63], v[204:207]
  buffer_load_dwordx4 v230, s[4:7], s25 offen offset:3072 nt lds
  v_mfma_f32_16x16x32_bf16 v[208:211], a[240:243], v[48:51], v[188:191]
  s_add_u32 s25, s25, 4096
  s_and_b32 s25, s25, 0x3ffff
  v_exp_f32 v219, v219
  v_mfma_f32_16x16x32_bf16 v[208:211], a[244:247], v[52:55], v[208:211]
  v_add_f32 v238, v238, v218
  v_add_f32 v238, v238, v219
  v_cvt_pk_bf16_f32 v235, v218, v219
  v_mfma_f32_16x16x32_bf16 v[208:211], a[248:251], v[56:59], v[208:211]
  v_exp_f32 v204, v204
  v_mfma_f32_16x16x32_bf16 v[208:211], a[252:255], v[60:63], v[208:211]
  ds_read_b64_tr_b16 v[114:115], v225 offset:512
  v_add_f32 v239, v239, v204
  v_mfma_f32_16x16x32_bf16 a[64:67], v[144:147], v[232:235], a[64:67]
  v_exp_f32 v205, v205
  v_mfma_f32_16x16x32_bf16 a[68:71], v[148:151], v[232:235], a[68:71]
  v_add_f32 v239, v239, v205
  v_cvt_pk_bf16_f32 v220, v204, v205
  v_mfma_f32_16x16x32_bf16 a[72:75], v[152:155], v[232:235], a[72:75]
  v_exp_f32 v206, v206
  v_mfma_f32_16x16x32_bf16 a[76:79], v[156:159], v[232:235], a[76:79]
  ds_read_b64_tr_b16 v[116:117], v225 offset:32
  v_add_f32 v239, v239, v206
  v_mfma_f32_16x16x32_bf16 a[80:83], v[160:163], v[232:235], a[80:83]
  v_exp_f32 v207, v207
  v_mfma_f32_16x16x32_bf16 a[84:87], v[164:167], v[232:235], a[84:87]
  v_add_f32 v239, v239, v207
  v_cvt_pk_bf16_f32 v221, v206, v207
  v_mfma_f32_16x16x32_bf16 a[88:91], v[168:171], v[232:235], a[88:91]
  v_exp_f32 v208, v208
  v_mfma_f32_16x16x32_bf16 a[92:95], v[172:175], v[232:235], a[92:95]
  ds_read_b64_tr_b16 v[118:119], v225 offset:544
  v_add_f32 v239, v239, v208
  v_mfma_f32_16x16x32_bf16 v[212:215], a[224:227], v[64:67], v[192:195]
  v_exp_f32 v209, v209
  v_mfma_f32_16x16x32_bf16 v[212:215], a[228:231], v[68:71], v[212:215]
  v_add_f32 v239, v239, v209
  v_cvt_pk_bf16_f32 v222, v208, v209
  v_mfma_f32_16x16x32_bf16 v[212:215], a[232:235], v[72:75], v[212:215]
  v_exp_f32 v210, v210
  v_mfma_f32_16x16x32_bf16 v[212:215], a[236:239], v[76:79], v[212:215]
  ds_read_b64_tr_b16 v[120:121], v225 offset:64
  v_add_f32 v239, v239, v210
  v_mfma_f32_16x16x32_bf16 v[216:219], a[240:243], v[64:67], v[192:195]
  v_exp_f32 v211, v211
  v_mfma_f32_16x16x32_bf16 v[216:219], a[244:247], v[68:71], v[216:219]
  v_add_f32 v239, v239, v211
  v_cvt_pk_bf16_f32 v223, v210, v211
  v_mfma_f32_16x16x32_bf16 v[216:219], a[248:251], v[72:75], v[216:219]
  v_exp_f32 v212, v212
  v_mfma_f32_16x16x32_bf16 v[216:219], a[252:255], v[76:79], v[216:219]
  ds_read_b64_tr_b16 v[122:123], v225 offset:576
  v_add_f32 v240, v240, v212
  v_mfma_f32_16x16x32_bf16 a[96:99], v[144:147], v[220:223], a[96:99]
  v_exp_f32 v213, v213
  v_mfma_f32_16x16x32_bf16 a[100:103], v[148:151], v[220:223], a[100:103]
  v_add_f32 v240, v240, v213
  v_cvt_pk_bf16_f32 v232, v212, v213
  v_mfma_f32_16x16x32_bf16 a[104:107], v[152:155], v[220:223], a[104:107]
  v_exp_f32 v214, v214
  v_mfma_f32_16x16x32_bf16 a[108:111], v[156:159], v[220:223], a[108:111]
  ds_read_b64_tr_b16 v[124:125], v225 offset:96
  v_add_f32 v240, v240, v214
  v_mfma_f32_16x16x32_bf16 a[112:115], v[160:163], v[220:223], a[112:115]
  v_exp_f32 v215, v215
  v_mfma_f32_16x16x32_bf16 a[116:119], v[164:167], v[220:223], a[116:119]
  v_add_f32 v240, v240, v215
  v_cvt_pk_bf16_f32 v233, v214, v215
  v_mfma_f32_16x16x32_bf16 a[120:123], v[168:171], v[220:223], a[120:123]
  v_exp_f32 v216, v216
  v_mfma_f32_16x16x32_bf16 a[124:127], v[172:175], v[220:223], a[124:127]
  ds_read_b64_tr_b16 v[126:127], v225 offset:608
  v_add_f32 v240, v240, v216
  v_mfma_f32_16x16x32_bf16 v[204:207], a[224:227], v[80:83], v[196:199]
  v_exp_f32 v217, v217
  v_mfma_f32_16x16x32_bf16 v[204:207], a[228:231], v[84:87], v[204:207]
  v_add_f32 v240, v240, v217
  v_cvt_pk_bf16_f32 v234, v216, v217
  v_mfma_f32_16x16x32_bf16 v[204:207], a[232:235], v[88:91], v[204:207]
  v_exp_f32 v218, v218
  v_mfma_f32_16x16x32_bf16 v[204:207], a[236:239], v[92:95], v[204:207]
  ds_read_b64_tr_b16 v[128:129], v225 offset:128
  v_add_f32 v240, v240, v218
  v_mfma_f32_16x16x32_bf16 v[208:211], a[240:243], v[80:83], v[196:199]
  v_exp_f32 v219, v219
  v_mfma_f32_16x16x32_bf16 v[208:211], a[244:247], v[84:87], v[208:211]
  v_add_f32 v240, v240, v219
  v_cvt_pk_bf16_f32 v235, v218, v219
  v_mfma_f32_16x16x32_bf16 v[208:211], a[248:251], v[88:91], v[208:211]
  v_exp_f32 v204, v204
  v_mfma_f32_16x16x32_bf16 v[208:211], a[252:255], v[92:95], v[208:211]
  ds_read_b64_tr_b16 v[130:131], v225 offset:640
  v_add_f32 v241, v241, v204
  v_mfma_f32_16x16x32_bf16 a[128:131], v[144:147], v[232:235], a[128:131]
  v_exp_f32 v205, v205
  v_mfma_f32_16x16x32_bf16 a[132:135], v[148:151], v[232:235], a[132:135]
  ds_read_b64_tr_b16 v[132:133], v225 offset:160
  v_add_f32 v241, v241, v205
  v_cvt_pk_bf16_f32 v220, v204, v205
  v_mfma_f32_16x16x32_bf16 a[136:139], v[152:155], v[232:235], a[136:139]
  v_exp_f32 v206, v206
  v_mfma_f32_16x16x32_bf16 a[140:143], v[156:159], v[232:235], a[140:143]
  ds_read_b64_tr_b16 v[134:135], v225 offset:672
  v_add_f32 v241, v241, v206
  v_mfma_f32_16x16x32_bf16 a[144:147], v[160:163], v[232:235], a[144:147]
  v_exp_f32 v207, v207
  v_mfma_f32_16x16x32_bf16 a[148:151], v[164:167], v[232:235], a[148:151]
  ds_read_b64_tr_b16 v[136:137], v225 offset:192
  v_add_f32 v241, v241, v207
  v_cvt_pk_bf16_f32 v221, v206, v207
  v_mfma_f32_16x16x32_bf16 a[152:155], v[168:171], v[232:235], a[152:155]
  v_exp_f32 v208, v208
  v_mfma_f32_16x16x32_bf16 a[156:159], v[172:175], v[232:235], a[156:159]
  ds_read_b64_tr_b16 v[138:139], v225 offset:704
  v_add_f32 v241, v241, v208
  v_mfma_f32_16x16x32_bf16 v[212:215], a[224:227], v[96:99], v[200:203]
  v_exp_f32 v209, v209
  v_mfma_f32_16x16x32_bf16 v[212:215], a[228:231], v[100:103], v[212:215]
  ds_read_b128 a[224:227], v224 offset:0
  v_add_f32 v241, v241, v209
  v_cvt_pk_bf16_f32 v222, v208, v209
  v_mfma_f32_16x16x32_bf16 v[212:215], a[232:235], v[104:107], v[212:215]
  v_exp_f32 v210, v210
  v_mfma_f32_16x16x32_bf16 v[212:215], a[236:239], v[108:111], v[212:215]
  ds_read_b128 a[228:231], v224 offset:64
  v_add_f32 v241, v241, v210
  v_mfma_f32_16x16x32_bf16 v[216:219], a[240:243], v[96:99], v[200:203]
  v_exp_f32 v211, v211
  v_mfma_f32_16x16x32_bf16 v[216:219], a[244:247], v[100:103], v[216:219]
  ds_read_b128 a[232:235], v224 offset:128
  v_add_f32 v241, v241, v211
  v_cvt_pk_bf16_f32 v223, v210, v211
  v_mfma_f32_16x16x32_bf16 v[216:219], a[248:251], v[104:107], v[216:219]
  v_exp_f32 v212, v212
  v_mfma_f32_16x16x32_bf16 v[216:219], a[252:255], v[108:111], v[216:219]
  ds_read_b128 a[236:239], v224 offset:192
  v_add_f32 v242, v242, v212
  v_mfma_f32_16x16x32_bf16 a[160:163], v[144:147], v[220:223], a[160:163]
  v_exp_f32 v213, v213
  v_mfma_f32_16x16x32_bf16 a[164:167], v[148:151], v[220:223], a[164:167]
  ds_read_b128 a[240:243], v224 offset:512
  v_add_f32 v242, v242, v213
  v_cvt_pk_bf16_f32 v232, v212, v213
  v_mfma_f32_16x16x32_bf16 a[168:171], v[152:155], v[220:223], a[168:171]
  v_exp_f32 v214, v214
  v_mfma_f32_16x16x32_bf16 a[172:175], v[156:159], v[220:223], a[172:175]
  ds_read_b128 a[244:247], v224 offset:576
  v_add_f32 v242, v242, v214
  v_mfma_f32_16x16x32_bf16 a[176:179], v[160:163], v[220:223], a[176:179]
  v_exp_f32 v215, v215
  v_mfma_f32_16x16x32_bf16 a[180:183], v[164:167], v[220:223], a[180:183]
  ds_read_b128 a[248:251], v224 offset:640
  v_add_f32 v242, v242, v215
  v_cvt_pk_bf16_f32 v233, v214, v215
  v_mfma_f32_16x16x32_bf16 a[184:187], v[168:171], v[220:223], a[184:187]
  s_waitcnt lgkmcnt(3)
  v_exp_f32 v216, v216
  v_mfma_f32_16x16x32_bf16 a[188:191], v[172:175], v[220:223], a[188:191]
  ds_read_b128 a[252:255], v224 offset:704
  v_add_f32 v242, v242, v216
  v_mfma_f32_16x16x32_bf16 v[204:207], a[224:227], v[0:3], v[176:179]
  v_exp_f32 v217, v217
  v_mfma_f32_16x16x32_bf16 v[204:207], a[228:231], v[4:7], v[204:207]
  v_add_f32 v242, v242, v217
  v_cvt_pk_bf16_f32 v234, v216, v217
  v_mfma_f32_16x16x32_bf16 v[204:207], a[232:235], v[8:11], v[204:207]
  s_waitcnt lgkmcnt(2)
  v_exp_f32 v218, v218
  v_mfma_f32_16x16x32_bf16 v[204:207], a[236:239], v[12:15], v[204:207]
  ds_read_b64_tr_b16 v[140:141], v225 offset:224
  v_add_f32 v242, v242, v218
  v_mfma_f32_16x16x32_bf16 v[208:211], a[240:243], v[0:3], v[176:179]
  s_waitcnt lgkmcnt(1)
  v_exp_f32 v219, v219
  v_mfma_f32_16x16x32_bf16 v[208:211], a[244:247], v[4:7], v[208:211]
  v_add_f32 v242, v242, v219
  v_cvt_pk_bf16_f32 v235, v218, v219
  v_mfma_f32_16x16x32_bf16 v[208:211], a[248:251], v[8:11], v[208:211]
  v_exp_f32 v204, v204
  v_mfma_f32_16x16x32_bf16 v[208:211], a[252:255], v[12:15], v[208:211]
  ds_read_b64_tr_b16 v[142:143], v225 offset:736
  v_add_f32 v236, v236, v204
  v_mfma_f32_16x16x32_bf16 a[192:195], v[144:147], v[232:235], a[192:195]
  v_exp_f32 v205, v205
  v_mfma_f32_16x16x32_bf16 a[196:199], v[148:151], v[232:235], a[196:199]
  v_add_f32 v236, v236, v205
  v_cvt_pk_bf16_f32 v220, v204, v205
  v_mfma_f32_16x16x32_bf16 a[200:203], v[152:155], v[232:235], a[200:203]
  s_sub_u32 s30, s30, 1
  v_exp_f32 v206, v206
  v_mfma_f32_16x16x32_bf16 a[204:207], v[156:159], v[232:235], a[204:207]
  v_add_f32 v236, v236, v206
  v_mfma_f32_16x16x32_bf16 a[208:211], v[160:163], v[232:235], a[208:211]
  v_exp_f32 v207, v207
  v_mfma_f32_16x16x32_bf16 a[212:215], v[164:167], v[232:235], a[212:215]
  v_add_f32 v236, v236, v207
  v_cvt_pk_bf16_f32 v221, v206, v207
  v_mfma_f32_16x16x32_bf16 a[216:219], v[168:171], v[232:235], a[216:219]
  v_exp_f32 v208, v208
  v_mfma_f32_16x16x32_bf16 a[220:223], v[172:175], v[232:235], a[220:223]
  s_cmp_lg_u32 s30, 0
  s_cbranch_scc1 A_AL
A_ALX:
  v_mfma_f32_16x16x32_bf16 v[212:215], a[224:227], v[16:19], v[180:183]
  s_waitcnt vmcnt(1) lgkmcnt(0)
  s_barrier
  v_exp_f32 v209, v209
  v_mfma_f32_16x16x32_bf16 v[212:215], a[228:231], v[20:23], v[212:215]
  buffer_load_dword v243, v228, s[96:99], 0 offen sc1
  buffer_load_dword v244, v228, s[16:19], s94 offen sc1
  buffer_load_dword v245, v228, s[16:19], s95 offen sc1
  v_add_f32 v236, v236, v208
  v_add_f32 v236, v236, v209
  v_cvt_pk_bf16_f32 v222, v208, v209
  v_mfma_f32_16x16x32_bf16 v[212:215], a[232:235], v[24:27], v[212:215]
  v_exp_f32 v210, v210
  v_mfma_f32_16x16x32_bf16 v[212:215], a[236:239], v[28:31], v[212:215]
  ds_read_b64_tr_b16 v[144:145], v225 offset:8704
  v_add_f32 v236, v236, v210
  v_mfma_f32_16x16x32_bf16 v[216:219], a[240:243], v[16:19], v[180:183]
  v_exp_f32 v211, v211
  v_mfma_f32_16x16x32_bf16 v[216:219], a[244:247], v[20:23], v[216:219]
  v_add_f32 v236, v236, v211
  v_cvt_pk_bf16_f32 v223, v210, v211
  v_mfma_f32_16x16x32_bf16 v[216:219], a[248:251], v[24:27], v[216:219]
  s_add_u32 m0, s24, 0
  v_exp_f32 v212, v212
  v_mfma_f32_16x16x32_bf16 v[216:219], a[252:255], v[28:31], v[216:219]
  buffer_load_dwordx4 v229, s[8:11], s31 offen lds
  v_mfma_f32_16x16x32_bf16 a[0:3], v[112:115], v[220:223], a[0:3]
  s_add_u32 s31, s31, s27
  v_exp_f32 v213, v213
  v_mfma_f32_16x16x32_bf16 a[4:7], v[116:119], v[220:223], a[4:7]
  v_add_f32 v237, v237, v212
  v_add_f32 v237, v237, v213
  v_cvt_pk_bf16_f32 v232, v212, v213
  v_mfma_f32_16x16x32_bf16 a[8:11], v[120:123], v[220:223], a[8:11]
  s_add_u32 m0, s24, 1088
  v_exp_f32 v214, v214
  v_mfma_f32_16x16x32_bf16 a[12:15], v[124:127], v[220:223], a[12:15]
  buffer_load_dwordx4 v229, s[8:11], s31 offen lds
  v_mfma_f32_16x16x32_bf16 a[16:19], v[128:131], v[220:223], a[16:19]
  s_add_u32 s31, s31, s27
  v_exp_f32 v215, v215
  v_mfma_f32_16x16x32_bf16 a[20:23], v[132:135], v[220:223], a[20:23]
  v_add_f32 v237, v237, v214
  v_add_f32 v237, v237, v215
  v_cvt_pk_bf16_f32 v233, v214, v215
  v_mfma_f32_16x16x32_bf16 a[24:27], v[136:139], v[220:223], a[24:27]
  s_add_u32 m0, s24, 2176
  v_exp_f32 v216, v216
  v_mfma_f32_16x16x32_bf16 a[28:31], v[140:143], v[220:223], a[28:31]
  buffer_load_dwordx4 v229, s[8:11], s31 offen lds
  v_mfma_f32_16x16x32_bf16 v[204:207], a[224:227], v[32:35], v[184:187]
  s_add_u32 s31, s31, s27
  v_exp_f32 v217, v217
  v_mfma_f32_16x16x32_bf16 v[204:207], a[228:231], v[36:39], v[204:207]
  v_add_f32 v237, v237, v216
  v_add_f32 v237, v237, v217
  v_cvt_pk_bf16_f32 v234, v216, v217
  v_mfma_f32_16x16x32_bf16 v[204:207], a[232:235], v[40:43], v[204:207]
  s_add_u32 m0, s24, 3264
  v_exp_f32 v218, v218
  v_mfma_f32_16x16x32_bf16 v[204:207], a[236:239], v[44:47], v[204:207]
  buffer_load_dwordx4 v229, s[8:11], s31 offen lds
  v_mfma_f32_16x16x32_bf16 v[208:211], a[240:243], v[32:35], v[184:187]
  s_add_u32 s31, s31, s27
  v_exp_f32 v219, v219
  v_mfma_f32_16x16x32_bf16 v[208:211], a[244:247], v[36:39], v[208:211]
  v_add_f32 v237, v237, v218
  v_add_f32 v237, v237, v219
  v_cvt_pk_bf16_f32 v235, v218, v219
  v_mfma_f32_16x16x32_bf16 v[208:211], a[248:251], v[40:43], v[208:211]
  s_add_u32 m0, s24, 4352
  v_exp_f32 v204, v204
  v_mfma_f32_16x16x32_bf16 v[208:211], a[252:255], v[44:47], v[208:211]
  buffer_load_dwordx4 v229, s[8:11], s31 offen lds
  v_mfma_f32_16x16x32_bf16 a[32:35], v[112:115], v[232:235], a[32:35]
  s_add_u32 s31, s31, s27
  v_exp_f32 v205, v205
  v_mfma_f32_16x16x32_bf16 a[36:39], v[116:119], v[232:235], a[36:39]
  v_add_f32 v238, v238, v204
  v_add_f32 v238, v238, v205
  v_cvt_pk_bf16_f32 v220, v204, v205
  v_mfma_f32_16x16x32_bf16 a[40:43], v[120:123], v[232:235], a[40:43]
  s_add_u32 m0, s24, 5440
  v_exp_f32 v206, v206
  v_mfma_f32_16x16x32_bf16 a[44:47], v[124:127], v[232:235], a[44:47]
  buffer_load_dwordx4 v229, s[8:11], s31 offen lds
  v_mfma_f32_16x16x32_bf16 a[48:51], v[128:131], v[232:235], a[48:51]
  s_add_u32 s31, s31, s27
  v_exp_f32 v207, v207
  v_mfma_f32_16x16x32_bf16 a[52:55], v[132:135], v[232:235], a[52:55]
  v_add_f32 v238, v238, v206
  v_add_f32 v238, v238, v207
  v_cvt_pk_bf16_f32 v221, v206, v207
  v_mfma_f32_16x16x32_bf16 a[56:59], v[136:139], v[232:235], a[56:59]
  s_add_u32 m0, s24, 6528
  v_exp_f32 v208, v208
  v_mfma_f32_16x16x32_bf16 a[60:63], v[140:143], v[232:235], a[60:63]
  buffer_load_dwordx4 v229, s[8:11], s31 offen lds
  v_mfma_f32_16x16x32_bf16 v[212:215], a[224:227], v[48:51], v[188:191]
  s_add_u32 s31, s31, s27
  v_exp_f32 v209, v209
  v_mfma_f32_16x16x32_bf16 v[212:215], a[228:231], v[52:55], v[212:215]
  v_add_f32 v238, v238, v208
  v_add_f32 v238, v238, v209
  v_cvt_pk_bf16_f32 v222, v208, v209
  v_mfma_f32_16x16x32_bf16 v[212:215], a[232:235], v[56:59], v[212:215]
  s_cmp_gt_u32 s22, s23
  s_cselect_b32 s46, s24, 0x30000
  s_cselect_b32 s40, 0, 2147418112
  s_add_u32 m0, s24, 7616
  v_exp_f32 v210, v210
  v_mfma_f32_16x16x32_bf16 v[212:215], a[236:239], v[60:63], v[212:215]
  buffer_load_dwordx4 v229, s[8:11], s31 offen lds
  v_mfma_f32_16x16x32_bf16 v[216:219], a[240:243], v[48:51], v[188:191]
  s_add_u32 m0, s46, 34816
  s_add_u32 s26, s26, s28
  s_mov_b32 s31, s26
  v_exp_f32 v211, v211
  v_mfma_f32_16x16x32_bf16 v[216:219], a[244:247], v[52:55], v[216:219]
  buffer_load_dwordx4 v229, s[8:11], s40 offen lds
  v_add_f32 v238, v238, v210
  v_add_f32 v238, v238, v211
  v_cvt_pk_bf16_f32 v223, v210, v211
  v_mfma_f32_16x16x32_bf16 v[216:219], a[248:251], v[56:59], v[216:219]
  s_add_u32 s40, s40, 10240
  v_exp_f32 v212, v212
  v_mfma_f32_16x16x32_bf16 v[216:219], a[252:255], v[60:63], v[216:219]
  ds_read_b64_tr_b16 v[146:147], v225 offset:9216
  v_add_f32 v239, v239, v212
  v_mfma_f32_16x16x32_bf16 a[64:67], v[112:115], v[220:223], a[64:67]
  s_add_u32 m0, s46, 35904
  v_exp_f32 v213, v213
  v_mfma_f32_16x16x32_bf16 a[68:71], v[116:119], v[220:223], a[68:71]
  buffer_load_dwordx4 v229, s[8:11], s40 offen lds
  v_add_f32 v239, v239, v213
  v_cvt_pk_bf16_f32 v232, v212, v213
  v_mfma_f32_16x16x32_bf16 a[72:75], v[120:123], v[220:223], a[72:75]
  s_add_u32 s40, s40, 10240
  v_exp_f32 v214, v214
  v_mfma_f32_16x16x32_bf16 a[76:79], v[124:127], v[220:223], a[76:79]
  ds_read_b64_tr_b16 v[148:149], v225 offset:8736
  v_add_f32 v239, v239, v214
  v_mfma_f32_16x16x32_bf16 a[80:83], v[128:131], v[220:223], a[80:83]
  s_add_u32 m0, s46, 36992
  v_exp_f32 v215, v215
  v_mfma_f32_16x16x32_bf16 a[84:87], v[132:135], v[220:223], a[84:87]
  buffer_load_dwordx4 v229, s[8:11], s40 offen lds
  v_add_f32 v239, v239, v215
  v_cvt_pk_bf16_f32 v233, v214, v215
  v_mfma_f32_16x16x32_bf16 a[88:91], v[136:139], v[220:223], a[88:91]
  s_add_u32 s40, s40, 10240
  v_exp_f32 v216, v216
  v_mfma_f32_16x16x32_bf16 a[92:95], v[140:143], v[220:223], a[92:95]
  ds_read_b64_tr_b16 v[150:151], v225 offset:9248
  v_add_f32 v239, v239, v216
  v_mfma_f32_16x16x32_bf16 v[204:207], a[224:227], v[64:67], v[192:195]
  s_add_u32 m0, s46, 38080
  v_exp_f32 v217, v217
  v_mfma_f32_16x16x32_bf16 v[204:207], a[228:231], v[68:71], v[204:207]
  buffer_load_dwordx4 v229, s[8:11], s40 offen lds
  v_add_f32 v239, v239, v217
  v_cvt_pk_bf16_f32 v234, v216, v217
  v_mfma_f32_16x16x32_bf16 v[204:207], a[232:235], v[72:75], v[204:207]
  s_add_u32 s40, s40, 10240
  v_exp_f32 v218, v218
  v_mfma_f32_16x16x32_bf16 v[204:207], a[236:239], v[76:79], v[204:207]
  ds_read_b64_tr_b16 v[152:153], v225 offset:8768
  v_add_f32 v239, v239, v218
  v_mfma_f32_16x16x32_bf16 v[208:211], a[240:243], v[64:67], v[192:195]
  s_add_u32 m0, s46, 39168
  v_exp_f32 v219, v219
  v_mfma_f32_16x16x32_bf16 v[208:211], a[244:247], v[68:71], v[208:211]
  buffer_load_dwordx4 v229, s[8:11], s40 offen lds
  v_add_f32 v239, v239, v219
  v_cvt_pk_bf16_f32 v235, v218, v219
  v_mfma_f32_16x16x32_bf16 v[208:211], a[248:251], v[72:75], v[208:211]
  s_add_u32 s40, s40, 10240
  v_exp_f32 v204, v204
  v_mfma_f32_16x16x32_bf16 v[208:211], a[252:255], v[76:79], v[208:211]
  ds_read_b64_tr_b16 v[154:155], v225 offset:9280
  v_add_f32 v240, v240, v204
  v_mfma_f32_16x16x32_bf16 a[96:99], v[112:115], v[232:235], a[96:99]
  s_add_u32 m0, s46, 40256
  v_exp_f32 v205, v205
  v_mfma_f32_16x16x32_bf16 a[100:103], v[116:119], v[232:235], a[100:103]
  buffer_load_dwordx4 v229, s[8:11], s40 offen lds
  v_add_f32 v240, v240, v205
  v_cvt_pk_bf16_f32 v220, v204, v205
  v_mfma_f32_16x16x32_bf16 a[104:107], v[120:123], v[232:235], a[104:107]
  s_add_u32 s40, s40, 10240
  v_exp_f32 v206, v206
  v_mfma_f32_16x16x32_bf16 a[108:111], v[124:127], v[232:235], a[108:111]
  ds_read_b64_tr_b16 v[156:157], v225 offset:8800
  v_add_f32 v240, v240, v206
  v_mfma_f32_16x16x32_bf16 a[112:115], v[128:131], v[232:235], a[112:115]
  s_add_u32 m0, s46, 41344
  v_exp_f32 v207, v207
  v_mfma_f32_16x16x32_bf16 a[116:119], v[132:135], v[232:235], a[116:119]
  buffer_load_dwordx4 v229, s[8:11], s40 offen lds
  v_add_f32 v240, v240, v207
  v_cvt_pk_bf16_f32 v221, v206, v207
  v_mfma_f32_16x16x32_bf16 a[120:123], v[136:139], v[232:235], a[120:123]
  s_add_u32 s40, s40, 10240
  v_exp_f32 v208, v208
  v_mfma_f32_16x16x32_bf16 a[124:127], v[140:143], v[232:235], a[124:127]
  ds_read_b64_tr_b16 v[158:159], v225 offset:9312
  v_add_f32 v240, v240, v208
  v_mfma_f32_16x16x32_bf16 v[212:215], a[224:227], v[80:83], v[196:199]
  s_add_u32 m0, s46, 42432
  v_exp_f32 v209, v209
  v_mfma_f32_16x16x32_bf16 v[212:215], a[228:231], v[84:87], v[212:215]
  buffer_load_dwordx4 v229, s[8:11], s40 offen lds
  v_add_f32 v240, v240, v209
  v_cvt_pk_bf16_f32 v222, v208, v209
  v_mfma_f32_16x16x32_bf16 v[212:215], a[232:235], v[88:91], v[212:215]
  s_add_u32 s40, s40, 10240
  v_exp_f32 v210, v210
  v_mfma_f32_16x16x32_bf16 v[212:215], a[236:239], v[92:95], v[212:215]
  ds_read_b64_tr_b16 v[160:161], v225 offset:8832
  v_add_f32 v240, v240, v210
  v_mfma_f32_16x16x32_bf16 v[216:219], a[240:243], v[80:83], v[196:199]
  v_exp_f32 v211, v211
  v_mfma_f32_16x16x32_bf16 v[216:219], a[244:247], v[84:87], v[216:219]
  v_add_f32 v240, v240, v211
  v_cvt_pk_bf16_f32 v223, v210, v211
  v_mfma_f32_16x16x32_bf16 v[216:219], a[248:251], v[88:91], v[216:219]
  v_exp_f32 v212, v212
  v_mfma_f32_16x16x32_bf16 v[216:219], a[252:255], v[92:95], v[216:219]
  ds_read_b64_tr_b16 v[162:163], v225 offset:9344
  v_add_f32 v241, v241, v212
  v_mfma_f32_16x16x32_bf16 a[128:131], v[112:115], v[220:223], a[128:131]
  v_exp_f32 v213, v213
  v_mfma_f32_16x16x32_bf16 a[132:135], v[116:119], v[220:223], a[132:135]
  ds_read_b64_tr_b16 v[164:165], v225 offset:8864
  v_add_f32 v241, v241, v213
  v_cvt_pk_bf16_f32 v232, v212, v213
  v_mfma_f32_16x16x32_bf16 a[136:139], v[120:123], v[220:223], a[136:139]
  v_exp_f32 v214, v214
  v_mfma_f32_16x16x32_bf16 a[140:143], v[124:127], v[220:223], a[140:143]
  ds_read_b64_tr_b16 v[166:167], v225 offset:9376
  v_add_f32 v241, v241, v214
  v_mfma_f32_16x16x32_bf16 a[144:147], v[128:131], v[220:223], a[144:147]
  v_exp_f32 v215, v215
  v_mfma_f32_16x16x32_bf16 a[148:151], v[132:135], v[220:223], a[148:151]
  ds_read_b64_tr_b16 v[168:169], v225 offset:8896
  v_add_f32 v241, v241, v215
  v_cvt_pk_bf16_f32 v233, v214, v215
  v_mfma_f32_16x16x32_bf16 a[152:155], v[136:139], v[220:223], a[152:155]
  v_exp_f32 v216, v216
  v_mfma_f32_16x16x32_bf16 a[156:159], v[140:143], v[220:223], a[156:159]
  ds_read_b64_tr_b16 v[170:171], v225 offset:9408
  v_add_f32 v241, v241, v216
  v_mfma_f32_16x16x32_bf16 v[204:207], a[224:227], v[96:99], v[200:203]
  v_exp_f32 v217, v217
  v_mfma_f32_16x16x32_bf16 v[204:207], a[228:231], v[100:103], v[204:207]
  ds_read_b128 a[224:227], v224 offset:8704
  v_add_f32 v241, v241, v217
  v_cvt_pk_bf16_f32 v234, v216, v217
  v_mfma_f32_16x16x32_bf16 v[204:207], a[232:235], v[104:107], v[204:207]
  v_exp_f32 v218, v218
  v_mfma_f32_16x16x32_bf16 v[204:207], a[236:239], v[108:111], v[204:207]
  ds_read_b128 a[228:231], v224 offset:8768
  v_add_f32 v241, v241, v218
  v_mfma_f32_16x16x32_bf16 v[208:211], a[240:243], v[96:99], v[200:203]
  v_exp_f32 v219, v219
  v_mfma_f32_16x16x32_bf16 v[208:211], a[244:247], v[100:103], v[208:211]
  ds_read_b128 a[232:235], v224 offset:8832
  v_add_f32 v241, v241, v219
  v_cvt_pk_bf16_f32 v235, v218, v219
  v_mfma_f32_16x16x32_bf16 v[208:211], a[248:251], v[104:107], v[208:211]
  v_exp_f32 v204, v204
  v_mfma_f32_16x16x32_bf16 v[208:211], a[252:255], v[108:111], v[208:211]
  ds_read_b128 a[236:239], v224 offset:8896
  v_add_f32 v242, v242, v204
  v_mfma_f32_16x16x32_bf16 a[160:163], v[112:115], v[232:235], a[160:163]
  v_exp_f32 v205, v205
  v_mfma_f32_16x16x32_bf16 a[164:167], v[116:119], v[232:235], a[164:167]
  ds_read_b128 a[240:243], v224 offset:9216
  v_add_f32 v242, v242, v205
  v_cvt_pk_bf16_f32 v220, v204, v205
  v_mfma_f32_16x16x32_bf16 a[168:171], v[120:123], v[232:235], a[168:171]
  v_exp_f32 v206, v206
  v_mfma_f32_16x16x32_bf16 a[172:175], v[124:127], v[232:235], a[172:175]
  ds_read_b128 a[244:247], v224 offset:9280
  v_add_f32 v242, v242, v206
  v_mfma_f32_16x16x32_bf16 a[176:179], v[128:131], v[232:235], a[176:179]
  v_exp_f32 v207, v207
  v_mfma_f32_16x16x32_bf16 a[180:183], v[132:135], v[232:235], a[180:183]
  ds_read_b128 a[248:251], v224 offset:9344
  v_add_f32 v242, v242, v207
  v_cvt_pk_bf16_f32 v221, v206, v207
  v_mfma_f32_16x16x32_bf16 a[184:187], v[136:139], v[232:235], a[184:187]
  s_waitcnt lgkmcnt(3)
  v_exp_f32 v208, v208
  v_mfma_f32_16x16x32_bf16 a[188:191], v[140:143], v[232:235], a[188:191]
  ds_read_b128 a[252:255], v224 offset:9408
  v_add_f32 v242, v242, v208
  v_mfma_f32_16x16x32_bf16 v[212:215], a[224:227], v[0:3], v[176:179]
  v_exp_f32 v209, v209
  v_mfma_f32_16x16x32_bf16 v[212:215], a[228:231], v[4:7], v[212:215]
  v_add_f32 v242, v242, v209
  v_cvt_pk_bf16_f32 v222, v208, v209
  v_mfma_f32_16x16x32_bf16 v[212:215], a[232:235], v[8:11], v[212:215]
  s_waitcnt lgkmcnt(2)
  v_exp_f32 v210, v210
  v_mfma_f32_16x16x32_bf16 v[212:215], a[236:239], v[12:15], v[212:215]
  ds_read_b64_tr_b16 v[172:173], v225 offset:8928
  v_add_f32 v242, v242, v210
  v_mfma_f32_16x16x32_bf16 v[216:219], a[240:243], v[0:3], v[176:179]
  s_waitcnt lgkmcnt(1)
  v_exp_f32 v211, v211
  v_mfma_f32_16x16x32_bf16 v[216:219], a[244:247], v[4:7], v[216:219]
  v_add_f32 v242, v242, v211
  v_cvt_pk_bf16_f32 v223, v210, v211
  v_mfma_f32_16x16x32_bf16 v[216:219], a[248:251], v[8:11], v[216:219]
  v_exp_f32 v212, v212
  v_mfma_f32_16x16x32_bf16 v[216:219], a[252:255], v[12:15], v[216:219]
  ds_read_b64_tr_b16 v[174:175], v225 offset:9440
  v_add_f32 v236, v236, v212
  v_mfma_f32_16x16x32_bf16 a[192:195], v[112:115], v[220:223], a[192:195]
  v_exp_f32 v213, v213
  v_mfma_f32_16x16x32_bf16 a[196:199], v[116:119], v[220:223], a[196:199]
  v_add_f32 v236, v236, v213
  v_cvt_pk_bf16_f32 v232, v212, v213
  v_mfma_f32_16x16x32_bf16 a[200:203], v[120:123], v[220:223], a[200:203]
  v_exp_f32 v214, v214
  v_mfma_f32_16x16x32_bf16 a[204:207], v[124:127], v[220:223], a[204:207]
  v_add_f32 v236, v236, v214
  v_mfma_f32_16x16x32_bf16 a[208:211], v[128:131], v[220:223], a[208:211]
  v_exp_f32 v215, v215
  v_mfma_f32_16x16x32_bf16 a[212:215], v[132:135], v[220:223], a[212:215]
  v_add_f32 v236, v236, v215
  v_cvt_pk_bf16_f32 v233, v214, v215
  v_mfma_f32_16x16x32_bf16 a[216:219], v[136:139], v[220:223], a[216:219]
  v_exp_f32 v216, v216
  v_mfma_f32_16x16x32_bf16 a[220:223], v[140:143], v[220:223], a[220:223]
  v_mfma_f32_16x16x32_bf16 v[204:207], a[224:227], v[16:19], v[180:183]
  s_waitcnt vmcnt(24) lgkmcnt(0)
  s_barrier
  v_exp_f32 v217, v217
  v_mfma_f32_16x16x32_bf16 v[204:207], a[228:231], v[20:23], v[204:207]
  v_add_f32 v236, v236, v216
  v_add_f32 v236, v236, v217
  v_cvt_pk_bf16_f32 v234, v216, v217
  v_mfma_f32_16x16x32_bf16 v[204:207], a[232:235], v[24:27], v[204:207]
  v_exp_f32 v218, v218
  v_mfma_f32_16x16x32_bf16 v[204:207], a[236:239], v[28:31], v[204:207]
  ds_read_b64_tr_b16 v[112:113], v225 offset:17408
  v_add_f32 v236, v236, v218
  v_mfma_f32_16x16x32_bf16 v[208:211], a[240:243], v[16:19], v[180:183]
  v_exp_f32 v219, v219
  v_mfma_f32_16x16x32_bf16 v[208:211], a[244:247], v[20:23], v[208:211]
  v_add_f32 v236, v236, v219
  v_cvt_pk_bf16_f32 v235, v218, v219
  v_mfma_f32_16x16x32_bf16 v[208:211], a[248:251], v[24:27], v[208:211]
  s_add_u32 m0, s24, 8704
  v_exp_f32 v204, v204
  v_mfma_f32_16x16x32_bf16 v[208:211], a[252:255], v[28:31], v[208:211]
  buffer_load_dwordx4 v229, s[8:11], s31 offen lds
  v_mfma_f32_16x16x32_bf16 a[0:3], v[144:147], v[232:235], a[0:3]
  s_add_u32 s31, s31, s27
  v_exp_f32 v205, v205
  v_mfma_f32_16x16x32_bf16 a[4:7], v[148:151], v[232:235], a[4:7]
  v_add_f32 v237, v237, v204
  v_add_f32 v237, v237, v205
  v_cvt_pk_bf16_f32 v220, v204, v205
  v_mfma_f32_16x16x32_bf16 a[8:11], v[152:155], v[232:235], a[8:11]
  s_add_u32 m0, s24, 9792
  v_exp_f32 v206, v206
  v_mfma_f32_16x16x32_bf16 a[12:15], v[156:159], v[232:235], a[12:15]
  buffer_load_dwordx4 v229, s[8:11], s31 offen lds
  v_mfma_f32_16x16x32_bf16 a[16:19], v[160:163], v[232:235], a[16:19]
  s_add_u32 s31, s31, s27
  v_exp_f32 v207, v207
  v_mfma_f32_16x16x32_bf16 a[20:23], v[164:167], v[232:235], a[20:23]
  v_add_f32 v237, v237, v206
  v_add_f32 v237, v237, v207
  v_cvt_pk_bf16_f32 v221, v206, v207
  v_mfma_f32_16x16x32_bf16 a[24:27], v[168:171], v[232:235], a[24:27]
  s_add_u32 m0, s24, 10880
  v_exp_f32 v208, v208
  v_mfma_f32_16x16x32_bf16 a[28:31], v[172:175], v[232:235], a[28:31]
  buffer_load_dwordx4 v229, s[8:11], s31 offen lds
  v_mfma_f32_16x16x32_bf16 v[212:215], a[224:227], v[32:35], v[184:187]
  s_add_u32 s31, s31, s27
  v_exp_f32 v209, v209
  v_mfma_f32_16x16x32_bf16 v[212:215], a[228:231], v[36:39], v[212:215]
  v_add_f32 v237, v237, v208
  v_add_f32 v237, v237, v209
  v_cvt_pk_bf16_f32 v222, v208, v209
  v_mfma_f32_16x16x32_bf16 v[212:215], a[232:235], v[40:43], v[212:215]
  s_add_u32 m0, s24, 11968
  v_exp_f32 v210, v210
  v_mfma_f32_16x16x32_bf16 v[212:215], a[236:239], v[44:47], v[212:215]
  buffer_load_dwordx4 v229, s[8:11], s31 offen lds
  v_mfma_f32_16x16x32_bf16 v[216:219], a[240:243], v[32:35], v[184:187]
  s_add_u32 s31, s31, s27
  v_exp_f32 v211, v211
  v_mfma_f32_16x16x32_bf16 v[216:219], a[244:247], v[36:39], v[216:219]
  v_add_f32 v237, v237, v210
  v_add_f32 v237, v237, v211
  v_cvt_pk_bf16_f32 v223, v210, v211
  v_mfma_f32_16x16x32_bf16 v[216:219], a[248:251], v[40:43], v[216:219]
  s_add_u32 m0, s24, 13056
  v_exp_f32 v212, v212
  v_mfma_f32_16x16x32_bf16 v[216:219], a[252:255], v[44:47], v[216:219]
  buffer_load_dwordx4 v229, s[8:11], s31 offen lds
  v_mfma_f32_16x16x32_bf16 a[32:35], v[144:147], v[220:223], a[32:35]
  s_add_u32 s31, s31, s27
  v_exp_f32 v213, v213
  v_mfma_f32_16x16x32_bf16 a[36:39], v[148:151], v[220:223], a[36:39]
  v_add_f32 v238, v238, v212
  v_add_f32 v238, v238, v213
  v_cvt_pk_bf16_f32 v232, v212, v213
  v_mfma_f32_16x16x32_bf16 a[40:43], v[152:155], v[220:223], a[40:43]
  s_add_u32 m0, s24, 14144
  v_exp_f32 v214, v214
  v_mfma_f32_16x16x32_bf16 a[44:47], v[156:159], v[220:223], a[44:47]
  buffer_load_dwordx4 v229, s[8:11], s31 offen lds
  v_mfma_f32_16x16x32_bf16 a[48:51], v[160:163], v[220:223], a[48:51]
  s_add_u32 s31, s31, s27
  v_exp_f32 v215, v215
  v_mfma_f32_16x16x32_bf16 a[52:55], v[164:167], v[220:223], a[52:55]
  v_add_f32 v238, v238, v214
  v_add_f32 v238, v238, v215
  v_cvt_pk_bf16_f32 v233, v214, v215
  v_mfma_f32_16x16x32_bf16 a[56:59], v[168:171], v[220:223], a[56:59]
  s_add_u32 m0, s24, 15232
  v_exp_f32 v216, v216
  v_mfma_f32_16x16x32_bf16 a[60:63], v[172:175], v[220:223], a[60:63]
  buffer_load_dwordx4 v229, s[8:11], s31 offen lds
  v_mfma_f32_16x16x32_bf16 v[204:207], a[224:227], v[48:51], v[188:191]
  s_add_u32 s31, s31, s27
  v_exp_f32 v217, v217
  v_mfma_f32_16x16x32_bf16 v[204:207], a[228:231], v[52:55], v[204:207]
  v_add_f32 v238, v238, v216
  v_add_f32 v238, v238, v217
  v_cvt_pk_bf16_f32 v234, v216, v217
  v_mfma_f32_16x16x32_bf16 v[204:207], a[232:235], v[56:59], v[204:207]
  s_add_u32 m0, s24, 16320
  v_exp_f32 v218, v218
  v_mfma_f32_16x16x32_bf16 v[204:207], a[236:239], v[60:63], v[204:207]
  buffer_load_dwordx4 v229, s[8:11], s31 offen lds
  v_mfma_f32_16x16x32_bf16 v[208:211], a[240:243], v[48:51], v[188:191]
  s_add_u32 s26, s26, s29
  s_mov_b32 s31, s26
  v_exp_f32 v219, v219
  v_mfma_f32_16x16x32_bf16 v[208:211], a[244:247], v[52:55], v[208:211]
  v_add_f32 v238, v238, v218
  v_add_f32 v238, v238, v219
  v_cvt_pk_bf16_f32 v235, v218, v219
  v_mfma_f32_16x16x32_bf16 v[208:211], a[248:251], v[56:59], v[208:211]
  s_and_b32 s40, s32, 7
  v_exp_f32 v204, v204
  v_mfma_f32_16x16x32_bf16 v[208:211], a[252:255], v[60:63], v[208:211]
  ds_read_b64_tr_b16 v[114:115], v225 offset:17920
  v_add_f32 v239, v239, v204
  v_mfma_f32_16x16x32_bf16 a[64:67], v[144:147], v[232:235], a[64:67]
  s_lshl_b32 s40, s40, 19
  v_exp_f32 v205, v205
  v_mfma_f32_16x16x32_bf16 a[68:71], v[148:151], v[232:235], a[68:71]
  v_add_f32 v239, v239, v205
  v_cvt_pk_bf16_f32 v220, v204, v205
  v_mfma_f32_16x16x32_bf16 a[72:75], v[152:155], v[232:235], a[72:75]
  s_add_u32 s40, s40, 1048576
  v_exp_f32 v206, v206
  v_mfma_f32_16x16x32_bf16 a[76:79], v[156:159], v[232:235], a[76:79]
  ds_read_b64_tr_b16 v[116:117], v225 offset:17440
  v_add_f32 v239, v239, v206
  v_mfma_f32_16x16x32_bf16 a[80:83], v[160:163], v[232:235], a[80:83]
  s_add_u32 s41, s22, s23
  v_exp_f32 v207, v207
  v_mfma_f32_16x16x32_bf16 a[84:87], v[164:167], v[232:235], a[84:87]
  v_add_f32 v239, v239, v207
  v_cvt_pk_bf16_f32 v221, v206, v207
  v_mfma_f32_16x16x32_bf16 a[88:91], v[168:171], v[232:235], a[88:91]
  s_cmp_eq_u32 s41, 0
  s_cselect_b32 s40, s40, 2147418112
  v_exp_f32 v208, v208
  v_mfma_f32_16x16x32_bf16 a[92:95], v[172:175], v[232:235], a[92:95]
  ds_read_b64_tr_b16 v[118:119], v225 offset:17952
  v_add_f32 v239, v239, v208
  v_mfma_f32_16x16x32_bf16 v[212:215], a[224:227], v[64:67], v[192:195]
  v_lshlrev_b32 v248, 9, v230
  v_exp_f32 v209, v209
  v_mfma_f32_16x16x32_bf16 v[212:215], a[228:231], v[68:71], v[212:215]
  buffer_load_dword v246, v248, s[8:11], s40 offen
  v_add_f32 v239, v239, v209
  v_cvt_pk_bf16_f32 v222, v208, v209
  v_mfma_f32_16x16x32_bf16 v[212:215], a[232:235], v[72:75], v[212:215]
  v_exp_f32 v210, v210
  v_mfma_f32_16x16x32_bf16 v[212:215], a[236:239], v[76:79], v[212:215]
  ds_read_b64_tr_b16 v[120:121], v225 offset:17472
  v_add_f32 v239, v239, v210
  v_mfma_f32_16x16x32_bf16 v[216:219], a[240:243], v[64:67], v[192:195]
  v_exp_f32 v211, v211
  v_mfma_f32_16x16x32_bf16 v[216:219], a[244:247], v[68:71], v[216:219]
  buffer_load_dword v246, v248, s[8:11], s40 offen offset:128
  v_add_f32 v239, v239, v211
  v_cvt_pk_bf16_f32 v223, v210, v211
  v_mfma_f32_16x16x32_bf16 v[216:219], a[248:251], v[72:75], v[216:219]
  v_exp_f32 v212, v212
  v_mfma_f32_16x16x32_bf16 v[216:219], a[252:255], v[76:79], v[216:219]
  ds_read_b64_tr_b16 v[122:123], v225 offset:17984
  v_add_f32 v240, v240, v212
  v_mfma_f32_16x16x32_bf16 a[96:99], v[144:147], v[220:223], a[96:99]
  v_exp_f32 v213, v213
  v_mfma_f32_16x16x32_bf16 a[100:103], v[148:151], v[220:223], a[100:103]
  v_add_f32 v240, v240, v213
  v_cvt_pk_bf16_f32 v232, v212, v213
  v_mfma_f32_16x16x32_bf16 a[104:107], v[152:155], v[220:223], a[104:107]
  v_exp_f32 v214, v214
  v_mfma_f32_16x16x32_bf16 a[108:111], v[156:159], v[220:223], a[108:111]
  ds_read_b64_tr_b16 v[124:125], v225 offset:17504
  v_add_f32 v240, v240, v214
  v_mfma_f32_16x16x32_bf16 a[112:115], v[160:163], v[220:223], a[112:115]
  v_exp_f32 v215, v215
  v_mfma_f32_16x16x32_bf16 a[116:119], v[164:167], v[220:223], a[116:119]
  v_add_f32 v240, v240, v215
  v_cvt_pk_bf16_f32 v233, v214, v215
  v_mfma_f32_16x16x32_bf16 a[120:123], v[168:171], v[220:223], a[120:123]
  v_exp_f32 v216, v216
  v_mfma_f32_16x16x32_bf16 a[124:127], v[172:175], v[220:223], a[124:127]
  ds_read_b64_tr_b16 v[126:127], v225 offset:18016
  v_add_f32 v240, v240, v216
  v_mfma_f32_16x16x32_bf16 v[204:207], a[224:227], v[80:83], v[196:199]
  v_exp_f32 v217, v217
  v_mfma_f32_16x16x32_bf16 v[204:207], a[228:231], v[84:87], v[204:207]
  v_add_f32 v240, v240, v217
  v_cvt_pk_bf16_f32 v234, v216, v217
  v_mfma_f32_16x16x32_bf16 v[204:207], a[232:235], v[88:91], v[204:207]
  v_exp_f32 v218, v218
  v_mfma_f32_16x16x32_bf16 v[204:207], a[236:239], v[92:95], v[204:207]
  ds_read_b64_tr_b16 v[128:129], v225 offset:17536
  v_add_f32 v240, v240, v218
  v_mfma_f32_16x16x32_bf16 v[208:211], a[240:243], v[80:83], v[196:199]
  v_exp_f32 v219, v219
  v_mfma_f32_16x16x32_bf16 v[208:211], a[244:247], v[84:87], v[208:211]
  v_add_f32 v240, v240, v219
  v_cvt_pk_bf16_f32 v235, v218, v219
  v_mfma_f32_16x16x32_bf16 v[208:211], a[248:251], v[88:91], v[208:211]
  v_exp_f32 v204, v204
  v_mfma_f32_16x16x32_bf16 v[208:211], a[252:255], v[92:95], v[208:211]
  ds_read_b64_tr_b16 v[130:131], v225 offset:18048
  v_add_f32 v241, v241, v204
  v_mfma_f32_16x16x32_bf16 a[128:131], v[144:147], v[232:235], a[128:131]
  v_exp_f32 v205, v205
  v_mfma_f32_16x16x32_bf16 a[132:135], v[148:151], v[232:235], a[132:135]
  ds_read_b64_tr_b16 v[132:133], v225 offset:17568
  v_add_f32 v241, v241, v205
  v_cvt_pk_bf16_f32 v220, v204, v205
  v_mfma_f32_16x16x32_bf16 a[136:139], v[152:155], v[232:235], a[136:139]
  v_exp_f32 v206, v206
  v_mfma_f32_16x16x32_bf16 a[140:143], v[156:159], v[232:235], a[140:143]
  ds_read_b64_tr_b16 v[134:135], v225 offset:18080
  v_add_f32 v241, v241, v206
  v_mfma_f32_16x16x32_bf16 a[144:147], v[160:163], v[232:235], a[144:147]
  v_exp_f32 v207, v207
  v_mfma_f32_16x16x32_bf16 a[148:151], v[164:167], v[232:235], a[148:151]
  ds_read_b64_tr_b16 v[136:137], v225 offset:17600
  v_add_f32 v241, v241, v207
  v_cvt_pk_bf16_f32 v221, v206, v207
  v_mfma_f32_16x16x32_bf16 a[152:155], v[168:171], v[232:235], a[152:155]
  v_exp_f32 v208, v208
  v_mfma_f32_16x16x32_bf16 a[156:159], v[172:175], v[232:235], a[156:159]
  ds_read_b64_tr_b16 v[138:139], v225 offset:18112
  v_add_f32 v241, v241, v208
  v_mfma_f32_16x16x32_bf16 v[212:215], a[224:227], v[96:99], v[200:203]
  v_exp_f32 v209, v209
  v_mfma_f32_16x16x32_bf16 v[212:215], a[228:231], v[100:103], v[212:215]
  ds_read_b128 a[224:227], v224 offset:17408
  v_add_f32 v241, v241, v209
  v_cvt_pk_bf16_f32 v222, v208, v209
  v_mfma_f32_16x16x32_bf16 v[212:215], a[232:235], v[104:107], v[212:215]
  v_exp_f32 v210, v210
  v_mfma_f32_16x16x32_bf16 v[212:215], a[236:239], v[108:111], v[212:215]
  ds_read_b128 a[228:231], v224 offset:17472
  v_add_f32 v241, v241, v210
  v_mfma_f32_16x16x32_bf16 v[216:219], a[240:243], v[96:99], v[200:203]
  v_exp_f32 v211, v211
  v_mfma_f32_16x16x32_bf16 v[216:219], a[244:247], v[100:103], v[216:219]
  ds_read_b128 a[232:235], v224 offset:17536
  v_add_f32 v241, v241, v211
  v_cvt_pk_bf16_f32 v223, v210, v211
  v_mfma_f32_16x16x32_bf16 v[216:219], a[248:251], v[104:107], v[216:219]
  v_exp_f32 v212, v212
  v_mfma_f32_16x16x32_bf16 v[216:219], a[252:255], v[108:111], v[216:219]
  ds_read_b128 a[236:239], v224 offset:17600
  v_add_f32 v242, v242, v212
  v_mfma_f32_16x16x32_bf16 a[160:163], v[144:147], v[220:223], a[160:163]
  v_exp_f32 v213, v213
  v_mfma_f32_16x16x32_bf16 a[164:167], v[148:151], v[220:223], a[164:167]
  ds_read_b128 a[240:243], v224 offset:17920
  v_add_f32 v242, v242, v213
  v_cvt_pk_bf16_f32 v232, v212, v213
  v_mfma_f32_16x16x32_bf16 a[168:171], v[152:155], v[220:223], a[168:171]
  v_exp_f32 v214, v214
  v_mfma_f32_16x16x32_bf16 a[172:175], v[156:159], v[220:223], a[172:175]
  ds_read_b128 a[244:247], v224 offset:17984
  v_add_f32 v242, v242, v214
  v_mfma_f32_16x16x32_bf16 a[176:179], v[160:163], v[220:223], a[176:179]
  v_exp_f32 v215, v215
  v_mfma_f32_16x16x32_bf16 a[180:183], v[164:167], v[220:223], a[180:183]
  ds_read_b128 a[248:251], v224 offset:18048
  v_add_f32 v242, v242, v215
  v_cvt_pk_bf16_f32 v233, v214, v215
  v_mfma_f32_16x16x32_bf16 a[184:187], v[168:171], v[220:223], a[184:187]
  s_waitcnt lgkmcnt(3)
  v_exp_f32 v216, v216
  v_mfma_f32_16x16x32_bf16 a[188:191], v[172:175], v[220:223], a[188:191]
  ds_read_b128 a[252:255], v224 offset:18112
  v_add_f32 v242, v242, v216
  v_mfma_f32_16x16x32_bf16 v[204:207], a[224:227], v[0:3], v[176:179]
  v_exp_f32 v217, v217
  v_mfma_f32_16x16x32_bf16 v[204:207], a[228:231], v[4:7], v[204:207]
  v_add_f32 v242, v242, v217
  v_cvt_pk_bf16_f32 v234, v216, v217
  v_mfma_f32_16x16x32_bf16 v[204:207], a[232:235], v[8:11], v[204:207]
  s_waitcnt lgkmcnt(2)
  v_exp_f32 v218, v218
  v_mfma_f32_16x16x32_bf16 v[204:207], a[236:239], v[12:15], v[204:207]
  ds_read_b64_tr_b16 v[140:141], v225 offset:17632
  v_add_f32 v242, v242, v218
  v_mfma_f32_16x16x32_bf16 v[208:211], a[240:243], v[0:3], v[176:179]
  s_waitcnt lgkmcnt(1)
  v_exp_f32 v219, v219
  v_mfma_f32_16x16x32_bf16 v[208:211], a[244:247], v[4:7], v[208:211]
  v_add_f32 v242, v242, v219
  v_cvt_pk_bf16_f32 v235, v218, v219
  v_mfma_f32_16x16x32_bf16 v[208:211], a[248:251], v[8:11], v[208:211]
  v_exp_f32 v204, v204
  v_mfma_f32_16x16x32_bf16 v[208:211], a[252:255], v[12:15], v[208:211]
  ds_read_b64_tr_b16 v[142:143], v225 offset:18144
  v_add_f32 v236, v236, v204
  v_mfma_f32_16x16x32_bf16 a[192:195], v[144:147], v[232:235], a[192:195]
  v_exp_f32 v205, v205
  v_mfma_f32_16x16x32_bf16 a[196:199], v[148:151], v[232:235], a[196:199]
  v_add_f32 v236, v236, v205
  v_cvt_pk_bf16_f32 v220, v204, v205
  v_mfma_f32_16x16x32_bf16 a[200:203], v[152:155], v[232:235], a[200:203]
  v_exp_f32 v206, v206
  v_mfma_f32_16x16x32_bf16 a[204:207], v[156:159], v[232:235], a[204:207]
  v_add_f32 v236, v236, v206
  v_mfma_f32_16x16x32_bf16 a[208:211], v[160:163], v[232:235], a[208:211]
  v_exp_f32 v207, v207
  v_mfma_f32_16x16x32_bf16 a[212:215], v[164:167], v[232:235], a[212:215]
  v_add_f32 v236, v236, v207
  v_cvt_pk_bf16_f32 v221, v206, v207
  v_mfma_f32_16x16x32_bf16 a[216:219], v[168:171], v[232:235], a[216:219]
  v_exp_f32 v208, v208
  v_mfma_f32_16x16x32_bf16 a[220:223], v[172:175], v[232:235], a[220:223]
  v_mfma_f32_16x16x32_bf16 v[212:215], a[224:227], v[16:19], v[180:183]
  s_waitcnt vmcnt(24) lgkmcnt(0)
  s_barrier
  v_exp_f32 v209, v209
  v_mfma_f32_16x16x32_bf16 v[212:215], a[228:231], v[20:23], v[212:215]
  v_add_f32 v236, v236, v208
  v_add_f32 v236, v236, v209
  v_cvt_pk_bf16_f32 v222, v208, v209
  v_mfma_f32_16x16x32_bf16 v[212:215], a[232:235], v[24:27], v[212:215]
  v_exp_f32 v210, v210
  v_mfma_f32_16x16x32_bf16 v[212:215], a[236:239], v[28:31], v[212:215]
  ds_read_b64_tr_b16 v[144:145], v225 offset:26112
  v_add_f32 v236, v236, v210
  v_mfma_f32_16x16x32_bf16 v[216:219], a[240:243], v[16:19], v[180:183]
  v_exp_f32 v211, v211
  v_mfma_f32_16x16x32_bf16 v[216:219], a[244:247], v[20:23], v[216:219]
  v_add_f32 v236, v236, v211
  v_cvt_pk_bf16_f32 v223, v210, v211
  v_mfma_f32_16x16x32_bf16 v[216:219], a[248:251], v[24:27], v[216:219]
  s_add_u32 m0, s24, 17408
  v_exp_f32 v212, v212
  v_mfma_f32_16x16x32_bf16 v[216:219], a[252:255], v[28:31], v[216:219]
  buffer_load_dwordx4 v229, s[8:11], s31 offen lds
  v_mfma_f32_16x16x32_bf16 a[0:3], v[112:115], v[220:223], a[0:3]
  s_add_u32 s31, s31, s27
  v_exp_f32 v213, v213
  v_mfma_f32_16x16x32_bf16 a[4:7], v[116:119], v[220:223], a[4:7]
  v_add_f32 v237, v237, v212
  v_add_f32 v237, v237, v213
  v_cvt_pk_bf16_f32 v232, v212, v213
  v_mfma_f32_16x16x32_bf16 a[8:11], v[120:123], v[220:223], a[8:11]
  s_add_u32 m0, s24, 18496
  v_exp_f32 v214, v214
  v_mfma_f32_16x16x32_bf16 a[12:15], v[124:127], v[220:223], a[12:15]
  buffer_load_dwordx4 v229, s[8:11], s31 offen lds
  v_mfma_f32_16x16x32_bf16 a[16:19], v[128:131], v[220:223], a[16:19]
  s_add_u32 s31, s31, s27
  v_exp_f32 v215, v215
  v_mfma_f32_16x16x32_bf16 a[20:23], v[132:135], v[220:223], a[20:23]
  v_add_f32 v237, v237, v214
  v_add_f32 v237, v237, v215
  v_cvt_pk_bf16_f32 v233, v214, v215
  v_mfma_f32_16x16x32_bf16 a[24:27], v[136:139], v[220:223], a[24:27]
  s_add_u32 m0, s24, 19584
  v_exp_f32 v216, v216
  v_mfma_f32_16x16x32_bf16 a[28:31], v[140:143], v[220:223], a[28:31]
  buffer_load_dwordx4 v229, s[8:11], s31 offen lds
  v_mfma_f32_16x16x32_bf16 v[204:207], a[224:227], v[32:35], v[184:187]
  s_add_u32 s31, s31, s27
  v_exp_f32 v217, v217
  v_mfma_f32_16x16x32_bf16 v[204:207], a[228:231], v[36:39], v[204:207]
  v_add_f32 v237, v237, v216
  v_add_f32 v237, v237, v217
  v_cvt_pk_bf16_f32 v234, v216, v217
  v_mfma_f32_16x16x32_bf16 v[204:207], a[232:235], v[40:43], v[204:207]
  s_add_u32 m0, s24, 20672
  v_exp_f32 v218, v218
  v_mfma_f32_16x16x32_bf16 v[204:207], a[236:239], v[44:47], v[204:207]
  buffer_load_dwordx4 v229, s[8:11], s31 offen lds
  v_mfma_f32_16x16x32_bf16 v[208:211], a[240:243], v[32:35], v[184:187]
  s_add_u32 s31, s31, s27
  v_exp_f32 v219, v219
  v_mfma_f32_16x16x32_bf16 v[208:211], a[244:247], v[36:39], v[208:211]
  v_add_f32 v237, v237, v218
  v_add_f32 v237, v237, v219
  v_cvt_pk_bf16_f32 v235, v218, v219
  v_mfma_f32_16x16x32_bf16 v[208:211], a[248:251], v[40:43], v[208:211]
  s_add_u32 m0, s24, 21760
  v_exp_f32 v204, v204
  v_mfma_f32_16x16x32_bf16 v[208:211], a[252:255], v[44:47], v[208:211]
  buffer_load_dwordx4 v229, s[8:11], s31 offen lds
  v_mfma_f32_16x16x32_bf16 a[32:35], v[112:115], v[232:235], a[32:35]
  s_add_u32 s31, s31, s27
  v_exp_f32 v205, v205
  v_mfma_f32_16x16x32_bf16 a[36:39], v[116:119], v[232:235], a[36:39]
  v_add_f32 v238, v238, v204
  v_add_f32 v238, v238, v205
  v_cvt_pk_bf16_f32 v220, v204, v205
  v_mfma_f32_16x16x32_bf16 a[40:43], v[120:123], v[232:235], a[40:43]
  s_add_u32 m0, s24, 22848
  v_exp_f32 v206, v206
  v_mfma_f32_16x16x32_bf16 a[44:47], v[124:127], v[232:235], a[44:47]
  buffer_load_dwordx4 v229, s[8:11], s31 offen lds
  v_mfma_f32_16x16x32_bf16 a[48:51], v[128:131], v[232:235], a[48:51]
  s_add_u32 s31, s31, s27
  v_exp_f32 v207, v207
  v_mfma_f32_16x16x32_bf16 a[52:55], v[132:135], v[232:235], a[52:55]
  v_add_f32 v238, v238, v206
  v_add_f32 v238, v238, v207
  v_cvt_pk_bf16_f32 v221, v206, v207
  v_mfma_f32_16x16x32_bf16 a[56:59], v[136:139], v[232:235], a[56:59]
  s_add_u32 m0, s24, 23936
  v_exp_f32 v208, v208
  v_mfma_f32_16x16x32_bf16 a[60:63], v[140:143], v[232:235], a[60:63]
  buffer_load_dwordx4 v229, s[8:11], s31 offen lds
  v_mfma_f32_16x16x32_bf16 v[212:215], a[224:227], v[48:51], v[188:191]
  s_add_u32 s31, s31, s27
  v_exp_f32 v209, v209
  v_mfma_f32_16x16x32_bf16 v[212:215], a[228:231], v[52:55], v[212:215]
  v_add_f32 v238, v238, v208
  v_add_f32 v238, v238, v209
  v_cvt_pk_bf16_f32 v222, v208, v209
  v_mfma_f32_16x16x32_bf16 v[212:215], a[232:235], v[56:59], v[212:215]
  s_add_u32 m0, s24, 25024
  v_exp_f32 v210, v210
  v_mfma_f32_16x16x32_bf16 v[212:215], a[236:239], v[60:63], v[212:215]
  buffer_load_dwordx4 v229, s[8:11], s31 offen lds
  v_mfma_f32_16x16x32_bf16 v[216:219], a[240:243], v[48:51], v[188:191]
  s_add_u32 s26, s26, s28
  s_mov_b32 s31, s26
  v_exp_f32 v211, v211
  v_mfma_f32_16x16x32_bf16 v[216:219], a[244:247], v[52:55], v[216:219]
  v_add_f32 v238, v238, v210
  v_add_f32 v238, v238, v211
  v_cvt_pk_bf16_f32 v223, v210, v211
  v_mfma_f32_16x16x32_bf16 v[216:219], a[248:251], v[56:59], v[216:219]
  v_exp_f32 v212, v212
  v_mfma_f32_16x16x32_bf16 v[216:219], a[252:255], v[60:63], v[216:219]
  ds_read_b64_tr_b16 v[146:147], v225 offset:26624
  v_add_f32 v239, v239, v212
  v_mfma_f32_16x16x32_bf16 a[64:67], v[112:115], v[220:223], a[64:67]
  v_exp_f32 v213, v213
  v_mfma_f32_16x16x32_bf16 a[68:71], v[116:119], v[220:223], a[68:71]
  v_add_f32 v239, v239, v213
  v_cvt_pk_bf16_f32 v232, v212, v213
  v_mfma_f32_16x16x32_bf16 a[72:75], v[120:123], v[220:223], a[72:75]
  v_exp_f32 v214, v214
  v_mfma_f32_16x16x32_bf16 a[76:79], v[124:127], v[220:223], a[76:79]
  ds_read_b64_tr_b16 v[148:149], v225 offset:26144
  v_add_f32 v239, v239, v214
  v_mfma_f32_16x16x32_bf16 a[80:83], v[128:131], v[220:223], a[80:83]
  v_exp_f32 v215, v215
  v_mfma_f32_16x16x32_bf16 a[84:87], v[132:135], v[220:223], a[84:87]
  v_add_f32 v239, v239, v215
  v_cvt_pk_bf16_f32 v233, v214, v215
  v_mfma_f32_16x16x32_bf16 a[88:91], v[136:139], v[220:223], a[88:91]
  v_exp_f32 v216, v216
  v_mfma_f32_16x16x32_bf16 a[92:95], v[140:143], v[220:223], a[92:95]
  ds_read_b64_tr_b16 v[150:151], v225 offset:26656
  v_add_f32 v239, v239, v216
  v_mfma_f32_16x16x32_bf16 v[204:207], a[224:227], v[64:67], v[192:195]
  v_exp_f32 v217, v217
  v_mfma_f32_16x16x32_bf16 v[204:207], a[228:231], v[68:71], v[204:207]
  v_add_f32 v239, v239, v217
  v_cvt_pk_bf16_f32 v234, v216, v217
  v_mfma_f32_16x16x32_bf16 v[204:207], a[232:235], v[72:75], v[204:207]
  v_exp_f32 v218, v218
  v_mfma_f32_16x16x32_bf16 v[204:207], a[236:239], v[76:79], v[204:207]
  ds_read_b64_tr_b16 v[152:153], v225 offset:26176
  v_add_f32 v239, v239, v218
  v_mfma_f32_16x16x32_bf16 v[208:211], a[240:243], v[64:67], v[192:195]
  v_exp_f32 v219, v219
  v_mfma_f32_16x16x32_bf16 v[208:211], a[244:247], v[68:71], v[208:211]
  v_add_f32 v239, v239, v219
  v_cvt_pk_bf16_f32 v235, v218, v219
  v_mfma_f32_16x16x32_bf16 v[208:211], a[248:251], v[72:75], v[208:211]
  v_exp_f32 v204, v204
  v_mfma_f32_16x16x32_bf16 v[208:211], a[252:255], v[76:79], v[208:211]
  ds_read_b64_tr_b16 v[154:155], v225 offset:26688
  v_add_f32 v240, v240, v204
  v_mfma_f32_16x16x32_bf16 a[96:99], v[112:115], v[232:235], a[96:99]
  v_exp_f32 v205, v205
  v_mfma_f32_16x16x32_bf16 a[100:103], v[116:119], v[232:235], a[100:103]
  v_add_f32 v240, v240, v205
  v_cvt_pk_bf16_f32 v220, v204, v205
  v_mfma_f32_16x16x32_bf16 a[104:107], v[120:123], v[232:235], a[104:107]
  v_exp_f32 v206, v206
  v_mfma_f32_16x16x32_bf16 a[108:111], v[124:127], v[232:235], a[108:111]
  ds_read_b64_tr_b16 v[156:157], v225 offset:26208
  v_add_f32 v240, v240, v206
  v_mfma_f32_16x16x32_bf16 a[112:115], v[128:131], v[232:235], a[112:115]
  v_exp_f32 v207, v207
  v_mfma_f32_16x16x32_bf16 a[116:119], v[132:135], v[232:235], a[116:119]
  v_add_f32 v240, v240, v207
  v_cvt_pk_bf16_f32 v221, v206, v207
  v_mfma_f32_16x16x32_bf16 a[120:123], v[136:139], v[232:235], a[120:123]
  v_exp_f32 v208, v208
  v_mfma_f32_16x16x32_bf16 a[124:127], v[140:143], v[232:235], a[124:127]
  ds_read_b64_tr_b16 v[158:159], v225 offset:26720
  v_add_f32 v240, v240, v208
  v_mfma_f32_16x16x32_bf16 v[212:215], a[224:227], v[80:83], v[196:199]
  v_exp_f32 v209, v209
  v_mfma_f32_16x16x32_bf16 v[212:215], a[228:231], v[84:87], v[212:215]
  buffer_load_dword v246, v247, s[8:11], s38 offen
  v_add_f32 v240, v240, v209
  v_cvt_pk_bf16_f32 v222, v208, v209
  v_mfma_f32_16x16x32_bf16 v[212:215], a[232:235], v[88:91], v[212:215]
  s_add_u32 s41, s38, 2048
  v_exp_f32 v210, v210
  v_mfma_f32_16x16x32_bf16 v[212:215], a[236:239], v[92:95], v[212:215]
  ds_read_b64_tr_b16 v[160:161], v225 offset:26240
  v_add_f32 v240, v240, v210
  v_mfma_f32_16x16x32_bf16 v[216:219], a[240:243], v[80:83], v[196:199]
  v_exp_f32 v211, v211
  v_mfma_f32_16x16x32_bf16 v[216:219], a[244:247], v[84:87], v[216:219]
  buffer_load_dword v246, v247, s[8:11], s41 offen
  v_add_f32 v240, v240, v211
  v_cvt_pk_bf16_f32 v223, v210, v211
  v_mfma_f32_16x16x32_bf16 v[216:219], a[248:251], v[88:91], v[216:219]
  v_exp_f32 v212, v212
  v_mfma_f32_16x16x32_bf16 v[216:219], a[252:255], v[92:95], v[216:219]
  ds_read_b64_tr_b16 v[162:163], v225 offset:26752
  v_add_f32 v241, v241, v212
  v_mfma_f32_16x16x32_bf16 a[128:131], v[112:115], v[220:223], a[128:131]
  v_exp_f32 v213, v213
  v_mfma_f32_16x16x32_bf16 a[132:135], v[116:119], v[220:223], a[132:135]
  ds_read_b64_tr_b16 v[164:165], v225 offset:26272
  v_add_f32 v241, v241, v213
  v_cvt_pk_bf16_f32 v232, v212, v213
  v_mfma_f32_16x16x32_bf16 a[136:139], v[120:123], v[220:223], a[136:139]
  v_exp_f32 v214, v214
  v_mfma_f32_16x16x32_bf16 a[140:143], v[124:127], v[220:223], a[140:143]
  ds_read_b64_tr_b16 v[166:167], v225 offset:26784
  v_add_f32 v241, v241, v214
  v_mfma_f32_16x16x32_bf16 a[144:147], v[128:131], v[220:223], a[144:147]
  v_exp_f32 v215, v215
  v_mfma_f32_16x16x32_bf16 a[148:151], v[132:135], v[220:223], a[148:151]
  ds_read_b64_tr_b16 v[168:169], v225 offset:26304
  v_add_f32 v241, v241, v215
  v_cvt_pk_bf16_f32 v233, v214, v215
  v_mfma_f32_16x16x32_bf16 a[152:155], v[136:139], v[220:223], a[152:155]
  v_exp_f32 v216, v216
  v_mfma_f32_16x16x32_bf16 a[156:159], v[140:143], v[220:223], a[156:159]
  ds_read_b64_tr_b16 v[170:171], v225 offset:26816
  v_add_f32 v241, v241, v216
  v_mfma_f32_16x16x32_bf16 v[204:207], a[224:227], v[96:99], v[200:203]
  v_exp_f32 v217, v217
  v_mfma_f32_16x16x32_bf16 v[204:207], a[228:231], v[100:103], v[204:207]
  ds_read_b128 a[224:227], v224 offset:26112
  v_add_f32 v241, v241, v217
  v_cvt_pk_bf16_f32 v234, v216, v217
  v_mfma_f32_16x16x32_bf16 v[204:207], a[232:235], v[104:107], v[204:207]
  v_exp_f32 v218, v218
  v_mfma_f32_16x16x32_bf16 v[204:207], a[236:239], v[108:111], v[204:207]
  ds_read_b128 a[228:231], v224 offset:26176
  v_add_f32 v241, v241, v218
  v_mfma_f32_16x16x32_bf16 v[208:211], a[240:243], v[96:99], v[200:203]
  v_exp_f32 v219, v219
  v_mfma_f32_16x16x32_bf16 v[208:211], a[244:247], v[100:103], v[208:211]
  ds_read_b128 a[232:235], v224 offset:26240
  v_add_f32 v241, v241, v219
  v_cvt_pk_bf16_f32 v235, v218, v219
  v_mfma_f32_16x16x32_bf16 v[208:211], a[248:251], v[104:107], v[208:211]
  v_exp_f32 v204, v204
  v_mfma_f32_16x16x32_bf16 v[208:211], a[252:255], v[108:111], v[208:211]
  ds_read_b128 a[236:239], v224 offset:26304
  v_add_f32 v242, v242, v204
  v_mfma_f32_16x16x32_bf16 a[160:163], v[112:115], v[232:235], a[160:163]
  v_exp_f32 v205, v205
  v_mfma_f32_16x16x32_bf16 a[164:167], v[116:119], v[232:235], a[164:167]
  ds_read_b128 a[240:243], v224 offset:26624
  v_add_f32 v242, v242, v205
  v_cvt_pk_bf16_f32 v220, v204, v205
  v_mfma_f32_16x16x32_bf16 a[168:171], v[120:123], v[232:235], a[168:171]
  v_exp_f32 v206, v206
  v_mfma_f32_16x16x32_bf16 a[172:175], v[124:127], v[232:235], a[172:175]
  ds_read_b128 a[244:247], v224 offset:26688
  v_add_f32 v242, v242, v206
  v_mfma_f32_16x16x32_bf16 a[176:179], v[128:131], v[232:235], a[176:179]
  v_exp_f32 v207, v207
  v_mfma_f32_16x16x32_bf16 a[180:183], v[132:135], v[232:235], a[180:183]
  ds_read_b128 a[248:251], v224 offset:26752
  v_add_f32 v242, v242, v207
  v_cvt_pk_bf16_f32 v221, v206, v207
  v_mfma_f32_16x16x32_bf16 a[184:187], v[136:139], v[232:235], a[184:187]
  s_waitcnt lgkmcnt(3)
  v_exp_f32 v208, v208
  v_mfma_f32_16x16x32_bf16 a[188:191], v[140:143], v[232:235], a[188:191]
  ds_read_b128 a[252:255], v224 offset:26816
  v_add_f32 v242, v242, v208
  v_mfma_f32_16x16x32_bf16 v[212:215], a[224:227], v[0:3], v[176:179]
  v_exp_f32 v209, v209
  v_mfma_f32_16x16x32_bf16 v[212:215], a[228:231], v[4:7], v[212:215]
  v_add_f32 v242, v242, v209
  v_cvt_pk_bf16_f32 v222, v208, v209
  v_mfma_f32_16x16x32_bf16 v[212:215], a[232:235], v[8:11], v[212:215]
  s_waitcnt lgkmcnt(2)
  v_exp_f32 v210, v210
  v_mfma_f32_16x16x32_bf16 v[212:215], a[236:239], v[12:15], v[212:215]
  ds_read_b64_tr_b16 v[172:173], v225 offset:26336
  v_add_f32 v242, v242, v210
  v_mfma_f32_16x16x32_bf16 v[216:219], a[240:243], v[0:3], v[176:179]
  s_waitcnt lgkmcnt(1)
  v_exp_f32 v211, v211
  v_mfma_f32_16x16x32_bf16 v[216:219], a[244:247], v[4:7], v[216:219]
  v_add_f32 v242, v242, v211
  v_cvt_pk_bf16_f32 v223, v210, v211
  v_mfma_f32_16x16x32_bf16 v[216:219], a[248:251], v[8:11], v[216:219]
  v_exp_f32 v212, v212
  v_mfma_f32_16x16x32_bf16 v[216:219], a[252:255], v[12:15], v[216:219]
  ds_read_b64_tr_b16 v[174:175], v225 offset:26848
  v_add_f32 v236, v236, v212
  v_mfma_f32_16x16x32_bf16 a[192:195], v[112:115], v[220:223], a[192:195]
  v_exp_f32 v213, v213
  v_mfma_f32_16x16x32_bf16 a[196:199], v[116:119], v[220:223], a[196:199]
  v_add_f32 v236, v236, v213
  v_cvt_pk_bf16_f32 v232, v212, v213
  v_mfma_f32_16x16x32_bf16 a[200:203], v[120:123], v[220:223], a[200:203]
  v_exp_f32 v214, v214
  v_mfma_f32_16x16x32_bf16 a[204:207], v[124:127], v[220:223], a[204:207]
  v_add_f32 v236, v236, v214
  v_mfma_f32_16x16x32_bf16 a[208:211], v[128:131], v[220:223], a[208:211]
  v_exp_f32 v215, v215
  v_mfma_f32_16x16x32_bf16 a[212:215], v[132:135], v[220:223], a[212:215]
  v_add_f32 v236, v236, v215
  v_cvt_pk_bf16_f32 v233, v214, v215
  v_mfma_f32_16x16x32_bf16 a[216:219], v[136:139], v[220:223], a[216:219]
  v_exp_f32 v216, v216
  v_mfma_f32_16x16x32_bf16 a[220:223], v[140:143], v[220:223], a[220:223]
  v_mfma_f32_16x16x32_bf16 v[204:207], a[224:227], v[16:19], v[180:183]
  s_waitcnt lgkmcnt(0)
  s_barrier
  v_exp_f32 v217, v217
  v_mfma_f32_16x16x32_bf16 v[204:207], a[228:231], v[20:23], v[204:207]
  v_add_f32 v236, v236, v216
  v_add_f32 v236, v236, v217
  v_cvt_pk_bf16_f32 v234, v216, v217
  v_mfma_f32_16x16x32_bf16 v[204:207], a[232:235], v[24:27], v[204:207]
  v_exp_f32 v218, v218
  v_mfma_f32_16x16x32_bf16 v[204:207], a[236:239], v[28:31], v[204:207]
  v_add_f32 v236, v236, v218
  v_mfma_f32_16x16x32_bf16 v[208:211], a[240:243], v[16:19], v[180:183]
  v_exp_f32 v219, v219
  v_mfma_f32_16x16x32_bf16 v[208:211], a[244:247], v[20:23], v[208:211]
  v_add_f32 v236, v236, v219
  v_cvt_pk_bf16_f32 v235, v218, v219
  v_mfma_f32_16x16x32_bf16 v[208:211], a[248:251], v[24:27], v[208:211]
  s_add_u32 m0, s24, 26112
  v_exp_f32 v204, v204
  v_mfma_f32_16x16x32_bf16 v[208:211], a[252:255], v[28:31], v[208:211]
  buffer_load_dwordx4 v229, s[8:11], s31 offen lds
  v_mfma_f32_16x16x32_bf16 a[0:3], v[144:147], v[232:235], a[0:3]
  s_add_u32 s31, s31, s27
  v_exp_f32 v205, v205
  v_mfma_f32_16x16x32_bf16 a[4:7], v[148:151], v[232:235], a[4:7]
  v_add_f32 v237, v237, v204
  v_add_f32 v237, v237, v205
  v_cvt_pk_bf16_f32 v220, v204, v205
  v_mfma_f32_16x16x32_bf16 a[8:11], v[152:155], v[232:235], a[8:11]
  s_add_u32 m0, s24, 27200
  v_exp_f32 v206, v206
  v_mfma_f32_16x16x32_bf16 a[12:15], v[156:159], v[232:235], a[12:15]
  buffer_load_dwordx4 v229, s[8:11], s31 offen lds
  v_mfma_f32_16x16x32_bf16 a[16:19], v[160:163], v[232:235], a[16:19]
  s_add_u32 s31, s31, s27
  v_exp_f32 v207, v207
  v_mfma_f32_16x16x32_bf16 a[20:23], v[164:167], v[232:235], a[20:23]
  v_add_f32 v237, v237, v206
  v_add_f32 v237, v237, v207
  v_cvt_pk_bf16_f32 v221, v206, v207
  v_mfma_f32_16x16x32_bf16 a[24:27], v[168:171], v[232:235], a[24:27]
  s_add_u32 m0, s24, 28288
  v_exp_f32 v208, v208
  v_mfma_f32_16x16x32_bf16 a[28:31], v[172:175], v[232:235], a[28:31]
  buffer_load_dwordx4 v229, s[8:11], s31 offen lds
  v_mfma_f32_16x16x32_bf16 v[212:215], a[224:227], v[32:35], v[184:187]
  s_add_u32 s31, s31, s27
  v_exp_f32 v209, v209
  v_mfma_f32_16x16x32_bf16 v[212:215], a[228:231], v[36:39], v[212:215]
  v_add_f32 v237, v237, v208
  v_add_f32 v237, v237, v209
  v_cvt_pk_bf16_f32 v222, v208, v209
  v_mfma_f32_16x16x32_bf16 v[212:215], a[232:235], v[40:43], v[212:215]
  s_add_u32 m0, s24, 29376
  v_exp_f32 v210, v210
  v_mfma_f32_16x16x32_bf16 v[212:215], a[236:239], v[44:47], v[212:215]
  buffer_load_dwordx4 v229, s[8:11], s31 offen lds
  v_mfma_f32_16x16x32_bf16 v[216:219], a[240:243], v[32:35], v[184:187]
  s_add_u32 s31, s31, s27
  v_exp_f32 v211, v211
  v_mfma_f32_16x16x32_bf16 v[216:219], a[244:247], v[36:39], v[216:219]
  v_add_f32 v237, v237, v210
  v_add_f32 v237, v237, v211
  v_cvt_pk_bf16_f32 v223, v210, v211
  v_mfma_f32_16x16x32_bf16 v[216:219], a[248:251], v[40:43], v[216:219]
  s_add_u32 m0, s24, 30464
  v_exp_f32 v212, v212
  v_mfma_f32_16x16x32_bf16 v[216:219], a[252:255], v[44:47], v[216:219]
  buffer_load_dwordx4 v229, s[8:11], s31 offen lds
  v_mfma_f32_16x16x32_bf16 a[32:35], v[144:147], v[220:223], a[32:35]
  s_add_u32 s31, s31, s27
  v_exp_f32 v213, v213
  v_mfma_f32_16x16x32_bf16 a[36:39], v[148:151], v[220:223], a[36:39]
  v_add_f32 v238, v238, v212
  v_add_f32 v238, v238, v213
  v_cvt_pk_bf16_f32 v232, v212, v213
  v_mfma_f32_16x16x32_bf16 a[40:43], v[152:155], v[220:223], a[40:43]
  s_add_u32 m0, s24, 31552
  v_exp_f32 v214, v214
  v_mfma_f32_16x16x32_bf16 a[44:47], v[156:159], v[220:223], a[44:47]
  buffer_load_dwordx4 v229, s[8:11], s31 offen lds
  v_mfma_f32_16x16x32_bf16 a[48:51], v[160:163], v[220:223], a[48:51]
  s_add_u32 s31, s31, s27
  v_exp_f32 v215, v215
  v_mfma_f32_16x16x32_bf16 a[52:55], v[164:167], v[220:223], a[52:55]
  v_add_f32 v238, v238, v214
  v_add_f32 v238, v238, v215
  v_cvt_pk_bf16_f32 v233, v214, v215
  v_mfma_f32_16x16x32_bf16 a[56:59], v[168:171], v[220:223], a[56:59]
  s_add_u32 m0, s24, 32640
  v_exp_f32 v216, v216
  v_mfma_f32_16x16x32_bf16 a[60:63], v[172:175], v[220:223], a[60:63]
  buffer_load_dwordx4 v229, s[8:11], s31 offen lds
  v_mfma_f32_16x16x32_bf16 v[204:207], a[224:227], v[48:51], v[188:191]
  s_add_u32 s31, s31, s27
  v_exp_f32 v217, v217
  v_mfma_f32_16x16x32_bf16 v[204:207], a[228:231], v[52:55], v[204:207]
  v_add_f32 v238, v238, v216
  v_add_f32 v238, v238, v217
  v_cvt_pk_bf16_f32 v234, v216, v217
  v_mfma_f32_16x16x32_bf16 v[204:207], a[232:235], v[56:59], v[204:207]
  s_add_u32 m0, s24, 33728
  v_exp_f32 v218, v218
  v_mfma_f32_16x16x32_bf16 v[204:207], a[236:239], v[60:63], v[204:207]
  buffer_load_dwordx4 v229, s[8:11], s31 offen lds
  v_mfma_f32_16x16x32_bf16 v[208:211], a[240:243], v[48:51], v[188:191]
  s_add_u32 s26, s26, s29
  s_mov_b32 s31, s26
  v_exp_f32 v219, v219
  v_mfma_f32_16x16x32_bf16 v[208:211], a[244:247], v[52:55], v[208:211]
  v_add_f32 v238, v238, v218
  v_add_f32 v238, v238, v219
  v_cvt_pk_bf16_f32 v235, v218, v219
  v_mfma_f32_16x16x32_bf16 v[208:211], a[248:251], v[56:59], v[208:211]
  v_exp_f32 v204, v204
  v_mfma_f32_16x16x32_bf16 v[208:211], a[252:255], v[60:63], v[208:211]
  v_add_f32 v239, v239, v204
  v_mfma_f32_16x16x32_bf16 a[64:67], v[144:147], v[232:235], a[64:67]
  v_exp_f32 v205, v205
  v_mfma_f32_16x16x32_bf16 a[68:71], v[148:151], v[232:235], a[68:71]
  v_add_f32 v239, v239, v205
  v_cvt_pk_bf16_f32 v220, v204, v205
  v_mfma_f32_16x16x32_bf16 a[72:75], v[152:155], v[232:235], a[72:75]
  v_exp_f32 v206, v206
  v_mfma_f32_16x16x32_bf16 a[76:79], v[156:159], v[232:235], a[76:79]
  v_add_f32 v239, v239, v206
  v_mfma_f32_16x16x32_bf16 a[80:83], v[160:163], v[232:235], a[80:83]
  v_exp_f32 v207, v207
  v_mfma_f32_16x16x32_bf16 a[84:87], v[164:167], v[232:235], a[84:87]
  v_add_f32 v239, v239, v207
  v_cvt_pk_bf16_f32 v221, v206, v207
  v_mfma_f32_16x16x32_bf16 a[88:91], v[168:171], v[232:235], a[88:91]
  v_exp_f32 v208, v208
  v_mfma_f32_16x16x32_bf16 a[92:95], v[172:175], v[232:235], a[92:95]
  v_add_f32 v239, v239, v208
  v_mfma_f32_16x16x32_bf16 v[212:215], a[224:227], v[64:67], v[192:195]
  v_exp_f32 v209, v209
  v_mfma_f32_16x16x32_bf16 v[212:215], a[228:231], v[68:71], v[212:215]
  v_add_f32 v239, v239, v209
  v_cvt_pk_bf16_f32 v222, v208, v209
  v_mfma_f32_16x16x32_bf16 v[212:215], a[232:235], v[72:75], v[212:215]
  v_exp_f32 v210, v210
  v_mfma_f32_16x16x32_bf16 v[212:215], a[236:239], v[76:79], v[212:215]
  v_add_f32 v239, v239, v210
  v_mfma_f32_16x16x32_bf16 v[216:219], a[240:243], v[64:67], v[192:195]
  v_exp_f32 v211, v211
  v_mfma_f32_16x16x32_bf16 v[216:219], a[244:247], v[68:71], v[216:219]
  v_add_f32 v239, v239, v211
  v_cvt_pk_bf16_f32 v223, v210, v211
  v_mfma_f32_16x16x32_bf16 v[216:219], a[248:251], v[72:75], v[216:219]
  s_nop 0
  v_exp_f32 v212, v212
  v_mfma_f32_16x16x32_bf16 v[216:219], a[252:255], v[76:79], v[216:219]
  v_add_f32 v240, v240, v212
  v_mfma_f32_16x16x32_bf16 a[96:99], v[144:147], v[220:223], a[96:99]
  v_exp_f32 v213, v213
  v_mfma_f32_16x16x32_bf16 a[100:103], v[148:151], v[220:223], a[100:103]
  v_add_f32 v240, v240, v213
  v_cvt_pk_bf16_f32 v232, v212, v213
  v_mfma_f32_16x16x32_bf16 a[104:107], v[152:155], v[220:223], a[104:107]
  v_exp_f32 v214, v214
  v_mfma_f32_16x16x32_bf16 a[108:111], v[156:159], v[220:223], a[108:111]
  v_add_f32 v240, v240, v214
  v_mfma_f32_16x16x32_bf16 a[112:115], v[160:163], v[220:223], a[112:115]
  v_exp_f32 v215, v215
  v_mfma_f32_16x16x32_bf16 a[116:119], v[164:167], v[220:223], a[116:119]
  v_add_f32 v240, v240, v215
  v_cvt_pk_bf16_f32 v233, v214, v215
  v_mfma_f32_16x16x32_bf16 a[120:123], v[168:171], v[220:223], a[120:123]
  v_exp_f32 v216, v216
  v_mfma_f32_16x16x32_bf16 a[124:127], v[172:175], v[220:223], a[124:127]
  v_add_f32 v240, v240, v216
  v_mfma_f32_16x16x32_bf16 v[204:207], a[224:227], v[80:83], v[196:199]
  v_exp_f32 v217, v217
  v_mfma_f32_16x16x32_bf16 v[204:207], a[228:231], v[84:87], v[204:207]
  v_add_f32 v240, v240, v217
  v_cvt_pk_bf16_f32 v234, v216, v217
  v_mfma_f32_16x16x32_bf16 v[204:207], a[232:235], v[88:91], v[204:207]
  v_exp_f32 v218, v218
  v_mfma_f32_16x16x32_bf16 v[204:207], a[236:239], v[92:95], v[204:207]
  v_add_f32 v240, v240, v218
  v_mfma_f32_16x16x32_bf16 v[208:211], a[240:243], v[80:83], v[196:199]
  v_exp_f32 v219, v219
  v_mfma_f32_16x16x32_bf16 v[208:211], a[244:247], v[84:87], v[208:211]
  v_add_f32 v240, v240, v219
  v_cvt_pk_bf16_f32 v235, v218, v219
  v_mfma_f32_16x16x32_bf16 v[208:211], a[248:251], v[88:91], v[208:211]
  s_nop 0
  v_exp_f32 v204, v204
  v_mfma_f32_16x16x32_bf16 v[208:211], a[252:255], v[92:95], v[208:211]
  v_add_f32 v241, v241, v204
  v_mfma_f32_16x16x32_bf16 a[128:131], v[144:147], v[232:235], a[128:131]
  v_exp_f32 v205, v205
  v_mfma_f32_16x16x32_bf16 a[132:135], v[148:151], v[232:235], a[132:135]
  v_add_f32 v241, v241, v205
  v_cvt_pk_bf16_f32 v220, v204, v205
  v_mfma_f32_16x16x32_bf16 a[136:139], v[152:155], v[232:235], a[136:139]
  v_exp_f32 v206, v206
  v_mfma_f32_16x16x32_bf16 a[140:143], v[156:159], v[232:235], a[140:143]
  v_add_f32 v241, v241, v206
  v_mfma_f32_16x16x32_bf16 a[144:147], v[160:163], v[232:235], a[144:147]
  v_exp_f32 v207, v207
  v_mfma_f32_16x16x32_bf16 a[148:151], v[164:167], v[232:235], a[148:151]
  v_add_f32 v241, v241, v207
  v_cvt_pk_bf16_f32 v221, v206, v207
  v_mfma_f32_16x16x32_bf16 a[152:155], v[168:171], v[232:235], a[152:155]
  v_exp_f32 v208, v208
  v_mfma_f32_16x16x32_bf16 a[156:159], v[172:175], v[232:235], a[156:159]
  v_add_f32 v241, v241, v208
  v_mfma_f32_16x16x32_bf16 v[212:215], a[224:227], v[96:99], v[200:203]
  v_exp_f32 v209, v209
  v_mfma_f32_16x16x32_bf16 v[212:215], a[228:231], v[100:103], v[212:215]
  v_add_f32 v241, v241, v209
  v_cvt_pk_bf16_f32 v222, v208, v209
  v_mfma_f32_16x16x32_bf16 v[212:215], a[232:235], v[104:107], v[212:215]
  v_exp_f32 v210, v210
  v_mfma_f32_16x16x32_bf16 v[212:215], a[236:239], v[108:111], v[212:215]
  v_add_f32 v241, v241, v210
  v_mfma_f32_16x16x32_bf16 v[216:219], a[240:243], v[96:99], v[200:203]
  v_exp_f32 v211, v211
  v_mfma_f32_16x16x32_bf16 v[216:219], a[244:247], v[100:103], v[216:219]
  v_add_f32 v241, v241, v211
  v_cvt_pk_bf16_f32 v223, v210, v211
  v_mfma_f32_16x16x32_bf16 v[216:219], a[248:251], v[104:107], v[216:219]
  s_nop 0
  v_exp_f32 v212, v212
  v_mfma_f32_16x16x32_bf16 v[216:219], a[252:255], v[108:111], v[216:219]
  v_add_f32 v242, v242, v212
  v_mfma_f32_16x16x32_bf16 a[160:163], v[144:147], v[220:223], a[160:163]
  v_exp_f32 v213, v213
  v_mfma_f32_16x16x32_bf16 a[164:167], v[148:151], v[220:223], a[164:167]
  v_add_f32 v242, v242, v213
  v_cvt_pk_bf16_f32 v232, v212, v213
  v_mfma_f32_16x16x32_bf16 a[168:171], v[152:155], v[220:223], a[168:171]
  v_exp_f32 v214, v214
  v_mfma_f32_16x16x32_bf16 a[172:175], v[156:159], v[220:223], a[172:175]
  v_add_f32 v242, v242, v214
  v_mfma_f32_16x16x32_bf16 a[176:179], v[160:163], v[220:223], a[176:179]
  v_exp_f32 v215, v215
  v_mfma_f32_16x16x32_bf16 a[180:183], v[164:167], v[220:223], a[180:183]
  v_add_f32 v242, v242, v215
  v_cvt_pk_bf16_f32 v233, v214, v215
  v_mfma_f32_16x16x32_bf16 a[184:187], v[168:171], v[220:223], a[184:187]
  v_exp_f32 v216, v216
  v_mfma_f32_16x16x32_bf16 a[188:191], v[172:175], v[220:223], a[188:191]
  v_add_f32 v242, v242, v216
  v_exp_f32 v217, v217
  s_nop 0
  v_add_f32 v242, v242, v217
  v_cvt_pk_bf16_f32 v234, v216, v217
  v_exp_f32 v218, v218
  s_nop 0
  v_add_f32 v242, v242, v218
  v_exp_f32 v219, v219
  s_nop 0
  v_add_f32 v242, v242, v219
  v_cvt_pk_bf16_f32 v235, v218, v219
  s_nop 1
  v_mfma_f32_16x16x32_bf16 a[192:195], v[144:147], v[232:235], a[192:195]
  v_mfma_f32_16x16x32_bf16 a[196:199], v[148:151], v[232:235], a[196:199]
  v_mfma_f32_16x16x32_bf16 a[200:203], v[152:155], v[232:235], a[200:203]
  v_mfma_f32_16x16x32_bf16 a[204:207], v[156:159], v[232:235], a[204:207]
  v_mfma_f32_16x16x32_bf16 a[208:211], v[160:163], v[232:235], a[208:211]
  v_mfma_f32_16x16x32_bf16 a[212:215], v[164:167], v[232:235], a[212:215]
  v_mfma_f32_16x16x32_bf16 a[216:219], v[168:171], v[232:235], a[216:219]
  v_mfma_f32_16x16x32_bf16 a[220:223], v[172:175], v[232:235], a[220:223]
  v_mov_b32 v144, v236
  v_mov_b32 v145, v237
  v_mov_b32 v146, v238
  v_mov_b32 v147, v239
  v_mov_b32 v148, v240
  v_mov_b32 v149, v241
  v_mov_b32 v150, v242
  s_nop 0
  v_permlane32_swap_b32 v144, v236
  v_permlane32_swap_b32 v145, v237
  v_permlane32_swap_b32 v146, v238
  v_permlane32_swap_b32 v147, v239
  v_permlane32_swap_b32 v148, v240
  v_permlane32_swap_b32 v149, v241
  v_permlane32_swap_b32 v150, v242
  v_add_f32 v236, v236, v144
  v_add_f32 v237, v237, v145
  v_add_f32 v238, v238, v146
  v_add_f32 v239, v239, v147
  v_add_f32 v240, v240, v148
  v_add_f32 v241, v241, v149
  v_add_f32 v242, v242, v150
  v_mov_b32 v144, v236
  v_mov_b32 v145, v237
  v_mov_b32 v146, v238
  v_mov_b32 v147, v239
  v_mov_b32 v148, v240
  v_mov_b32 v149, v241
  v_mov_b32 v150, v242
  s_nop 0
  v_permlane16_swap_b32 v144, v236
  v_permlane16_swap_b32 v145, v237
  v_permlane16_swap_b32 v146, v238
  v_permlane16_swap_b32 v147, v239
  v_permlane16_swap_b32 v148, v240
  v_permlane16_swap_b32 v149, v241
  v_permlane16_swap_b32 v150, v242
  v_add_f32 v236, v236, v144
  v_add_f32 v237, v237, v145
  v_add_f32 v238, v238, v146
  v_add_f32 v239, v239, v147
  v_add_f32 v240, v240, v148
  v_add_f32 v241, v241, v149
  v_add_f32 v242, v242, v150
  v_add_f32 v144, v236, v237
  v_min_f32 v145, v236, v237
  v_add_f32 v144, v144, v238
  v_min_f32 v145, v145, v238
  v_add_f32 v144, v144, v239
  v_min_f32 v145, v145, v239
  v_add_f32 v144, v144, v240
  v_min_f32 v145, v145, v240
  v_add_f32 v144, v144, v241
  v_min_f32 v145, v145, v241
  v_add_f32 v144, v144, v242
  v_min_f32 v145, v145, v242
  s_lshl_b32 s41, s20, 2
  s_add_u32 s41, s41, 156672
  v_cmp_nge_f32 s[44:45], s61, v144
  v_cmp_nle_f32 s[46:47], s62, v145
  v_mov_b32 v146, s41
  v_mov_b32 v148, 156672
  s_or_b64 s[44:45], s[44:45], s[46:47]
  s_cselect_b32 s40, 1, 0
  v_mov_b32 v147, s40
  ds_write_b32 v146, v147
  v_rcp_f32 v236, v236
  v_rcp_f32 v237, v237
  v_rcp_f32 v238, v238
  v_rcp_f32 v239, v239
  v_rcp_f32 v240, v240
  v_rcp_f32 v241, v241
  v_rcp_f32 v242, v242
  s_waitcnt vmcnt(18) lgkmcnt(0)
  s_barrier
  ds_read_b128 v[152:155], v148
  s_mov_b32 s42, 786432
  v_accvgpr_read_b32 v176, a192
  v_accvgpr_read_b32 v177, a193
  v_accvgpr_read_b32 v178, a194
  v_accvgpr_read_b32 v179, a195
  v_accvgpr_read_b32 v180, a196
  v_accvgpr_read_b32 v181, a197
  v_accvgpr_read_b32 v182, a198
  v_accvgpr_read_b32 v183, a199
  v_pk_mul_f32 v[176:177], v[176:177], v[242:243] op_sel:[0,0] op_sel_hi:[1,0]
  v_pk_mul_f32 v[178:179], v[178:179], v[242:243] op_sel:[0,0] op_sel_hi:[1,0]
  v_pk_mul_f32 v[180:181], v[180:181], v[242:243] op_sel:[0,0] op_sel_hi:[1,0]
  v_pk_mul_f32 v[182:183], v[182:183], v[242:243] op_sel:[0,0] op_sel_hi:[1,0]
  v_cvt_pk_bf16_f32 v192, v176, v177
  v_cvt_pk_bf16_f32 v193, v178, v179
  v_cvt_pk_bf16_f32 v194, v180, v181
  v_cvt_pk_bf16_f32 v195, v182, v183
  buffer_store_dwordx4 v[192:195], v230, s[12:15], s42 offen offset:0 sc0 sc1
  v_accvgpr_read_b32 v184, a200
  v_accvgpr_read_b32 v185, a201
  v_accvgpr_read_b32 v186, a202
  v_accvgpr_read_b32 v187, a203
  v_accvgpr_read_b32 v188, a204
  v_accvgpr_read_b32 v189, a205
  v_accvgpr_read_b32 v190, a206
  v_accvgpr_read_b32 v191, a207
  v_pk_mul_f32 v[184:185], v[184:185], v[242:243] op_sel:[0,0] op_sel_hi:[1,0]
  v_pk_mul_f32 v[186:187], v[186:187], v[242:243] op_sel:[0,0] op_sel_hi:[1,0]
  v_pk_mul_f32 v[188:189], v[188:189], v[242:243] op_sel:[0,0] op_sel_hi:[1,0]
  v_pk_mul_f32 v[190:191], v[190:191], v[242:243] op_sel:[0,0] op_sel_hi:[1,0]
  v_cvt_pk_bf16_f32 v196, v184, v185
  v_cvt_pk_bf16_f32 v197, v186, v187
  v_cvt_pk_bf16_f32 v198, v188, v189
  v_cvt_pk_bf16_f32 v199, v190, v191
  buffer_store_dwordx4 v[196:199], v230, s[12:15], s42 offen offset:1024 sc0 sc1
  v_accvgpr_read_b32 v176, a208
  v_accvgpr_read_b32 v177, a209
  v_accvgpr_read_b32 v178, a210
  v_accvgpr_read_b32 v179, a211
  v_accvgpr_read_b32 v180, a212
  v_accvgpr_read_b32 v181, a213
  v_accvgpr_read_b32 v182, a214
  v_accvgpr_read_b32 v183, a215
  v_pk_mul_f32 v[176:177], v[176:177], v[242:243] op_sel:[0,0] op_sel_hi:[1,0]
  v_pk_mul_f32 v[178:179], v[178:179], v[242:243] op_sel:[0,0] op_sel_hi:[1,0]
  v_pk_mul_f32 v[180:181], v[180:181], v[242:243] op_sel:[0,0] op_sel_hi:[1,0]
  v_pk_mul_f32 v[182:183], v[182:183], v[242:243] op_sel:[0,0] op_sel_hi:[1,0]
  v_cvt_pk_bf16_f32 v200, v176, v177
  v_cvt_pk_bf16_f32 v201, v178, v179
  v_cvt_pk_bf16_f32 v202, v180, v181
  v_cvt_pk_bf16_f32 v203, v182, v183
  buffer_store_dwordx4 v[200:203], v230, s[12:15], s42 offen offset:2048 sc0 sc1
  v_accvgpr_read_b32 v184, a216
  v_accvgpr_read_b32 v185, a217
  v_accvgpr_read_b32 v186, a218
  v_accvgpr_read_b32 v187, a219
  v_accvgpr_read_b32 v188, a220
  v_accvgpr_read_b32 v189, a221
  v_accvgpr_read_b32 v190, a222
  v_accvgpr_read_b32 v191, a223
  v_pk_mul_f32 v[184:185], v[184:185], v[242:243] op_sel:[0,0] op_sel_hi:[1,0]
  v_pk_mul_f32 v[186:187], v[186:187], v[242:243] op_sel:[0,0] op_sel_hi:[1,0]
  v_pk_mul_f32 v[188:189], v[188:189], v[242:243] op_sel:[0,0] op_sel_hi:[1,0]
  v_pk_mul_f32 v[190:191], v[190:191], v[242:243] op_sel:[0,0] op_sel_hi:[1,0]
  v_cvt_pk_bf16_f32 v204, v184, v185
  v_cvt_pk_bf16_f32 v205, v186, v187
  v_cvt_pk_bf16_f32 v206, v188, v189
  v_cvt_pk_bf16_f32 v207, v190, v191
  buffer_store_dwordx4 v[204:207], v230, s[12:15], s42 offen offset:3072 sc0 sc1
  s_waitcnt lgkmcnt(0)
  v_or3_b32 v152, v152, v153, v154
  v_min_u32 v244, v244, v245
  v_or_b32 v152, v152, v155
  v_readfirstlane_b32 s41, v243
  v_readfirstlane_b32 s40, v152
  v_readfirstlane_b32 s43, v244
  s_nop 0
  s_andn2_b32 s40, s40, s33
  s_cbranch_scc1 A_FB
  s_cmp_lt_u32 s41, 64
  s_cbranch_scc1 A_INIT
A_INITOK:
  s_cmp_eq_u32 s23, 0
  s_cbranch_scc0 A_LAST
  s_mov_b32 s42, 655360
  v_accvgpr_read_b32 v176, a160
  v_accvgpr_read_b32 v177, a161
  v_accvgpr_read_b32 v178, a162
  v_accvgpr_read_b32 v179, a163
  v_accvgpr_read_b32 v180, a164
  v_accvgpr_read_b32 v181, a165
  v_accvgpr_read_b32 v182, a166
  v_accvgpr_read_b32 v183, a167
  v_pk_mul_f32 v[176:177], v[176:177], v[240:241] op_sel:[0,1] op_sel_hi:[1,1]
  v_pk_mul_f32 v[178:179], v[178:179], v[240:241] op_sel:[0,1] op_sel_hi:[1,1]
  v_pk_mul_f32 v[180:181], v[180:181], v[240:241] op_sel:[0,1] op_sel_hi:[1,1]
  v_pk_mul_f32 v[182:183], v[182:183], v[240:241] op_sel:[0,1] op_sel_hi:[1,1]
  v_cvt_pk_bf16_f32 v192, v176, v177
  v_cvt_pk_bf16_f32 v193, v178, v179
  v_cvt_pk_bf16_f32 v194, v180, v181
  v_cvt_pk_bf16_f32 v195, v182, v183
  buffer_store_dwordx4 v[192:195], v230, s[12:15], s42 offen offset:0 sc0 sc1
  v_accvgpr_read_b32 v184, a168
  v_accvgpr_read_b32 v185, a169
  v_accvgpr_read_b32 v186, a170
  v_accvgpr_read_b32 v187, a171
  v_accvgpr_read_b32 v188, a172
  v_accvgpr_read_b32 v189, a173
  v_accvgpr_read_b32 v190, a174
  v_accvgpr_read_b32 v191, a175
  v_pk_mul_f32 v[184:185], v[184:185], v[240:241] op_sel:[0,1] op_sel_hi:[1,1]
  v_pk_mul_f32 v[186:187], v[186:187], v[240:241] op_sel:[0,1] op_sel_hi:[1,1]
  v_pk_mul_f32 v[188:189], v[188:189], v[240:241] op_sel:[0,1] op_sel_hi:[1,1]
  v_pk_mul_f32 v[190:191], v[190:191], v[240:241] op_sel:[0,1] op_sel_hi:[1,1]
  v_cvt_pk_bf16_f32 v196, v184, v185
  v_cvt_pk_bf16_f32 v197, v186, v187
  v_cvt_pk_bf16_f32 v198, v188, v189
  v_cvt_pk_bf16_f32 v199, v190, v191
  buffer_store_dwordx4 v[196:199], v230, s[12:15], s42 offen offset:1024 sc0 sc1
  v_accvgpr_read_b32 v176, a176
  v_accvgpr_read_b32 v177, a177
  v_accvgpr_read_b32 v178, a178
  v_accvgpr_read_b32 v179, a179
  v_accvgpr_read_b32 v180, a180
  v_accvgpr_read_b32 v181, a181
  v_accvgpr_read_b32 v182, a182
  v_accvgpr_read_b32 v183, a183
  v_pk_mul_f32 v[176:177], v[176:177], v[240:241] op_sel:[0,1] op_sel_hi:[1,1]
  v_pk_mul_f32 v[178:179], v[178:179], v[240:241] op_sel:[0,1] op_sel_hi:[1,1]
  v_pk_mul_f32 v[180:181], v[180:181], v[240:241] op_sel:[0,1] op_sel_hi:[1,1]
  v_pk_mul_f32 v[182:183], v[182:183], v[240:241] op_sel:[0,1] op_sel_hi:[1,1]
  v_cvt_pk_bf16_f32 v200, v176, v177
  v_cvt_pk_bf16_f32 v201, v178, v179
  v_cvt_pk_bf16_f32 v202, v180, v181
  v_cvt_pk_bf16_f32 v203, v182, v183
  buffer_store_dwordx4 v[200:203], v230, s[12:15], s42 offen offset:2048 sc0 sc1
  v_accvgpr_read_b32 v184, a184
  v_accvgpr_read_b32 v185, a185
  v_accvgpr_read_b32 v186, a186
  v_accvgpr_read_b32 v187, a187
  v_accvgpr_read_b32 v188, a188
  v_accvgpr_read_b32 v189, a189
  v_accvgpr_read_b32 v190, a190
  v_accvgpr_read_b32 v191, a191
  v_pk_mul_f32 v[184:185], v[184:185], v[240:241] op_sel:[0,1] op_sel_hi:[1,1]
  v_pk_mul_f32 v[186:187], v[186:187], v[240:241] op_sel:[0,1] op_sel_hi:[1,1]
  v_pk_mul_f32 v[188:189], v[188:189], v[240:241] op_sel:[0,1] op_sel_hi:[1,1]
  v_pk_mul_f32 v[190:191], v[190:191], v[240:241] op_sel:[0,1] op_sel_hi:[1,1]
  v_cvt_pk_bf16_f32 v204, v184, v185
  v_cvt_pk_bf16_f32 v205, v186, v187
  v_cvt_pk_bf16_f32 v206, v188, v189
  v_cvt_pk_bf16_f32 v207, v190, v191
  buffer_store_dwordx4 v[204:207], v230, s[12:15], s42 offen offset:3072 sc0 sc1
  s_mov_b32 s42, 524288
  v_accvgpr_read_b32 v176, a128
  v_accvgpr_read_b32 v177, a129
  ds_read_b128 a[192:195], v227 offset:34816
  v_accvgpr_read_b32 v178, a130
  v_accvgpr_read_b32 v179, a131
  v_accvgpr_read_b32 v180, a132
  ds_read_b128 a[196:199], v227 offset:36992
  v_accvgpr_read_b32 v181, a133
  v_accvgpr_read_b32 v182, a134
  v_accvgpr_read_b32 v183, a135
  ds_read_b128 a[200:203], v227 offset:39168
  v_pk_mul_f32 v[176:177], v[176:177], v[240:241] op_sel:[0,0] op_sel_hi:[1,0]
  v_pk_mul_f32 v[178:179], v[178:179], v[240:241] op_sel:[0,0] op_sel_hi:[1,0]
  v_pk_mul_f32 v[180:181], v[180:181], v[240:241] op_sel:[0,0] op_sel_hi:[1,0]
  v_pk_mul_f32 v[182:183], v[182:183], v[240:241] op_sel:[0,0] op_sel_hi:[1,0]
  v_cvt_pk_bf16_f32 v192, v176, v177
  v_cvt_pk_bf16_f32 v193, v178, v179
  v_cvt_pk_bf16_f32 v194, v180, v181
  v_cvt_pk_bf16_f32 v195, v182, v183
  buffer_store_dwordx4 v[192:195], v230, s[12:15], s42 offen offset:0 sc0 sc1
  v_accvgpr_read_b32 v184, a136
  v_accvgpr_read_b32 v185, a137
  ds_read_b128 a[204:207], v227 offset:41344
  v_accvgpr_read_b32 v186, a138
  v_accvgpr_read_b32 v187, a139
  v_accvgpr_read_b32 v188, a140
  ds_read_b128 a[208:211], v227 offset:0
  v_accvgpr_read_b32 v189, a141
  v_accvgpr_read_b32 v190, a142
  v_accvgpr_read_b32 v191, a143
  ds_read_b128 a[212:215], v227 offset:2176
  v_pk_mul_f32 v[184:185], v[184:185], v[240:241] op_sel:[0,0] op_sel_hi:[1,0]
  v_pk_mul_f32 v[186:187], v[186:187], v[240:241] op_sel:[0,0] op_sel_hi:[1,0]
  v_pk_mul_f32 v[188:189], v[188:189], v[240:241] op_sel:[0,0] op_sel_hi:[1,0]
  v_pk_mul_f32 v[190:191], v[190:191], v[240:241] op_sel:[0,0] op_sel_hi:[1,0]
  v_cvt_pk_bf16_f32 v196, v184, v185
  v_cvt_pk_bf16_f32 v197, v186, v187
  v_cvt_pk_bf16_f32 v198, v188, v189
  v_cvt_pk_bf16_f32 v199, v190, v191
  buffer_store_dwordx4 v[196:199], v230, s[12:15], s42 offen offset:1024 sc0 sc1
  v_accvgpr_read_b32 v176, a144
  v_accvgpr_read_b32 v177, a145
  ds_read_b128 a[216:219], v227 offset:4352
  v_accvgpr_read_b32 v178, a146
  v_accvgpr_read_b32 v179, a147
  v_accvgpr_read_b32 v180, a148
  ds_read_b64_tr_b16 a[224:225], v226 offset:0
  v_accvgpr_read_b32 v181, a149
  v_accvgpr_read_b32 v182, a150
  v_accvgpr_read_b32 v183, a151
  ds_read_b64_tr_b16 a[226:227], v226 offset:4352
  v_pk_mul_f32 v[176:177], v[176:177], v[240:241] op_sel:[0,0] op_sel_hi:[1,0]
  v_pk_mul_f32 v[178:179], v[178:179], v[240:241] op_sel:[0,0] op_sel_hi:[1,0]
  v_pk_mul_f32 v[180:181], v[180:181], v[240:241] op_sel:[0,0] op_sel_hi:[1,0]
  v_pk_mul_f32 v[182:183], v[182:183], v[240:241] op_sel:[0,0] op_sel_hi:[1,0]
  v_cvt_pk_bf16_f32 v200, v176, v177
  v_cvt_pk_bf16_f32 v201, v178, v179
  v_cvt_pk_bf16_f32 v202, v180, v181
  v_cvt_pk_bf16_f32 v203, v182, v183
  buffer_store_dwordx4 v[200:203], v230, s[12:15], s42 offen offset:2048 sc0 sc1
  v_accvgpr_read_b32 v184, a152
  v_accvgpr_read_b32 v185, a153
  ds_read_b64_tr_b16 a[228:229], v226 offset:8
  v_accvgpr_read_b32 v186, a154
  v_accvgpr_read_b32 v187, a155
  v_accvgpr_read_b32 v188, a156
  ds_read_b64_tr_b16 a[230:231], v226 offset:4360
  v_accvgpr_read_b32 v189, a157
  v_accvgpr_read_b32 v190, a158
  v_accvgpr_read_b32 v191, a159
  ds_read_b64_tr_b16 a[232:233], v226 offset:64
  v_pk_mul_f32 v[184:185], v[184:185], v[240:241] op_sel:[0,0] op_sel_hi:[1,0]
  v_pk_mul_f32 v[186:187], v[186:187], v[240:241] op_sel:[0,0] op_sel_hi:[1,0]
  v_pk_mul_f32 v[188:189], v[188:189], v[240:241] op_sel:[0,0] op_sel_hi:[1,0]
  v_pk_mul_f32 v[190:191], v[190:191], v[240:241] op_sel:[0,0] op_sel_hi:[1,0]
  v_cvt_pk_bf16_f32 v204, v184, v185
  v_cvt_pk_bf16_f32 v205, v186, v187
  v_cvt_pk_bf16_f32 v206, v188, v189
  v_cvt_pk_bf16_f32 v207, v190, v191
  buffer_store_dwordx4 v[204:207], v230, s[12:15], s42 offen offset:3072 sc0 sc1
  s_mov_b32 s42, 393216
  v_accvgpr_read_b32 v176, a96
  v_accvgpr_read_b32 v177, a97
  ds_read_b64_tr_b16 a[234:235], v226 offset:4416
  v_accvgpr_read_b32 v178, a98
  v_accvgpr_read_b32 v179, a99
  v_accvgpr_read_b32 v180, a100
  ds_read_b64_tr_b16 a[236:237], v226 offset:72
  v_accvgpr_read_b32 v181, a101
  v_accvgpr_read_b32 v182, a102
  v_accvgpr_read_b32 v183, a103
  ds_read_b64_tr_b16 a[238:239], v226 offset:4424
  v_pk_mul_f32 v[176:177], v[176:177], v[238:239] op_sel:[0,1] op_sel_hi:[1,1]
  v_pk_mul_f32 v[178:179], v[178:179], v[238:239] op_sel:[0,1] op_sel_hi:[1,1]
  v_pk_mul_f32 v[180:181], v[180:181], v[238:239] op_sel:[0,1] op_sel_hi:[1,1]
  v_pk_mul_f32 v[182:183], v[182:183], v[238:239] op_sel:[0,1] op_sel_hi:[1,1]
  v_cvt_pk_bf16_f32 v192, v176, v177
  v_cvt_pk_bf16_f32 v193, v178, v179
  v_cvt_pk_bf16_f32 v194, v180, v181
  v_cvt_pk_bf16_f32 v195, v182, v183
  buffer_store_dwordx4 v[192:195], v230, s[12:15], s42 offen offset:0 sc0 sc1
  v_accvgpr_read_b32 v184, a104
  v_accvgpr_read_b32 v185, a105
  ds_read_b64_tr_b16 a[240:241], v226 offset:128
  v_accvgpr_read_b32 v186, a106
  v_accvgpr_read_b32 v187, a107
  v_accvgpr_read_b32 v188, a108
  ds_read_b64_tr_b16 a[242:243], v226 offset:4480
  v_accvgpr_read_b32 v189, a109
  v_accvgpr_read_b32 v190, a110
  v_accvgpr_read_b32 v191, a111
  ds_read_b64_tr_b16 a[244:245], v226 offset:136
  v_pk_mul_f32 v[184:185], v[184:185], v[238:239] op_sel:[0,1] op_sel_hi:[1,1]
  v_pk_mul_f32 v[186:187], v[186:187], v[238:239] op_sel:[0,1] op_sel_hi:[1,1]
  v_pk_mul_f32 v[188:189], v[188:189], v[238:239] op_sel:[0,1] op_sel_hi:[1,1]
  v_pk_mul_f32 v[190:191], v[190:191], v[238:239] op_sel:[0,1] op_sel_hi:[1,1]
  v_cvt_pk_bf16_f32 v196, v184, v185
  v_cvt_pk_bf16_f32 v197, v186, v187
  v_cvt_pk_bf16_f32 v198, v188, v189
  v_cvt_pk_bf16_f32 v199, v190, v191
  buffer_store_dwordx4 v[196:199], v230, s[12:15], s42 offen offset:1024 sc0 sc1
  v_accvgpr_read_b32 v176, a112
  v_accvgpr_read_b32 v177, a113
  ds_read_b64_tr_b16 a[246:247], v226 offset:4488
  v_accvgpr_read_b32 v178, a114
  v_accvgpr_read_b32 v179, a115
  v_accvgpr_read_b32 v180, a116
  ds_read_b64_tr_b16 a[248:249], v226 offset:192
  v_accvgpr_read_b32 v181, a117
  v_accvgpr_read_b32 v182, a118
  v_accvgpr_read_b32 v183, a119
  ds_read_b64_tr_b16 a[250:251], v226 offset:4544
  v_pk_mul_f32 v[176:177], v[176:177], v[238:239] op_sel:[0,1] op_sel_hi:[1,1]
  v_pk_mul_f32 v[178:179], v[178:179], v[238:239] op_sel:[0,1] op_sel_hi:[1,1]
  v_pk_mul_f32 v[180:181], v[180:181], v[238:239] op_sel:[0,1] op_sel_hi:[1,1]
  v_pk_mul_f32 v[182:183], v[182:183], v[238:239] op_sel:[0,1] op_sel_hi:[1,1]
  v_cvt_pk_bf16_f32 v200, v176, v177
  v_cvt_pk_bf16_f32 v201, v178, v179
  v_cvt_pk_bf16_f32 v202, v180, v181
  v_cvt_pk_bf16_f32 v203, v182, v183
  buffer_store_dwordx4 v[200:203], v230, s[12:15], s42 offen offset:2048 sc0 sc1
  v_accvgpr_read_b32 v184, a120
  v_accvgpr_read_b32 v185, a121
  ds_read_b64_tr_b16 a[252:253], v226 offset:200
  v_accvgpr_read_b32 v186, a122
  v_accvgpr_read_b32 v187, a123
  v_accvgpr_read_b32 v188, a124
  ds_read_b64_tr_b16 a[254:255], v226 offset:4552
  v_accvgpr_read_b32 v189, a125
  v_accvgpr_read_b32 v190, a126
  v_accvgpr_read_b32 v191, a127
  ds_read_b128 a[160:163], v227 offset:34880
  v_pk_mul_f32 v[184:185], v[184:185], v[238:239] op_sel:[0,1] op_sel_hi:[1,1]
  v_pk_mul_f32 v[186:187], v[186:187], v[238:239] op_sel:[0,1] op_sel_hi:[1,1]
  v_pk_mul_f32 v[188:189], v[188:189], v[238:239] op_sel:[0,1] op_sel_hi:[1,1]
  v_pk_mul_f32 v[190:191], v[190:191], v[238:239] op_sel:[0,1] op_sel_hi:[1,1]
  v_cvt_pk_bf16_f32 v204, v184, v185
  v_cvt_pk_bf16_f32 v205, v186, v187
  v_cvt_pk_bf16_f32 v206, v188, v189
  v_cvt_pk_bf16_f32 v207, v190, v191
  buffer_store_dwordx4 v[204:207], v230, s[12:15], s42 offen offset:3072 sc0 sc1
  s_mov_b32 s42, 262144
  v_accvgpr_read_b32 v176, a64
  v_accvgpr_read_b32 v177, a65
  ds_read_b128 a[164:167], v227 offset:37056
  v_accvgpr_read_b32 v178, a66
  v_accvgpr_read_b32 v179, a67
  v_accvgpr_read_b32 v180, a68
  ds_read_b128 a[168:171], v227 offset:39232
  v_accvgpr_read_b32 v181, a69
  v_accvgpr_read_b32 v182, a70
  v_accvgpr_read_b32 v183, a71
  ds_read_b128 a[172:175], v227 offset:41408
  v_pk_mul_f32 v[176:177], v[176:177], v[238:239] op_sel:[0,0] op_sel_hi:[1,0]
  v_pk_mul_f32 v[178:179], v[178:179], v[238:239] op_sel:[0,0] op_sel_hi:[1,0]
  v_pk_mul_f32 v[180:181], v[180:181], v[238:239] op_sel:[0,0] op_sel_hi:[1,0]
  v_pk_mul_f32 v[182:183], v[182:183], v[238:239] op_sel:[0,0] op_sel_hi:[1,0]
  v_cvt_pk_bf16_f32 v192, v176, v177
  v_cvt_pk_bf16_f32 v193, v178, v179
  v_cvt_pk_bf16_f32 v194, v180, v181
  v_cvt_pk_bf16_f32 v195, v182, v183
  buffer_store_dwordx4 v[192:195], v230, s[12:15], s42 offen offset:0 sc0 sc1
  v_accvgpr_read_b32 v184, a72
  v_accvgpr_read_b32 v185, a73
  ds_read_b128 a[176:179], v227 offset:64
  v_accvgpr_read_b32 v186, a74
  v_accvgpr_read_b32 v187, a75
  v_accvgpr_read_b32 v188, a76
  ds_read_b128 a[180:183], v227 offset:2240
  v_accvgpr_read_b32 v189, a77
  v_accvgpr_read_b32 v190, a78
  v_accvgpr_read_b32 v191, a79
  ds_read_b128 a[184:187], v227 offset:4416
  v_pk_mul_f32 v[184:185], v[184:185], v[238:239] op_sel:[0,0] op_sel_hi:[1,0]
  v_pk_mul_f32 v[186:187], v[186:187], v[238:239] op_sel:[0,0] op_sel_hi:[1,0]
  v_pk_mul_f32 v[188:189], v[188:189], v[238:239] op_sel:[0,0] op_sel_hi:[1,0]
  v_pk_mul_f32 v[190:191], v[190:191], v[238:239] op_sel:[0,0] op_sel_hi:[1,0]
  v_cvt_pk_bf16_f32 v196, v184, v185
  v_cvt_pk_bf16_f32 v197, v186, v187
  v_cvt_pk_bf16_f32 v198, v188, v189
  v_cvt_pk_bf16_f32 v199, v190, v191
  buffer_store_dwordx4 v[196:199], v230, s[12:15], s42 offen offset:1024 sc0 sc1
  v_accvgpr_read_b32 v176, a80
  v_accvgpr_read_b32 v177, a81
  v_accvgpr_read_b32 v178, a82
  v_accvgpr_read_b32 v179, a83
  v_accvgpr_read_b32 v180, a84
  v_accvgpr_read_b32 v181, a85
  v_accvgpr_read_b32 v182, a86
  v_accvgpr_read_b32 v183, a87
  v_pk_mul_f32 v[176:177], v[176:177], v[238:239] op_sel:[0,0] op_sel_hi:[1,0]
  v_pk_mul_f32 v[178:179], v[178:179], v[238:239] op_sel:[0,0] op_sel_hi:[1,0]
  v_pk_mul_f32 v[180:181], v[180:181], v[238:239] op_sel:[0,0] op_sel_hi:[1,0]
  v_pk_mul_f32 v[182:183], v[182:183], v[238:239] op_sel:[0,0] op_sel_hi:[1,0]
  v_cvt_pk_bf16_f32 v200, v176, v177
  v_cvt_pk_bf16_f32 v201, v178, v179
  v_cvt_pk_bf16_f32 v202, v180, v181
  v_cvt_pk_bf16_f32 v203, v182, v183
  buffer_store_dwordx4 v[200:203], v230, s[12:15], s42 offen offset:2048 sc0 sc1
  v_accvgpr_read_b32 v184, a88
  v_accvgpr_read_b32 v185, a89
  v_accvgpr_read_b32 v186, a90
  v_accvgpr_read_b32 v187, a91
  v_accvgpr_read_b32 v188, a92
  v_accvgpr_read_b32 v189, a93
  v_accvgpr_read_b32 v190, a94
  v_accvgpr_read_b32 v191, a95
  v_pk_mul_f32 v[184:185], v[184:185], v[238:239] op_sel:[0,0] op_sel_hi:[1,0]
  v_pk_mul_f32 v[186:187], v[186:187], v[238:239] op_sel:[0,0] op_sel_hi:[1,0]
  v_pk_mul_f32 v[188:189], v[188:189], v[238:239] op_sel:[0,0] op_sel_hi:[1,0]
  v_pk_mul_f32 v[190:191], v[190:191], v[238:239] op_sel:[0,0] op_sel_hi:[1,0]
  v_cvt_pk_bf16_f32 v204, v184, v185
  v_cvt_pk_bf16_f32 v205, v186, v187
  v_cvt_pk_bf16_f32 v206, v188, v189
  v_cvt_pk_bf16_f32 v207, v190, v191
  buffer_store_dwordx4 v[204:207], v230, s[12:15], s42 offen offset:3072 sc0 sc1
  s_mov_b32 s42, 131072
  v_accvgpr_read_b32 v176, a32
  v_accvgpr_read_b32 v177, a33
  v_accvgpr_read_b32 v178, a34
  v_accvgpr_read_b32 v179, a35
  v_accvgpr_read_b32 v180, a36
  v_accvgpr_read_b32 v181, a37
  v_accvgpr_read_b32 v182, a38
  v_accvgpr_read_b32 v183, a39
  v_pk_mul_f32 v[176:177], v[176:177], v[236:237] op_sel:[0,1] op_sel_hi:[1,1]
  v_pk_mul_f32 v[178:179], v[178:179], v[236:237] op_sel:[0,1] op_sel_hi:[1,1]
  v_pk_mul_f32 v[180:181], v[180:181], v[236:237] op_sel:[0,1] op_sel_hi:[1,1]
  v_pk_mul_f32 v[182:183], v[182:183], v[236:237] op_sel:[0,1] op_sel_hi:[1,1]
  v_cvt_pk_bf16_f32 v192, v176, v177
  v_cvt_pk_bf16_f32 v193, v178, v179
  v_cvt_pk_bf16_f32 v194, v180, v181
  v_cvt_pk_bf16_f32 v195, v182, v183
  buffer_store_dwordx4 v[192:195], v230, s[12:15], s42 offen offset:0 sc0 sc1
  v_accvgpr_read_b32 v184, a40
  v_accvgpr_read_b32 v185, a41
  v_accvgpr_read_b32 v186, a42
  v_accvgpr_read_b32 v187, a43
  v_accvgpr_read_b32 v188, a44
  v_accvgpr_read_b32 v189, a45
  v_accvgpr_read_b32 v190, a46
  v_accvgpr_read_b32 v191, a47
  v_pk_mul_f32 v[184:185], v[184:185], v[236:237] op_sel:[0,1] op_sel_hi:[1,1]
  v_pk_mul_f32 v[186:187], v[186:187], v[236:237] op_sel:[0,1] op_sel_hi:[1,1]
  v_pk_mul_f32 v[188:189], v[188:189], v[236:237] op_sel:[0,1] op_sel_hi:[1,1]
  v_pk_mul_f32 v[190:191], v[190:191], v[236:237] op_sel:[0,1] op_sel_hi:[1,1]
  v_cvt_pk_bf16_f32 v196, v184, v185
  v_cvt_pk_bf16_f32 v197, v186, v187
  v_cvt_pk_bf16_f32 v198, v188, v189
  v_cvt_pk_bf16_f32 v199, v190, v191
  buffer_store_dwordx4 v[196:199], v230, s[12:15], s42 offen offset:1024 sc0 sc1
  v_accvgpr_read_b32 v176, a48
  v_accvgpr_read_b32 v177, a49
  v_accvgpr_read_b32 v178, a50
  v_accvgpr_read_b32 v179, a51
  v_accvgpr_read_b32 v180, a52
  v_accvgpr_read_b32 v181, a53
  v_accvgpr_read_b32 v182, a54
  v_accvgpr_read_b32 v183, a55
  v_pk_mul_f32 v[176:177], v[176:177], v[236:237] op_sel:[0,1] op_sel_hi:[1,1]
  v_pk_mul_f32 v[178:179], v[178:179], v[236:237] op_sel:[0,1] op_sel_hi:[1,1]
  v_pk_mul_f32 v[180:181], v[180:181], v[236:237] op_sel:[0,1] op_sel_hi:[1,1]
  v_pk_mul_f32 v[182:183], v[182:183], v[236:237] op_sel:[0,1] op_sel_hi:[1,1]
  v_cvt_pk_bf16_f32 v200, v176, v177
  v_cvt_pk_bf16_f32 v201, v178, v179
  v_cvt_pk_bf16_f32 v202, v180, v181
  v_cvt_pk_bf16_f32 v203, v182, v183
  buffer_store_dwordx4 v[200:203], v230, s[12:15], s42 offen offset:2048 sc0 sc1
  v_accvgpr_read_b32 v184, a56
  v_accvgpr_read_b32 v185, a57
  v_accvgpr_read_b32 v186, a58
  v_accvgpr_read_b32 v187, a59
  v_accvgpr_read_b32 v188, a60
  v_accvgpr_read_b32 v189, a61
  v_accvgpr_read_b32 v190, a62
  v_accvgpr_read_b32 v191, a63
  v_pk_mul_f32 v[184:185], v[184:185], v[236:237] op_sel:[0,1] op_sel_hi:[1,1]
  v_pk_mul_f32 v[186:187], v[186:187], v[236:237] op_sel:[0,1] op_sel_hi:[1,1]
  v_pk_mul_f32 v[188:189], v[188:189], v[236:237] op_sel:[0,1] op_sel_hi:[1,1]
  v_pk_mul_f32 v[190:191], v[190:191], v[236:237] op_sel:[0,1] op_sel_hi:[1,1]
  v_cvt_pk_bf16_f32 v204, v184, v185
  v_cvt_pk_bf16_f32 v205, v186, v187
  v_cvt_pk_bf16_f32 v206, v188, v189
  v_cvt_pk_bf16_f32 v207, v190, v191
  buffer_store_dwordx4 v[204:207], v230, s[12:15], s42 offen offset:3072 sc0 sc1
  s_mov_b32 s42, 0
  v_accvgpr_read_b32 v176, a0
  v_accvgpr_read_b32 v177, a1
  v_accvgpr_read_b32 v178, a2
  v_accvgpr_read_b32 v179, a3
  v_accvgpr_read_b32 v180, a4
  v_accvgpr_read_b32 v181, a5
  v_accvgpr_read_b32 v182, a6
  v_accvgpr_read_b32 v183, a7
  v_pk_mul_f32 v[176:177], v[176:177], v[236:237] op_sel:[0,0] op_sel_hi:[1,0]
  v_pk_mul_f32 v[178:179], v[178:179], v[236:237] op_sel:[0,0] op_sel_hi:[1,0]
  v_pk_mul_f32 v[180:181], v[180:181], v[236:237] op_sel:[0,0] op_sel_hi:[1,0]
  v_pk_mul_f32 v[182:183], v[182:183], v[236:237] op_sel:[0,0] op_sel_hi:[1,0]
  v_cvt_pk_bf16_f32 v192, v176, v177
  v_cvt_pk_bf16_f32 v193, v178, v179
  v_cvt_pk_bf16_f32 v194, v180, v181
  v_cvt_pk_bf16_f32 v195, v182, v183
  buffer_store_dwordx4 v[192:195], v230, s[12:15], s42 offen offset:0 sc0 sc1
  v_accvgpr_read_b32 v184, a8
  v_accvgpr_read_b32 v185, a9
  v_accvgpr_read_b32 v186, a10
  v_accvgpr_read_b32 v187, a11
  v_accvgpr_read_b32 v188, a12
  v_accvgpr_read_b32 v189, a13
  v_accvgpr_read_b32 v190, a14
  v_accvgpr_read_b32 v191, a15
  v_pk_mul_f32 v[184:185], v[184:185], v[236:237] op_sel:[0,0] op_sel_hi:[1,0]
  v_pk_mul_f32 v[186:187], v[186:187], v[236:237] op_sel:[0,0] op_sel_hi:[1,0]
  v_pk_mul_f32 v[188:189], v[188:189], v[236:237] op_sel:[0,0] op_sel_hi:[1,0]
  v_pk_mul_f32 v[190:191], v[190:191], v[236:237] op_sel:[0,0] op_sel_hi:[1,0]
  v_cvt_pk_bf16_f32 v196, v184, v185
  v_cvt_pk_bf16_f32 v197, v186, v187
  v_cvt_pk_bf16_f32 v198, v188, v189
  v_cvt_pk_bf16_f32 v199, v190, v191
  buffer_store_dwordx4 v[196:199], v230, s[12:15], s42 offen offset:1024 sc0 sc1
  v_accvgpr_read_b32 v176, a16
  v_accvgpr_read_b32 v177, a17
  v_accvgpr_read_b32 v178, a18
  v_accvgpr_read_b32 v179, a19
  v_accvgpr_read_b32 v180, a20
  v_accvgpr_read_b32 v181, a21
  v_accvgpr_read_b32 v182, a22
  v_accvgpr_read_b32 v183, a23
  v_pk_mul_f32 v[176:177], v[176:177], v[236:237] op_sel:[0,0] op_sel_hi:[1,0]
  v_pk_mul_f32 v[178:179], v[178:179], v[236:237] op_sel:[0,0] op_sel_hi:[1,0]
  v_pk_mul_f32 v[180:181], v[180:181], v[236:237] op_sel:[0,0] op_sel_hi:[1,0]
  v_pk_mul_f32 v[182:183], v[182:183], v[236:237] op_sel:[0,0] op_sel_hi:[1,0]
  v_cvt_pk_bf16_f32 v200, v176, v177
  v_cvt_pk_bf16_f32 v201, v178, v179
  v_cvt_pk_bf16_f32 v202, v180, v181
  v_cvt_pk_bf16_f32 v203, v182, v183
  buffer_store_dwordx4 v[200:203], v230, s[12:15], s42 offen offset:2048 sc0 sc1
  v_accvgpr_read_b32 v184, a24
  v_accvgpr_read_b32 v185, a25
  v_accvgpr_read_b32 v186, a26
  v_accvgpr_read_b32 v187, a27
  v_accvgpr_read_b32 v188, a28
  v_accvgpr_read_b32 v189, a29
  v_accvgpr_read_b32 v190, a30
  v_accvgpr_read_b32 v191, a31
  v_pk_mul_f32 v[184:185], v[184:185], v[236:237] op_sel:[0,0] op_sel_hi:[1,0]
  v_pk_mul_f32 v[186:187], v[186:187], v[236:237] op_sel:[0,0] op_sel_hi:[1,0]
  v_pk_mul_f32 v[188:189], v[188:189], v[236:237] op_sel:[0,0] op_sel_hi:[1,0]
  v_pk_mul_f32 v[190:191], v[190:191], v[236:237] op_sel:[0,0] op_sel_hi:[1,0]
  v_cvt_pk_bf16_f32 v204, v184, v185
  v_cvt_pk_bf16_f32 v205, v186, v187
  v_cvt_pk_bf16_f32 v206, v188, v189
  v_cvt_pk_bf16_f32 v207, v190, v191
  buffer_store_dwordx4 v[204:207], v230, s[12:15], s42 offen offset:3072 sc0 sc1
  s_mov_b32 s33, 0
  s_mov_b32 s23, 1
  s_branch A_QP
A_LAST:
  s_xor_b32 s40, s37, 0
  s_lshl_b32 s40, s40, 4
  s_add_u32 s40, s40, s32
  s_add_u32 s40, s40, 32
  s_lshl_b32 s63, s40, 8
  s_cmp_lt_u32 s92, 25
  s_cbranch_scc1 O_TILE
  s_mov_b32 s42, 0
  v_accvgpr_read_b32 v176, a0
  v_accvgpr_read_b32 v177, a1
  v_accvgpr_read_b32 v178, a2
  v_accvgpr_read_b32 v179, a3
  v_accvgpr_read_b32 v180, a4
  v_accvgpr_read_b32 v181, a5
  v_accvgpr_read_b32 v182, a6
  v_accvgpr_read_b32 v183, a7
  v_pk_mul_f32 v[176:177], v[176:177], v[236:237] op_sel:[0,0] op_sel_hi:[1,0]
  v_pk_mul_f32 v[178:179], v[178:179], v[236:237] op_sel:[0,0] op_sel_hi:[1,0]
  v_pk_mul_f32 v[180:181], v[180:181], v[236:237] op_sel:[0,0] op_sel_hi:[1,0]
  v_pk_mul_f32 v[182:183], v[182:183], v[236:237] op_sel:[0,0] op_sel_hi:[1,0]
  v_cvt_pk_bf16_f32 v192, v176, v177
  v_cvt_pk_bf16_f32 v193, v178, v179
  v_cvt_pk_bf16_f32 v194, v180, v181
  v_cvt_pk_bf16_f32 v195, v182, v183
  buffer_store_dwordx4 v[192:195], v230, s[12:15], s42 offen offset:0 sc0 sc1
  v_accvgpr_read_b32 v184, a8
  v_accvgpr_read_b32 v185, a9
  v_accvgpr_read_b32 v186, a10
  v_accvgpr_read_b32 v187, a11
  v_accvgpr_read_b32 v188, a12
  v_accvgpr_read_b32 v189, a13
  v_accvgpr_read_b32 v190, a14
  v_accvgpr_read_b32 v191, a15
  v_pk_mul_f32 v[184:185], v[184:185], v[236:237] op_sel:[0,0] op_sel_hi:[1,0]
  v_pk_mul_f32 v[186:187], v[186:187], v[236:237] op_sel:[0,0] op_sel_hi:[1,0]
  v_pk_mul_f32 v[188:189], v[188:189], v[236:237] op_sel:[0,0] op_sel_hi:[1,0]
  v_pk_mul_f32 v[190:191], v[190:191], v[236:237] op_sel:[0,0] op_sel_hi:[1,0]
  v_cvt_pk_bf16_f32 v196, v184, v185
  v_cvt_pk_bf16_f32 v197, v186, v187
  v_cvt_pk_bf16_f32 v198, v188, v189
  v_cvt_pk_bf16_f32 v199, v190, v191
  buffer_store_dwordx4 v[196:199], v230, s[12:15], s42 offen offset:1024 sc0 sc1
  v_accvgpr_read_b32 v176, a16
  v_accvgpr_read_b32 v177, a17
  v_accvgpr_read_b32 v178, a18
  v_accvgpr_read_b32 v179, a19
  v_accvgpr_read_b32 v180, a20
  v_accvgpr_read_b32 v181, a21
  v_accvgpr_read_b32 v182, a22
  v_accvgpr_read_b32 v183, a23
  v_pk_mul_f32 v[176:177], v[176:177], v[236:237] op_sel:[0,0] op_sel_hi:[1,0]
  v_pk_mul_f32 v[178:179], v[178:179], v[236:237] op_sel:[0,0] op_sel_hi:[1,0]
  v_pk_mul_f32 v[180:181], v[180:181], v[236:237] op_sel:[0,0] op_sel_hi:[1,0]
  v_pk_mul_f32 v[182:183], v[182:183], v[236:237] op_sel:[0,0] op_sel_hi:[1,0]
  v_cvt_pk_bf16_f32 v200, v176, v177
  v_cvt_pk_bf16_f32 v201, v178, v179
  v_cvt_pk_bf16_f32 v202, v180, v181
  v_cvt_pk_bf16_f32 v203, v182, v183
  buffer_store_dwordx4 v[200:203], v230, s[12:15], s42 offen offset:2048 sc0 sc1
  v_accvgpr_read_b32 v184, a24
  v_accvgpr_read_b32 v185, a25
  v_accvgpr_read_b32 v186, a26
  v_accvgpr_read_b32 v187, a27
  v_accvgpr_read_b32 v188, a28
  v_accvgpr_read_b32 v189, a29
  v_accvgpr_read_b32 v190, a30
  v_accvgpr_read_b32 v191, a31
  v_pk_mul_f32 v[184:185], v[184:185], v[236:237] op_sel:[0,0] op_sel_hi:[1,0]
  v_pk_mul_f32 v[186:187], v[186:187], v[236:237] op_sel:[0,0] op_sel_hi:[1,0]
  v_pk_mul_f32 v[188:189], v[188:189], v[236:237] op_sel:[0,0] op_sel_hi:[1,0]
  v_pk_mul_f32 v[190:191], v[190:191], v[236:237] op_sel:[0,0] op_sel_hi:[1,0]
  v_cvt_pk_bf16_f32 v204, v184, v185
  v_cvt_pk_bf16_f32 v205, v186, v187
  v_cvt_pk_bf16_f32 v206, v188, v189
  v_cvt_pk_bf16_f32 v207, v190, v191
  buffer_store_dwordx4 v[204:207], v230, s[12:15], s42 offen offset:3072 sc0 sc1
  s_mov_b32 s42, 131072
  v_accvgpr_read_b32 v176, a32
  v_accvgpr_read_b32 v177, a33
  v_accvgpr_read_b32 v178, a34
  v_accvgpr_read_b32 v179, a35
  v_accvgpr_read_b32 v180, a36
  v_accvgpr_read_b32 v181, a37
  v_accvgpr_read_b32 v182, a38
  v_accvgpr_read_b32 v183, a39
  v_pk_mul_f32 v[176:177], v[176:177], v[236:237] op_sel:[0,1] op_sel_hi:[1,1]
  v_pk_mul_f32 v[178:179], v[178:179], v[236:237] op_sel:[0,1] op_sel_hi:[1,1]
  v_pk_mul_f32 v[180:181], v[180:181], v[236:237] op_sel:[0,1] op_sel_hi:[1,1]
  v_pk_mul_f32 v[182:183], v[182:183], v[236:237] op_sel:[0,1] op_sel_hi:[1,1]
  v_cvt_pk_bf16_f32 v192, v176, v177
  v_cvt_pk_bf16_f32 v193, v178, v179
  v_cvt_pk_bf16_f32 v194, v180, v181
  v_cvt_pk_bf16_f32 v195, v182, v183
  buffer_store_dwordx4 v[192:195], v230, s[12:15], s42 offen offset:0 sc0 sc1
  v_accvgpr_read_b32 v184, a40
  v_accvgpr_read_b32 v185, a41
  v_accvgpr_read_b32 v186, a42
  v_accvgpr_read_b32 v187, a43
  v_accvgpr_read_b32 v188, a44
  v_accvgpr_read_b32 v189, a45
  v_accvgpr_read_b32 v190, a46
  v_accvgpr_read_b32 v191, a47
  v_pk_mul_f32 v[184:185], v[184:185], v[236:237] op_sel:[0,1] op_sel_hi:[1,1]
  v_pk_mul_f32 v[186:187], v[186:187], v[236:237] op_sel:[0,1] op_sel_hi:[1,1]
  v_pk_mul_f32 v[188:189], v[188:189], v[236:237] op_sel:[0,1] op_sel_hi:[1,1]
  v_pk_mul_f32 v[190:191], v[190:191], v[236:237] op_sel:[0,1] op_sel_hi:[1,1]
  v_cvt_pk_bf16_f32 v196, v184, v185
  v_cvt_pk_bf16_f32 v197, v186, v187
  v_cvt_pk_bf16_f32 v198, v188, v189
  v_cvt_pk_bf16_f32 v199, v190, v191
  buffer_store_dwordx4 v[196:199], v230, s[12:15], s42 offen offset:1024 sc0 sc1
  v_accvgpr_read_b32 v176, a48
  v_accvgpr_read_b32 v177, a49
  v_accvgpr_read_b32 v178, a50
  v_accvgpr_read_b32 v179, a51
  v_accvgpr_read_b32 v180, a52
  v_accvgpr_read_b32 v181, a53
  v_accvgpr_read_b32 v182, a54
  v_accvgpr_read_b32 v183, a55
  v_pk_mul_f32 v[176:177], v[176:177], v[236:237] op_sel:[0,1] op_sel_hi:[1,1]
  v_pk_mul_f32 v[178:179], v[178:179], v[236:237] op_sel:[0,1] op_sel_hi:[1,1]
  v_pk_mul_f32 v[180:181], v[180:181], v[236:237] op_sel:[0,1] op_sel_hi:[1,1]
  v_pk_mul_f32 v[182:183], v[182:183], v[236:237] op_sel:[0,1] op_sel_hi:[1,1]
  v_cvt_pk_bf16_f32 v200, v176, v177
  v_cvt_pk_bf16_f32 v201, v178, v179
  v_cvt_pk_bf16_f32 v202, v180, v181
  v_cvt_pk_bf16_f32 v203, v182, v183
  buffer_store_dwordx4 v[200:203], v230, s[12:15], s42 offen offset:2048 sc0 sc1
  v_accvgpr_read_b32 v184, a56
  v_accvgpr_read_b32 v185, a57
  v_accvgpr_read_b32 v186, a58
  v_accvgpr_read_b32 v187, a59
  v_accvgpr_read_b32 v188, a60
  v_accvgpr_read_b32 v189, a61
  v_accvgpr_read_b32 v190, a62
  v_accvgpr_read_b32 v191, a63
  v_pk_mul_f32 v[184:185], v[184:185], v[236:237] op_sel:[0,1] op_sel_hi:[1,1]
  v_pk_mul_f32 v[186:187], v[186:187], v[236:237] op_sel:[0,1] op_sel_hi:[1,1]
  v_pk_mul_f32 v[188:189], v[188:189], v[236:237] op_sel:[0,1] op_sel_hi:[1,1]
  v_pk_mul_f32 v[190:191], v[190:191], v[236:237] op_sel:[0,1] op_sel_hi:[1,1]
  v_cvt_pk_bf16_f32 v204, v184, v185
  v_cvt_pk_bf16_f32 v205, v186, v187
  v_cvt_pk_bf16_f32 v206, v188, v189
  v_cvt_pk_bf16_f32 v207, v190, v191
  buffer_store_dwordx4 v[204:207], v230, s[12:15], s42 offen offset:3072 sc0 sc1
  s_mov_b32 s42, 262144
  v_accvgpr_read_b32 v176, a64
  v_accvgpr_read_b32 v177, a65
  v_accvgpr_read_b32 v178, a66
  v_accvgpr_read_b32 v179, a67
  v_accvgpr_read_b32 v180, a68
  v_accvgpr_read_b32 v181, a69
  v_accvgpr_read_b32 v182, a70
  v_accvgpr_read_b32 v183, a71
  v_pk_mul_f32 v[176:177], v[176:177], v[238:239] op_sel:[0,0] op_sel_hi:[1,0]
  v_pk_mul_f32 v[178:179], v[178:179], v[238:239] op_sel:[0,0] op_sel_hi:[1,0]
  v_pk_mul_f32 v[180:181], v[180:181], v[238:239] op_sel:[0,0] op_sel_hi:[1,0]
  v_pk_mul_f32 v[182:183], v[182:183], v[238:239] op_sel:[0,0] op_sel_hi:[1,0]
  v_cvt_pk_bf16_f32 v192, v176, v177
  v_cvt_pk_bf16_f32 v193, v178, v179
  v_cvt_pk_bf16_f32 v194, v180, v181
  v_cvt_pk_bf16_f32 v195, v182, v183
  buffer_store_dwordx4 v[192:195], v230, s[12:15], s42 offen offset:0 sc0 sc1
  v_accvgpr_read_b32 v184, a72
  v_accvgpr_read_b32 v185, a73
  v_accvgpr_read_b32 v186, a74
  v_accvgpr_read_b32 v187, a75
  v_accvgpr_read_b32 v188, a76
  v_accvgpr_read_b32 v189, a77
  v_accvgpr_read_b32 v190, a78
  v_accvgpr_read_b32 v191, a79
  v_pk_mul_f32 v[184:185], v[184:185], v[238:239] op_sel:[0,0] op_sel_hi:[1,0]
  v_pk_mul_f32 v[186:187], v[186:187], v[238:239] op_sel:[0,0] op_sel_hi:[1,0]
  v_pk_mul_f32 v[188:189], v[188:189], v[238:239] op_sel:[0,0] op_sel_hi:[1,0]
  v_pk_mul_f32 v[190:191], v[190:191], v[238:239] op_sel:[0,0] op_sel_hi:[1,0]
  v_cvt_pk_bf16_f32 v196, v184, v185
  v_cvt_pk_bf16_f32 v197, v186, v187
  v_cvt_pk_bf16_f32 v198, v188, v189
  v_cvt_pk_bf16_f32 v199, v190, v191
  buffer_store_dwordx4 v[196:199], v230, s[12:15], s42 offen offset:1024 sc0 sc1
  v_accvgpr_read_b32 v176, a80
  v_accvgpr_read_b32 v177, a81
  v_accvgpr_read_b32 v178, a82
  v_accvgpr_read_b32 v179, a83
  v_accvgpr_read_b32 v180, a84
  v_accvgpr_read_b32 v181, a85
  v_accvgpr_read_b32 v182, a86
  v_accvgpr_read_b32 v183, a87
  v_pk_mul_f32 v[176:177], v[176:177], v[238:239] op_sel:[0,0] op_sel_hi:[1,0]
  v_pk_mul_f32 v[178:179], v[178:179], v[238:239] op_sel:[0,0] op_sel_hi:[1,0]
  v_pk_mul_f32 v[180:181], v[180:181], v[238:239] op_sel:[0,0] op_sel_hi:[1,0]
  v_pk_mul_f32 v[182:183], v[182:183], v[238:239] op_sel:[0,0] op_sel_hi:[1,0]
  v_cvt_pk_bf16_f32 v200, v176, v177
  v_cvt_pk_bf16_f32 v201, v178, v179
  v_cvt_pk_bf16_f32 v202, v180, v181
  v_cvt_pk_bf16_f32 v203, v182, v183
  buffer_store_dwordx4 v[200:203], v230, s[12:15], s42 offen offset:2048 sc0 sc1
  v_accvgpr_read_b32 v184, a88
  v_accvgpr_read_b32 v185, a89
  v_accvgpr_read_b32 v186, a90
  v_accvgpr_read_b32 v187, a91
  v_accvgpr_read_b32 v188, a92
  v_accvgpr_read_b32 v189, a93
  v_accvgpr_read_b32 v190, a94
  v_accvgpr_read_b32 v191, a95
  v_pk_mul_f32 v[184:185], v[184:185], v[238:239] op_sel:[0,0] op_sel_hi:[1,0]
  v_pk_mul_f32 v[186:187], v[186:187], v[238:239] op_sel:[0,0] op_sel_hi:[1,0]
  v_pk_mul_f32 v[188:189], v[188:189], v[238:239] op_sel:[0,0] op_sel_hi:[1,0]
  v_pk_mul_f32 v[190:191], v[190:191], v[238:239] op_sel:[0,0] op_sel_hi:[1,0]
  v_cvt_pk_bf16_f32 v204, v184, v185
  v_cvt_pk_bf16_f32 v205, v186, v187
  v_cvt_pk_bf16_f32 v206, v188, v189
  v_cvt_pk_bf16_f32 v207, v190, v191
  buffer_store_dwordx4 v[204:207], v230, s[12:15], s42 offen offset:3072 sc0 sc1
  s_mov_b32 s42, 393216
  v_accvgpr_read_b32 v176, a96
  v_accvgpr_read_b32 v177, a97
  v_accvgpr_read_b32 v178, a98
  v_accvgpr_read_b32 v179, a99
  v_accvgpr_read_b32 v180, a100
  v_accvgpr_read_b32 v181, a101
  v_accvgpr_read_b32 v182, a102
  v_accvgpr_read_b32 v183, a103
  v_pk_mul_f32 v[176:177], v[176:177], v[238:239] op_sel:[0,1] op_sel_hi:[1,1]
  v_pk_mul_f32 v[178:179], v[178:179], v[238:239] op_sel:[0,1] op_sel_hi:[1,1]
  v_pk_mul_f32 v[180:181], v[180:181], v[238:239] op_sel:[0,1] op_sel_hi:[1,1]
  v_pk_mul_f32 v[182:183], v[182:183], v[238:239] op_sel:[0,1] op_sel_hi:[1,1]
  v_cvt_pk_bf16_f32 v192, v176, v177
  v_cvt_pk_bf16_f32 v193, v178, v179
  v_cvt_pk_bf16_f32 v194, v180, v181
  v_cvt_pk_bf16_f32 v195, v182, v183
  buffer_store_dwordx4 v[192:195], v230, s[12:15], s42 offen offset:0 sc0 sc1
  v_accvgpr_read_b32 v184, a104
  v_accvgpr_read_b32 v185, a105
  v_accvgpr_read_b32 v186, a106
  v_accvgpr_read_b32 v187, a107
  v_accvgpr_read_b32 v188, a108
  v_accvgpr_read_b32 v189, a109
  v_accvgpr_read_b32 v190, a110
  v_accvgpr_read_b32 v191, a111
  v_pk_mul_f32 v[184:185], v[184:185], v[238:239] op_sel:[0,1] op_sel_hi:[1,1]
  v_pk_mul_f32 v[186:187], v[186:187], v[238:239] op_sel:[0,1] op_sel_hi:[1,1]
  v_pk_mul_f32 v[188:189], v[188:189], v[238:239] op_sel:[0,1] op_sel_hi:[1,1]
  v_pk_mul_f32 v[190:191], v[190:191], v[238:239] op_sel:[0,1] op_sel_hi:[1,1]
  v_cvt_pk_bf16_f32 v196, v184, v185
  v_cvt_pk_bf16_f32 v197, v186, v187
  v_cvt_pk_bf16_f32 v198, v188, v189
  v_cvt_pk_bf16_f32 v199, v190, v191
  buffer_store_dwordx4 v[196:199], v230, s[12:15], s42 offen offset:1024 sc0 sc1
  v_accvgpr_read_b32 v176, a112
  v_accvgpr_read_b32 v177, a113
  v_accvgpr_read_b32 v178, a114
  v_accvgpr_read_b32 v179, a115
  v_accvgpr_read_b32 v180, a116
  v_accvgpr_read_b32 v181, a117
  v_accvgpr_read_b32 v182, a118
  v_accvgpr_read_b32 v183, a119
  v_pk_mul_f32 v[176:177], v[176:177], v[238:239] op_sel:[0,1] op_sel_hi:[1,1]
  v_pk_mul_f32 v[178:179], v[178:179], v[238:239] op_sel:[0,1] op_sel_hi:[1,1]
  v_pk_mul_f32 v[180:181], v[180:181], v[238:239] op_sel:[0,1] op_sel_hi:[1,1]
  v_pk_mul_f32 v[182:183], v[182:183], v[238:239] op_sel:[0,1] op_sel_hi:[1,1]
  v_cvt_pk_bf16_f32 v200, v176, v177
  v_cvt_pk_bf16_f32 v201, v178, v179
  v_cvt_pk_bf16_f32 v202, v180, v181
  v_cvt_pk_bf16_f32 v203, v182, v183
  buffer_store_dwordx4 v[200:203], v230, s[12:15], s42 offen offset:2048 sc0 sc1
  v_accvgpr_read_b32 v184, a120
  v_accvgpr_read_b32 v185, a121
  v_accvgpr_read_b32 v186, a122
  v_accvgpr_read_b32 v187, a123
  v_accvgpr_read_b32 v188, a124
  v_accvgpr_read_b32 v189, a125
  v_accvgpr_read_b32 v190, a126
  v_accvgpr_read_b32 v191, a127
  v_pk_mul_f32 v[184:185], v[184:185], v[238:239] op_sel:[0,1] op_sel_hi:[1,1]
  v_pk_mul_f32 v[186:187], v[186:187], v[238:239] op_sel:[0,1] op_sel_hi:[1,1]
  v_pk_mul_f32 v[188:189], v[188:189], v[238:239] op_sel:[0,1] op_sel_hi:[1,1]
  v_pk_mul_f32 v[190:191], v[190:191], v[238:239] op_sel:[0,1] op_sel_hi:[1,1]
  v_cvt_pk_bf16_f32 v204, v184, v185
  v_cvt_pk_bf16_f32 v205, v186, v187
  v_cvt_pk_bf16_f32 v206, v188, v189
  v_cvt_pk_bf16_f32 v207, v190, v191
  buffer_store_dwordx4 v[204:207], v230, s[12:15], s42 offen offset:3072 sc0 sc1
  s_mov_b32 s42, 524288
  v_accvgpr_read_b32 v176, a128
  v_accvgpr_read_b32 v177, a129
  v_accvgpr_read_b32 v178, a130
  v_accvgpr_read_b32 v179, a131
  v_accvgpr_read_b32 v180, a132
  v_accvgpr_read_b32 v181, a133
  v_accvgpr_read_b32 v182, a134
  v_accvgpr_read_b32 v183, a135
  v_pk_mul_f32 v[176:177], v[176:177], v[240:241] op_sel:[0,0] op_sel_hi:[1,0]
  v_pk_mul_f32 v[178:179], v[178:179], v[240:241] op_sel:[0,0] op_sel_hi:[1,0]
  v_pk_mul_f32 v[180:181], v[180:181], v[240:241] op_sel:[0,0] op_sel_hi:[1,0]
  v_pk_mul_f32 v[182:183], v[182:183], v[240:241] op_sel:[0,0] op_sel_hi:[1,0]
  v_cvt_pk_bf16_f32 v192, v176, v177
  v_cvt_pk_bf16_f32 v193, v178, v179
  v_cvt_pk_bf16_f32 v194, v180, v181
  v_cvt_pk_bf16_f32 v195, v182, v183
  buffer_store_dwordx4 v[192:195], v230, s[12:15], s42 offen offset:0 sc0 sc1
  v_accvgpr_read_b32 v184, a136
  v_accvgpr_read_b32 v185, a137
  v_accvgpr_read_b32 v186, a138
  v_accvgpr_read_b32 v187, a139
  v_accvgpr_read_b32 v188, a140
  v_accvgpr_read_b32 v189, a141
  v_accvgpr_read_b32 v190, a142
  v_accvgpr_read_b32 v191, a143
  v_pk_mul_f32 v[184:185], v[184:185], v[240:241] op_sel:[0,0] op_sel_hi:[1,0]
  v_pk_mul_f32 v[186:187], v[186:187], v[240:241] op_sel:[0,0] op_sel_hi:[1,0]
  v_pk_mul_f32 v[188:189], v[188:189], v[240:241] op_sel:[0,0] op_sel_hi:[1,0]
  v_pk_mul_f32 v[190:191], v[190:191], v[240:241] op_sel:[0,0] op_sel_hi:[1,0]
  v_cvt_pk_bf16_f32 v196, v184, v185
  v_cvt_pk_bf16_f32 v197, v186, v187
  v_cvt_pk_bf16_f32 v198, v188, v189
  v_cvt_pk_bf16_f32 v199, v190, v191
  buffer_store_dwordx4 v[196:199], v230, s[12:15], s42 offen offset:1024 sc0 sc1
  v_accvgpr_read_b32 v176, a144
  v_accvgpr_read_b32 v177, a145
  v_accvgpr_read_b32 v178, a146
  v_accvgpr_read_b32 v179, a147
  v_accvgpr_read_b32 v180, a148
  v_accvgpr_read_b32 v181, a149
  v_accvgpr_read_b32 v182, a150
  v_accvgpr_read_b32 v183, a151
  v_pk_mul_f32 v[176:177], v[176:177], v[240:241] op_sel:[0,0] op_sel_hi:[1,0]
  v_pk_mul_f32 v[178:179], v[178:179], v[240:241] op_sel:[0,0] op_sel_hi:[1,0]
  v_pk_mul_f32 v[180:181], v[180:181], v[240:241] op_sel:[0,0] op_sel_hi:[1,0]
  v_pk_mul_f32 v[182:183], v[182:183], v[240:241] op_sel:[0,0] op_sel_hi:[1,0]
  v_cvt_pk_bf16_f32 v200, v176, v177
  v_cvt_pk_bf16_f32 v201, v178, v179
  v_cvt_pk_bf16_f32 v202, v180, v181
  v_cvt_pk_bf16_f32 v203, v182, v183
  buffer_store_dwordx4 v[200:203], v230, s[12:15], s42 offen offset:2048 sc0 sc1
  v_accvgpr_read_b32 v184, a152
  v_accvgpr_read_b32 v185, a153
  v_accvgpr_read_b32 v186, a154
  v_accvgpr_read_b32 v187, a155
  v_accvgpr_read_b32 v188, a156
  v_accvgpr_read_b32 v189, a157
  v_accvgpr_read_b32 v190, a158
  v_accvgpr_read_b32 v191, a159
  v_pk_mul_f32 v[184:185], v[184:185], v[240:241] op_sel:[0,0] op_sel_hi:[1,0]
  v_pk_mul_f32 v[186:187], v[186:187], v[240:241] op_sel:[0,0] op_sel_hi:[1,0]
  v_pk_mul_f32 v[188:189], v[188:189], v[240:241] op_sel:[0,0] op_sel_hi:[1,0]
  v_pk_mul_f32 v[190:191], v[190:191], v[240:241] op_sel:[0,0] op_sel_hi:[1,0]
  v_cvt_pk_bf16_f32 v204, v184, v185
  v_cvt_pk_bf16_f32 v205, v186, v187
  v_cvt_pk_bf16_f32 v206, v188, v189
  v_cvt_pk_bf16_f32 v207, v190, v191
  buffer_store_dwordx4 v[204:207], v230, s[12:15], s42 offen offset:3072 sc0 sc1
  s_mov_b32 s42, 655360
  v_accvgpr_read_b32 v176, a160
  v_accvgpr_read_b32 v177, a161
  v_accvgpr_read_b32 v178, a162
  v_accvgpr_read_b32 v179, a163
  v_accvgpr_read_b32 v180, a164
  v_accvgpr_read_b32 v181, a165
  v_accvgpr_read_b32 v182, a166
  v_accvgpr_read_b32 v183, a167
  v_pk_mul_f32 v[176:177], v[176:177], v[240:241] op_sel:[0,1] op_sel_hi:[1,1]
  v_pk_mul_f32 v[178:179], v[178:179], v[240:241] op_sel:[0,1] op_sel_hi:[1,1]
  v_pk_mul_f32 v[180:181], v[180:181], v[240:241] op_sel:[0,1] op_sel_hi:[1,1]
  v_pk_mul_f32 v[182:183], v[182:183], v[240:241] op_sel:[0,1] op_sel_hi:[1,1]
  v_cvt_pk_bf16_f32 v192, v176, v177
  v_cvt_pk_bf16_f32 v193, v178, v179
  v_cvt_pk_bf16_f32 v194, v180, v181
  v_cvt_pk_bf16_f32 v195, v182, v183
  buffer_store_dwordx4 v[192:195], v230, s[12:15], s42 offen offset:0 sc0 sc1
  v_accvgpr_read_b32 v184, a168
  v_accvgpr_read_b32 v185, a169
  v_accvgpr_read_b32 v186, a170
  v_accvgpr_read_b32 v187, a171
  v_accvgpr_read_b32 v188, a172
  v_accvgpr_read_b32 v189, a173
  v_accvgpr_read_b32 v190, a174
  v_accvgpr_read_b32 v191, a175
  v_pk_mul_f32 v[184:185], v[184:185], v[240:241] op_sel:[0,1] op_sel_hi:[1,1]
  v_pk_mul_f32 v[186:187], v[186:187], v[240:241] op_sel:[0,1] op_sel_hi:[1,1]
  v_pk_mul_f32 v[188:189], v[188:189], v[240:241] op_sel:[0,1] op_sel_hi:[1,1]
  v_pk_mul_f32 v[190:191], v[190:191], v[240:241] op_sel:[0,1] op_sel_hi:[1,1]
  v_cvt_pk_bf16_f32 v196, v184, v185
  v_cvt_pk_bf16_f32 v197, v186, v187
  v_cvt_pk_bf16_f32 v198, v188, v189
  v_cvt_pk_bf16_f32 v199, v190, v191
  buffer_store_dwordx4 v[196:199], v230, s[12:15], s42 offen offset:1024 sc0 sc1
  v_accvgpr_read_b32 v176, a176
  v_accvgpr_read_b32 v177, a177
  v_accvgpr_read_b32 v178, a178
  v_accvgpr_read_b32 v179, a179
  v_accvgpr_read_b32 v180, a180
  v_accvgpr_read_b32 v181, a181
  v_accvgpr_read_b32 v182, a182
  v_accvgpr_read_b32 v183, a183
  v_pk_mul_f32 v[176:177], v[176:177], v[240:241] op_sel:[0,1] op_sel_hi:[1,1]
  v_pk_mul_f32 v[178:179], v[178:179], v[240:241] op_sel:[0,1] op_sel_hi:[1,1]
  v_pk_mul_f32 v[180:181], v[180:181], v[240:241] op_sel:[0,1] op_sel_hi:[1,1]
  v_pk_mul_f32 v[182:183], v[182:183], v[240:241] op_sel:[0,1] op_sel_hi:[1,1]
  v_cvt_pk_bf16_f32 v200, v176, v177
  v_cvt_pk_bf16_f32 v201, v178, v179
  v_cvt_pk_bf16_f32 v202, v180, v181
  v_cvt_pk_bf16_f32 v203, v182, v183
  buffer_store_dwordx4 v[200:203], v230, s[12:15], s42 offen offset:2048 sc0 sc1
  v_accvgpr_read_b32 v184, a184
  v_accvgpr_read_b32 v185, a185
  v_accvgpr_read_b32 v186, a186
  v_accvgpr_read_b32 v187, a187
  v_accvgpr_read_b32 v188, a188
  v_accvgpr_read_b32 v189, a189
  v_accvgpr_read_b32 v190, a190
  v_accvgpr_read_b32 v191, a191
  v_pk_mul_f32 v[184:185], v[184:185], v[240:241] op_sel:[0,1] op_sel_hi:[1,1]
  v_pk_mul_f32 v[186:187], v[186:187], v[240:241] op_sel:[0,1] op_sel_hi:[1,1]
  v_pk_mul_f32 v[188:189], v[188:189], v[240:241] op_sel:[0,1] op_sel_hi:[1,1]
  v_pk_mul_f32 v[190:191], v[190:191], v[240:241] op_sel:[0,1] op_sel_hi:[1,1]
  v_cvt_pk_bf16_f32 v204, v184, v185
  v_cvt_pk_bf16_f32 v205, v186, v187
  v_cvt_pk_bf16_f32 v206, v188, v189
  v_cvt_pk_bf16_f32 v207, v190, v191
  buffer_store_dwordx4 v[204:207], v230, s[12:15], s42 offen offset:3072 sc0 sc1
  s_waitcnt vmcnt(0)
  v_mov_b32 v243, 1
  buffer_atomic_add v243, v228, s[16:19], s63 offen sc1
  s_endpgm
O_TILE:
  s_cmp_lt_u32 s43, 32
  s_cbranch_scc1 O_DEP0
O_DEP0OK:
  s_cmp_eq_u32 s92, 24
  s_cselect_b32 s33, 8, 9
  s_mul_i32 s41, s37, 224
  s_mul_i32 s42, s92, 9
  s_add_u32 s41, s41, s42
  s_lshl_b32 s41, s41, 17
  s_add_u32 s4, s52, s41
  s_addc_u32 s5, s53, 0
  s_lshl_b32 s6, s33, 17
  s_lshl_b32 s25, s20, 10
  v_mov_b32 v208, v230
  v_mov_b32 v215, v228
  v_mov_b32 v209, v229
  v_lshrrev_b32 v128, 4, v230
  v_lshrrev_b32 v129, 4, v128
  v_and_b32 v130, 15, v128
  v_bfe_u32 v131, v128, 2, 2
  v_and_b32 v132, 3, v128
  v_and_b32 v133, 1, v129
  v_lshl_add_u32 v133, v133, 2, v131
  v_mul_u32_u24 v133, 1088, v133
  v_lshrrev_b32 v134, 1, v129
  v_lshl_add_u32 v133, v134, 8, v133
  v_lshl_add_u32 v133, v132, 4, v133
  v_add_u32 v210, s24, v133
  v_mul_u32_u24 v133, 2560, v130
  v_lshl_add_u32 v211, v129, 4, v133
  s_lshl_b32 s40, s20, 6
  v_add_u32 v211, s40, v211
  s_add_u32 s94, s94, 8192
  s_add_u32 s95, s95, 8192
  s_add_u32 s27, s25, 0
  buffer_load_dwordx4 v[0:3], v208, s[4:7], s27 offen sc1
  s_add_u32 s27, s25, 131072
  buffer_load_dwordx4 v[4:7], v208, s[4:7], s27 offen sc1
  s_add_u32 s27, s25, 262144
  buffer_load_dwordx4 v[8:11], v208, s[4:7], s27 offen sc1
  s_add_u32 s27, s25, 393216
  buffer_load_dwordx4 v[12:15], v208, s[4:7], s27 offen sc1
  s_add_u32 s27, s25, 524288
  buffer_load_dwordx4 v[16:19], v208, s[4:7], s27 offen sc1
  s_add_u32 s27, s25, 655360
  buffer_load_dwordx4 v[20:23], v208, s[4:7], s27 offen sc1
  s_add_u32 s27, s25, 786432
  buffer_load_dwordx4 v[24:27], v208, s[4:7], s27 offen sc1
  s_add_u32 s27, s25, 917504
  buffer_load_dwordx4 v[28:31], v208, s[4:7], s27 offen sc1
  s_add_u32 s27, s25, 1048576
  buffer_load_dwordx4 v[32:35], v208, s[4:7], s27 offen sc1
  s_add_u32 s25, s25, 4096
  s_add_u32 s27, s25, 0
  buffer_load_dwordx4 v[36:39], v208, s[4:7], s27 offen sc1
  s_add_u32 s27, s25, 131072
  buffer_load_dwordx4 v[40:43], v208, s[4:7], s27 offen sc1
  s_add_u32 s27, s25, 262144
  buffer_load_dwordx4 v[44:47], v208, s[4:7], s27 offen sc1
  s_add_u32 s27, s25, 393216
  buffer_load_dwordx4 v[48:51], v208, s[4:7], s27 offen sc1
  s_add_u32 s27, s25, 524288
  buffer_load_dwordx4 v[52:55], v208, s[4:7], s27 offen sc1
  s_add_u32 s27, s25, 655360
  buffer_load_dwordx4 v[56:59], v208, s[4:7], s27 offen sc1
  s_add_u32 s27, s25, 786432
  buffer_load_dwordx4 v[60:63], v208, s[4:7], s27 offen sc1
  s_add_u32 s27, s25, 917504
  buffer_load_dwordx4 v[64:67], v208, s[4:7], s27 offen sc1
  s_add_u32 s27, s25, 1048576
  buffer_load_dwordx4 v[68:71], v208, s[4:7], s27 offen sc1
  s_add_u32 s25, s25, 4096
  s_add_u32 s27, s25, 0
  buffer_load_dwordx4 v[72:75], v208, s[4:7], s27 offen sc1
  s_add_u32 s27, s25, 131072
  buffer_load_dwordx4 v[76:79], v208, s[4:7], s27 offen sc1
  s_add_u32 s27, s25, 262144
  buffer_load_dwordx4 v[80:83], v208, s[4:7], s27 offen sc1
  s_add_u32 s27, s25, 393216
  buffer_load_dwordx4 v[84:87], v208, s[4:7], s27 offen sc1
  s_add_u32 s27, s25, 524288
  buffer_load_dwordx4 v[88:91], v208, s[4:7], s27 offen sc1
  s_add_u32 s27, s25, 655360
  buffer_load_dwordx4 v[92:95], v208, s[4:7], s27 offen sc1
  s_add_u32 s27, s25, 786432
  buffer_load_dwordx4 v[96:99], v208, s[4:7], s27 offen sc1
  s_add_u32 s27, s25, 917504
  buffer_load_dwordx4 v[100:103], v208, s[4:7], s27 offen sc1
  s_add_u32 s27, s25, 1048576
  buffer_load_dwordx4 v[104:107], v208, s[4:7], s27 offen sc1
  s_add_u32 s25, s25, 4096
  s_mov_b32 s42, 0
  v_accvgpr_read_b32 v176, a0
  v_accvgpr_read_b32 v177, a1
  v_accvgpr_read_b32 v178, a2
  v_accvgpr_read_b32 v179, a3
  v_accvgpr_read_b32 v180, a4
  v_accvgpr_read_b32 v181, a5
  v_accvgpr_read_b32 v182, a6
  v_accvgpr_read_b32 v183, a7
  v_pk_mul_f32 v[176:177], v[176:177], v[236:237] op_sel:[0,0] op_sel_hi:[1,0]
  v_pk_mul_f32 v[178:179], v[178:179], v[236:237] op_sel:[0,0] op_sel_hi:[1,0]
  v_pk_mul_f32 v[180:181], v[180:181], v[236:237] op_sel:[0,0] op_sel_hi:[1,0]
  v_pk_mul_f32 v[182:183], v[182:183], v[236:237] op_sel:[0,0] op_sel_hi:[1,0]
  v_cvt_pk_bf16_f32 v192, v176, v177
  v_cvt_pk_bf16_f32 v193, v178, v179
  v_cvt_pk_bf16_f32 v194, v180, v181
  v_cvt_pk_bf16_f32 v195, v182, v183
  buffer_store_dwordx4 v[192:195], v230, s[12:15], s42 offen offset:0 sc0 sc1
  v_accvgpr_read_b32 v184, a8
  v_accvgpr_read_b32 v185, a9
  v_accvgpr_read_b32 v186, a10
  v_accvgpr_read_b32 v187, a11
  v_accvgpr_read_b32 v188, a12
  v_accvgpr_read_b32 v189, a13
  v_accvgpr_read_b32 v190, a14
  v_accvgpr_read_b32 v191, a15
  v_pk_mul_f32 v[184:185], v[184:185], v[236:237] op_sel:[0,0] op_sel_hi:[1,0]
  v_pk_mul_f32 v[186:187], v[186:187], v[236:237] op_sel:[0,0] op_sel_hi:[1,0]
  v_pk_mul_f32 v[188:189], v[188:189], v[236:237] op_sel:[0,0] op_sel_hi:[1,0]
  v_pk_mul_f32 v[190:191], v[190:191], v[236:237] op_sel:[0,0] op_sel_hi:[1,0]
  v_cvt_pk_bf16_f32 v196, v184, v185
  v_cvt_pk_bf16_f32 v197, v186, v187
  v_cvt_pk_bf16_f32 v198, v188, v189
  v_cvt_pk_bf16_f32 v199, v190, v191
  buffer_store_dwordx4 v[196:199], v230, s[12:15], s42 offen offset:1024 sc0 sc1
  v_accvgpr_read_b32 v176, a16
  v_accvgpr_read_b32 v177, a17
  v_accvgpr_read_b32 v178, a18
  v_accvgpr_read_b32 v179, a19
  v_accvgpr_read_b32 v180, a20
  v_accvgpr_read_b32 v181, a21
  v_accvgpr_read_b32 v182, a22
  v_accvgpr_read_b32 v183, a23
  v_pk_mul_f32 v[176:177], v[176:177], v[236:237] op_sel:[0,0] op_sel_hi:[1,0]
  v_pk_mul_f32 v[178:179], v[178:179], v[236:237] op_sel:[0,0] op_sel_hi:[1,0]
  v_pk_mul_f32 v[180:181], v[180:181], v[236:237] op_sel:[0,0] op_sel_hi:[1,0]
  v_pk_mul_f32 v[182:183], v[182:183], v[236:237] op_sel:[0,0] op_sel_hi:[1,0]
  v_cvt_pk_bf16_f32 v200, v176, v177
  v_cvt_pk_bf16_f32 v201, v178, v179
  v_cvt_pk_bf16_f32 v202, v180, v181
  v_cvt_pk_bf16_f32 v203, v182, v183
  buffer_store_dwordx4 v[200:203], v230, s[12:15], s42 offen offset:2048 sc0 sc1
  v_accvgpr_read_b32 v184, a24
  v_accvgpr_read_b32 v185, a25
  v_accvgpr_read_b32 v186, a26
  v_accvgpr_read_b32 v187, a27
  v_accvgpr_read_b32 v188, a28
  v_accvgpr_read_b32 v189, a29
  v_accvgpr_read_b32 v190, a30
  v_accvgpr_read_b32 v191, a31
  v_pk_mul_f32 v[184:185], v[184:185], v[236:237] op_sel:[0,0] op_sel_hi:[1,0]
  v_pk_mul_f32 v[186:187], v[186:187], v[236:237] op_sel:[0,0] op_sel_hi:[1,0]
  v_pk_mul_f32 v[188:189], v[188:189], v[236:237] op_sel:[0,0] op_sel_hi:[1,0]
  v_pk_mul_f32 v[190:191], v[190:191], v[236:237] op_sel:[0,0] op_sel_hi:[1,0]
  v_cvt_pk_bf16_f32 v204, v184, v185
  v_cvt_pk_bf16_f32 v205, v186, v187
  v_cvt_pk_bf16_f32 v206, v188, v189
  v_cvt_pk_bf16_f32 v207, v190, v191
  buffer_store_dwordx4 v[204:207], v230, s[12:15], s42 offen offset:3072 sc0 sc1
  s_mov_b32 s42, 131072
  v_accvgpr_read_b32 v176, a32
  v_accvgpr_read_b32 v177, a33
  v_accvgpr_read_b32 v178, a34
  v_accvgpr_read_b32 v179, a35
  v_accvgpr_read_b32 v180, a36
  v_accvgpr_read_b32 v181, a37
  v_accvgpr_read_b32 v182, a38
  v_accvgpr_read_b32 v183, a39
  v_pk_mul_f32 v[176:177], v[176:177], v[236:237] op_sel:[0,1] op_sel_hi:[1,1]
  v_pk_mul_f32 v[178:179], v[178:179], v[236:237] op_sel:[0,1] op_sel_hi:[1,1]
  v_pk_mul_f32 v[180:181], v[180:181], v[236:237] op_sel:[0,1] op_sel_hi:[1,1]
  v_pk_mul_f32 v[182:183], v[182:183], v[236:237] op_sel:[0,1] op_sel_hi:[1,1]
  v_cvt_pk_bf16_f32 v192, v176, v177
  v_cvt_pk_bf16_f32 v193, v178, v179
  v_cvt_pk_bf16_f32 v194, v180, v181
  v_cvt_pk_bf16_f32 v195, v182, v183
  buffer_store_dwordx4 v[192:195], v230, s[12:15], s42 offen offset:0 sc0 sc1
  v_accvgpr_read_b32 v184, a40
  v_accvgpr_read_b32 v185, a41
  v_accvgpr_read_b32 v186, a42
  v_accvgpr_read_b32 v187, a43
  v_accvgpr_read_b32 v188, a44
  v_accvgpr_read_b32 v189, a45
  v_accvgpr_read_b32 v190, a46
  v_accvgpr_read_b32 v191, a47
  v_pk_mul_f32 v[184:185], v[184:185], v[236:237] op_sel:[0,1] op_sel_hi:[1,1]
  v_pk_mul_f32 v[186:187], v[186:187], v[236:237] op_sel:[0,1] op_sel_hi:[1,1]
  v_pk_mul_f32 v[188:189], v[188:189], v[236:237] op_sel:[0,1] op_sel_hi:[1,1]
  v_pk_mul_f32 v[190:191], v[190:191], v[236:237] op_sel:[0,1] op_sel_hi:[1,1]
  v_cvt_pk_bf16_f32 v196, v184, v185
  v_cvt_pk_bf16_f32 v197, v186, v187
  v_cvt_pk_bf16_f32 v198, v188, v189
  v_cvt_pk_bf16_f32 v199, v190, v191
  buffer_store_dwordx4 v[196:199], v230, s[12:15], s42 offen offset:1024 sc0 sc1
  v_accvgpr_read_b32 v176, a48
  v_accvgpr_read_b32 v177, a49
  v_accvgpr_read_b32 v178, a50
  v_accvgpr_read_b32 v179, a51
  v_accvgpr_read_b32 v180, a52
  v_accvgpr_read_b32 v181, a53
  v_accvgpr_read_b32 v182, a54
  v_accvgpr_read_b32 v183, a55
  v_pk_mul_f32 v[176:177], v[176:177], v[236:237] op_sel:[0,1] op_sel_hi:[1,1]
  v_pk_mul_f32 v[178:179], v[178:179], v[236:237] op_sel:[0,1] op_sel_hi:[1,1]
  v_pk_mul_f32 v[180:181], v[180:181], v[236:237] op_sel:[0,1] op_sel_hi:[1,1]
  v_pk_mul_f32 v[182:183], v[182:183], v[236:237] op_sel:[0,1] op_sel_hi:[1,1]
  v_cvt_pk_bf16_f32 v200, v176, v177
  v_cvt_pk_bf16_f32 v201, v178, v179
  v_cvt_pk_bf16_f32 v202, v180, v181
  v_cvt_pk_bf16_f32 v203, v182, v183
  buffer_store_dwordx4 v[200:203], v230, s[12:15], s42 offen offset:2048 sc0 sc1
  v_accvgpr_read_b32 v184, a56
  v_accvgpr_read_b32 v185, a57
  v_accvgpr_read_b32 v186, a58
  v_accvgpr_read_b32 v187, a59
  v_accvgpr_read_b32 v188, a60
  v_accvgpr_read_b32 v189, a61
  v_accvgpr_read_b32 v190, a62
  v_accvgpr_read_b32 v191, a63
  v_pk_mul_f32 v[184:185], v[184:185], v[236:237] op_sel:[0,1] op_sel_hi:[1,1]
  v_pk_mul_f32 v[186:187], v[186:187], v[236:237] op_sel:[0,1] op_sel_hi:[1,1]
  v_pk_mul_f32 v[188:189], v[188:189], v[236:237] op_sel:[0,1] op_sel_hi:[1,1]
  v_pk_mul_f32 v[190:191], v[190:191], v[236:237] op_sel:[0,1] op_sel_hi:[1,1]
  v_cvt_pk_bf16_f32 v204, v184, v185
  v_cvt_pk_bf16_f32 v205, v186, v187
  v_cvt_pk_bf16_f32 v206, v188, v189
  v_cvt_pk_bf16_f32 v207, v190, v191
  buffer_store_dwordx4 v[204:207], v230, s[12:15], s42 offen offset:3072 sc0 sc1
  s_mov_b32 s42, 262144
  v_accvgpr_read_b32 v176, a64
  v_accvgpr_read_b32 v177, a65
  v_accvgpr_read_b32 v178, a66
  v_accvgpr_read_b32 v179, a67
  v_accvgpr_read_b32 v180, a68
  v_accvgpr_read_b32 v181, a69
  v_accvgpr_read_b32 v182, a70
  v_accvgpr_read_b32 v183, a71
  v_pk_mul_f32 v[176:177], v[176:177], v[238:239] op_sel:[0,0] op_sel_hi:[1,0]
  v_pk_mul_f32 v[178:179], v[178:179], v[238:239] op_sel:[0,0] op_sel_hi:[1,0]
  v_pk_mul_f32 v[180:181], v[180:181], v[238:239] op_sel:[0,0] op_sel_hi:[1,0]
  v_pk_mul_f32 v[182:183], v[182:183], v[238:239] op_sel:[0,0] op_sel_hi:[1,0]
  v_cvt_pk_bf16_f32 v192, v176, v177
  v_cvt_pk_bf16_f32 v193, v178, v179
  v_cvt_pk_bf16_f32 v194, v180, v181
  v_cvt_pk_bf16_f32 v195, v182, v183
  buffer_store_dwordx4 v[192:195], v230, s[12:15], s42 offen offset:0 sc0 sc1
  v_accvgpr_read_b32 v184, a72
  v_accvgpr_read_b32 v185, a73
  v_accvgpr_read_b32 v186, a74
  v_accvgpr_read_b32 v187, a75
  v_accvgpr_read_b32 v188, a76
  v_accvgpr_read_b32 v189, a77
  v_accvgpr_read_b32 v190, a78
  v_accvgpr_read_b32 v191, a79
  v_pk_mul_f32 v[184:185], v[184:185], v[238:239] op_sel:[0,0] op_sel_hi:[1,0]
  v_pk_mul_f32 v[186:187], v[186:187], v[238:239] op_sel:[0,0] op_sel_hi:[1,0]
  v_pk_mul_f32 v[188:189], v[188:189], v[238:239] op_sel:[0,0] op_sel_hi:[1,0]
  v_pk_mul_f32 v[190:191], v[190:191], v[238:239] op_sel:[0,0] op_sel_hi:[1,0]
  v_cvt_pk_bf16_f32 v196, v184, v185
  v_cvt_pk_bf16_f32 v197, v186, v187
  v_cvt_pk_bf16_f32 v198, v188, v189
  v_cvt_pk_bf16_f32 v199, v190, v191
  buffer_store_dwordx4 v[196:199], v230, s[12:15], s42 offen offset:1024 sc0 sc1
  v_accvgpr_read_b32 v176, a80
  v_accvgpr_read_b32 v177, a81
  v_accvgpr_read_b32 v178, a82
  v_accvgpr_read_b32 v179, a83
  v_accvgpr_read_b32 v180, a84
  v_accvgpr_read_b32 v181, a85
  v_accvgpr_read_b32 v182, a86
  v_accvgpr_read_b32 v183, a87
  v_pk_mul_f32 v[176:177], v[176:177], v[238:239] op_sel:[0,0] op_sel_hi:[1,0]
  v_pk_mul_f32 v[178:179], v[178:179], v[238:239] op_sel:[0,0] op_sel_hi:[1,0]
  v_pk_mul_f32 v[180:181], v[180:181], v[238:239] op_sel:[0,0] op_sel_hi:[1,0]
  v_pk_mul_f32 v[182:183], v[182:183], v[238:239] op_sel:[0,0] op_sel_hi:[1,0]
  v_cvt_pk_bf16_f32 v200, v176, v177
  v_cvt_pk_bf16_f32 v201, v178, v179
  v_cvt_pk_bf16_f32 v202, v180, v181
  v_cvt_pk_bf16_f32 v203, v182, v183
  buffer_store_dwordx4 v[200:203], v230, s[12:15], s42 offen offset:2048 sc0 sc1
  v_accvgpr_read_b32 v184, a88
  v_accvgpr_read_b32 v185, a89
  v_accvgpr_read_b32 v186, a90
  v_accvgpr_read_b32 v187, a91
  v_accvgpr_read_b32 v188, a92
  v_accvgpr_read_b32 v189, a93
  v_accvgpr_read_b32 v190, a94
  v_accvgpr_read_b32 v191, a95
  v_pk_mul_f32 v[184:185], v[184:185], v[238:239] op_sel:[0,0] op_sel_hi:[1,0]
  v_pk_mul_f32 v[186:187], v[186:187], v[238:239] op_sel:[0,0] op_sel_hi:[1,0]
  v_pk_mul_f32 v[188:189], v[188:189], v[238:239] op_sel:[0,0] op_sel_hi:[1,0]
  v_pk_mul_f32 v[190:191], v[190:191], v[238:239] op_sel:[0,0] op_sel_hi:[1,0]
  v_cvt_pk_bf16_f32 v204, v184, v185
  v_cvt_pk_bf16_f32 v205, v186, v187
  v_cvt_pk_bf16_f32 v206, v188, v189
  v_cvt_pk_bf16_f32 v207, v190, v191
  buffer_store_dwordx4 v[204:207], v230, s[12:15], s42 offen offset:3072 sc0 sc1
  s_mov_b32 s42, 393216
  v_accvgpr_read_b32 v176, a96
  v_accvgpr_read_b32 v177, a97
  v_accvgpr_read_b32 v178, a98
  v_accvgpr_read_b32 v179, a99
  v_accvgpr_read_b32 v180, a100
  v_accvgpr_read_b32 v181, a101
  v_accvgpr_read_b32 v182, a102
  v_accvgpr_read_b32 v183, a103
  v_pk_mul_f32 v[176:177], v[176:177], v[238:239] op_sel:[0,1] op_sel_hi:[1,1]
  v_pk_mul_f32 v[178:179], v[178:179], v[238:239] op_sel:[0,1] op_sel_hi:[1,1]
  v_pk_mul_f32 v[180:181], v[180:181], v[238:239] op_sel:[0,1] op_sel_hi:[1,1]
  v_pk_mul_f32 v[182:183], v[182:183], v[238:239] op_sel:[0,1] op_sel_hi:[1,1]
  v_cvt_pk_bf16_f32 v192, v176, v177
  v_cvt_pk_bf16_f32 v193, v178, v179
  v_cvt_pk_bf16_f32 v194, v180, v181
  v_cvt_pk_bf16_f32 v195, v182, v183
  buffer_store_dwordx4 v[192:195], v230, s[12:15], s42 offen offset:0 sc0 sc1
  v_accvgpr_read_b32 v184, a104
  v_accvgpr_read_b32 v185, a105
  v_accvgpr_read_b32 v186, a106
  v_accvgpr_read_b32 v187, a107
  v_accvgpr_read_b32 v188, a108
  v_accvgpr_read_b32 v189, a109
  v_accvgpr_read_b32 v190, a110
  v_accvgpr_read_b32 v191, a111
  v_pk_mul_f32 v[184:185], v[184:185], v[238:239] op_sel:[0,1] op_sel_hi:[1,1]
  v_pk_mul_f32 v[186:187], v[186:187], v[238:239] op_sel:[0,1] op_sel_hi:[1,1]
  v_pk_mul_f32 v[188:189], v[188:189], v[238:239] op_sel:[0,1] op_sel_hi:[1,1]
  v_pk_mul_f32 v[190:191], v[190:191], v[238:239] op_sel:[0,1] op_sel_hi:[1,1]
  v_cvt_pk_bf16_f32 v196, v184, v185
  v_cvt_pk_bf16_f32 v197, v186, v187
  v_cvt_pk_bf16_f32 v198, v188, v189
  v_cvt_pk_bf16_f32 v199, v190, v191
  buffer_store_dwordx4 v[196:199], v230, s[12:15], s42 offen offset:1024 sc0 sc1
  v_accvgpr_read_b32 v176, a112
  v_accvgpr_read_b32 v177, a113
  v_accvgpr_read_b32 v178, a114
  v_accvgpr_read_b32 v179, a115
  v_accvgpr_read_b32 v180, a116
  v_accvgpr_read_b32 v181, a117
  v_accvgpr_read_b32 v182, a118
  v_accvgpr_read_b32 v183, a119
  v_pk_mul_f32 v[176:177], v[176:177], v[238:239] op_sel:[0,1] op_sel_hi:[1,1]
  v_pk_mul_f32 v[178:179], v[178:179], v[238:239] op_sel:[0,1] op_sel_hi:[1,1]
  v_pk_mul_f32 v[180:181], v[180:181], v[238:239] op_sel:[0,1] op_sel_hi:[1,1]
  v_pk_mul_f32 v[182:183], v[182:183], v[238:239] op_sel:[0,1] op_sel_hi:[1,1]
  v_cvt_pk_bf16_f32 v200, v176, v177
  v_cvt_pk_bf16_f32 v201, v178, v179
  v_cvt_pk_bf16_f32 v202, v180, v181
  v_cvt_pk_bf16_f32 v203, v182, v183
  buffer_store_dwordx4 v[200:203], v230, s[12:15], s42 offen offset:2048 sc0 sc1
  v_accvgpr_read_b32 v184, a120
  v_accvgpr_read_b32 v185, a121
  v_accvgpr_read_b32 v186, a122
  v_accvgpr_read_b32 v187, a123
  v_accvgpr_read_b32 v188, a124
  v_accvgpr_read_b32 v189, a125
  v_accvgpr_read_b32 v190, a126
  v_accvgpr_read_b32 v191, a127
  v_pk_mul_f32 v[184:185], v[184:185], v[238:239] op_sel:[0,1] op_sel_hi:[1,1]
  v_pk_mul_f32 v[186:187], v[186:187], v[238:239] op_sel:[0,1] op_sel_hi:[1,1]
  v_pk_mul_f32 v[188:189], v[188:189], v[238:239] op_sel:[0,1] op_sel_hi:[1,1]
  v_pk_mul_f32 v[190:191], v[190:191], v[238:239] op_sel:[0,1] op_sel_hi:[1,1]
  v_cvt_pk_bf16_f32 v204, v184, v185
  v_cvt_pk_bf16_f32 v205, v186, v187
  v_cvt_pk_bf16_f32 v206, v188, v189
  v_cvt_pk_bf16_f32 v207, v190, v191
  buffer_store_dwordx4 v[204:207], v230, s[12:15], s42 offen offset:3072 sc0 sc1
  s_mov_b32 s42, 524288
  v_accvgpr_read_b32 v176, a128
  v_accvgpr_read_b32 v177, a129
  ds_read_b64_tr_b16 v[144:145], v210 offset:0
  v_accvgpr_read_b32 v178, a130
  v_accvgpr_read_b32 v179, a131
  v_accvgpr_read_b32 v180, a132
  ds_read_b64_tr_b16 v[146:147], v210 offset:512
  v_accvgpr_read_b32 v181, a133
  v_accvgpr_read_b32 v182, a134
  v_accvgpr_read_b32 v183, a135
  ds_read_b64_tr_b16 v[148:149], v210 offset:8
  v_pk_mul_f32 v[176:177], v[176:177], v[240:241] op_sel:[0,0] op_sel_hi:[1,0]
  v_pk_mul_f32 v[178:179], v[178:179], v[240:241] op_sel:[0,0] op_sel_hi:[1,0]
  v_pk_mul_f32 v[180:181], v[180:181], v[240:241] op_sel:[0,0] op_sel_hi:[1,0]
  v_pk_mul_f32 v[182:183], v[182:183], v[240:241] op_sel:[0,0] op_sel_hi:[1,0]
  v_cvt_pk_bf16_f32 v192, v176, v177
  v_cvt_pk_bf16_f32 v193, v178, v179
  v_cvt_pk_bf16_f32 v194, v180, v181
  v_cvt_pk_bf16_f32 v195, v182, v183
  buffer_store_dwordx4 v[192:195], v230, s[12:15], s42 offen offset:0 sc0 sc1
  v_accvgpr_read_b32 v184, a136
  v_accvgpr_read_b32 v185, a137
  ds_read_b64_tr_b16 v[150:151], v210 offset:520
  v_accvgpr_read_b32 v186, a138
  v_accvgpr_read_b32 v187, a139
  v_accvgpr_read_b32 v188, a140
  ds_read_b64_tr_b16 v[152:153], v210 offset:64
  v_accvgpr_read_b32 v189, a141
  v_accvgpr_read_b32 v190, a142
  v_accvgpr_read_b32 v191, a143
  ds_read_b64_tr_b16 v[154:155], v210 offset:576
  v_pk_mul_f32 v[184:185], v[184:185], v[240:241] op_sel:[0,0] op_sel_hi:[1,0]
  v_pk_mul_f32 v[186:187], v[186:187], v[240:241] op_sel:[0,0] op_sel_hi:[1,0]
  v_pk_mul_f32 v[188:189], v[188:189], v[240:241] op_sel:[0,0] op_sel_hi:[1,0]
  v_pk_mul_f32 v[190:191], v[190:191], v[240:241] op_sel:[0,0] op_sel_hi:[1,0]
  v_cvt_pk_bf16_f32 v196, v184, v185
  v_cvt_pk_bf16_f32 v197, v186, v187
  v_cvt_pk_bf16_f32 v198, v188, v189
  v_cvt_pk_bf16_f32 v199, v190, v191
  buffer_store_dwordx4 v[196:199], v230, s[12:15], s42 offen offset:1024 sc0 sc1
  v_accvgpr_read_b32 v176, a144
  v_accvgpr_read_b32 v177, a145
  ds_read_b64_tr_b16 v[156:157], v210 offset:72
  v_accvgpr_read_b32 v178, a146
  v_accvgpr_read_b32 v179, a147
  v_accvgpr_read_b32 v180, a148
  ds_read_b64_tr_b16 v[158:159], v210 offset:584
  v_accvgpr_read_b32 v181, a149
  v_accvgpr_read_b32 v182, a150
  v_accvgpr_read_b32 v183, a151
  ds_read_b64_tr_b16 v[160:161], v210 offset:128
  v_pk_mul_f32 v[176:177], v[176:177], v[240:241] op_sel:[0,0] op_sel_hi:[1,0]
  v_pk_mul_f32 v[178:179], v[178:179], v[240:241] op_sel:[0,0] op_sel_hi:[1,0]
  v_pk_mul_f32 v[180:181], v[180:181], v[240:241] op_sel:[0,0] op_sel_hi:[1,0]
  v_pk_mul_f32 v[182:183], v[182:183], v[240:241] op_sel:[0,0] op_sel_hi:[1,0]
  v_cvt_pk_bf16_f32 v200, v176, v177
  v_cvt_pk_bf16_f32 v201, v178, v179
  v_cvt_pk_bf16_f32 v202, v180, v181
  v_cvt_pk_bf16_f32 v203, v182, v183
  buffer_store_dwordx4 v[200:203], v230, s[12:15], s42 offen offset:2048 sc0 sc1
  v_accvgpr_read_b32 v184, a152
  v_accvgpr_read_b32 v185, a153
  ds_read_b64_tr_b16 v[162:163], v210 offset:640
  v_accvgpr_read_b32 v186, a154
  v_accvgpr_read_b32 v187, a155
  v_accvgpr_read_b32 v188, a156
  ds_read_b64_tr_b16 v[164:165], v210 offset:136
  v_accvgpr_read_b32 v189, a157
  v_accvgpr_read_b32 v190, a158
  v_accvgpr_read_b32 v191, a159
  ds_read_b64_tr_b16 v[166:167], v210 offset:648
  v_pk_mul_f32 v[184:185], v[184:185], v[240:241] op_sel:[0,0] op_sel_hi:[1,0]
  v_pk_mul_f32 v[186:187], v[186:187], v[240:241] op_sel:[0,0] op_sel_hi:[1,0]
  v_pk_mul_f32 v[188:189], v[188:189], v[240:241] op_sel:[0,0] op_sel_hi:[1,0]
  v_pk_mul_f32 v[190:191], v[190:191], v[240:241] op_sel:[0,0] op_sel_hi:[1,0]
  v_cvt_pk_bf16_f32 v204, v184, v185
  v_cvt_pk_bf16_f32 v205, v186, v187
  v_cvt_pk_bf16_f32 v206, v188, v189
  v_cvt_pk_bf16_f32 v207, v190, v191
  buffer_store_dwordx4 v[204:207], v230, s[12:15], s42 offen offset:3072 sc0 sc1
  s_mov_b32 s42, 655360
  v_accvgpr_read_b32 v176, a160
  v_accvgpr_read_b32 v177, a161
  ds_read_b64_tr_b16 v[168:169], v210 offset:192
  v_accvgpr_read_b32 v178, a162
  v_accvgpr_read_b32 v179, a163
  v_accvgpr_read_b32 v180, a164
  ds_read_b64_tr_b16 v[170:171], v210 offset:704
  v_accvgpr_read_b32 v181, a165
  v_accvgpr_read_b32 v182, a166
  v_accvgpr_read_b32 v183, a167
  ds_read_b64_tr_b16 v[172:173], v210 offset:200
  v_pk_mul_f32 v[176:177], v[176:177], v[240:241] op_sel:[0,1] op_sel_hi:[1,1]
  v_pk_mul_f32 v[178:179], v[178:179], v[240:241] op_sel:[0,1] op_sel_hi:[1,1]
  v_pk_mul_f32 v[180:181], v[180:181], v[240:241] op_sel:[0,1] op_sel_hi:[1,1]
  v_pk_mul_f32 v[182:183], v[182:183], v[240:241] op_sel:[0,1] op_sel_hi:[1,1]
  v_cvt_pk_bf16_f32 v192, v176, v177
  v_cvt_pk_bf16_f32 v193, v178, v179
  v_cvt_pk_bf16_f32 v194, v180, v181
  v_cvt_pk_bf16_f32 v195, v182, v183
  buffer_store_dwordx4 v[192:195], v230, s[12:15], s42 offen offset:0 sc0 sc1
  v_accvgpr_read_b32 v184, a168
  v_accvgpr_read_b32 v185, a169
  ds_read_b64_tr_b16 v[174:175], v210 offset:712
  v_accvgpr_read_b32 v186, a170
  v_accvgpr_read_b32 v187, a171
  v_accvgpr_read_b32 v188, a172
  v_accvgpr_read_b32 v189, a173
  v_accvgpr_read_b32 v190, a174
  v_accvgpr_read_b32 v191, a175
  v_pk_mul_f32 v[184:185], v[184:185], v[240:241] op_sel:[0,1] op_sel_hi:[1,1]
  v_pk_mul_f32 v[186:187], v[186:187], v[240:241] op_sel:[0,1] op_sel_hi:[1,1]
  v_pk_mul_f32 v[188:189], v[188:189], v[240:241] op_sel:[0,1] op_sel_hi:[1,1]
  v_pk_mul_f32 v[190:191], v[190:191], v[240:241] op_sel:[0,1] op_sel_hi:[1,1]
  v_cvt_pk_bf16_f32 v196, v184, v185
  v_cvt_pk_bf16_f32 v197, v186, v187
  v_cvt_pk_bf16_f32 v198, v188, v189
  v_cvt_pk_bf16_f32 v199, v190, v191
  buffer_store_dwordx4 v[196:199], v230, s[12:15], s42 offen offset:1024 sc0 sc1
  v_accvgpr_read_b32 v176, a176
  v_accvgpr_read_b32 v177, a177
  v_accvgpr_read_b32 v178, a178
  v_accvgpr_read_b32 v179, a179
  v_accvgpr_read_b32 v180, a180
  v_accvgpr_read_b32 v181, a181
  v_accvgpr_read_b32 v182, a182
  v_accvgpr_read_b32 v183, a183
  v_pk_mul_f32 v[176:177], v[176:177], v[240:241] op_sel:[0,1] op_sel_hi:[1,1]
  v_pk_mul_f32 v[178:179], v[178:179], v[240:241] op_sel:[0,1] op_sel_hi:[1,1]
  v_pk_mul_f32 v[180:181], v[180:181], v[240:241] op_sel:[0,1] op_sel_hi:[1,1]
  v_pk_mul_f32 v[182:183], v[182:183], v[240:241] op_sel:[0,1] op_sel_hi:[1,1]
  v_cvt_pk_bf16_f32 v200, v176, v177
  v_cvt_pk_bf16_f32 v201, v178, v179
  v_cvt_pk_bf16_f32 v202, v180, v181
  v_cvt_pk_bf16_f32 v203, v182, v183
  buffer_store_dwordx4 v[200:203], v230, s[12:15], s42 offen offset:2048 sc0 sc1
  v_accvgpr_read_b32 v184, a184
  v_accvgpr_read_b32 v185, a185
  v_accvgpr_read_b32 v186, a186
  v_accvgpr_read_b32 v187, a187
  v_accvgpr_read_b32 v188, a188
  v_accvgpr_read_b32 v189, a189
  v_accvgpr_read_b32 v190, a190
  v_accvgpr_read_b32 v191, a191
  v_pk_mul_f32 v[184:185], v[184:185], v[240:241] op_sel:[0,1] op_sel_hi:[1,1]
  v_pk_mul_f32 v[186:187], v[186:187], v[240:241] op_sel:[0,1] op_sel_hi:[1,1]
  v_pk_mul_f32 v[188:189], v[188:189], v[240:241] op_sel:[0,1] op_sel_hi:[1,1]
  v_pk_mul_f32 v[190:191], v[190:191], v[240:241] op_sel:[0,1] op_sel_hi:[1,1]
  v_cvt_pk_bf16_f32 v204, v184, v185
  v_cvt_pk_bf16_f32 v205, v186, v187
  v_cvt_pk_bf16_f32 v206, v188, v189
  v_cvt_pk_bf16_f32 v207, v190, v191
  buffer_store_dwordx4 v[204:207], v230, s[12:15], s42 offen offset:3072 sc0 sc1
  s_lshl_b32 s40, s93, 8
  s_mul_i32 s41, s92, 368640
  s_add_u32 s40, s40, s41
  s_mul_i32 s41, s37, 1280
  s_add_u32 s40, s40, s41
  s_add_u32 s12, s56, s40
  s_addc_u32 s13, s57, 0
  s_mul_i32 s41, s33, 40960
  s_sub_u32 s14, s41, 2304
  s_mov_b32 s30, 6
  s_waitcnt vmcnt(42) lgkmcnt(0)
  v_mfma_f32_16x16x32_bf16 a[0:3], v[144:147], v[0:3], 0
  s_add_u32 m0, s24, 0
  s_add_u32 s27, s26, 0
  v_mfma_f32_16x16x32_bf16 a[32:35], v[144:147], v[4:7], 0
  buffer_load_dwordx4 v209, s[8:11], s27 offen lds
  v_mfma_f32_16x16x32_bf16 a[64:67], v[144:147], v[8:11], 0
  v_mfma_f32_16x16x32_bf16 a[96:99], v[144:147], v[12:15], 0
  ds_read_b64_tr_b16 v[176:177], v210 offset:8704
  v_mfma_f32_16x16x32_bf16 a[128:131], v[144:147], v[16:19], 0
  s_add_u32 m0, s24, 1088
  s_add_u32 s27, s26, 1280
  v_mfma_f32_16x16x32_bf16 a[160:163], v[144:147], v[20:23], 0
  buffer_load_dwordx4 v209, s[8:11], s27 offen lds
  v_mfma_f32_16x16x32_bf16 a[192:195], v[144:147], v[24:27], 0
  v_mfma_f32_16x16x32_bf16 a[224:227], v[144:147], v[28:31], 0
  ds_read_b64_tr_b16 v[178:179], v210 offset:9216
  v_mfma_f32_16x16x32_bf16 v[224:227], v[144:147], v[32:35], 0
  s_add_u32 m0, s24, 2176
  s_add_u32 s27, s26, 2560
  v_mfma_f32_16x16x32_bf16 a[4:7], v[148:151], v[0:3], 0
  buffer_load_dwordx4 v209, s[8:11], s27 offen lds
  v_mfma_f32_16x16x32_bf16 a[36:39], v[148:151], v[4:7], 0
  v_mfma_f32_16x16x32_bf16 a[68:71], v[148:151], v[8:11], 0
  ds_read_b64_tr_b16 v[180:181], v210 offset:8712
  v_mfma_f32_16x16x32_bf16 a[100:103], v[148:151], v[12:15], 0
  s_add_u32 m0, s24, 3264
  s_add_u32 s27, s26, 3840
  v_mfma_f32_16x16x32_bf16 a[132:135], v[148:151], v[16:19], 0
  buffer_load_dwordx4 v209, s[8:11], s27 offen lds
  v_mfma_f32_16x16x32_bf16 a[164:167], v[148:151], v[20:23], 0
  v_mfma_f32_16x16x32_bf16 a[196:199], v[148:151], v[24:27], 0
  ds_read_b64_tr_b16 v[182:183], v210 offset:9224
  v_mfma_f32_16x16x32_bf16 a[228:231], v[148:151], v[28:31], 0
  s_add_u32 m0, s24, 4352
  s_add_u32 s27, s26, 5120
  v_mfma_f32_16x16x32_bf16 v[228:231], v[148:151], v[32:35], 0
  buffer_load_dwordx4 v209, s[8:11], s27 offen lds
  v_mfma_f32_16x16x32_bf16 a[8:11], v[152:155], v[0:3], 0
  v_mfma_f32_16x16x32_bf16 a[40:43], v[152:155], v[4:7], 0
  ds_read_b64_tr_b16 v[184:185], v210 offset:8768
  v_mfma_f32_16x16x32_bf16 a[72:75], v[152:155], v[8:11], 0
  s_add_u32 m0, s24, 5440
  s_add_u32 s27, s26, 6400
  v_mfma_f32_16x16x32_bf16 a[104:107], v[152:155], v[12:15], 0
  buffer_load_dwordx4 v209, s[8:11], s27 offen lds
  v_mfma_f32_16x16x32_bf16 a[136:139], v[152:155], v[16:19], 0
  v_mfma_f32_16x16x32_bf16 a[168:171], v[152:155], v[20:23], 0
  ds_read_b64_tr_b16 v[186:187], v210 offset:9280
  v_mfma_f32_16x16x32_bf16 a[200:203], v[152:155], v[24:27], 0
  s_add_u32 m0, s24, 6528
  s_add_u32 s27, s26, 7680
  v_mfma_f32_16x16x32_bf16 a[232:235], v[152:155], v[28:31], 0
  buffer_load_dwordx4 v209, s[8:11], s27 offen lds
  v_mfma_f32_16x16x32_bf16 v[232:235], v[152:155], v[32:35], 0
  v_mfma_f32_16x16x32_bf16 a[12:15], v[156:159], v[0:3], 0
  ds_read_b64_tr_b16 v[188:189], v210 offset:8776
  v_mfma_f32_16x16x32_bf16 a[44:47], v[156:159], v[4:7], 0
  s_add_u32 m0, s24, 7616
  s_add_u32 s27, s26, 8960
  v_mfma_f32_16x16x32_bf16 a[76:79], v[156:159], v[8:11], 0
  buffer_load_dwordx4 v209, s[8:11], s27 offen lds
  v_mfma_f32_16x16x32_bf16 a[108:111], v[156:159], v[12:15], 0
  s_add_u32 s26, s26, 163840
  v_mfma_f32_16x16x32_bf16 a[140:143], v[156:159], v[16:19], 0
  ds_read_b64_tr_b16 v[190:191], v210 offset:9288
  v_mfma_f32_16x16x32_bf16 a[172:175], v[156:159], v[20:23], 0
  s_add_u32 s27, s25, 0
  v_mfma_f32_16x16x32_bf16 a[204:207], v[156:159], v[24:27], 0
  buffer_load_dwordx4 v[108:111], v208, s[4:7], s27 offen sc1
  v_mfma_f32_16x16x32_bf16 a[236:239], v[156:159], v[28:31], 0
  v_mfma_f32_16x16x32_bf16 v[236:239], v[156:159], v[32:35], 0
  ds_read_b64_tr_b16 v[192:193], v210 offset:8832
  v_mfma_f32_16x16x32_bf16 a[16:19], v[160:163], v[0:3], 0
  s_add_u32 s27, s25, 131072
  v_mfma_f32_16x16x32_bf16 a[48:51], v[160:163], v[4:7], 0
  buffer_load_dwordx4 v[112:115], v208, s[4:7], s27 offen sc1
  v_mfma_f32_16x16x32_bf16 a[80:83], v[160:163], v[8:11], 0
  v_mfma_f32_16x16x32_bf16 a[112:115], v[160:163], v[12:15], 0
  ds_read_b64_tr_b16 v[194:195], v210 offset:9344
  v_mfma_f32_16x16x32_bf16 a[144:147], v[160:163], v[16:19], 0
  s_add_u32 s27, s25, 262144
  v_mfma_f32_16x16x32_bf16 a[176:179], v[160:163], v[20:23], 0
  buffer_load_dwordx4 v[116:119], v208, s[4:7], s27 offen sc1
  v_mfma_f32_16x16x32_bf16 a[208:211], v[160:163], v[24:27], 0
  v_mfma_f32_16x16x32_bf16 a[240:243], v[160:163], v[28:31], 0
  ds_read_b64_tr_b16 v[196:197], v210 offset:8840
  v_mfma_f32_16x16x32_bf16 v[240:243], v[160:163], v[32:35], 0
  s_add_u32 s27, s25, 393216
  v_mfma_f32_16x16x32_bf16 a[20:23], v[164:167], v[0:3], 0
  buffer_load_dwordx4 v[120:123], v208, s[4:7], s27 offen sc1
  v_mfma_f32_16x16x32_bf16 a[52:55], v[164:167], v[4:7], 0
  v_mfma_f32_16x16x32_bf16 a[84:87], v[164:167], v[8:11], 0
  ds_read_b64_tr_b16 v[198:199], v210 offset:9352
  v_mfma_f32_16x16x32_bf16 a[116:119], v[164:167], v[12:15], 0
  s_add_u32 s27, s25, 524288
  v_mfma_f32_16x16x32_bf16 a[148:151], v[164:167], v[16:19], 0
  buffer_load_dwordx4 v[124:127], v208, s[4:7], s27 offen sc1
  v_mfma_f32_16x16x32_bf16 a[180:183], v[164:167], v[20:23], 0
  v_mfma_f32_16x16x32_bf16 a[212:215], v[164:167], v[24:27], 0
  ds_read_b64_tr_b16 v[200:201], v210 offset:8896
  v_mfma_f32_16x16x32_bf16 a[244:247], v[164:167], v[28:31], 0
  s_add_u32 s27, s25, 655360
  v_mfma_f32_16x16x32_bf16 v[244:247], v[164:167], v[32:35], 0
  buffer_load_dwordx4 v[128:131], v208, s[4:7], s27 offen sc1
  v_mfma_f32_16x16x32_bf16 a[24:27], v[168:171], v[0:3], 0
  v_mfma_f32_16x16x32_bf16 a[56:59], v[168:171], v[4:7], 0
  ds_read_b64_tr_b16 v[202:203], v210 offset:9408
  v_mfma_f32_16x16x32_bf16 a[88:91], v[168:171], v[8:11], 0
  s_add_u32 s27, s25, 786432
  v_mfma_f32_16x16x32_bf16 a[120:123], v[168:171], v[12:15], 0
  buffer_load_dwordx4 v[132:135], v208, s[4:7], s27 offen sc1
  v_mfma_f32_16x16x32_bf16 a[152:155], v[168:171], v[16:19], 0
  v_mfma_f32_16x16x32_bf16 a[184:187], v[168:171], v[20:23], 0
  ds_read_b64_tr_b16 v[204:205], v210 offset:8904
  v_mfma_f32_16x16x32_bf16 a[216:219], v[168:171], v[24:27], 0
  s_add_u32 s27, s25, 917504
  v_mfma_f32_16x16x32_bf16 a[248:251], v[168:171], v[28:31], 0
  buffer_load_dwordx4 v[136:139], v208, s[4:7], s27 offen sc1
  v_mfma_f32_16x16x32_bf16 v[248:251], v[168:171], v[32:35], 0
  v_mfma_f32_16x16x32_bf16 a[28:31], v[172:175], v[0:3], 0
  ds_read_b64_tr_b16 v[206:207], v210 offset:9416
  v_mfma_f32_16x16x32_bf16 a[60:63], v[172:175], v[4:7], 0
  s_add_u32 s27, s25, 1048576
  v_mfma_f32_16x16x32_bf16 a[92:95], v[172:175], v[8:11], 0
  buffer_load_dwordx4 v[140:143], v208, s[4:7], s27 offen sc1
  v_mfma_f32_16x16x32_bf16 a[124:127], v[172:175], v[12:15], 0
  s_add_u32 s25, s25, 4096
  v_mfma_f32_16x16x32_bf16 a[156:159], v[172:175], v[16:19], 0
  v_mfma_f32_16x16x32_bf16 a[188:191], v[172:175], v[20:23], 0
  v_mfma_f32_16x16x32_bf16 a[220:223], v[172:175], v[24:27], 0
  v_mfma_f32_16x16x32_bf16 a[252:255], v[172:175], v[28:31], 0
  s_waitcnt vmcnt(50) lgkmcnt(0)
  v_mfma_f32_16x16x32_bf16 v[252:255], v[172:175], v[32:35], 0
  v_mfma_f32_16x16x32_bf16 a[0:3], v[176:179], v[36:39], a[0:3]
  s_add_u32 m0, s24, 8704
  s_add_u32 s27, s26, 0
  v_mfma_f32_16x16x32_bf16 a[32:35], v[176:179], v[40:43], a[32:35]
  buffer_load_dwordx4 v209, s[8:11], s27 offen lds
  v_mfma_f32_16x16x32_bf16 a[64:67], v[176:179], v[44:47], a[64:67]
  v_mfma_f32_16x16x32_bf16 a[96:99], v[176:179], v[48:51], a[96:99]
  ds_read_b64_tr_b16 v[144:145], v210 offset:17408
  v_mfma_f32_16x16x32_bf16 a[128:131], v[176:179], v[52:55], a[128:131]
  s_add_u32 m0, s24, 9792
  s_add_u32 s27, s26, 1280
  v_mfma_f32_16x16x32_bf16 a[160:163], v[176:179], v[56:59], a[160:163]
  buffer_load_dwordx4 v209, s[8:11], s27 offen lds
  v_mfma_f32_16x16x32_bf16 a[192:195], v[176:179], v[60:63], a[192:195]
  v_mfma_f32_16x16x32_bf16 a[224:227], v[176:179], v[64:67], a[224:227]
  ds_read_b64_tr_b16 v[146:147], v210 offset:17920
  v_mfma_f32_16x16x32_bf16 v[224:227], v[176:179], v[68:71], v[224:227]
  s_add_u32 m0, s24, 10880
  s_add_u32 s27, s26, 2560
  v_mfma_f32_16x16x32_bf16 a[4:7], v[180:183], v[36:39], a[4:7]
  buffer_load_dwordx4 v209, s[8:11], s27 offen lds
  v_mfma_f32_16x16x32_bf16 a[36:39], v[180:183], v[40:43], a[36:39]
  v_mfma_f32_16x16x32_bf16 a[68:71], v[180:183], v[44:47], a[68:71]
  ds_read_b64_tr_b16 v[148:149], v210 offset:17416
  v_mfma_f32_16x16x32_bf16 a[100:103], v[180:183], v[48:51], a[100:103]
  s_add_u32 m0, s24, 11968
  s_add_u32 s27, s26, 3840
  v_mfma_f32_16x16x32_bf16 a[132:135], v[180:183], v[52:55], a[132:135]
  buffer_load_dwordx4 v209, s[8:11], s27 offen lds
  v_mfma_f32_16x16x32_bf16 a[164:167], v[180:183], v[56:59], a[164:167]
  v_mfma_f32_16x16x32_bf16 a[196:199], v[180:183], v[60:63], a[196:199]
  ds_read_b64_tr_b16 v[150:151], v210 offset:17928
  v_mfma_f32_16x16x32_bf16 a[228:231], v[180:183], v[64:67], a[228:231]
  s_add_u32 m0, s24, 13056
  s_add_u32 s27, s26, 5120
  v_mfma_f32_16x16x32_bf16 v[228:231], v[180:183], v[68:71], v[228:231]
  buffer_load_dwordx4 v209, s[8:11], s27 offen lds
  v_mfma_f32_16x16x32_bf16 a[8:11], v[184:187], v[36:39], a[8:11]
  v_mfma_f32_16x16x32_bf16 a[40:43], v[184:187], v[40:43], a[40:43]
  ds_read_b64_tr_b16 v[152:153], v210 offset:17472
  v_mfma_f32_16x16x32_bf16 a[72:75], v[184:187], v[44:47], a[72:75]
  s_add_u32 m0, s24, 14144
  s_add_u32 s27, s26, 6400
  v_mfma_f32_16x16x32_bf16 a[104:107], v[184:187], v[48:51], a[104:107]
  buffer_load_dwordx4 v209, s[8:11], s27 offen lds
  v_mfma_f32_16x16x32_bf16 a[136:139], v[184:187], v[52:55], a[136:139]
  v_mfma_f32_16x16x32_bf16 a[168:171], v[184:187], v[56:59], a[168:171]
  ds_read_b64_tr_b16 v[154:155], v210 offset:17984
  v_mfma_f32_16x16x32_bf16 a[200:203], v[184:187], v[60:63], a[200:203]
  s_add_u32 m0, s24, 15232
  s_add_u32 s27, s26, 7680
  v_mfma_f32_16x16x32_bf16 a[232:235], v[184:187], v[64:67], a[232:235]
  buffer_load_dwordx4 v209, s[8:11], s27 offen lds
  v_mfma_f32_16x16x32_bf16 v[232:235], v[184:187], v[68:71], v[232:235]
  v_mfma_f32_16x16x32_bf16 a[12:15], v[188:191], v[36:39], a[12:15]
  ds_read_b64_tr_b16 v[156:157], v210 offset:17480
  v_mfma_f32_16x16x32_bf16 a[44:47], v[188:191], v[40:43], a[44:47]
  s_add_u32 m0, s24, 16320
  s_add_u32 s27, s26, 8960
  v_mfma_f32_16x16x32_bf16 a[76:79], v[188:191], v[44:47], a[76:79]
  buffer_load_dwordx4 v209, s[8:11], s27 offen lds
  v_mfma_f32_16x16x32_bf16 a[108:111], v[188:191], v[48:51], a[108:111]
  s_add_u32 s26, s26, 163840
  v_mfma_f32_16x16x32_bf16 a[140:143], v[188:191], v[52:55], a[140:143]
  ds_read_b64_tr_b16 v[158:159], v210 offset:17992
  v_mfma_f32_16x16x32_bf16 a[172:175], v[188:191], v[56:59], a[172:175]
  s_add_u32 s27, s25, 0
  v_mfma_f32_16x16x32_bf16 a[204:207], v[188:191], v[60:63], a[204:207]
  buffer_load_dwordx4 v[0:3], v208, s[4:7], s27 offen sc1
  v_mfma_f32_16x16x32_bf16 a[236:239], v[188:191], v[64:67], a[236:239]
  v_mfma_f32_16x16x32_bf16 v[236:239], v[188:191], v[68:71], v[236:239]
  ds_read_b64_tr_b16 v[160:161], v210 offset:17536
  v_mfma_f32_16x16x32_bf16 a[16:19], v[192:195], v[36:39], a[16:19]
  s_add_u32 s27, s25, 131072
  v_mfma_f32_16x16x32_bf16 a[48:51], v[192:195], v[40:43], a[48:51]
  buffer_load_dwordx4 v[4:7], v208, s[4:7], s27 offen sc1
  v_mfma_f32_16x16x32_bf16 a[80:83], v[192:195], v[44:47], a[80:83]
  v_mfma_f32_16x16x32_bf16 a[112:115], v[192:195], v[48:51], a[112:115]
  ds_read_b64_tr_b16 v[162:163], v210 offset:18048
  v_mfma_f32_16x16x32_bf16 a[144:147], v[192:195], v[52:55], a[144:147]
  s_add_u32 s27, s25, 262144
  v_mfma_f32_16x16x32_bf16 a[176:179], v[192:195], v[56:59], a[176:179]
  buffer_load_dwordx4 v[8:11], v208, s[4:7], s27 offen sc1
  v_mfma_f32_16x16x32_bf16 a[208:211], v[192:195], v[60:63], a[208:211]
  v_mfma_f32_16x16x32_bf16 a[240:243], v[192:195], v[64:67], a[240:243]
  ds_read_b64_tr_b16 v[164:165], v210 offset:17544
  v_mfma_f32_16x16x32_bf16 v[240:243], v[192:195], v[68:71], v[240:243]
  s_add_u32 s27, s25, 393216
  v_mfma_f32_16x16x32_bf16 a[20:23], v[196:199], v[36:39], a[20:23]
  buffer_load_dwordx4 v[12:15], v208, s[4:7], s27 offen sc1
  v_mfma_f32_16x16x32_bf16 a[52:55], v[196:199], v[40:43], a[52:55]
  v_mfma_f32_16x16x32_bf16 a[84:87], v[196:199], v[44:47], a[84:87]
  ds_read_b64_tr_b16 v[166:167], v210 offset:18056
  v_mfma_f32_16x16x32_bf16 a[116:119], v[196:199], v[48:51], a[116:119]
  s_add_u32 s27, s25, 524288
  v_mfma_f32_16x16x32_bf16 a[148:151], v[196:199], v[52:55], a[148:151]
  buffer_load_dwordx4 v[16:19], v208, s[4:7], s27 offen sc1
  v_mfma_f32_16x16x32_bf16 a[180:183], v[196:199], v[56:59], a[180:183]
  v_mfma_f32_16x16x32_bf16 a[212:215], v[196:199], v[60:63], a[212:215]
  ds_read_b64_tr_b16 v[168:169], v210 offset:17600
  v_mfma_f32_16x16x32_bf16 a[244:247], v[196:199], v[64:67], a[244:247]
  s_add_u32 s27, s25, 655360
  v_mfma_f32_16x16x32_bf16 v[244:247], v[196:199], v[68:71], v[244:247]
  buffer_load_dwordx4 v[20:23], v208, s[4:7], s27 offen sc1
  v_mfma_f32_16x16x32_bf16 a[24:27], v[200:203], v[36:39], a[24:27]
  v_mfma_f32_16x16x32_bf16 a[56:59], v[200:203], v[40:43], a[56:59]
  ds_read_b64_tr_b16 v[170:171], v210 offset:18112
  v_mfma_f32_16x16x32_bf16 a[88:91], v[200:203], v[44:47], a[88:91]
  s_add_u32 s27, s25, 786432
  v_mfma_f32_16x16x32_bf16 a[120:123], v[200:203], v[48:51], a[120:123]
  buffer_load_dwordx4 v[24:27], v208, s[4:7], s27 offen sc1
  v_mfma_f32_16x16x32_bf16 a[152:155], v[200:203], v[52:55], a[152:155]
  v_mfma_f32_16x16x32_bf16 a[184:187], v[200:203], v[56:59], a[184:187]
  ds_read_b64_tr_b16 v[172:173], v210 offset:17608
  v_mfma_f32_16x16x32_bf16 a[216:219], v[200:203], v[60:63], a[216:219]
  s_add_u32 s27, s25, 917504
  v_mfma_f32_16x16x32_bf16 a[248:251], v[200:203], v[64:67], a[248:251]
  buffer_load_dwordx4 v[28:31], v208, s[4:7], s27 offen sc1
  v_mfma_f32_16x16x32_bf16 v[248:251], v[200:203], v[68:71], v[248:251]
  v_mfma_f32_16x16x32_bf16 a[28:31], v[204:207], v[36:39], a[28:31]
  ds_read_b64_tr_b16 v[174:175], v210 offset:18120
  v_mfma_f32_16x16x32_bf16 a[60:63], v[204:207], v[40:43], a[60:63]
  s_add_u32 s27, s25, 1048576
  v_mfma_f32_16x16x32_bf16 a[92:95], v[204:207], v[44:47], a[92:95]
  buffer_load_dwordx4 v[32:35], v208, s[4:7], s27 offen sc1
  v_mfma_f32_16x16x32_bf16 a[124:127], v[204:207], v[48:51], a[124:127]
  s_add_u32 s25, s25, 4096
  v_mfma_f32_16x16x32_bf16 a[156:159], v[204:207], v[52:55], a[156:159]
  v_mfma_f32_16x16x32_bf16 a[188:191], v[204:207], v[56:59], a[188:191]
  v_mfma_f32_16x16x32_bf16 a[220:223], v[204:207], v[60:63], a[220:223]
  v_mfma_f32_16x16x32_bf16 a[252:255], v[204:207], v[64:67], a[252:255]
  s_waitcnt vmcnt(58) lgkmcnt(0)
  v_mfma_f32_16x16x32_bf16 v[252:255], v[204:207], v[68:71], v[252:255]
  v_mfma_f32_16x16x32_bf16 a[0:3], v[144:147], v[72:75], a[0:3]
  s_add_u32 m0, s24, 17408
  s_add_u32 s27, s26, 0
  v_mfma_f32_16x16x32_bf16 a[32:35], v[144:147], v[76:79], a[32:35]
  buffer_load_dwordx4 v209, s[8:11], s27 offen lds
  v_mfma_f32_16x16x32_bf16 a[64:67], v[144:147], v[80:83], a[64:67]
  v_mfma_f32_16x16x32_bf16 a[96:99], v[144:147], v[84:87], a[96:99]
  ds_read_b64_tr_b16 v[176:177], v210 offset:26112
  v_mfma_f32_16x16x32_bf16 a[128:131], v[144:147], v[88:91], a[128:131]
  s_add_u32 m0, s24, 18496
  s_add_u32 s27, s26, 1280
  v_mfma_f32_16x16x32_bf16 a[160:163], v[144:147], v[92:95], a[160:163]
  buffer_load_dwordx4 v209, s[8:11], s27 offen lds
  v_mfma_f32_16x16x32_bf16 a[192:195], v[144:147], v[96:99], a[192:195]
  v_mfma_f32_16x16x32_bf16 a[224:227], v[144:147], v[100:103], a[224:227]
  ds_read_b64_tr_b16 v[178:179], v210 offset:26624
  v_mfma_f32_16x16x32_bf16 v[224:227], v[144:147], v[104:107], v[224:227]
  s_add_u32 m0, s24, 19584
  s_add_u32 s27, s26, 2560
  v_mfma_f32_16x16x32_bf16 a[4:7], v[148:151], v[72:75], a[4:7]
  buffer_load_dwordx4 v209, s[8:11], s27 offen lds
  v_mfma_f32_16x16x32_bf16 a[36:39], v[148:151], v[76:79], a[36:39]
  v_mfma_f32_16x16x32_bf16 a[68:71], v[148:151], v[80:83], a[68:71]
  ds_read_b64_tr_b16 v[180:181], v210 offset:26120
  v_mfma_f32_16x16x32_bf16 a[100:103], v[148:151], v[84:87], a[100:103]
  s_add_u32 m0, s24, 20672
  s_add_u32 s27, s26, 3840
  v_mfma_f32_16x16x32_bf16 a[132:135], v[148:151], v[88:91], a[132:135]
  buffer_load_dwordx4 v209, s[8:11], s27 offen lds
  v_mfma_f32_16x16x32_bf16 a[164:167], v[148:151], v[92:95], a[164:167]
  v_mfma_f32_16x16x32_bf16 a[196:199], v[148:151], v[96:99], a[196:199]
  ds_read_b64_tr_b16 v[182:183], v210 offset:26632
  v_mfma_f32_16x16x32_bf16 a[228:231], v[148:151], v[100:103], a[228:231]
  s_add_u32 m0, s24, 21760
  s_add_u32 s27, s26, 5120
  v_mfma_f32_16x16x32_bf16 v[228:231], v[148:151], v[104:107], v[228:231]
  buffer_load_dwordx4 v209, s[8:11], s27 offen lds
  v_mfma_f32_16x16x32_bf16 a[8:11], v[152:155], v[72:75], a[8:11]
  v_mfma_f32_16x16x32_bf16 a[40:43], v[152:155], v[76:79], a[40:43]
  ds_read_b64_tr_b16 v[184:185], v210 offset:26176
  v_mfma_f32_16x16x32_bf16 a[72:75], v[152:155], v[80:83], a[72:75]
  s_add_u32 m0, s24, 22848
  s_add_u32 s27, s26, 6400
  v_mfma_f32_16x16x32_bf16 a[104:107], v[152:155], v[84:87], a[104:107]
  buffer_load_dwordx4 v209, s[8:11], s27 offen lds
  v_mfma_f32_16x16x32_bf16 a[136:139], v[152:155], v[88:91], a[136:139]
  v_mfma_f32_16x16x32_bf16 a[168:171], v[152:155], v[92:95], a[168:171]
  ds_read_b64_tr_b16 v[186:187], v210 offset:26688
  v_mfma_f32_16x16x32_bf16 a[200:203], v[152:155], v[96:99], a[200:203]
  s_add_u32 m0, s24, 23936
  s_add_u32 s27, s26, 7680
  v_mfma_f32_16x16x32_bf16 a[232:235], v[152:155], v[100:103], a[232:235]
  buffer_load_dwordx4 v209, s[8:11], s27 offen lds
  v_mfma_f32_16x16x32_bf16 v[232:235], v[152:155], v[104:107], v[232:235]
  v_mfma_f32_16x16x32_bf16 a[12:15], v[156:159], v[72:75], a[12:15]
  ds_read_b64_tr_b16 v[188:189], v210 offset:26184
  v_mfma_f32_16x16x32_bf16 a[44:47], v[156:159], v[76:79], a[44:47]
  s_add_u32 m0, s24, 25024
  s_add_u32 s27, s26, 8960
  v_mfma_f32_16x16x32_bf16 a[76:79], v[156:159], v[80:83], a[76:79]
  buffer_load_dwordx4 v209, s[8:11], s27 offen lds
  v_mfma_f32_16x16x32_bf16 a[108:111], v[156:159], v[84:87], a[108:111]
  s_add_u32 s26, s26, 163840
  v_mfma_f32_16x16x32_bf16 a[140:143], v[156:159], v[88:91], a[140:143]
  ds_read_b64_tr_b16 v[190:191], v210 offset:26696
  v_mfma_f32_16x16x32_bf16 a[172:175], v[156:159], v[92:95], a[172:175]
  s_add_u32 s27, s25, 0
  v_mfma_f32_16x16x32_bf16 a[204:207], v[156:159], v[96:99], a[204:207]
  buffer_load_dwordx4 v[36:39], v208, s[4:7], s27 offen sc1
  v_mfma_f32_16x16x32_bf16 a[236:239], v[156:159], v[100:103], a[236:239]
  v_mfma_f32_16x16x32_bf16 v[236:239], v[156:159], v[104:107], v[236:239]
  ds_read_b64_tr_b16 v[192:193], v210 offset:26240
  v_mfma_f32_16x16x32_bf16 a[16:19], v[160:163], v[72:75], a[16:19]
  s_add_u32 s27, s25, 131072
  v_mfma_f32_16x16x32_bf16 a[48:51], v[160:163], v[76:79], a[48:51]
  buffer_load_dwordx4 v[40:43], v208, s[4:7], s27 offen sc1
  v_mfma_f32_16x16x32_bf16 a[80:83], v[160:163], v[80:83], a[80:83]
  v_mfma_f32_16x16x32_bf16 a[112:115], v[160:163], v[84:87], a[112:115]
  ds_read_b64_tr_b16 v[194:195], v210 offset:26752
  v_mfma_f32_16x16x32_bf16 a[144:147], v[160:163], v[88:91], a[144:147]
  s_add_u32 s27, s25, 262144
  v_mfma_f32_16x16x32_bf16 a[176:179], v[160:163], v[92:95], a[176:179]
  buffer_load_dwordx4 v[44:47], v208, s[4:7], s27 offen sc1
  v_mfma_f32_16x16x32_bf16 a[208:211], v[160:163], v[96:99], a[208:211]
  v_mfma_f32_16x16x32_bf16 a[240:243], v[160:163], v[100:103], a[240:243]
  ds_read_b64_tr_b16 v[196:197], v210 offset:26248
  v_mfma_f32_16x16x32_bf16 v[240:243], v[160:163], v[104:107], v[240:243]
  s_add_u32 s27, s25, 393216
  v_mfma_f32_16x16x32_bf16 a[20:23], v[164:167], v[72:75], a[20:23]
  buffer_load_dwordx4 v[48:51], v208, s[4:7], s27 offen sc1
  v_mfma_f32_16x16x32_bf16 a[52:55], v[164:167], v[76:79], a[52:55]
  v_mfma_f32_16x16x32_bf16 a[84:87], v[164:167], v[80:83], a[84:87]
  ds_read_b64_tr_b16 v[198:199], v210 offset:26760
  v_mfma_f32_16x16x32_bf16 a[116:119], v[164:167], v[84:87], a[116:119]
  s_add_u32 s27, s25, 524288
  v_mfma_f32_16x16x32_bf16 a[148:151], v[164:167], v[88:91], a[148:151]
  buffer_load_dwordx4 v[52:55], v208, s[4:7], s27 offen sc1
  v_mfma_f32_16x16x32_bf16 a[180:183], v[164:167], v[92:95], a[180:183]
  v_mfma_f32_16x16x32_bf16 a[212:215], v[164:167], v[96:99], a[212:215]
  ds_read_b64_tr_b16 v[200:201], v210 offset:26304
  v_mfma_f32_16x16x32_bf16 a[244:247], v[164:167], v[100:103], a[244:247]
  s_add_u32 s27, s25, 655360
  v_mfma_f32_16x16x32_bf16 v[244:247], v[164:167], v[104:107], v[244:247]
  buffer_load_dwordx4 v[56:59], v208, s[4:7], s27 offen sc1
  v_mfma_f32_16x16x32_bf16 a[24:27], v[168:171], v[72:75], a[24:27]
  v_mfma_f32_16x16x32_bf16 a[56:59], v[168:171], v[76:79], a[56:59]
  ds_read_b64_tr_b16 v[202:203], v210 offset:26816
  v_mfma_f32_16x16x32_bf16 a[88:91], v[168:171], v[80:83], a[88:91]
  s_add_u32 s27, s25, 786432
  v_mfma_f32_16x16x32_bf16 a[120:123], v[168:171], v[84:87], a[120:123]
  buffer_load_dwordx4 v[60:63], v208, s[4:7], s27 offen sc1
  v_mfma_f32_16x16x32_bf16 a[152:155], v[168:171], v[88:91], a[152:155]
  v_mfma_f32_16x16x32_bf16 a[184:187], v[168:171], v[92:95], a[184:187]
  ds_read_b64_tr_b16 v[204:205], v210 offset:26312
  v_mfma_f32_16x16x32_bf16 a[216:219], v[168:171], v[96:99], a[216:219]
  s_add_u32 s27, s25, 917504
  v_mfma_f32_16x16x32_bf16 a[248:251], v[168:171], v[100:103], a[248:251]
  buffer_load_dwordx4 v[64:67], v208, s[4:7], s27 offen sc1
  v_mfma_f32_16x16x32_bf16 v[248:251], v[168:171], v[104:107], v[248:251]
  v_mfma_f32_16x16x32_bf16 a[28:31], v[172:175], v[72:75], a[28:31]
  ds_read_b64_tr_b16 v[206:207], v210 offset:26824
  v_mfma_f32_16x16x32_bf16 a[60:63], v[172:175], v[76:79], a[60:63]
  s_add_u32 s27, s25, 1048576
  v_mfma_f32_16x16x32_bf16 a[92:95], v[172:175], v[80:83], a[92:95]
  buffer_load_dwordx4 v[68:71], v208, s[4:7], s27 offen sc1
  v_mfma_f32_16x16x32_bf16 a[124:127], v[172:175], v[84:87], a[124:127]
  s_add_u32 s25, s25, 4096
  v_mfma_f32_16x16x32_bf16 a[156:159], v[172:175], v[88:91], a[156:159]
  v_mfma_f32_16x16x32_bf16 a[188:191], v[172:175], v[92:95], a[188:191]
  v_mfma_f32_16x16x32_bf16 a[220:223], v[172:175], v[96:99], a[220:223]
  v_mfma_f32_16x16x32_bf16 a[252:255], v[172:175], v[100:103], a[252:255]
  s_waitcnt vmcnt(34) lgkmcnt(0)
  v_mfma_f32_16x16x32_bf16 v[252:255], v[172:175], v[104:107], v[252:255]
  v_mfma_f32_16x16x32_bf16 a[0:3], v[176:179], v[108:111], a[0:3]
  s_add_u32 m0, s24, 26112
  s_add_u32 s27, s26, 0
  v_mov_b32 v218, 1
  v_mfma_f32_16x16x32_bf16 a[32:35], v[176:179], v[112:115], a[32:35]
  buffer_load_dwordx4 v209, s[8:11], s27 offen lds
  v_mfma_f32_16x16x32_bf16 a[64:67], v[176:179], v[116:119], a[64:67]
  buffer_atomic_add v218, v215, s[16:19], s63 offen sc1
  v_mfma_f32_16x16x32_bf16 a[96:99], v[176:179], v[120:123], a[96:99]
  ds_read_b64_tr_b16 v[144:145], v210 offset:0
  v_mfma_f32_16x16x32_bf16 a[128:131], v[176:179], v[124:127], a[128:131]
  s_add_u32 m0, s24, 27200
  s_add_u32 s27, s26, 1280
  v_mfma_f32_16x16x32_bf16 a[160:163], v[176:179], v[128:131], a[160:163]
  buffer_load_dwordx4 v209, s[8:11], s27 offen lds
  v_mfma_f32_16x16x32_bf16 a[192:195], v[176:179], v[132:135], a[192:195]
  v_mfma_f32_16x16x32_bf16 a[224:227], v[176:179], v[136:139], a[224:227]
  ds_read_b64_tr_b16 v[146:147], v210 offset:512
  v_mfma_f32_16x16x32_bf16 v[224:227], v[176:179], v[140:143], v[224:227]
  s_add_u32 m0, s24, 28288
  s_add_u32 s27, s26, 2560
  v_mfma_f32_16x16x32_bf16 a[4:7], v[180:183], v[108:111], a[4:7]
  buffer_load_dwordx4 v209, s[8:11], s27 offen lds
  v_mfma_f32_16x16x32_bf16 a[36:39], v[180:183], v[112:115], a[36:39]
  v_mfma_f32_16x16x32_bf16 a[68:71], v[180:183], v[116:119], a[68:71]
  ds_read_b64_tr_b16 v[148:149], v210 offset:8
  v_mfma_f32_16x16x32_bf16 a[100:103], v[180:183], v[120:123], a[100:103]
  s_add_u32 m0, s24, 29376
  s_add_u32 s27, s26, 3840
  v_mfma_f32_16x16x32_bf16 a[132:135], v[180:183], v[124:127], a[132:135]
  buffer_load_dwordx4 v209, s[8:11], s27 offen lds
  v_mfma_f32_16x16x32_bf16 a[164:167], v[180:183], v[128:131], a[164:167]
  v_mfma_f32_16x16x32_bf16 a[196:199], v[180:183], v[132:135], a[196:199]
  ds_read_b64_tr_b16 v[150:151], v210 offset:520
  v_mfma_f32_16x16x32_bf16 a[228:231], v[180:183], v[136:139], a[228:231]
  s_add_u32 m0, s24, 30464
  s_add_u32 s27, s26, 5120
  v_mfma_f32_16x16x32_bf16 v[228:231], v[180:183], v[140:143], v[228:231]
  buffer_load_dwordx4 v209, s[8:11], s27 offen lds
  v_mfma_f32_16x16x32_bf16 a[8:11], v[184:187], v[108:111], a[8:11]
  v_mfma_f32_16x16x32_bf16 a[40:43], v[184:187], v[112:115], a[40:43]
  ds_read_b64_tr_b16 v[152:153], v210 offset:64
  v_mfma_f32_16x16x32_bf16 a[72:75], v[184:187], v[116:119], a[72:75]
  s_add_u32 m0, s24, 31552
  s_add_u32 s27, s26, 6400
  v_mfma_f32_16x16x32_bf16 a[104:107], v[184:187], v[120:123], a[104:107]
  buffer_load_dwordx4 v209, s[8:11], s27 offen lds
  v_mfma_f32_16x16x32_bf16 a[136:139], v[184:187], v[124:127], a[136:139]
  v_mfma_f32_16x16x32_bf16 a[168:171], v[184:187], v[128:131], a[168:171]
  ds_read_b64_tr_b16 v[154:155], v210 offset:576
  v_mfma_f32_16x16x32_bf16 a[200:203], v[184:187], v[132:135], a[200:203]
  s_add_u32 m0, s24, 32640
  s_add_u32 s27, s26, 7680
  v_mfma_f32_16x16x32_bf16 a[232:235], v[184:187], v[136:139], a[232:235]
  buffer_load_dwordx4 v209, s[8:11], s27 offen lds
  v_mfma_f32_16x16x32_bf16 v[232:235], v[184:187], v[140:143], v[232:235]
  v_mfma_f32_16x16x32_bf16 a[12:15], v[188:191], v[108:111], a[12:15]
  ds_read_b64_tr_b16 v[156:157], v210 offset:72
  v_mfma_f32_16x16x32_bf16 a[44:47], v[188:191], v[112:115], a[44:47]
  s_add_u32 m0, s24, 33728
  s_add_u32 s27, s26, 8960
  v_mfma_f32_16x16x32_bf16 a[76:79], v[188:191], v[116:119], a[76:79]
  buffer_load_dwordx4 v209, s[8:11], s27 offen lds
  v_mfma_f32_16x16x32_bf16 a[108:111], v[188:191], v[120:123], a[108:111]
  s_add_u32 s26, s26, 163840
  v_mfma_f32_16x16x32_bf16 a[140:143], v[188:191], v[124:127], a[140:143]
  ds_read_b64_tr_b16 v[158:159], v210 offset:584
  v_mfma_f32_16x16x32_bf16 a[172:175], v[188:191], v[128:131], a[172:175]
  s_add_u32 s27, s25, 0
  v_mfma_f32_16x16x32_bf16 a[204:207], v[188:191], v[132:135], a[204:207]
  buffer_load_dwordx4 v[72:75], v208, s[4:7], s27 offen sc1
  v_mfma_f32_16x16x32_bf16 a[236:239], v[188:191], v[136:139], a[236:239]
  v_mfma_f32_16x16x32_bf16 v[236:239], v[188:191], v[140:143], v[236:239]
  ds_read_b64_tr_b16 v[160:161], v210 offset:128
  v_mfma_f32_16x16x32_bf16 a[16:19], v[192:195], v[108:111], a[16:19]
  s_add_u32 s27, s25, 131072
  v_mfma_f32_16x16x32_bf16 a[48:51], v[192:195], v[112:115], a[48:51]
  buffer_load_dwordx4 v[76:79], v208, s[4:7], s27 offen sc1
  v_mfma_f32_16x16x32_bf16 a[80:83], v[192:195], v[116:119], a[80:83]
  v_mfma_f32_16x16x32_bf16 a[112:115], v[192:195], v[120:123], a[112:115]
  ds_read_b64_tr_b16 v[162:163], v210 offset:640
  v_mfma_f32_16x16x32_bf16 a[144:147], v[192:195], v[124:127], a[144:147]
  s_add_u32 s27, s25, 262144
  v_mfma_f32_16x16x32_bf16 a[176:179], v[192:195], v[128:131], a[176:179]
  buffer_load_dwordx4 v[80:83], v208, s[4:7], s27 offen sc1
  v_mfma_f32_16x16x32_bf16 a[208:211], v[192:195], v[132:135], a[208:211]
  v_mfma_f32_16x16x32_bf16 a[240:243], v[192:195], v[136:139], a[240:243]
  ds_read_b64_tr_b16 v[164:165], v210 offset:136
  v_mfma_f32_16x16x32_bf16 v[240:243], v[192:195], v[140:143], v[240:243]
  s_add_u32 s27, s25, 393216
  v_mfma_f32_16x16x32_bf16 a[20:23], v[196:199], v[108:111], a[20:23]
  buffer_load_dwordx4 v[84:87], v208, s[4:7], s27 offen sc1
  v_mfma_f32_16x16x32_bf16 a[52:55], v[196:199], v[112:115], a[52:55]
  v_mfma_f32_16x16x32_bf16 a[84:87], v[196:199], v[116:119], a[84:87]
  ds_read_b64_tr_b16 v[166:167], v210 offset:648
  v_mfma_f32_16x16x32_bf16 a[116:119], v[196:199], v[120:123], a[116:119]
  s_add_u32 s27, s25, 524288
  v_mfma_f32_16x16x32_bf16 a[148:151], v[196:199], v[124:127], a[148:151]
  buffer_load_dwordx4 v[88:91], v208, s[4:7], s27 offen sc1
  v_mfma_f32_16x16x32_bf16 a[180:183], v[196:199], v[128:131], a[180:183]
  v_mfma_f32_16x16x32_bf16 a[212:215], v[196:199], v[132:135], a[212:215]
  ds_read_b64_tr_b16 v[168:169], v210 offset:192
  v_mfma_f32_16x16x32_bf16 a[244:247], v[196:199], v[136:139], a[244:247]
  s_add_u32 s27, s25, 655360
  v_mfma_f32_16x16x32_bf16 v[244:247], v[196:199], v[140:143], v[244:247]
  buffer_load_dwordx4 v[92:95], v208, s[4:7], s27 offen sc1
  v_mfma_f32_16x16x32_bf16 a[24:27], v[200:203], v[108:111], a[24:27]
  v_mfma_f32_16x16x32_bf16 a[56:59], v[200:203], v[112:115], a[56:59]
  ds_read_b64_tr_b16 v[170:171], v210 offset:704
  v_mfma_f32_16x16x32_bf16 a[88:91], v[200:203], v[116:119], a[88:91]
  s_add_u32 s27, s25, 786432
  v_mfma_f32_16x16x32_bf16 a[120:123], v[200:203], v[120:123], a[120:123]
  buffer_load_dwordx4 v[96:99], v208, s[4:7], s27 offen sc1
  v_mfma_f32_16x16x32_bf16 a[152:155], v[200:203], v[124:127], a[152:155]
  v_mfma_f32_16x16x32_bf16 a[184:187], v[200:203], v[128:131], a[184:187]
  ds_read_b64_tr_b16 v[172:173], v210 offset:200
  v_mfma_f32_16x16x32_bf16 a[216:219], v[200:203], v[132:135], a[216:219]
  s_add_u32 s27, s25, 917504
  v_mfma_f32_16x16x32_bf16 a[248:251], v[200:203], v[136:139], a[248:251]
  buffer_load_dwordx4 v[100:103], v208, s[4:7], s27 offen sc1
  v_mfma_f32_16x16x32_bf16 v[248:251], v[200:203], v[140:143], v[248:251]
  v_mfma_f32_16x16x32_bf16 a[28:31], v[204:207], v[108:111], a[28:31]
  ds_read_b64_tr_b16 v[174:175], v210 offset:712
  v_mfma_f32_16x16x32_bf16 a[60:63], v[204:207], v[112:115], a[60:63]
  s_add_u32 s27, s25, 1048576
  v_mfma_f32_16x16x32_bf16 a[92:95], v[204:207], v[116:119], a[92:95]
  buffer_load_dwordx4 v[104:107], v208, s[4:7], s27 offen sc1
  v_mfma_f32_16x16x32_bf16 a[124:127], v[204:207], v[120:123], a[124:127]
  s_add_u32 s25, s25, 4096
  v_mfma_f32_16x16x32_bf16 a[156:159], v[204:207], v[124:127], a[156:159]
  v_mfma_f32_16x16x32_bf16 a[188:191], v[204:207], v[128:131], a[188:191]
  v_mfma_f32_16x16x32_bf16 a[220:223], v[204:207], v[132:135], a[220:223]
  v_mfma_f32_16x16x32_bf16 a[252:255], v[204:207], v[136:139], a[252:255]
  s_waitcnt vmcnt(35) lgkmcnt(0)
  v_mfma_f32_16x16x32_bf16 v[252:255], v[204:207], v[140:143], v[252:255]
.p2align 3
O_L:
  v_mfma_f32_16x16x32_bf16 a[0:3], v[144:147], v[0:3], a[0:3]
  s_add_u32 m0, s24, 0
  s_add_u32 s27, s26, 0
  s_cmp_eq_u32 s30, 5
  s_cselect_b32 s28, s94, 2147418112
  s_cselect_b32 s29, s95, 2147418112
  v_mfma_f32_16x16x32_bf16 a[32:35], v[144:147], v[4:7], a[32:35]
  buffer_load_dwordx4 v209, s[8:11], s27 offen lds
  v_mfma_f32_16x16x32_bf16 a[64:67], v[144:147], v[8:11], a[64:67]
  buffer_load_dword v216, v215, s[16:19], s28 offen sc1
  v_mfma_f32_16x16x32_bf16 a[96:99], v[144:147], v[12:15], a[96:99]
  ds_read_b64_tr_b16 v[176:177], v210 offset:8704
  v_mfma_f32_16x16x32_bf16 a[128:131], v[144:147], v[16:19], a[128:131]
  s_add_u32 m0, s24, 1088
  s_add_u32 s27, s26, 1280
  v_mfma_f32_16x16x32_bf16 a[160:163], v[144:147], v[20:23], a[160:163]
  buffer_load_dwordx4 v209, s[8:11], s27 offen lds
  v_mfma_f32_16x16x32_bf16 a[192:195], v[144:147], v[24:27], a[192:195]
  v_mfma_f32_16x16x32_bf16 a[224:227], v[144:147], v[28:31], a[224:227]
  ds_read_b64_tr_b16 v[178:179], v210 offset:9216
  v_mfma_f32_16x16x32_bf16 v[224:227], v[144:147], v[32:35], v[224:227]
  s_add_u32 m0, s24, 2176
  s_add_u32 s27, s26, 2560
  v_mfma_f32_16x16x32_bf16 a[4:7], v[148:151], v[0:3], a[4:7]
  buffer_load_dwordx4 v209, s[8:11], s27 offen lds
  v_mfma_f32_16x16x32_bf16 a[36:39], v[148:151], v[4:7], a[36:39]
  v_mfma_f32_16x16x32_bf16 a[68:71], v[148:151], v[8:11], a[68:71]
  ds_read_b64_tr_b16 v[180:181], v210 offset:8712
  v_mfma_f32_16x16x32_bf16 a[100:103], v[148:151], v[12:15], a[100:103]
  s_add_u32 m0, s24, 3264
  s_add_u32 s27, s26, 3840
  v_mfma_f32_16x16x32_bf16 a[132:135], v[148:151], v[16:19], a[132:135]
  buffer_load_dwordx4 v209, s[8:11], s27 offen lds
  v_mfma_f32_16x16x32_bf16 a[164:167], v[148:151], v[20:23], a[164:167]
  v_mfma_f32_16x16x32_bf16 a[196:199], v[148:151], v[24:27], a[196:199]
  ds_read_b64_tr_b16 v[182:183], v210 offset:9224
  v_mfma_f32_16x16x32_bf16 a[228:231], v[148:151], v[28:31], a[228:231]
  s_add_u32 m0, s24, 4352
  s_add_u32 s27, s26, 5120
  v_mfma_f32_16x16x32_bf16 v[228:231], v[148:151], v[32:35], v[228:231]
  buffer_load_dwordx4 v209, s[8:11], s27 offen lds
  v_mfma_f32_16x16x32_bf16 a[8:11], v[152:155], v[0:3], a[8:11]
  v_mfma_f32_16x16x32_bf16 a[40:43], v[152:155], v[4:7], a[40:43]
  ds_read_b64_tr_b16 v[184:185], v210 offset:8768
  v_mfma_f32_16x16x32_bf16 a[72:75], v[152:155], v[8:11], a[72:75]
  s_add_u32 m0, s24, 5440
  s_add_u32 s27, s26, 6400
  v_mfma_f32_16x16x32_bf16 a[104:107], v[152:155], v[12:15], a[104:107]
  buffer_load_dwordx4 v209, s[8:11], s27 offen lds
  v_mfma_f32_16x16x32_bf16 a[136:139], v[152:155], v[16:19], a[136:139]
  v_mfma_f32_16x16x32_bf16 a[168:171], v[152:155], v[20:23], a[168:171]
  ds_read_b64_tr_b16 v[186:187], v210 offset:9280
  v_mfma_f32_16x16x32_bf16 a[200:203], v[152:155], v[24:27], a[200:203]
  s_add_u32 m0, s24, 6528
  s_add_u32 s27, s26, 7680
  v_mfma_f32_16x16x32_bf16 a[232:235], v[152:155], v[28:31], a[232:235]
  buffer_load_dwordx4 v209, s[8:11], s27 offen lds
  v_mfma_f32_16x16x32_bf16 v[232:235], v[152:155], v[32:35], v[232:235]
  v_mfma_f32_16x16x32_bf16 a[12:15], v[156:159], v[0:3], a[12:15]
  ds_read_b64_tr_b16 v[188:189], v210 offset:8776
  v_mfma_f32_16x16x32_bf16 a[44:47], v[156:159], v[4:7], a[44:47]
  s_add_u32 m0, s24, 7616
  s_add_u32 s27, s26, 8960
  v_mfma_f32_16x16x32_bf16 a[76:79], v[156:159], v[8:11], a[76:79]
  buffer_load_dwordx4 v209, s[8:11], s27 offen lds
  v_mfma_f32_16x16x32_bf16 a[108:111], v[156:159], v[12:15], a[108:111]
  s_add_u32 s26, s26, 163840
  v_mfma_f32_16x16x32_bf16 a[140:143], v[156:159], v[16:19], a[140:143]
  ds_read_b64_tr_b16 v[190:191], v210 offset:9288
  v_mfma_f32_16x16x32_bf16 a[172:175], v[156:159], v[20:23], a[172:175]
  s_add_u32 s27, s25, 0
  v_mfma_f32_16x16x32_bf16 a[204:207], v[156:159], v[24:27], a[204:207]
  buffer_load_dwordx4 v[108:111], v208, s[4:7], s27 offen sc1
  v_mfma_f32_16x16x32_bf16 a[236:239], v[156:159], v[28:31], a[236:239]
  v_mfma_f32_16x16x32_bf16 v[236:239], v[156:159], v[32:35], v[236:239]
  ds_read_b64_tr_b16 v[192:193], v210 offset:8832
  v_mfma_f32_16x16x32_bf16 a[16:19], v[160:163], v[0:3], a[16:19]
  s_add_u32 s27, s25, 131072
  v_mfma_f32_16x16x32_bf16 a[48:51], v[160:163], v[4:7], a[48:51]
  buffer_load_dwordx4 v[112:115], v208, s[4:7], s27 offen sc1
  v_mfma_f32_16x16x32_bf16 a[80:83], v[160:163], v[8:11], a[80:83]
  v_mfma_f32_16x16x32_bf16 a[112:115], v[160:163], v[12:15], a[112:115]
  ds_read_b64_tr_b16 v[194:195], v210 offset:9344
  v_mfma_f32_16x16x32_bf16 a[144:147], v[160:163], v[16:19], a[144:147]
  s_add_u32 s27, s25, 262144
  v_mfma_f32_16x16x32_bf16 a[176:179], v[160:163], v[20:23], a[176:179]
  buffer_load_dwordx4 v[116:119], v208, s[4:7], s27 offen sc1
  v_mfma_f32_16x16x32_bf16 a[208:211], v[160:163], v[24:27], a[208:211]
  v_mfma_f32_16x16x32_bf16 a[240:243], v[160:163], v[28:31], a[240:243]
  ds_read_b64_tr_b16 v[196:197], v210 offset:8840
  v_mfma_f32_16x16x32_bf16 v[240:243], v[160:163], v[32:35], v[240:243]
  s_add_u32 s27, s25, 393216
  v_mfma_f32_16x16x32_bf16 a[20:23], v[164:167], v[0:3], a[20:23]
  buffer_load_dwordx4 v[120:123], v208, s[4:7], s27 offen sc1
  v_mfma_f32_16x16x32_bf16 a[52:55], v[164:167], v[4:7], a[52:55]
  v_mfma_f32_16x16x32_bf16 a[84:87], v[164:167], v[8:11], a[84:87]
  ds_read_b64_tr_b16 v[198:199], v210 offset:9352
  v_mfma_f32_16x16x32_bf16 a[116:119], v[164:167], v[12:15], a[116:119]
  s_add_u32 s27, s25, 524288
  v_mfma_f32_16x16x32_bf16 a[148:151], v[164:167], v[16:19], a[148:151]
  buffer_load_dwordx4 v[124:127], v208, s[4:7], s27 offen sc1
  v_mfma_f32_16x16x32_bf16 a[180:183], v[164:167], v[20:23], a[180:183]
  v_mfma_f32_16x16x32_bf16 a[212:215], v[164:167], v[24:27], a[212:215]
  ds_read_b64_tr_b16 v[200:201], v210 offset:8896
  v_mfma_f32_16x16x32_bf16 a[244:247], v[164:167], v[28:31], a[244:247]
  s_add_u32 s27, s25, 655360
  v_mfma_f32_16x16x32_bf16 v[244:247], v[164:167], v[32:35], v[244:247]
  buffer_load_dwordx4 v[128:131], v208, s[4:7], s27 offen sc1
  v_mfma_f32_16x16x32_bf16 a[24:27], v[168:171], v[0:3], a[24:27]
  v_mfma_f32_16x16x32_bf16 a[56:59], v[168:171], v[4:7], a[56:59]
  ds_read_b64_tr_b16 v[202:203], v210 offset:9408
  v_mfma_f32_16x16x32_bf16 a[88:91], v[168:171], v[8:11], a[88:91]
  s_add_u32 s27, s25, 786432
  v_mfma_f32_16x16x32_bf16 a[120:123], v[168:171], v[12:15], a[120:123]
  buffer_load_dwordx4 v[132:135], v208, s[4:7], s27 offen sc1
  v_mfma_f32_16x16x32_bf16 a[152:155], v[168:171], v[16:19], a[152:155]
  v_mfma_f32_16x16x32_bf16 a[184:187], v[168:171], v[20:23], a[184:187]
  ds_read_b64_tr_b16 v[204:205], v210 offset:8904
  v_mfma_f32_16x16x32_bf16 a[216:219], v[168:171], v[24:27], a[216:219]
  s_add_u32 s27, s25, 917504
  v_mfma_f32_16x16x32_bf16 a[248:251], v[168:171], v[28:31], a[248:251]
  buffer_load_dwordx4 v[136:139], v208, s[4:7], s27 offen sc1
  v_mfma_f32_16x16x32_bf16 v[248:251], v[168:171], v[32:35], v[248:251]
  v_mfma_f32_16x16x32_bf16 a[28:31], v[172:175], v[0:3], a[28:31]
  ds_read_b64_tr_b16 v[206:207], v210 offset:9416
  v_mfma_f32_16x16x32_bf16 a[60:63], v[172:175], v[4:7], a[60:63]
  s_add_u32 s27, s25, 1048576
  v_mfma_f32_16x16x32_bf16 a[92:95], v[172:175], v[8:11], a[92:95]
  buffer_load_dwordx4 v[140:143], v208, s[4:7], s27 offen sc1
  v_mfma_f32_16x16x32_bf16 a[124:127], v[172:175], v[12:15], a[124:127]
  s_add_u32 s25, s25, 4096
  v_mfma_f32_16x16x32_bf16 a[156:159], v[172:175], v[16:19], a[156:159]
  buffer_load_dword v217, v215, s[16:19], s29 offen sc1
  v_mfma_f32_16x16x32_bf16 a[188:191], v[172:175], v[20:23], a[188:191]
  v_mfma_f32_16x16x32_bf16 a[220:223], v[172:175], v[24:27], a[220:223]
  v_mfma_f32_16x16x32_bf16 a[252:255], v[172:175], v[28:31], a[252:255]
  s_waitcnt vmcnt(36) lgkmcnt(0)
  v_mfma_f32_16x16x32_bf16 v[252:255], v[172:175], v[32:35], v[252:255]
  v_mfma_f32_16x16x32_bf16 a[0:3], v[176:179], v[36:39], a[0:3]
  s_add_u32 m0, s24, 8704
  s_add_u32 s27, s26, 0
  v_mfma_f32_16x16x32_bf16 a[32:35], v[176:179], v[40:43], a[32:35]
  buffer_load_dwordx4 v209, s[8:11], s27 offen lds
  v_mfma_f32_16x16x32_bf16 a[64:67], v[176:179], v[44:47], a[64:67]
  v_mfma_f32_16x16x32_bf16 a[96:99], v[176:179], v[48:51], a[96:99]
  ds_read_b64_tr_b16 v[144:145], v210 offset:17408
  v_mfma_f32_16x16x32_bf16 a[128:131], v[176:179], v[52:55], a[128:131]
  s_add_u32 m0, s24, 9792
  s_add_u32 s27, s26, 1280
  v_mfma_f32_16x16x32_bf16 a[160:163], v[176:179], v[56:59], a[160:163]
  buffer_load_dwordx4 v209, s[8:11], s27 offen lds
  v_mfma_f32_16x16x32_bf16 a[192:195], v[176:179], v[60:63], a[192:195]
  v_mfma_f32_16x16x32_bf16 a[224:227], v[176:179], v[64:67], a[224:227]
  ds_read_b64_tr_b16 v[146:147], v210 offset:17920
  v_mfma_f32_16x16x32_bf16 v[224:227], v[176:179], v[68:71], v[224:227]
  s_add_u32 m0, s24, 10880
  s_add_u32 s27, s26, 2560
  v_mfma_f32_16x16x32_bf16 a[4:7], v[180:183], v[36:39], a[4:7]
  buffer_load_dwordx4 v209, s[8:11], s27 offen lds
  v_mfma_f32_16x16x32_bf16 a[36:39], v[180:183], v[40:43], a[36:39]
  v_mfma_f32_16x16x32_bf16 a[68:71], v[180:183], v[44:47], a[68:71]
  ds_read_b64_tr_b16 v[148:149], v210 offset:17416
  v_mfma_f32_16x16x32_bf16 a[100:103], v[180:183], v[48:51], a[100:103]
  s_add_u32 m0, s24, 11968
  s_add_u32 s27, s26, 3840
  v_mfma_f32_16x16x32_bf16 a[132:135], v[180:183], v[52:55], a[132:135]
  buffer_load_dwordx4 v209, s[8:11], s27 offen lds
  v_mfma_f32_16x16x32_bf16 a[164:167], v[180:183], v[56:59], a[164:167]
  v_mfma_f32_16x16x32_bf16 a[196:199], v[180:183], v[60:63], a[196:199]
  ds_read_b64_tr_b16 v[150:151], v210 offset:17928
  v_mfma_f32_16x16x32_bf16 a[228:231], v[180:183], v[64:67], a[228:231]
  s_add_u32 m0, s24, 13056
  s_add_u32 s27, s26, 5120
  v_mfma_f32_16x16x32_bf16 v[228:231], v[180:183], v[68:71], v[228:231]
  buffer_load_dwordx4 v209, s[8:11], s27 offen lds
  v_mfma_f32_16x16x32_bf16 a[8:11], v[184:187], v[36:39], a[8:11]
  v_mfma_f32_16x16x32_bf16 a[40:43], v[184:187], v[40:43], a[40:43]
  ds_read_b64_tr_b16 v[152:153], v210 offset:17472
  v_mfma_f32_16x16x32_bf16 a[72:75], v[184:187], v[44:47], a[72:75]
  s_add_u32 m0, s24, 14144
  s_add_u32 s27, s26, 6400
  v_mfma_f32_16x16x32_bf16 a[104:107], v[184:187], v[48:51], a[104:107]
  buffer_load_dwordx4 v209, s[8:11], s27 offen lds
  v_mfma_f32_16x16x32_bf16 a[136:139], v[184:187], v[52:55], a[136:139]
  v_mfma_f32_16x16x32_bf16 a[168:171], v[184:187], v[56:59], a[168:171]
  ds_read_b64_tr_b16 v[154:155], v210 offset:17984
  v_mfma_f32_16x16x32_bf16 a[200:203], v[184:187], v[60:63], a[200:203]
  s_add_u32 m0, s24, 15232
  s_add_u32 s27, s26, 7680
  v_mfma_f32_16x16x32_bf16 a[232:235], v[184:187], v[64:67], a[232:235]
  buffer_load_dwordx4 v209, s[8:11], s27 offen lds
  v_mfma_f32_16x16x32_bf16 v[232:235], v[184:187], v[68:71], v[232:235]
  v_mfma_f32_16x16x32_bf16 a[12:15], v[188:191], v[36:39], a[12:15]
  ds_read_b64_tr_b16 v[156:157], v210 offset:17480
  v_mfma_f32_16x16x32_bf16 a[44:47], v[188:191], v[40:43], a[44:47]
  s_add_u32 m0, s24, 16320
  s_add_u32 s27, s26, 8960
  v_mfma_f32_16x16x32_bf16 a[76:79], v[188:191], v[44:47], a[76:79]
  buffer_load_dwordx4 v209, s[8:11], s27 offen lds
  v_mfma_f32_16x16x32_bf16 a[108:111], v[188:191], v[48:51], a[108:111]
  s_add_u32 s26, s26, 163840
  v_mfma_f32_16x16x32_bf16 a[140:143], v[188:191], v[52:55], a[140:143]
  ds_read_b64_tr_b16 v[158:159], v210 offset:17992
  v_mfma_f32_16x16x32_bf16 a[172:175], v[188:191], v[56:59], a[172:175]
  s_add_u32 s27, s25, 0
  v_mfma_f32_16x16x32_bf16 a[204:207], v[188:191], v[60:63], a[204:207]
  buffer_load_dwordx4 v[0:3], v208, s[4:7], s27 offen sc1
  v_mfma_f32_16x16x32_bf16 a[236:239], v[188:191], v[64:67], a[236:239]
  v_mfma_f32_16x16x32_bf16 v[236:239], v[188:191], v[68:71], v[236:239]
  ds_read_b64_tr_b16 v[160:161], v210 offset:17536
  v_mfma_f32_16x16x32_bf16 a[16:19], v[192:195], v[36:39], a[16:19]
  s_add_u32 s27, s25, 131072
  v_mfma_f32_16x16x32_bf16 a[48:51], v[192:195], v[40:43], a[48:51]
  buffer_load_dwordx4 v[4:7], v208, s[4:7], s27 offen sc1
  v_mfma_f32_16x16x32_bf16 a[80:83], v[192:195], v[44:47], a[80:83]
  v_mfma_f32_16x16x32_bf16 a[112:115], v[192:195], v[48:51], a[112:115]
  ds_read_b64_tr_b16 v[162:163], v210 offset:18048
  v_mfma_f32_16x16x32_bf16 a[144:147], v[192:195], v[52:55], a[144:147]
  s_add_u32 s27, s25, 262144
  v_mfma_f32_16x16x32_bf16 a[176:179], v[192:195], v[56:59], a[176:179]
  buffer_load_dwordx4 v[8:11], v208, s[4:7], s27 offen sc1
  v_mfma_f32_16x16x32_bf16 a[208:211], v[192:195], v[60:63], a[208:211]
  v_mfma_f32_16x16x32_bf16 a[240:243], v[192:195], v[64:67], a[240:243]
  ds_read_b64_tr_b16 v[164:165], v210 offset:17544
  v_mfma_f32_16x16x32_bf16 v[240:243], v[192:195], v[68:71], v[240:243]
  s_add_u32 s27, s25, 393216
  v_mfma_f32_16x16x32_bf16 a[20:23], v[196:199], v[36:39], a[20:23]
  buffer_load_dwordx4 v[12:15], v208, s[4:7], s27 offen sc1
  v_mfma_f32_16x16x32_bf16 a[52:55], v[196:199], v[40:43], a[52:55]
  v_mfma_f32_16x16x32_bf16 a[84:87], v[196:199], v[44:47], a[84:87]
  ds_read_b64_tr_b16 v[166:167], v210 offset:18056
  v_mfma_f32_16x16x32_bf16 a[116:119], v[196:199], v[48:51], a[116:119]
  s_add_u32 s27, s25, 524288
  v_mfma_f32_16x16x32_bf16 a[148:151], v[196:199], v[52:55], a[148:151]
  buffer_load_dwordx4 v[16:19], v208, s[4:7], s27 offen sc1
  v_mfma_f32_16x16x32_bf16 a[180:183], v[196:199], v[56:59], a[180:183]
  v_mfma_f32_16x16x32_bf16 a[212:215], v[196:199], v[60:63], a[212:215]
  ds_read_b64_tr_b16 v[168:169], v210 offset:17600
  v_mfma_f32_16x16x32_bf16 a[244:247], v[196:199], v[64:67], a[244:247]
  s_add_u32 s27, s25, 655360
  v_mfma_f32_16x16x32_bf16 v[244:247], v[196:199], v[68:71], v[244:247]
  buffer_load_dwordx4 v[20:23], v208, s[4:7], s27 offen sc1
  v_mfma_f32_16x16x32_bf16 a[24:27], v[200:203], v[36:39], a[24:27]
  v_mfma_f32_16x16x32_bf16 a[56:59], v[200:203], v[40:43], a[56:59]
  ds_read_b64_tr_b16 v[170:171], v210 offset:18112
  v_mfma_f32_16x16x32_bf16 a[88:91], v[200:203], v[44:47], a[88:91]
  s_add_u32 s27, s25, 786432
  v_mfma_f32_16x16x32_bf16 a[120:123], v[200:203], v[48:51], a[120:123]
  buffer_load_dwordx4 v[24:27], v208, s[4:7], s27 offen sc1
  v_mfma_f32_16x16x32_bf16 a[152:155], v[200:203], v[52:55], a[152:155]
  v_mfma_f32_16x16x32_bf16 a[184:187], v[200:203], v[56:59], a[184:187]
  ds_read_b64_tr_b16 v[172:173], v210 offset:17608
  v_mfma_f32_16x16x32_bf16 a[216:219], v[200:203], v[60:63], a[216:219]
  s_add_u32 s27, s25, 917504
  v_mfma_f32_16x16x32_bf16 a[248:251], v[200:203], v[64:67], a[248:251]
  buffer_load_dwordx4 v[28:31], v208, s[4:7], s27 offen sc1
  v_mfma_f32_16x16x32_bf16 v[248:251], v[200:203], v[68:71], v[248:251]
  v_mfma_f32_16x16x32_bf16 a[28:31], v[204:207], v[36:39], a[28:31]
  ds_read_b64_tr_b16 v[174:175], v210 offset:18120
  v_mfma_f32_16x16x32_bf16 a[60:63], v[204:207], v[40:43], a[60:63]
  s_add_u32 s27, s25, 1048576
  v_mfma_f32_16x16x32_bf16 a[92:95], v[204:207], v[44:47], a[92:95]
  buffer_load_dwordx4 v[32:35], v208, s[4:7], s27 offen sc1
  v_mfma_f32_16x16x32_bf16 a[124:127], v[204:207], v[48:51], a[124:127]
  s_add_u32 s25, s25, 4096
  v_mfma_f32_16x16x32_bf16 a[156:159], v[204:207], v[52:55], a[156:159]
  v_mfma_f32_16x16x32_bf16 a[188:191], v[204:207], v[56:59], a[188:191]
  v_mfma_f32_16x16x32_bf16 a[220:223], v[204:207], v[60:63], a[220:223]
  v_mfma_f32_16x16x32_bf16 a[252:255], v[204:207], v[64:67], a[252:255]
  s_waitcnt vmcnt(36) lgkmcnt(0)
  v_mfma_f32_16x16x32_bf16 v[252:255], v[204:207], v[68:71], v[252:255]
  v_mfma_f32_16x16x32_bf16 a[0:3], v[144:147], v[72:75], a[0:3]
  s_add_u32 m0, s24, 17408
  s_add_u32 s27, s26, 0
  v_mfma_f32_16x16x32_bf16 a[32:35], v[144:147], v[76:79], a[32:35]
  buffer_load_dwordx4 v209, s[8:11], s27 offen lds
  v_mfma_f32_16x16x32_bf16 a[64:67], v[144:147], v[80:83], a[64:67]
  v_mfma_f32_16x16x32_bf16 a[96:99], v[144:147], v[84:87], a[96:99]
  ds_read_b64_tr_b16 v[176:177], v210 offset:26112
  v_mfma_f32_16x16x32_bf16 a[128:131], v[144:147], v[88:91], a[128:131]
  s_add_u32 m0, s24, 18496
  s_add_u32 s27, s26, 1280
  v_mfma_f32_16x16x32_bf16 a[160:163], v[144:147], v[92:95], a[160:163]
  buffer_load_dwordx4 v209, s[8:11], s27 offen lds
  v_mfma_f32_16x16x32_bf16 a[192:195], v[144:147], v[96:99], a[192:195]
  v_mfma_f32_16x16x32_bf16 a[224:227], v[144:147], v[100:103], a[224:227]
  ds_read_b64_tr_b16 v[178:179], v210 offset:26624
  v_mfma_f32_16x16x32_bf16 v[224:227], v[144:147], v[104:107], v[224:227]
  s_add_u32 m0, s24, 19584
  s_add_u32 s27, s26, 2560
  v_mfma_f32_16x16x32_bf16 a[4:7], v[148:151], v[72:75], a[4:7]
  buffer_load_dwordx4 v209, s[8:11], s27 offen lds
  v_mfma_f32_16x16x32_bf16 a[36:39], v[148:151], v[76:79], a[36:39]
  v_mfma_f32_16x16x32_bf16 a[68:71], v[148:151], v[80:83], a[68:71]
  ds_read_b64_tr_b16 v[180:181], v210 offset:26120
  v_mfma_f32_16x16x32_bf16 a[100:103], v[148:151], v[84:87], a[100:103]
  s_add_u32 m0, s24, 20672
  s_add_u32 s27, s26, 3840
  v_mfma_f32_16x16x32_bf16 a[132:135], v[148:151], v[88:91], a[132:135]
  buffer_load_dwordx4 v209, s[8:11], s27 offen lds
  v_mfma_f32_16x16x32_bf16 a[164:167], v[148:151], v[92:95], a[164:167]
  v_mfma_f32_16x16x32_bf16 a[196:199], v[148:151], v[96:99], a[196:199]
  ds_read_b64_tr_b16 v[182:183], v210 offset:26632
  v_mfma_f32_16x16x32_bf16 a[228:231], v[148:151], v[100:103], a[228:231]
  s_add_u32 m0, s24, 21760
  s_add_u32 s27, s26, 5120
  v_mfma_f32_16x16x32_bf16 v[228:231], v[148:151], v[104:107], v[228:231]
  buffer_load_dwordx4 v209, s[8:11], s27 offen lds
  v_mfma_f32_16x16x32_bf16 a[8:11], v[152:155], v[72:75], a[8:11]
  v_mfma_f32_16x16x32_bf16 a[40:43], v[152:155], v[76:79], a[40:43]
  ds_read_b64_tr_b16 v[184:185], v210 offset:26176
  v_mfma_f32_16x16x32_bf16 a[72:75], v[152:155], v[80:83], a[72:75]
  s_add_u32 m0, s24, 22848
  s_add_u32 s27, s26, 6400
  v_mfma_f32_16x16x32_bf16 a[104:107], v[152:155], v[84:87], a[104:107]
  buffer_load_dwordx4 v209, s[8:11], s27 offen lds
  v_mfma_f32_16x16x32_bf16 a[136:139], v[152:155], v[88:91], a[136:139]
  v_mfma_f32_16x16x32_bf16 a[168:171], v[152:155], v[92:95], a[168:171]
  ds_read_b64_tr_b16 v[186:187], v210 offset:26688
  v_mfma_f32_16x16x32_bf16 a[200:203], v[152:155], v[96:99], a[200:203]
  s_add_u32 m0, s24, 23936
  s_add_u32 s27, s26, 7680
  v_mfma_f32_16x16x32_bf16 a[232:235], v[152:155], v[100:103], a[232:235]
  buffer_load_dwordx4 v209, s[8:11], s27 offen lds
  v_mfma_f32_16x16x32_bf16 v[232:235], v[152:155], v[104:107], v[232:235]
  v_mfma_f32_16x16x32_bf16 a[12:15], v[156:159], v[72:75], a[12:15]
  ds_read_b64_tr_b16 v[188:189], v210 offset:26184
  v_mfma_f32_16x16x32_bf16 a[44:47], v[156:159], v[76:79], a[44:47]
  s_add_u32 m0, s24, 25024
  s_add_u32 s27, s26, 8960
  v_mfma_f32_16x16x32_bf16 a[76:79], v[156:159], v[80:83], a[76:79]
  buffer_load_dwordx4 v209, s[8:11], s27 offen lds
  v_mfma_f32_16x16x32_bf16 a[108:111], v[156:159], v[84:87], a[108:111]
  s_add_u32 s26, s26, 163840
  v_mfma_f32_16x16x32_bf16 a[140:143], v[156:159], v[88:91], a[140:143]
  ds_read_b64_tr_b16 v[190:191], v210 offset:26696
  v_mfma_f32_16x16x32_bf16 a[172:175], v[156:159], v[92:95], a[172:175]
  s_add_u32 s27, s25, 0
  v_mfma_f32_16x16x32_bf16 a[204:207], v[156:159], v[96:99], a[204:207]
  buffer_load_dwordx4 v[36:39], v208, s[4:7], s27 offen sc1
  v_mfma_f32_16x16x32_bf16 a[236:239], v[156:159], v[100:103], a[236:239]
  v_mfma_f32_16x16x32_bf16 v[236:239], v[156:159], v[104:107], v[236:239]
  ds_read_b64_tr_b16 v[192:193], v210 offset:26240
  v_mfma_f32_16x16x32_bf16 a[16:19], v[160:163], v[72:75], a[16:19]
  s_add_u32 s27, s25, 131072
  v_mfma_f32_16x16x32_bf16 a[48:51], v[160:163], v[76:79], a[48:51]
  buffer_load_dwordx4 v[40:43], v208, s[4:7], s27 offen sc1
  v_mfma_f32_16x16x32_bf16 a[80:83], v[160:163], v[80:83], a[80:83]
  v_mfma_f32_16x16x32_bf16 a[112:115], v[160:163], v[84:87], a[112:115]
  ds_read_b64_tr_b16 v[194:195], v210 offset:26752
  v_mfma_f32_16x16x32_bf16 a[144:147], v[160:163], v[88:91], a[144:147]
  s_add_u32 s27, s25, 262144
  v_mfma_f32_16x16x32_bf16 a[176:179], v[160:163], v[92:95], a[176:179]
  buffer_load_dwordx4 v[44:47], v208, s[4:7], s27 offen sc1
  v_mfma_f32_16x16x32_bf16 a[208:211], v[160:163], v[96:99], a[208:211]
  v_mfma_f32_16x16x32_bf16 a[240:243], v[160:163], v[100:103], a[240:243]
  ds_read_b64_tr_b16 v[196:197], v210 offset:26248
  v_mfma_f32_16x16x32_bf16 v[240:243], v[160:163], v[104:107], v[240:243]
  s_add_u32 s27, s25, 393216
  v_mfma_f32_16x16x32_bf16 a[20:23], v[164:167], v[72:75], a[20:23]
  buffer_load_dwordx4 v[48:51], v208, s[4:7], s27 offen sc1
  v_mfma_f32_16x16x32_bf16 a[52:55], v[164:167], v[76:79], a[52:55]
  v_mfma_f32_16x16x32_bf16 a[84:87], v[164:167], v[80:83], a[84:87]
  ds_read_b64_tr_b16 v[198:199], v210 offset:26760
  v_mfma_f32_16x16x32_bf16 a[116:119], v[164:167], v[84:87], a[116:119]
  s_add_u32 s27, s25, 524288
  v_mfma_f32_16x16x32_bf16 a[148:151], v[164:167], v[88:91], a[148:151]
  buffer_load_dwordx4 v[52:55], v208, s[4:7], s27 offen sc1
  v_mfma_f32_16x16x32_bf16 a[180:183], v[164:167], v[92:95], a[180:183]
  v_mfma_f32_16x16x32_bf16 a[212:215], v[164:167], v[96:99], a[212:215]
  ds_read_b64_tr_b16 v[200:201], v210 offset:26304
  v_mfma_f32_16x16x32_bf16 a[244:247], v[164:167], v[100:103], a[244:247]
  s_add_u32 s27, s25, 655360
  v_mfma_f32_16x16x32_bf16 v[244:247], v[164:167], v[104:107], v[244:247]
  buffer_load_dwordx4 v[56:59], v208, s[4:7], s27 offen sc1
  v_mfma_f32_16x16x32_bf16 a[24:27], v[168:171], v[72:75], a[24:27]
  v_mfma_f32_16x16x32_bf16 a[56:59], v[168:171], v[76:79], a[56:59]
  ds_read_b64_tr_b16 v[202:203], v210 offset:26816
  v_mfma_f32_16x16x32_bf16 a[88:91], v[168:171], v[80:83], a[88:91]
  s_add_u32 s27, s25, 786432
  v_mfma_f32_16x16x32_bf16 a[120:123], v[168:171], v[84:87], a[120:123]
  buffer_load_dwordx4 v[60:63], v208, s[4:7], s27 offen sc1
  v_mfma_f32_16x16x32_bf16 a[152:155], v[168:171], v[88:91], a[152:155]
  v_mfma_f32_16x16x32_bf16 a[184:187], v[168:171], v[92:95], a[184:187]
  ds_read_b64_tr_b16 v[204:205], v210 offset:26312
  v_mfma_f32_16x16x32_bf16 a[216:219], v[168:171], v[96:99], a[216:219]
  s_add_u32 s27, s25, 917504
  v_mfma_f32_16x16x32_bf16 a[248:251], v[168:171], v[100:103], a[248:251]
  buffer_load_dwordx4 v[64:67], v208, s[4:7], s27 offen sc1
  v_mfma_f32_16x16x32_bf16 v[248:251], v[168:171], v[104:107], v[248:251]
  v_mfma_f32_16x16x32_bf16 a[28:31], v[172:175], v[72:75], a[28:31]
  ds_read_b64_tr_b16 v[206:207], v210 offset:26824
  v_mfma_f32_16x16x32_bf16 a[60:63], v[172:175], v[76:79], a[60:63]
  s_add_u32 s27, s25, 1048576
  v_mfma_f32_16x16x32_bf16 a[92:95], v[172:175], v[80:83], a[92:95]
  buffer_load_dwordx4 v[68:71], v208, s[4:7], s27 offen sc1
  v_mfma_f32_16x16x32_bf16 a[124:127], v[172:175], v[84:87], a[124:127]
  s_add_u32 s25, s25, 4096
  v_mfma_f32_16x16x32_bf16 a[156:159], v[172:175], v[88:91], a[156:159]
  v_mfma_f32_16x16x32_bf16 a[188:191], v[172:175], v[92:95], a[188:191]
  v_mfma_f32_16x16x32_bf16 a[220:223], v[172:175], v[96:99], a[220:223]
  v_mfma_f32_16x16x32_bf16 a[252:255], v[172:175], v[100:103], a[252:255]
  s_waitcnt vmcnt(34) lgkmcnt(0)
  v_mfma_f32_16x16x32_bf16 v[252:255], v[172:175], v[104:107], v[252:255]
  v_mfma_f32_16x16x32_bf16 a[0:3], v[176:179], v[108:111], a[0:3]
  s_add_u32 m0, s24, 26112
  s_add_u32 s27, s26, 0
  v_mfma_f32_16x16x32_bf16 a[32:35], v[176:179], v[112:115], a[32:35]
  buffer_load_dwordx4 v209, s[8:11], s27 offen lds
  v_mfma_f32_16x16x32_bf16 a[64:67], v[176:179], v[116:119], a[64:67]
  v_mfma_f32_16x16x32_bf16 a[96:99], v[176:179], v[120:123], a[96:99]
  ds_read_b64_tr_b16 v[144:145], v210 offset:0
  v_mfma_f32_16x16x32_bf16 a[128:131], v[176:179], v[124:127], a[128:131]
  s_add_u32 m0, s24, 27200
  s_add_u32 s27, s26, 1280
  v_mfma_f32_16x16x32_bf16 a[160:163], v[176:179], v[128:131], a[160:163]
  buffer_load_dwordx4 v209, s[8:11], s27 offen lds
  v_mfma_f32_16x16x32_bf16 a[192:195], v[176:179], v[132:135], a[192:195]
  v_mfma_f32_16x16x32_bf16 a[224:227], v[176:179], v[136:139], a[224:227]
  ds_read_b64_tr_b16 v[146:147], v210 offset:512
  v_mfma_f32_16x16x32_bf16 v[224:227], v[176:179], v[140:143], v[224:227]
  s_add_u32 m0, s24, 28288
  s_add_u32 s27, s26, 2560
  v_mfma_f32_16x16x32_bf16 a[4:7], v[180:183], v[108:111], a[4:7]
  buffer_load_dwordx4 v209, s[8:11], s27 offen lds
  v_mfma_f32_16x16x32_bf16 a[36:39], v[180:183], v[112:115], a[36:39]
  v_mfma_f32_16x16x32_bf16 a[68:71], v[180:183], v[116:119], a[68:71]
  ds_read_b64_tr_b16 v[148:149], v210 offset:8
  v_mfma_f32_16x16x32_bf16 a[100:103], v[180:183], v[120:123], a[100:103]
  s_add_u32 m0, s24, 29376
  s_add_u32 s27, s26, 3840
  v_mfma_f32_16x16x32_bf16 a[132:135], v[180:183], v[124:127], a[132:135]
  buffer_load_dwordx4 v209, s[8:11], s27 offen lds
  v_mfma_f32_16x16x32_bf16 a[164:167], v[180:183], v[128:131], a[164:167]
  v_mfma_f32_16x16x32_bf16 a[196:199], v[180:183], v[132:135], a[196:199]
  ds_read_b64_tr_b16 v[150:151], v210 offset:520
  v_mfma_f32_16x16x32_bf16 a[228:231], v[180:183], v[136:139], a[228:231]
  s_add_u32 m0, s24, 30464
  s_add_u32 s27, s26, 5120
  v_mfma_f32_16x16x32_bf16 v[228:231], v[180:183], v[140:143], v[228:231]
  buffer_load_dwordx4 v209, s[8:11], s27 offen lds
  v_mfma_f32_16x16x32_bf16 a[8:11], v[184:187], v[108:111], a[8:11]
  v_mfma_f32_16x16x32_bf16 a[40:43], v[184:187], v[112:115], a[40:43]
  ds_read_b64_tr_b16 v[152:153], v210 offset:64
  v_mfma_f32_16x16x32_bf16 a[72:75], v[184:187], v[116:119], a[72:75]
  s_add_u32 m0, s24, 31552
  s_add_u32 s27, s26, 6400
  v_mfma_f32_16x16x32_bf16 a[104:107], v[184:187], v[120:123], a[104:107]
  buffer_load_dwordx4 v209, s[8:11], s27 offen lds
  v_mfma_f32_16x16x32_bf16 a[136:139], v[184:187], v[124:127], a[136:139]
  v_mfma_f32_16x16x32_bf16 a[168:171], v[184:187], v[128:131], a[168:171]
  ds_read_b64_tr_b16 v[154:155], v210 offset:576
  v_mfma_f32_16x16x32_bf16 a[200:203], v[184:187], v[132:135], a[200:203]
  s_add_u32 m0, s24, 32640
  s_add_u32 s27, s26, 7680
  v_mfma_f32_16x16x32_bf16 a[232:235], v[184:187], v[136:139], a[232:235]
  buffer_load_dwordx4 v209, s[8:11], s27 offen lds
  v_mfma_f32_16x16x32_bf16 v[232:235], v[184:187], v[140:143], v[232:235]
  v_mfma_f32_16x16x32_bf16 a[12:15], v[188:191], v[108:111], a[12:15]
  ds_read_b64_tr_b16 v[156:157], v210 offset:72
  v_mfma_f32_16x16x32_bf16 a[44:47], v[188:191], v[112:115], a[44:47]
  s_add_u32 m0, s24, 33728
  s_add_u32 s27, s26, 8960
  v_mfma_f32_16x16x32_bf16 a[76:79], v[188:191], v[116:119], a[76:79]
  buffer_load_dwordx4 v209, s[8:11], s27 offen lds
  v_mfma_f32_16x16x32_bf16 a[108:111], v[188:191], v[120:123], a[108:111]
  s_add_u32 s26, s26, 163840
  v_mfma_f32_16x16x32_bf16 a[140:143], v[188:191], v[124:127], a[140:143]
  ds_read_b64_tr_b16 v[158:159], v210 offset:584
  v_mfma_f32_16x16x32_bf16 a[172:175], v[188:191], v[128:131], a[172:175]
  s_add_u32 s27, s25, 0
  v_mfma_f32_16x16x32_bf16 a[204:207], v[188:191], v[132:135], a[204:207]
  buffer_load_dwordx4 v[72:75], v208, s[4:7], s27 offen sc1
  v_mfma_f32_16x16x32_bf16 a[236:239], v[188:191], v[136:139], a[236:239]
  v_mfma_f32_16x16x32_bf16 v[236:239], v[188:191], v[140:143], v[236:239]
  ds_read_b64_tr_b16 v[160:161], v210 offset:128
  v_mfma_f32_16x16x32_bf16 a[16:19], v[192:195], v[108:111], a[16:19]
  s_add_u32 s27, s25, 131072
  v_mfma_f32_16x16x32_bf16 a[48:51], v[192:195], v[112:115], a[48:51]
  buffer_load_dwordx4 v[76:79], v208, s[4:7], s27 offen sc1
  v_mfma_f32_16x16x32_bf16 a[80:83], v[192:195], v[116:119], a[80:83]
  v_mfma_f32_16x16x32_bf16 a[112:115], v[192:195], v[120:123], a[112:115]
  ds_read_b64_tr_b16 v[162:163], v210 offset:640
  v_mfma_f32_16x16x32_bf16 a[144:147], v[192:195], v[124:127], a[144:147]
  s_add_u32 s27, s25, 262144
  v_mfma_f32_16x16x32_bf16 a[176:179], v[192:195], v[128:131], a[176:179]
  buffer_load_dwordx4 v[80:83], v208, s[4:7], s27 offen sc1
  v_mfma_f32_16x16x32_bf16 a[208:211], v[192:195], v[132:135], a[208:211]
  v_mfma_f32_16x16x32_bf16 a[240:243], v[192:195], v[136:139], a[240:243]
  ds_read_b64_tr_b16 v[164:165], v210 offset:136
  v_mfma_f32_16x16x32_bf16 v[240:243], v[192:195], v[140:143], v[240:243]
  s_add_u32 s27, s25, 393216
  v_mfma_f32_16x16x32_bf16 a[20:23], v[196:199], v[108:111], a[20:23]
  buffer_load_dwordx4 v[84:87], v208, s[4:7], s27 offen sc1
  v_mfma_f32_16x16x32_bf16 a[52:55], v[196:199], v[112:115], a[52:55]
  v_mfma_f32_16x16x32_bf16 a[84:87], v[196:199], v[116:119], a[84:87]
  ds_read_b64_tr_b16 v[166:167], v210 offset:648
  v_mfma_f32_16x16x32_bf16 a[116:119], v[196:199], v[120:123], a[116:119]
  s_add_u32 s27, s25, 524288
  v_mfma_f32_16x16x32_bf16 a[148:151], v[196:199], v[124:127], a[148:151]
  buffer_load_dwordx4 v[88:91], v208, s[4:7], s27 offen sc1
  v_mfma_f32_16x16x32_bf16 a[180:183], v[196:199], v[128:131], a[180:183]
  v_mfma_f32_16x16x32_bf16 a[212:215], v[196:199], v[132:135], a[212:215]
  ds_read_b64_tr_b16 v[168:169], v210 offset:192
  v_mfma_f32_16x16x32_bf16 a[244:247], v[196:199], v[136:139], a[244:247]
  s_add_u32 s27, s25, 655360
  v_mfma_f32_16x16x32_bf16 v[244:247], v[196:199], v[140:143], v[244:247]
  buffer_load_dwordx4 v[92:95], v208, s[4:7], s27 offen sc1
  v_mfma_f32_16x16x32_bf16 a[24:27], v[200:203], v[108:111], a[24:27]
  v_mfma_f32_16x16x32_bf16 a[56:59], v[200:203], v[112:115], a[56:59]
  ds_read_b64_tr_b16 v[170:171], v210 offset:704
  v_mfma_f32_16x16x32_bf16 a[88:91], v[200:203], v[116:119], a[88:91]
  s_add_u32 s27, s25, 786432
  v_mfma_f32_16x16x32_bf16 a[120:123], v[200:203], v[120:123], a[120:123]
  buffer_load_dwordx4 v[96:99], v208, s[4:7], s27 offen sc1
  v_mfma_f32_16x16x32_bf16 a[152:155], v[200:203], v[124:127], a[152:155]
  v_mfma_f32_16x16x32_bf16 a[184:187], v[200:203], v[128:131], a[184:187]
  ds_read_b64_tr_b16 v[172:173], v210 offset:200
  v_mfma_f32_16x16x32_bf16 a[216:219], v[200:203], v[132:135], a[216:219]
  s_add_u32 s27, s25, 917504
  v_min_u32 v216, v216, v217
  v_mfma_f32_16x16x32_bf16 a[248:251], v[200:203], v[136:139], a[248:251]
  buffer_load_dwordx4 v[100:103], v208, s[4:7], s27 offen sc1
  v_mfma_f32_16x16x32_bf16 v[248:251], v[200:203], v[140:143], v[248:251]
  v_mfma_f32_16x16x32_bf16 a[28:31], v[204:207], v[108:111], a[28:31]
  ds_read_b64_tr_b16 v[174:175], v210 offset:712
  v_readfirstlane_b32 s43, v216
  v_mfma_f32_16x16x32_bf16 a[60:63], v[204:207], v[112:115], a[60:63]
  s_add_u32 s27, s25, 1048576
  v_mfma_f32_16x16x32_bf16 a[92:95], v[204:207], v[116:119], a[92:95]
  buffer_load_dwordx4 v[104:107], v208, s[4:7], s27 offen sc1
  v_mfma_f32_16x16x32_bf16 a[124:127], v[204:207], v[120:123], a[124:127]
  s_add_u32 s25, s25, 4096
  v_mfma_f32_16x16x32_bf16 a[156:159], v[204:207], v[124:127], a[156:159]
  v_mfma_f32_16x16x32_bf16 a[188:191], v[204:207], v[128:131], a[188:191]
  v_mfma_f32_16x16x32_bf16 a[220:223], v[204:207], v[132:135], a[220:223]
  s_sub_u32 s30, s30, 1
  v_mfma_f32_16x16x32_bf16 a[252:255], v[204:207], v[136:139], a[252:255]
  s_waitcnt vmcnt(34) lgkmcnt(0)
  v_mfma_f32_16x16x32_bf16 v[252:255], v[204:207], v[140:143], v[252:255]
  s_cmp_lg_u32 s30, 4
  s_cbranch_scc1 O_DEP1OK
  s_cmp_lt_u32 s43, 32
  s_cbranch_scc1 O_DEP1
O_DEP1OK:
  s_cmp_lg_u32 s30, 0
  s_cbranch_scc1 O_L
  v_mfma_f32_16x16x32_bf16 a[0:3], v[144:147], v[0:3], a[0:3]
  s_add_u32 s27, s25, 0
  v_mfma_f32_16x16x32_bf16 a[32:35], v[144:147], v[4:7], a[32:35]
  buffer_load_dwordx4 v[108:111], v208, s[4:7], s27 offen sc1
  v_mfma_f32_16x16x32_bf16 a[64:67], v[144:147], v[8:11], a[64:67]
  v_mfma_f32_16x16x32_bf16 a[96:99], v[144:147], v[12:15], a[96:99]
  ds_read_b64_tr_b16 v[176:177], v210 offset:8704
  v_mfma_f32_16x16x32_bf16 a[128:131], v[144:147], v[16:19], a[128:131]
  s_add_u32 s27, s25, 131072
  v_mfma_f32_16x16x32_bf16 a[160:163], v[144:147], v[20:23], a[160:163]
  buffer_load_dwordx4 v[112:115], v208, s[4:7], s27 offen sc1
  v_mfma_f32_16x16x32_bf16 a[192:195], v[144:147], v[24:27], a[192:195]
  v_mfma_f32_16x16x32_bf16 a[224:227], v[144:147], v[28:31], a[224:227]
  ds_read_b64_tr_b16 v[178:179], v210 offset:9216
  v_mfma_f32_16x16x32_bf16 v[224:227], v[144:147], v[32:35], v[224:227]
  s_add_u32 s27, s25, 262144
  v_mfma_f32_16x16x32_bf16 a[4:7], v[148:151], v[0:3], a[4:7]
  buffer_load_dwordx4 v[116:119], v208, s[4:7], s27 offen sc1
  v_mfma_f32_16x16x32_bf16 a[36:39], v[148:151], v[4:7], a[36:39]
  v_mfma_f32_16x16x32_bf16 a[68:71], v[148:151], v[8:11], a[68:71]
  ds_read_b64_tr_b16 v[180:181], v210 offset:8712
  v_mfma_f32_16x16x32_bf16 a[100:103], v[148:151], v[12:15], a[100:103]
  s_add_u32 s27, s25, 393216
  v_mfma_f32_16x16x32_bf16 a[132:135], v[148:151], v[16:19], a[132:135]
  buffer_load_dwordx4 v[120:123], v208, s[4:7], s27 offen sc1
  v_mfma_f32_16x16x32_bf16 a[164:167], v[148:151], v[20:23], a[164:167]
  v_mfma_f32_16x16x32_bf16 a[196:199], v[148:151], v[24:27], a[196:199]
  ds_read_b64_tr_b16 v[182:183], v210 offset:9224
  v_mfma_f32_16x16x32_bf16 a[228:231], v[148:151], v[28:31], a[228:231]
  s_add_u32 s27, s25, 524288
  v_mfma_f32_16x16x32_bf16 v[228:231], v[148:151], v[32:35], v[228:231]
  buffer_load_dwordx4 v[124:127], v208, s[4:7], s27 offen sc1
  v_mfma_f32_16x16x32_bf16 a[8:11], v[152:155], v[0:3], a[8:11]
  v_mfma_f32_16x16x32_bf16 a[40:43], v[152:155], v[4:7], a[40:43]
  ds_read_b64_tr_b16 v[184:185], v210 offset:8768
  v_mfma_f32_16x16x32_bf16 a[72:75], v[152:155], v[8:11], a[72:75]
  s_add_u32 s27, s25, 655360
  v_mfma_f32_16x16x32_bf16 a[104:107], v[152:155], v[12:15], a[104:107]
  buffer_load_dwordx4 v[128:131], v208, s[4:7], s27 offen sc1
  v_mfma_f32_16x16x32_bf16 a[136:139], v[152:155], v[16:19], a[136:139]
  v_mfma_f32_16x16x32_bf16 a[168:171], v[152:155], v[20:23], a[168:171]
  ds_read_b64_tr_b16 v[186:187], v210 offset:9280
  v_mfma_f32_16x16x32_bf16 a[200:203], v[152:155], v[24:27], a[200:203]
  s_add_u32 s27, s25, 786432
  v_mfma_f32_16x16x32_bf16 a[232:235], v[152:155], v[28:31], a[232:235]
  buffer_load_dwordx4 v[132:135], v208, s[4:7], s27 offen sc1
  v_mfma_f32_16x16x32_bf16 v[232:235], v[152:155], v[32:35], v[232:235]
  v_mfma_f32_16x16x32_bf16 a[12:15], v[156:159], v[0:3], a[12:15]
  ds_read_b64_tr_b16 v[188:189], v210 offset:8776
  v_mfma_f32_16x16x32_bf16 a[44:47], v[156:159], v[4:7], a[44:47]
  s_add_u32 s27, s25, 917504
  v_mfma_f32_16x16x32_bf16 a[76:79], v[156:159], v[8:11], a[76:79]
  buffer_load_dwordx4 v[136:139], v208, s[4:7], s27 offen sc1
  v_mfma_f32_16x16x32_bf16 a[108:111], v[156:159], v[12:15], a[108:111]
  v_mfma_f32_16x16x32_bf16 a[140:143], v[156:159], v[16:19], a[140:143]
  ds_read_b64_tr_b16 v[190:191], v210 offset:9288
  v_mfma_f32_16x16x32_bf16 a[172:175], v[156:159], v[20:23], a[172:175]
  s_add_u32 s27, s25, 1048576
  v_mfma_f32_16x16x32_bf16 a[204:207], v[156:159], v[24:27], a[204:207]
  buffer_load_dwordx4 v[140:143], v208, s[4:7], s27 offen sc1
  v_mfma_f32_16x16x32_bf16 a[236:239], v[156:159], v[28:31], a[236:239]
  s_add_u32 s25, s25, 4096
  v_mfma_f32_16x16x32_bf16 v[236:239], v[156:159], v[32:35], v[236:239]
  ds_read_b64_tr_b16 v[192:193], v210 offset:8832
  v_mfma_f32_16x16x32_bf16 a[16:19], v[160:163], v[0:3], a[16:19]
  v_mfma_f32_16x16x32_bf16 a[48:51], v[160:163], v[4:7], a[48:51]
  v_mfma_f32_16x16x32_bf16 a[80:83], v[160:163], v[8:11], a[80:83]
  v_mfma_f32_16x16x32_bf16 a[112:115], v[160:163], v[12:15], a[112:115]
  ds_read_b64_tr_b16 v[194:195], v210 offset:9344
  v_mfma_f32_16x16x32_bf16 a[144:147], v[160:163], v[16:19], a[144:147]
  v_mfma_f32_16x16x32_bf16 a[176:179], v[160:163], v[20:23], a[176:179]
  v_mfma_f32_16x16x32_bf16 a[208:211], v[160:163], v[24:27], a[208:211]
  v_mfma_f32_16x16x32_bf16 a[240:243], v[160:163], v[28:31], a[240:243]
  ds_read_b64_tr_b16 v[196:197], v210 offset:8840
  v_mfma_f32_16x16x32_bf16 v[240:243], v[160:163], v[32:35], v[240:243]
  v_mfma_f32_16x16x32_bf16 a[20:23], v[164:167], v[0:3], a[20:23]
  v_mfma_f32_16x16x32_bf16 a[52:55], v[164:167], v[4:7], a[52:55]
  v_mfma_f32_16x16x32_bf16 a[84:87], v[164:167], v[8:11], a[84:87]
  ds_read_b64_tr_b16 v[198:199], v210 offset:9352
  v_mfma_f32_16x16x32_bf16 a[116:119], v[164:167], v[12:15], a[116:119]
  v_mfma_f32_16x16x32_bf16 a[148:151], v[164:167], v[16:19], a[148:151]
  v_mfma_f32_16x16x32_bf16 a[180:183], v[164:167], v[20:23], a[180:183]
  v_mfma_f32_16x16x32_bf16 a[212:215], v[164:167], v[24:27], a[212:215]
  ds_read_b64_tr_b16 v[200:201], v210 offset:8896
  v_mfma_f32_16x16x32_bf16 a[244:247], v[164:167], v[28:31], a[244:247]
  v_mfma_f32_16x16x32_bf16 v[244:247], v[164:167], v[32:35], v[244:247]
  v_mfma_f32_16x16x32_bf16 a[24:27], v[168:171], v[0:3], a[24:27]
  v_mfma_f32_16x16x32_bf16 a[56:59], v[168:171], v[4:7], a[56:59]
  ds_read_b64_tr_b16 v[202:203], v210 offset:9408
  v_mfma_f32_16x16x32_bf16 a[88:91], v[168:171], v[8:11], a[88:91]
  v_mfma_f32_16x16x32_bf16 a[120:123], v[168:171], v[12:15], a[120:123]
  v_mfma_f32_16x16x32_bf16 a[152:155], v[168:171], v[16:19], a[152:155]
  v_mfma_f32_16x16x32_bf16 a[184:187], v[168:171], v[20:23], a[184:187]
  ds_read_b64_tr_b16 v[204:205], v210 offset:8904
  v_mfma_f32_16x16x32_bf16 a[216:219], v[168:171], v[24:27], a[216:219]
  v_mfma_f32_16x16x32_bf16 a[248:251], v[168:171], v[28:31], a[248:251]
  v_mfma_f32_16x16x32_bf16 v[248:251], v[168:171], v[32:35], v[248:251]
  v_mfma_f32_16x16x32_bf16 a[28:31], v[172:175], v[0:3], a[28:31]
  ds_read_b64_tr_b16 v[206:207], v210 offset:9416
  v_mfma_f32_16x16x32_bf16 a[60:63], v[172:175], v[4:7], a[60:63]
  v_mfma_f32_16x16x32_bf16 a[92:95], v[172:175], v[8:11], a[92:95]
  v_mfma_f32_16x16x32_bf16 a[124:127], v[172:175], v[12:15], a[124:127]
  v_mfma_f32_16x16x32_bf16 a[156:159], v[172:175], v[16:19], a[156:159]
  v_mfma_f32_16x16x32_bf16 a[188:191], v[172:175], v[20:23], a[188:191]
  v_mfma_f32_16x16x32_bf16 a[220:223], v[172:175], v[24:27], a[220:223]
  v_mfma_f32_16x16x32_bf16 a[252:255], v[172:175], v[28:31], a[252:255]
  s_waitcnt vmcnt(26) lgkmcnt(0)
  v_mfma_f32_16x16x32_bf16 v[252:255], v[172:175], v[32:35], v[252:255]
  v_mfma_f32_16x16x32_bf16 a[0:3], v[176:179], v[36:39], a[0:3]
  v_mfma_f32_16x16x32_bf16 a[32:35], v[176:179], v[40:43], a[32:35]
  v_mfma_f32_16x16x32_bf16 a[64:67], v[176:179], v[44:47], a[64:67]
  v_mfma_f32_16x16x32_bf16 a[96:99], v[176:179], v[48:51], a[96:99]
  ds_read_b64_tr_b16 v[144:145], v210 offset:17408
  v_mfma_f32_16x16x32_bf16 a[128:131], v[176:179], v[52:55], a[128:131]
  v_mfma_f32_16x16x32_bf16 a[160:163], v[176:179], v[56:59], a[160:163]
  v_mfma_f32_16x16x32_bf16 a[192:195], v[176:179], v[60:63], a[192:195]
  v_mfma_f32_16x16x32_bf16 a[224:227], v[176:179], v[64:67], a[224:227]
  ds_read_b64_tr_b16 v[146:147], v210 offset:17920
  v_mfma_f32_16x16x32_bf16 v[224:227], v[176:179], v[68:71], v[224:227]
  v_mfma_f32_16x16x32_bf16 a[4:7], v[180:183], v[36:39], a[4:7]
  v_mfma_f32_16x16x32_bf16 a[36:39], v[180:183], v[40:43], a[36:39]
  v_mfma_f32_16x16x32_bf16 a[68:71], v[180:183], v[44:47], a[68:71]
  ds_read_b64_tr_b16 v[148:149], v210 offset:17416
  v_mfma_f32_16x16x32_bf16 a[100:103], v[180:183], v[48:51], a[100:103]
  v_mfma_f32_16x16x32_bf16 a[132:135], v[180:183], v[52:55], a[132:135]
  v_mfma_f32_16x16x32_bf16 a[164:167], v[180:183], v[56:59], a[164:167]
  v_mfma_f32_16x16x32_bf16 a[196:199], v[180:183], v[60:63], a[196:199]
  ds_read_b64_tr_b16 v[150:151], v210 offset:17928
  v_mfma_f32_16x16x32_bf16 a[228:231], v[180:183], v[64:67], a[228:231]
  v_mfma_f32_16x16x32_bf16 v[228:231], v[180:183], v[68:71], v[228:231]
  v_mfma_f32_16x16x32_bf16 a[8:11], v[184:187], v[36:39], a[8:11]
  v_mfma_f32_16x16x32_bf16 a[40:43], v[184:187], v[40:43], a[40:43]
  ds_read_b64_tr_b16 v[152:153], v210 offset:17472
  v_mfma_f32_16x16x32_bf16 a[72:75], v[184:187], v[44:47], a[72:75]
  v_mfma_f32_16x16x32_bf16 a[104:107], v[184:187], v[48:51], a[104:107]
  v_mfma_f32_16x16x32_bf16 a[136:139], v[184:187], v[52:55], a[136:139]
  v_mfma_f32_16x16x32_bf16 a[168:171], v[184:187], v[56:59], a[168:171]
  ds_read_b64_tr_b16 v[154:155], v210 offset:17984
  v_mfma_f32_16x16x32_bf16 a[200:203], v[184:187], v[60:63], a[200:203]
  v_mfma_f32_16x16x32_bf16 a[232:235], v[184:187], v[64:67], a[232:235]
  v_mfma_f32_16x16x32_bf16 v[232:235], v[184:187], v[68:71], v[232:235]
  v_mfma_f32_16x16x32_bf16 a[12:15], v[188:191], v[36:39], a[12:15]
  ds_read_b64_tr_b16 v[156:157], v210 offset:17480
  v_mfma_f32_16x16x32_bf16 a[44:47], v[188:191], v[40:43], a[44:47]
  v_mfma_f32_16x16x32_bf16 a[76:79], v[188:191], v[44:47], a[76:79]
  v_mfma_f32_16x16x32_bf16 a[108:111], v[188:191], v[48:51], a[108:111]
  v_mfma_f32_16x16x32_bf16 a[140:143], v[188:191], v[52:55], a[140:143]
  ds_read_b64_tr_b16 v[158:159], v210 offset:17992
  v_mfma_f32_16x16x32_bf16 a[172:175], v[188:191], v[56:59], a[172:175]
  v_mfma_f32_16x16x32_bf16 a[204:207], v[188:191], v[60:63], a[204:207]
  v_mfma_f32_16x16x32_bf16 a[236:239], v[188:191], v[64:67], a[236:239]
  v_mfma_f32_16x16x32_bf16 v[236:239], v[188:191], v[68:71], v[236:239]
  ds_read_b64_tr_b16 v[160:161], v210 offset:17536
  v_mfma_f32_16x16x32_bf16 a[16:19], v[192:195], v[36:39], a[16:19]
  v_mfma_f32_16x16x32_bf16 a[48:51], v[192:195], v[40:43], a[48:51]
  v_mfma_f32_16x16x32_bf16 a[80:83], v[192:195], v[44:47], a[80:83]
  v_mfma_f32_16x16x32_bf16 a[112:115], v[192:195], v[48:51], a[112:115]
  ds_read_b64_tr_b16 v[162:163], v210 offset:18048
  v_mfma_f32_16x16x32_bf16 a[144:147], v[192:195], v[52:55], a[144:147]
  v_mfma_f32_16x16x32_bf16 a[176:179], v[192:195], v[56:59], a[176:179]
  v_mfma_f32_16x16x32_bf16 a[208:211], v[192:195], v[60:63], a[208:211]
  v_mfma_f32_16x16x32_bf16 a[240:243], v[192:195], v[64:67], a[240:243]
  ds_read_b64_tr_b16 v[164:165], v210 offset:17544
  v_mfma_f32_16x16x32_bf16 v[240:243], v[192:195], v[68:71], v[240:243]
  v_mfma_f32_16x16x32_bf16 a[20:23], v[196:199], v[36:39], a[20:23]
  v_mfma_f32_16x16x32_bf16 a[52:55], v[196:199], v[40:43], a[52:55]
  v_mfma_f32_16x16x32_bf16 a[84:87], v[196:199], v[44:47], a[84:87]
  ds_read_b64_tr_b16 v[166:167], v210 offset:18056
  v_mfma_f32_16x16x32_bf16 a[116:119], v[196:199], v[48:51], a[116:119]
  v_mfma_f32_16x16x32_bf16 a[148:151], v[196:199], v[52:55], a[148:151]
  v_mfma_f32_16x16x32_bf16 a[180:183], v[196:199], v[56:59], a[180:183]
  v_mfma_f32_16x16x32_bf16 a[212:215], v[196:199], v[60:63], a[212:215]
  ds_read_b64_tr_b16 v[168:169], v210 offset:17600
  v_mfma_f32_16x16x32_bf16 a[244:247], v[196:199], v[64:67], a[244:247]
  v_mfma_f32_16x16x32_bf16 v[244:247], v[196:199], v[68:71], v[244:247]
  v_mfma_f32_16x16x32_bf16 a[24:27], v[200:203], v[36:39], a[24:27]
  v_mfma_f32_16x16x32_bf16 a[56:59], v[200:203], v[40:43], a[56:59]
  ds_read_b64_tr_b16 v[170:171], v210 offset:18112
  v_mfma_f32_16x16x32_bf16 a[88:91], v[200:203], v[44:47], a[88:91]
  v_mfma_f32_16x16x32_bf16 a[120:123], v[200:203], v[48:51], a[120:123]
  v_mfma_f32_16x16x32_bf16 a[152:155], v[200:203], v[52:55], a[152:155]
  v_mfma_f32_16x16x32_bf16 a[184:187], v[200:203], v[56:59], a[184:187]
  ds_read_b64_tr_b16 v[172:173], v210 offset:17608
  v_mfma_f32_16x16x32_bf16 a[216:219], v[200:203], v[60:63], a[216:219]
  v_mfma_f32_16x16x32_bf16 a[248:251], v[200:203], v[64:67], a[248:251]
  v_mfma_f32_16x16x32_bf16 v[248:251], v[200:203], v[68:71], v[248:251]
  v_mfma_f32_16x16x32_bf16 a[28:31], v[204:207], v[36:39], a[28:31]
  ds_read_b64_tr_b16 v[174:175], v210 offset:18120
  v_mfma_f32_16x16x32_bf16 a[60:63], v[204:207], v[40:43], a[60:63]
  v_mfma_f32_16x16x32_bf16 a[92:95], v[204:207], v[44:47], a[92:95]
  v_mfma_f32_16x16x32_bf16 a[124:127], v[204:207], v[48:51], a[124:127]
  v_mfma_f32_16x16x32_bf16 a[156:159], v[204:207], v[52:55], a[156:159]
  v_mfma_f32_16x16x32_bf16 a[188:191], v[204:207], v[56:59], a[188:191]
  v_mfma_f32_16x16x32_bf16 a[220:223], v[204:207], v[60:63], a[220:223]
  v_mfma_f32_16x16x32_bf16 a[252:255], v[204:207], v[64:67], a[252:255]
  s_waitcnt vmcnt(9) lgkmcnt(0)
  v_mfma_f32_16x16x32_bf16 v[252:255], v[204:207], v[68:71], v[252:255]
  v_mfma_f32_16x16x32_bf16 a[0:3], v[144:147], v[72:75], a[0:3]
  s_xor_b32 s40, s20, 1
  v_mfma_f32_16x16x32_bf16 a[32:35], v[144:147], v[76:79], a[32:35]
  v_mfma_f32_16x16x32_bf16 a[64:67], v[144:147], v[80:83], a[64:67]
  s_mul_i32 s40, s40, 6144
  v_mfma_f32_16x16x32_bf16 a[96:99], v[144:147], v[84:87], a[96:99]
  ds_read_b64_tr_b16 v[176:177], v210 offset:26112
  v_mfma_f32_16x16x32_bf16 a[128:131], v[144:147], v[88:91], a[128:131]
  s_add_u32 s40, s40, 0
  v_mfma_f32_16x16x32_bf16 a[160:163], v[144:147], v[92:95], a[160:163]
  v_mfma_f32_16x16x32_bf16 a[192:195], v[144:147], v[96:99], a[192:195]
  v_add_u32 v32, s40, v208
  v_mfma_f32_16x16x32_bf16 a[224:227], v[144:147], v[100:103], a[224:227]
  ds_read_b64_tr_b16 v[178:179], v210 offset:26624
  v_mfma_f32_16x16x32_bf16 v[224:227], v[144:147], v[104:107], v[224:227]
  v_add_u32 v35, 73728, v32
  v_mfma_f32_16x16x32_bf16 a[4:7], v[148:151], v[72:75], a[4:7]
  v_mfma_f32_16x16x32_bf16 a[36:39], v[148:151], v[76:79], a[36:39]
  s_xor_b32 s40, s20, 2
  v_mfma_f32_16x16x32_bf16 a[68:71], v[148:151], v[80:83], a[68:71]
  ds_read_b64_tr_b16 v[180:181], v210 offset:26120
  v_mfma_f32_16x16x32_bf16 a[100:103], v[148:151], v[84:87], a[100:103]
  s_mul_i32 s40, s40, 6144
  v_mfma_f32_16x16x32_bf16 a[132:135], v[148:151], v[88:91], a[132:135]
  v_mfma_f32_16x16x32_bf16 a[164:167], v[148:151], v[92:95], a[164:167]
  s_add_u32 s40, s40, 2048
  v_mfma_f32_16x16x32_bf16 a[196:199], v[148:151], v[96:99], a[196:199]
  ds_read_b64_tr_b16 v[182:183], v210 offset:26632
  v_mfma_f32_16x16x32_bf16 a[228:231], v[148:151], v[100:103], a[228:231]
  v_add_u32 v33, s40, v208
  v_mfma_f32_16x16x32_bf16 v[228:231], v[148:151], v[104:107], v[228:231]
  v_mfma_f32_16x16x32_bf16 a[8:11], v[152:155], v[72:75], a[8:11]
  v_add_u32 v36, 73728, v33
  v_mfma_f32_16x16x32_bf16 a[40:43], v[152:155], v[76:79], a[40:43]
  ds_read_b64_tr_b16 v[184:185], v210 offset:26176
  v_mfma_f32_16x16x32_bf16 a[72:75], v[152:155], v[80:83], a[72:75]
  s_xor_b32 s40, s20, 3
  v_mfma_f32_16x16x32_bf16 a[104:107], v[152:155], v[84:87], a[104:107]
  v_mfma_f32_16x16x32_bf16 a[136:139], v[152:155], v[88:91], a[136:139]
  s_mul_i32 s40, s40, 6144
  v_mfma_f32_16x16x32_bf16 a[168:171], v[152:155], v[92:95], a[168:171]
  ds_read_b64_tr_b16 v[186:187], v210 offset:26688
  v_mfma_f32_16x16x32_bf16 a[200:203], v[152:155], v[96:99], a[200:203]
  s_add_u32 s40, s40, 4096
  v_mfma_f32_16x16x32_bf16 a[232:235], v[152:155], v[100:103], a[232:235]
  v_mfma_f32_16x16x32_bf16 v[232:235], v[152:155], v[104:107], v[232:235]
  v_add_u32 v34, s40, v208
  v_mfma_f32_16x16x32_bf16 a[12:15], v[156:159], v[72:75], a[12:15]
  ds_read_b64_tr_b16 v[188:189], v210 offset:26184
  v_mfma_f32_16x16x32_bf16 a[44:47], v[156:159], v[76:79], a[44:47]
  v_add_u32 v37, 73728, v34
  v_mfma_f32_16x16x32_bf16 a[76:79], v[156:159], v[80:83], a[76:79]
  v_mfma_f32_16x16x32_bf16 a[108:111], v[156:159], v[84:87], a[108:111]
  s_mul_i32 s40, s20, 6144
  v_mfma_f32_16x16x32_bf16 a[140:143], v[156:159], v[88:91], a[140:143]
  ds_read_b64_tr_b16 v[190:191], v210 offset:26696
  v_mfma_f32_16x16x32_bf16 a[172:175], v[156:159], v[92:95], a[172:175]
  v_add_u32 v38, s40, v208
  v_mfma_f32_16x16x32_bf16 a[204:207], v[156:159], v[96:99], a[204:207]
  v_mfma_f32_16x16x32_bf16 a[236:239], v[156:159], v[100:103], a[236:239]
  v_add_u32 v39, 73728, v38
  v_mfma_f32_16x16x32_bf16 v[236:239], v[156:159], v[104:107], v[236:239]
  ds_read_b64_tr_b16 v[192:193], v210 offset:26240
  v_mfma_f32_16x16x32_bf16 a[16:19], v[160:163], v[72:75], a[16:19]
  v_mfma_f32_16x16x32_bf16 a[48:51], v[160:163], v[76:79], a[48:51]
  v_mfma_f32_16x16x32_bf16 a[80:83], v[160:163], v[80:83], a[80:83]
  v_mfma_f32_16x16x32_bf16 a[112:115], v[160:163], v[84:87], a[112:115]
  ds_read_b64_tr_b16 v[194:195], v210 offset:26752
  v_mfma_f32_16x16x32_bf16 a[144:147], v[160:163], v[88:91], a[144:147]
  v_mfma_f32_16x16x32_bf16 a[176:179], v[160:163], v[92:95], a[176:179]
  v_mfma_f32_16x16x32_bf16 a[208:211], v[160:163], v[96:99], a[208:211]
  v_mfma_f32_16x16x32_bf16 a[240:243], v[160:163], v[100:103], a[240:243]
  ds_read_b64_tr_b16 v[196:197], v210 offset:26248
  v_mfma_f32_16x16x32_bf16 v[240:243], v[160:163], v[104:107], v[240:243]
  v_mfma_f32_16x16x32_bf16 a[20:23], v[164:167], v[72:75], a[20:23]
  v_mfma_f32_16x16x32_bf16 a[52:55], v[164:167], v[76:79], a[52:55]
  v_mfma_f32_16x16x32_bf16 a[84:87], v[164:167], v[80:83], a[84:87]
  ds_read_b64_tr_b16 v[198:199], v210 offset:26760
  v_mfma_f32_16x16x32_bf16 a[116:119], v[164:167], v[84:87], a[116:119]
  v_mfma_f32_16x16x32_bf16 a[148:151], v[164:167], v[88:91], a[148:151]
  v_mfma_f32_16x16x32_bf16 a[180:183], v[164:167], v[92:95], a[180:183]
  v_mfma_f32_16x16x32_bf16 a[212:215], v[164:167], v[96:99], a[212:215]
  ds_read_b64_tr_b16 v[200:201], v210 offset:26304
  v_mfma_f32_16x16x32_bf16 a[244:247], v[164:167], v[100:103], a[244:247]
  v_mfma_f32_16x16x32_bf16 v[244:247], v[164:167], v[104:107], v[244:247]
  v_mfma_f32_16x16x32_bf16 a[24:27], v[168:171], v[72:75], a[24:27]
  v_mfma_f32_16x16x32_bf16 a[56:59], v[168:171], v[76:79], a[56:59]
  ds_read_b64_tr_b16 v[202:203], v210 offset:26816
  v_mfma_f32_16x16x32_bf16 a[88:91], v[168:171], v[80:83], a[88:91]
  v_mfma_f32_16x16x32_bf16 a[120:123], v[168:171], v[84:87], a[120:123]
  v_mfma_f32_16x16x32_bf16 a[152:155], v[168:171], v[88:91], a[152:155]
  v_mfma_f32_16x16x32_bf16 a[184:187], v[168:171], v[92:95], a[184:187]
  ds_read_b64_tr_b16 v[204:205], v210 offset:26312
  v_mfma_f32_16x16x32_bf16 a[216:219], v[168:171], v[96:99], a[216:219]
  v_mfma_f32_16x16x32_bf16 a[248:251], v[168:171], v[100:103], a[248:251]
  v_mfma_f32_16x16x32_bf16 v[248:251], v[168:171], v[104:107], v[248:251]
  v_mfma_f32_16x16x32_bf16 a[28:31], v[172:175], v[72:75], a[28:31]
  ds_read_b64_tr_b16 v[206:207], v210 offset:26824
  v_mfma_f32_16x16x32_bf16 a[60:63], v[172:175], v[76:79], a[60:63]
  v_mfma_f32_16x16x32_bf16 a[92:95], v[172:175], v[80:83], a[92:95]
  v_mfma_f32_16x16x32_bf16 a[124:127], v[172:175], v[84:87], a[124:127]
  v_mfma_f32_16x16x32_bf16 a[156:159], v[172:175], v[88:91], a[156:159]
  v_mfma_f32_16x16x32_bf16 a[188:191], v[172:175], v[92:95], a[188:191]
  v_mfma_f32_16x16x32_bf16 a[220:223], v[172:175], v[96:99], a[220:223]
  v_mfma_f32_16x16x32_bf16 a[252:255], v[172:175], v[100:103], a[252:255]
  s_waitcnt vmcnt(0) lgkmcnt(0)
  v_mfma_f32_16x16x32_bf16 v[252:255], v[172:175], v[104:107], v[252:255]
  s_barrier
  v_mfma_f32_16x16x32_bf16 a[0:3], v[176:179], v[108:111], a[0:3]
  v_mfma_f32_16x16x32_bf16 a[4:7], v[180:183], v[108:111], a[4:7]
  v_mfma_f32_16x16x32_bf16 a[8:11], v[184:187], v[108:111], a[8:11]
  v_mfma_f32_16x16x32_bf16 a[12:15], v[188:191], v[108:111], a[12:15]
  v_mfma_f32_16x16x32_bf16 a[16:19], v[192:195], v[108:111], a[16:19]
  v_mfma_f32_16x16x32_bf16 a[20:23], v[196:199], v[108:111], a[20:23]
  v_mfma_f32_16x16x32_bf16 a[24:27], v[200:203], v[108:111], a[24:27]
  v_mfma_f32_16x16x32_bf16 a[28:31], v[204:207], v[108:111], a[28:31]
  v_mfma_f32_16x16x32_bf16 a[32:35], v[176:179], v[112:115], a[32:35]
  v_mfma_f32_16x16x32_bf16 a[36:39], v[180:183], v[112:115], a[36:39]
  v_mfma_f32_16x16x32_bf16 a[40:43], v[184:187], v[112:115], a[40:43]
  v_mfma_f32_16x16x32_bf16 a[44:47], v[188:191], v[112:115], a[44:47]
  v_mfma_f32_16x16x32_bf16 a[48:51], v[192:195], v[112:115], a[48:51]
  v_mfma_f32_16x16x32_bf16 a[52:55], v[196:199], v[112:115], a[52:55]
  v_mfma_f32_16x16x32_bf16 a[56:59], v[200:203], v[112:115], a[56:59]
  v_mfma_f32_16x16x32_bf16 a[60:63], v[204:207], v[112:115], a[60:63]
  v_mfma_f32_16x16x32_bf16 a[64:67], v[176:179], v[116:119], a[64:67]
  v_mfma_f32_16x16x32_bf16 a[68:71], v[180:183], v[116:119], a[68:71]
  v_mfma_f32_16x16x32_bf16 a[72:75], v[184:187], v[116:119], a[72:75]
  v_mfma_f32_16x16x32_bf16 a[76:79], v[188:191], v[116:119], a[76:79]
  v_mfma_f32_16x16x32_bf16 a[80:83], v[192:195], v[116:119], a[80:83]
  v_mfma_f32_16x16x32_bf16 a[84:87], v[196:199], v[116:119], a[84:87]
  v_mfma_f32_16x16x32_bf16 a[88:91], v[200:203], v[116:119], a[88:91]
  v_mfma_f32_16x16x32_bf16 a[92:95], v[204:207], v[116:119], a[92:95]
  v_mfma_f32_16x16x32_bf16 a[96:99], v[176:179], v[120:123], a[96:99]
  v_mfma_f32_16x16x32_bf16 a[100:103], v[180:183], v[120:123], a[100:103]
  v_mfma_f32_16x16x32_bf16 a[104:107], v[184:187], v[120:123], a[104:107]
  ds_write_b128 v32, a[8:11] offset:0
  v_mfma_f32_16x16x32_bf16 a[108:111], v[188:191], v[120:123], a[108:111]
  ds_write_b128 v32, a[12:15] offset:1024
  v_mfma_f32_16x16x32_bf16 a[112:115], v[192:195], v[120:123], a[112:115]
  ds_write_b128 v33, a[16:19] offset:0
  v_mfma_f32_16x16x32_bf16 a[116:119], v[196:199], v[120:123], a[116:119]
  ds_write_b128 v33, a[20:23] offset:1024
  v_mfma_f32_16x16x32_bf16 a[120:123], v[200:203], v[120:123], a[120:123]
  ds_write_b128 v34, a[24:27] offset:0
  v_mfma_f32_16x16x32_bf16 a[124:127], v[204:207], v[120:123], a[124:127]
  ds_write_b128 v34, a[28:31] offset:1024
  v_mfma_f32_16x16x32_bf16 a[128:131], v[176:179], v[124:127], a[128:131]
  ds_write_b128 v32, a[40:43] offset:24576
  v_mfma_f32_16x16x32_bf16 a[132:135], v[180:183], v[124:127], a[132:135]
  ds_write_b128 v32, a[44:47] offset:25600
  v_mfma_f32_16x16x32_bf16 a[136:139], v[184:187], v[124:127], a[136:139]
  ds_write_b128 v33, a[48:51] offset:24576
  v_mfma_f32_16x16x32_bf16 a[140:143], v[188:191], v[124:127], a[140:143]
  ds_write_b128 v33, a[52:55] offset:25600
  v_mfma_f32_16x16x32_bf16 a[144:147], v[192:195], v[124:127], a[144:147]
  ds_write_b128 v34, a[56:59] offset:24576
  v_mfma_f32_16x16x32_bf16 a[148:151], v[196:199], v[124:127], a[148:151]
  ds_write_b128 v34, a[60:63] offset:25600
  v_mfma_f32_16x16x32_bf16 a[152:155], v[200:203], v[124:127], a[152:155]
  ds_write_b128 v32, a[72:75] offset:49152
  v_mfma_f32_16x16x32_bf16 a[156:159], v[204:207], v[124:127], a[156:159]
  ds_write_b128 v32, a[76:79] offset:50176
  v_mfma_f32_16x16x32_bf16 a[160:163], v[176:179], v[128:131], a[160:163]
  ds_write_b128 v33, a[80:83] offset:49152
  v_mfma_f32_16x16x32_bf16 a[164:167], v[180:183], v[128:131], a[164:167]
  ds_write_b128 v33, a[84:87] offset:50176
  v_mfma_f32_16x16x32_bf16 a[168:171], v[184:187], v[128:131], a[168:171]
  ds_write_b128 v34, a[88:91] offset:49152
  v_mfma_f32_16x16x32_bf16 a[172:175], v[188:191], v[128:131], a[172:175]
  ds_write_b128 v34, a[92:95] offset:50176
  v_mfma_f32_16x16x32_bf16 a[176:179], v[192:195], v[128:131], a[176:179]
  v_mfma_f32_16x16x32_bf16 a[180:183], v[196:199], v[128:131], a[180:183]
  v_mfma_f32_16x16x32_bf16 a[184:187], v[200:203], v[128:131], a[184:187]
  v_mfma_f32_16x16x32_bf16 a[188:191], v[204:207], v[128:131], a[188:191]
  v_mfma_f32_16x16x32_bf16 a[192:195], v[176:179], v[132:135], a[192:195]
  v_mfma_f32_16x16x32_bf16 a[196:199], v[180:183], v[132:135], a[196:199]
  v_mfma_f32_16x16x32_bf16 a[200:203], v[184:187], v[132:135], a[200:203]
  ds_write_b128 v35, a[104:107] offset:0
  v_mfma_f32_16x16x32_bf16 a[204:207], v[188:191], v[132:135], a[204:207]
  ds_write_b128 v35, a[108:111] offset:1024
  v_mfma_f32_16x16x32_bf16 a[208:211], v[192:195], v[132:135], a[208:211]
  ds_write_b128 v36, a[112:115] offset:0
  v_mfma_f32_16x16x32_bf16 a[212:215], v[196:199], v[132:135], a[212:215]
  ds_write_b128 v36, a[116:119] offset:1024
  v_mfma_f32_16x16x32_bf16 a[216:219], v[200:203], v[132:135], a[216:219]
  ds_write_b128 v37, a[120:123] offset:0
  v_mfma_f32_16x16x32_bf16 a[220:223], v[204:207], v[132:135], a[220:223]
  ds_write_b128 v37, a[124:127] offset:1024
  v_mfma_f32_16x16x32_bf16 a[224:227], v[176:179], v[136:139], a[224:227]
  ds_write_b128 v35, a[136:139] offset:24576
  v_mfma_f32_16x16x32_bf16 a[228:231], v[180:183], v[136:139], a[228:231]
  ds_write_b128 v35, a[140:143] offset:25600
  v_mfma_f32_16x16x32_bf16 a[232:235], v[184:187], v[136:139], a[232:235]
  ds_write_b128 v36, a[144:147] offset:24576
  v_mfma_f32_16x16x32_bf16 a[236:239], v[188:191], v[136:139], a[236:239]
  ds_write_b128 v36, a[148:151] offset:25600
  v_mfma_f32_16x16x32_bf16 a[240:243], v[192:195], v[136:139], a[240:243]
  ds_write_b128 v37, a[152:155] offset:24576
  v_mfma_f32_16x16x32_bf16 a[244:247], v[196:199], v[136:139], a[244:247]
  ds_write_b128 v37, a[156:159] offset:25600
  v_mfma_f32_16x16x32_bf16 a[248:251], v[200:203], v[136:139], a[248:251]
  ds_write_b128 v35, a[168:171] offset:49152
  v_mfma_f32_16x16x32_bf16 a[252:255], v[204:207], v[136:139], a[252:255]
  ds_write_b128 v35, a[172:175] offset:50176
  v_mfma_f32_16x16x32_bf16 v[224:227], v[176:179], v[140:143], v[224:227]
  ds_write_b128 v36, a[176:179] offset:49152
  v_mfma_f32_16x16x32_bf16 v[228:231], v[180:183], v[140:143], v[228:231]
  ds_write_b128 v36, a[180:183] offset:50176
  v_mfma_f32_16x16x32_bf16 v[232:235], v[184:187], v[140:143], v[232:235]
  ds_write_b128 v37, a[184:187] offset:49152
  v_mfma_f32_16x16x32_bf16 v[236:239], v[188:191], v[140:143], v[236:239]
  ds_write_b128 v37, a[188:191] offset:50176
  v_mfma_f32_16x16x32_bf16 v[240:243], v[192:195], v[140:143], v[240:243]
  v_mfma_f32_16x16x32_bf16 v[244:247], v[196:199], v[140:143], v[244:247]
  v_mfma_f32_16x16x32_bf16 v[248:251], v[200:203], v[140:143], v[248:251]
  v_mfma_f32_16x16x32_bf16 v[252:255], v[204:207], v[140:143], v[252:255]
  s_waitcnt lgkmcnt(0)
  s_barrier
  ds_read_b128 v[40:43], v38 offset:0
  ds_read_b128 v[44:47], v38 offset:1024
  ds_read_b128 v[48:51], v38 offset:2048
  ds_read_b128 v[52:55], v38 offset:3072
  ds_read_b128 v[56:59], v38 offset:4096
  ds_read_b128 v[60:63], v38 offset:5120
  ds_read_b128 v[64:67], v38 offset:24576
  ds_read_b128 v[68:71], v38 offset:25600
  ds_read_b128 v[72:75], v38 offset:26624
  ds_read_b128 v[76:79], v38 offset:27648
  ds_read_b128 v[80:83], v38 offset:28672
  ds_read_b128 v[84:87], v38 offset:29696
  ds_read_b128 v[88:91], v38 offset:49152
  ds_read_b128 v[92:95], v38 offset:50176
  ds_read_b128 v[96:99], v38 offset:51200
  ds_read_b128 v[100:103], v38 offset:52224
  ds_read_b128 v[104:107], v38 offset:53248
  ds_read_b128 v[108:111], v38 offset:54272
  ds_read_b128 v[112:115], v39 offset:0
  ds_read_b128 v[116:119], v39 offset:1024
  ds_read_b128 v[120:123], v39 offset:2048
  ds_read_b128 v[124:127], v39 offset:3072
  ds_read_b128 v[128:131], v39 offset:4096
  ds_read_b128 v[132:135], v39 offset:5120
  ds_read_b128 v[136:139], v39 offset:24576
  ds_read_b128 v[140:143], v39 offset:25600
  ds_read_b128 v[144:147], v39 offset:26624
  ds_read_b128 v[148:151], v39 offset:27648
  ds_read_b128 v[152:155], v39 offset:28672
  ds_read_b128 v[156:159], v39 offset:29696
  s_waitcnt lgkmcnt(12)
  s_barrier
  ds_read_b128 v[160:163], v39 offset:49152
  ds_read_b128 v[164:167], v39 offset:50176
  ds_read_b128 v[168:171], v39 offset:51200
  ds_read_b128 v[172:175], v39 offset:52224
  ds_read_b128 v[176:179], v39 offset:53248
  ds_read_b128 v[180:183], v39 offset:54272
  ds_write_b128 v32, a[200:203] offset:0
  ds_write_b128 v32, a[204:207] offset:1024
  ds_write_b128 v33, a[208:211] offset:0
  ds_write_b128 v33, a[212:215] offset:1024
  ds_write_b128 v34, a[216:219] offset:0
  ds_write_b128 v34, a[220:223] offset:1024
  v_accvgpr_read_b32 v24, a0
  v_accvgpr_read_b32 v25, a1
  v_accvgpr_read_b32 v26, a2
  v_accvgpr_read_b32 v27, a3
  v_accvgpr_read_b32 v28, a4
  v_accvgpr_read_b32 v29, a5
  v_accvgpr_read_b32 v30, a6
  v_accvgpr_read_b32 v31, a7
  v_pk_add_f32 v[40:41], v[40:41], v[48:49]
  v_pk_add_f32 v[24:25], v[24:25], v[56:57]
  v_pk_add_f32 v[42:43], v[42:43], v[50:51]
  v_pk_add_f32 v[26:27], v[26:27], v[58:59]
  v_pk_add_f32 v[44:45], v[44:45], v[52:53]
  v_pk_add_f32 v[28:29], v[28:29], v[60:61]
  v_pk_add_f32 v[46:47], v[46:47], v[54:55]
  v_pk_add_f32 v[30:31], v[30:31], v[62:63]
  v_pk_add_f32 v[40:41], v[40:41], v[24:25]
  v_pk_add_f32 v[42:43], v[42:43], v[26:27]
  v_pk_add_f32 v[44:45], v[44:45], v[28:29]
  v_pk_add_f32 v[46:47], v[46:47], v[30:31]
  v_cvt_pk_bf16_f32 v48, v40, v41
  v_cvt_pk_bf16_f32 v49, v42, v43
  v_cvt_pk_bf16_f32 v50, v44, v45
  v_cvt_pk_bf16_f32 v51, v46, v47
  s_mov_b32 s27, 0
  buffer_store_dwordx4 v[48:51], v211, s[12:15], s27 offen sc0 sc1
  ds_write_b128 v32, a[232:235] offset:24576
  ds_write_b128 v32, a[236:239] offset:25600
  ds_write_b128 v33, a[240:243] offset:24576
  ds_write_b128 v33, a[244:247] offset:25600
  ds_write_b128 v34, a[248:251] offset:24576
  ds_write_b128 v34, a[252:255] offset:25600
  v_accvgpr_read_b32 v24, a32
  v_accvgpr_read_b32 v25, a33
  v_accvgpr_read_b32 v26, a34
  v_accvgpr_read_b32 v27, a35
  v_accvgpr_read_b32 v28, a36
  v_accvgpr_read_b32 v29, a37
  v_accvgpr_read_b32 v30, a38
  v_accvgpr_read_b32 v31, a39
  v_pk_add_f32 v[64:65], v[64:65], v[72:73]
  v_pk_add_f32 v[24:25], v[24:25], v[80:81]
  v_pk_add_f32 v[66:67], v[66:67], v[74:75]
  v_pk_add_f32 v[26:27], v[26:27], v[82:83]
  v_pk_add_f32 v[68:69], v[68:69], v[76:77]
  v_pk_add_f32 v[28:29], v[28:29], v[84:85]
  v_pk_add_f32 v[70:71], v[70:71], v[78:79]
  v_pk_add_f32 v[30:31], v[30:31], v[86:87]
  v_pk_add_f32 v[64:65], v[64:65], v[24:25]
  v_pk_add_f32 v[66:67], v[66:67], v[26:27]
  v_pk_add_f32 v[68:69], v[68:69], v[28:29]
  v_pk_add_f32 v[70:71], v[70:71], v[30:31]
  v_cvt_pk_bf16_f32 v72, v64, v65
  v_cvt_pk_bf16_f32 v73, v66, v67
  v_cvt_pk_bf16_f32 v74, v68, v69
  v_cvt_pk_bf16_f32 v75, v70, v71
  s_mov_b32 s27, 40960
  buffer_store_dwordx4 v[72:75], v211, s[12:15], s27 offen sc0 sc1
  ds_write_b128 v32, v[232:235] offset:49152
  ds_write_b128 v32, v[236:239] offset:50176
  ds_write_b128 v33, v[240:243] offset:49152
  ds_write_b128 v33, v[244:247] offset:50176
  ds_write_b128 v34, v[248:251] offset:49152
  ds_write_b128 v34, v[252:255] offset:50176
  v_accvgpr_read_b32 v24, a64
  v_accvgpr_read_b32 v25, a65
  v_accvgpr_read_b32 v26, a66
  v_accvgpr_read_b32 v27, a67
  v_accvgpr_read_b32 v28, a68
  v_accvgpr_read_b32 v29, a69
  v_accvgpr_read_b32 v30, a70
  v_accvgpr_read_b32 v31, a71
  v_pk_add_f32 v[88:89], v[88:89], v[96:97]
  v_pk_add_f32 v[24:25], v[24:25], v[104:105]
  v_pk_add_f32 v[90:91], v[90:91], v[98:99]
  v_pk_add_f32 v[26:27], v[26:27], v[106:107]
  v_pk_add_f32 v[92:93], v[92:93], v[100:101]
  v_pk_add_f32 v[28:29], v[28:29], v[108:109]
  v_pk_add_f32 v[94:95], v[94:95], v[102:103]
  v_pk_add_f32 v[30:31], v[30:31], v[110:111]
  v_pk_add_f32 v[88:89], v[88:89], v[24:25]
  v_pk_add_f32 v[90:91], v[90:91], v[26:27]
  v_pk_add_f32 v[92:93], v[92:93], v[28:29]
  v_pk_add_f32 v[94:95], v[94:95], v[30:31]
  v_cvt_pk_bf16_f32 v96, v88, v89
  v_cvt_pk_bf16_f32 v97, v90, v91
  v_cvt_pk_bf16_f32 v98, v92, v93
  v_cvt_pk_bf16_f32 v99, v94, v95
  s_mov_b32 s27, 81920
  buffer_store_dwordx4 v[96:99], v211, s[12:15], s27 offen sc0 sc1
  s_waitcnt lgkmcnt(15)
  v_accvgpr_read_b32 v24, a96
  v_accvgpr_read_b32 v25, a97
  v_accvgpr_read_b32 v26, a98
  v_accvgpr_read_b32 v27, a99
  v_accvgpr_read_b32 v28, a100
  v_accvgpr_read_b32 v29, a101
  v_accvgpr_read_b32 v30, a102
  v_accvgpr_read_b32 v31, a103
  v_pk_add_f32 v[112:113], v[112:113], v[120:121]
  v_pk_add_f32 v[24:25], v[24:25], v[128:129]
  v_pk_add_f32 v[114:115], v[114:115], v[122:123]
  v_pk_add_f32 v[26:27], v[26:27], v[130:131]
  v_pk_add_f32 v[116:117], v[116:117], v[124:125]
  v_pk_add_f32 v[28:29], v[28:29], v[132:133]
  v_pk_add_f32 v[118:119], v[118:119], v[126:127]
  v_pk_add_f32 v[30:31], v[30:31], v[134:135]
  v_pk_add_f32 v[112:113], v[112:113], v[24:25]
  v_pk_add_f32 v[114:115], v[114:115], v[26:27]
  v_pk_add_f32 v[116:117], v[116:117], v[28:29]
  v_pk_add_f32 v[118:119], v[118:119], v[30:31]
  v_cvt_pk_bf16_f32 v120, v112, v113
  v_cvt_pk_bf16_f32 v121, v114, v115
  v_cvt_pk_bf16_f32 v122, v116, v117
  v_cvt_pk_bf16_f32 v123, v118, v119
  s_mov_b32 s27, 122880
  buffer_store_dwordx4 v[120:123], v211, s[12:15], s27 offen sc0 sc1
  v_accvgpr_read_b32 v24, a128
  v_accvgpr_read_b32 v25, a129
  v_accvgpr_read_b32 v26, a130
  v_accvgpr_read_b32 v27, a131
  v_accvgpr_read_b32 v28, a132
  v_accvgpr_read_b32 v29, a133
  v_accvgpr_read_b32 v30, a134
  v_accvgpr_read_b32 v31, a135
  v_pk_add_f32 v[136:137], v[136:137], v[144:145]
  v_pk_add_f32 v[24:25], v[24:25], v[152:153]
  v_pk_add_f32 v[138:139], v[138:139], v[146:147]
  v_pk_add_f32 v[26:27], v[26:27], v[154:155]
  v_pk_add_f32 v[140:141], v[140:141], v[148:149]
  v_pk_add_f32 v[28:29], v[28:29], v[156:157]
  v_pk_add_f32 v[142:143], v[142:143], v[150:151]
  v_pk_add_f32 v[30:31], v[30:31], v[158:159]
  v_pk_add_f32 v[136:137], v[136:137], v[24:25]
  v_pk_add_f32 v[138:139], v[138:139], v[26:27]
  v_pk_add_f32 v[140:141], v[140:141], v[28:29]
  v_pk_add_f32 v[142:143], v[142:143], v[30:31]
  v_cvt_pk_bf16_f32 v144, v136, v137
  v_cvt_pk_bf16_f32 v145, v138, v139
  v_cvt_pk_bf16_f32 v146, v140, v141
  v_cvt_pk_bf16_f32 v147, v142, v143
  s_mov_b32 s27, 163840
  buffer_store_dwordx4 v[144:147], v211, s[12:15], s27 offen sc0 sc1
  v_accvgpr_read_b32 v24, a160
  v_accvgpr_read_b32 v25, a161
  v_accvgpr_read_b32 v26, a162
  v_accvgpr_read_b32 v27, a163
  v_accvgpr_read_b32 v28, a164
  v_accvgpr_read_b32 v29, a165
  v_accvgpr_read_b32 v30, a166
  v_accvgpr_read_b32 v31, a167
  v_pk_add_f32 v[160:161], v[160:161], v[168:169]
  v_pk_add_f32 v[24:25], v[24:25], v[176:177]
  v_pk_add_f32 v[162:163], v[162:163], v[170:171]
  v_pk_add_f32 v[26:27], v[26:27], v[178:179]
  v_pk_add_f32 v[164:165], v[164:165], v[172:173]
  v_pk_add_f32 v[28:29], v[28:29], v[180:181]
  v_pk_add_f32 v[166:167], v[166:167], v[174:175]
  v_pk_add_f32 v[30:31], v[30:31], v[182:183]
  v_pk_add_f32 v[160:161], v[160:161], v[24:25]
  v_pk_add_f32 v[162:163], v[162:163], v[26:27]
  v_pk_add_f32 v[164:165], v[164:165], v[28:29]
  v_pk_add_f32 v[166:167], v[166:167], v[30:31]
  v_cvt_pk_bf16_f32 v168, v160, v161
  v_cvt_pk_bf16_f32 v169, v162, v163
  v_cvt_pk_bf16_f32 v170, v164, v165
  v_cvt_pk_bf16_f32 v171, v166, v167
  s_mov_b32 s27, 204800
  buffer_store_dwordx4 v[168:171], v211, s[12:15], s27 offen sc0 sc1
  s_waitcnt lgkmcnt(0)
  s_barrier
  ds_read_b128 v[40:43], v38 offset:0
  ds_read_b128 v[44:47], v38 offset:1024
  ds_read_b128 v[48:51], v38 offset:2048
  ds_read_b128 v[52:55], v38 offset:3072
  ds_read_b128 v[56:59], v38 offset:4096
  ds_read_b128 v[60:63], v38 offset:5120
  ds_read_b128 v[64:67], v38 offset:24576
  ds_read_b128 v[68:71], v38 offset:25600
  ds_read_b128 v[72:75], v38 offset:26624
  ds_read_b128 v[76:79], v38 offset:27648
  ds_read_b128 v[80:83], v38 offset:28672
  ds_read_b128 v[84:87], v38 offset:29696
  ds_read_b128 v[88:91], v38 offset:49152
  ds_read_b128 v[92:95], v38 offset:50176
  ds_read_b128 v[96:99], v38 offset:51200
  ds_read_b128 v[100:103], v38 offset:52224
  ds_read_b128 v[104:107], v38 offset:53248
  ds_read_b128 v[108:111], v38 offset:54272
  s_waitcnt lgkmcnt(12)
  v_accvgpr_read_b32 v24, a192
  v_accvgpr_read_b32 v25, a193
  v_accvgpr_read_b32 v26, a194
  v_accvgpr_read_b32 v27, a195
  v_accvgpr_read_b32 v28, a196
  v_accvgpr_read_b32 v29, a197
  v_accvgpr_read_b32 v30, a198
  v_accvgpr_read_b32 v31, a199
  v_pk_add_f32 v[40:41], v[40:41], v[48:49]
  v_pk_add_f32 v[24:25], v[24:25], v[56:57]
  v_pk_add_f32 v[42:43], v[42:43], v[50:51]
  v_pk_add_f32 v[26:27], v[26:27], v[58:59]
  v_pk_add_f32 v[44:45], v[44:45], v[52:53]
  v_pk_add_f32 v[28:29], v[28:29], v[60:61]
  v_pk_add_f32 v[46:47], v[46:47], v[54:55]
  v_pk_add_f32 v[30:31], v[30:31], v[62:63]
  v_pk_add_f32 v[40:41], v[40:41], v[24:25]
  v_pk_add_f32 v[42:43], v[42:43], v[26:27]
  v_pk_add_f32 v[44:45], v[44:45], v[28:29]
  v_pk_add_f32 v[46:47], v[46:47], v[30:31]
  v_cvt_pk_bf16_f32 v48, v40, v41
  v_cvt_pk_bf16_f32 v49, v42, v43
  v_cvt_pk_bf16_f32 v50, v44, v45
  v_cvt_pk_bf16_f32 v51, v46, v47
  s_mov_b32 s27, 245760
  buffer_store_dwordx4 v[48:51], v211, s[12:15], s27 offen sc0 sc1
  s_waitcnt lgkmcnt(6)
  v_accvgpr_read_b32 v24, a224
  v_accvgpr_read_b32 v25, a225
  v_accvgpr_read_b32 v26, a226
  v_accvgpr_read_b32 v27, a227
  v_accvgpr_read_b32 v28, a228
  v_accvgpr_read_b32 v29, a229
  v_accvgpr_read_b32 v30, a230
  v_accvgpr_read_b32 v31, a231
  v_pk_add_f32 v[64:65], v[64:65], v[72:73]
  v_pk_add_f32 v[24:25], v[24:25], v[80:81]
  v_pk_add_f32 v[66:67], v[66:67], v[74:75]
  v_pk_add_f32 v[26:27], v[26:27], v[82:83]
  v_pk_add_f32 v[68:69], v[68:69], v[76:77]
  v_pk_add_f32 v[28:29], v[28:29], v[84:85]
  v_pk_add_f32 v[70:71], v[70:71], v[78:79]
  v_pk_add_f32 v[30:31], v[30:31], v[86:87]
  v_pk_add_f32 v[64:65], v[64:65], v[24:25]
  v_pk_add_f32 v[66:67], v[66:67], v[26:27]
  v_pk_add_f32 v[68:69], v[68:69], v[28:29]
  v_pk_add_f32 v[70:71], v[70:71], v[30:31]
  v_cvt_pk_bf16_f32 v72, v64, v65
  v_cvt_pk_bf16_f32 v73, v66, v67
  v_cvt_pk_bf16_f32 v74, v68, v69
  v_cvt_pk_bf16_f32 v75, v70, v71
  s_mov_b32 s27, 286720
  buffer_store_dwordx4 v[72:75], v211, s[12:15], s27 offen sc0 sc1
  s_waitcnt lgkmcnt(0)
  v_mov_b32 v24, v224
  v_mov_b32 v25, v225
  v_mov_b32 v26, v226
  v_mov_b32 v27, v227
  v_mov_b32 v28, v228
  v_mov_b32 v29, v229
  v_mov_b32 v30, v230
  v_mov_b32 v31, v231
  v_pk_add_f32 v[88:89], v[88:89], v[96:97]
  v_pk_add_f32 v[24:25], v[24:25], v[104:105]
  v_pk_add_f32 v[90:91], v[90:91], v[98:99]
  v_pk_add_f32 v[26:27], v[26:27], v[106:107]
  v_pk_add_f32 v[92:93], v[92:93], v[100:101]
  v_pk_add_f32 v[28:29], v[28:29], v[108:109]
  v_pk_add_f32 v[94:95], v[94:95], v[102:103]
  v_pk_add_f32 v[30:31], v[30:31], v[110:111]
  v_pk_add_f32 v[88:89], v[88:89], v[24:25]
  v_pk_add_f32 v[90:91], v[90:91], v[26:27]
  v_pk_add_f32 v[92:93], v[92:93], v[28:29]
  v_pk_add_f32 v[94:95], v[94:95], v[30:31]
  v_cvt_pk_bf16_f32 v96, v88, v89
  v_cvt_pk_bf16_f32 v97, v90, v91
  v_cvt_pk_bf16_f32 v98, v92, v93
  v_cvt_pk_bf16_f32 v99, v94, v95
  s_mov_b32 s27, 327680
  buffer_store_dwordx4 v[96:99], v211, s[12:15], s27 offen sc0 sc1
A_END:
  s_endpgm
A_INIT:
  s_mov_b32 s40, 0x40000
A_INITL:
  buffer_load_dword v243, v228, s[96:99], 0 offen sc1
  s_waitcnt vmcnt(0)
  v_readfirstlane_b32 s41, v243
  s_nop 1
  s_cmp_ge_u32 s41, 64
  s_cbranch_scc1 A_INITOK
  s_sleep 16
  s_sub_u32 s40, s40, 1
  s_cmp_lg_u32 s40, 0
  s_cbranch_scc1 A_INITL
  s_branch A_INITOK
O_DEP0:
  s_mov_b32 s40, 0x40000
O_DEP0L:
  buffer_load_dword v244, v228, s[16:19], s94 offen sc1
  buffer_load_dword v245, v228, s[16:19], s95 offen sc1
  s_waitcnt vmcnt(0)
  v_min_u32 v244, v244, v245
  s_nop 0
  v_readfirstlane_b32 s41, v244
  s_nop 1
  s_cmp_ge_u32 s41, 32
  s_cbranch_scc1 O_DEP0OK
  s_sleep 16
  s_sub_u32 s40, s40, 1
  s_cmp_lg_u32 s40, 0
  s_cbranch_scc1 O_DEP0L
  s_branch O_DEP0OK
O_DEP1:
  s_mov_b32 s40, 0x40000
O_DEP1L:
  buffer_load_dword v216, v215, s[16:19], s94 offen sc1
  buffer_load_dword v217, v215, s[16:19], s95 offen sc1
  s_waitcnt vmcnt(0)
  v_min_u32 v216, v216, v217
  s_nop 0
  v_readfirstlane_b32 s41, v216
  s_nop 1
  s_cmp_ge_u32 s41, 32
  s_cbranch_scc1 O_DEP1OK
  s_sleep 16
  s_sub_u32 s40, s40, 1
  s_cmp_lg_u32 s40, 0
  s_cbranch_scc1 O_DEP1L
  s_branch O_DEP1OK
A_FB:
  s_waitcnt vmcnt(0)
  s_barrier
  v_mov_b32 v236, 0xff800000
  v_mov_b32 v237, 0xff800000
  v_mov_b32 v238, 0xff800000
  v_mov_b32 v239, 0xff800000
  v_mov_b32 v240, 0xff800000
  v_mov_b32 v241, 0xff800000
  v_mov_b32 v242, 0xff800000
  s_mov_b32 s30, 32
  s_mov_b32 s25, s39
A_FBL:
  s_add_u32 m0, s24, 0
  s_nop 0
  buffer_load_dwordx4 v230, s[4:7], s25 offen offset:0 nt lds
  s_add_u32 m0, s24, 32
  s_nop 0
  buffer_load_dwordx4 v230, s[4:7], s25 offen offset:1024 nt lds
  s_add_u32 m0, s24, 64
  s_nop 0
  buffer_load_dwordx4 v230, s[4:7], s25 offen offset:2048 nt lds
  s_add_u32 m0, s24, 96
  s_nop 0
  buffer_load_dwordx4 v230, s[4:7], s25 offen offset:3072 nt lds
  s_add_u32 s25, s25, 4096
  s_add_u32 m0, s24, 4224
  s_nop 0
  buffer_load_dwordx4 v230, s[4:7], s25 offen offset:0 nt lds
  s_add_u32 m0, s24, 4256
  s_nop 0
  buffer_load_dwordx4 v230, s[4:7], s25 offen offset:1024 nt lds
  s_add_u32 m0, s24, 4288
  s_nop 0
  buffer_load_dwordx4 v230, s[4:7], s25 offen offset:2048 nt lds
  s_add_u32 m0, s24, 4320
  s_nop 0
  buffer_load_dwordx4 v230, s[4:7], s25 offen offset:3072 nt lds
  s_add_u32 s25, s25, 4096
  s_and_b32 s25, s25, 0x3ffff
  s_waitcnt vmcnt(0)
  s_barrier
  ds_read_b128 a[224:227], v224 offset:0
  ds_read_b128 a[228:231], v224 offset:64
  ds_read_b128 a[232:235], v224 offset:128
  ds_read_b128 a[236:239], v224 offset:192
  ds_read_b128 a[240:243], v224 offset:512
  ds_read_b128 a[244:247], v224 offset:576
  ds_read_b128 a[248:251], v224 offset:640
  ds_read_b128 a[252:255], v224 offset:704
  s_waitcnt lgkmcnt(0)
  s_barrier
  v_mfma_f32_16x16x32_bf16 v[204:207], a[224:227], v[0:3], 0
  v_mfma_f32_16x16x32_bf16 v[204:207], a[228:231], v[4:7], v[204:207]
  v_mfma_f32_16x16x32_bf16 v[204:207], a[232:235], v[8:11], v[204:207]
  v_mfma_f32_16x16x32_bf16 v[204:207], a[236:239], v[12:15], v[204:207]
  v_mfma_f32_16x16x32_bf16 v[208:211], a[240:243], v[0:3], 0
  v_mfma_f32_16x16x32_bf16 v[208:211], a[244:247], v[4:7], v[208:211]
  v_mfma_f32_16x16x32_bf16 v[208:211], a[248:251], v[8:11], v[208:211]
  v_mfma_f32_16x16x32_bf16 v[208:211], a[252:255], v[12:15], v[208:211]
  s_nop 7
  v_max3_f32 v236, v204, v205, v236
  v_max3_f32 v236, v206, v207, v236
  v_max3_f32 v236, v208, v209, v236
  v_max3_f32 v236, v210, v211, v236
  s_nop 3
  v_mfma_f32_16x16x32_bf16 v[204:207], a[224:227], v[16:19], 0
  v_mfma_f32_16x16x32_bf16 v[204:207], a[228:231], v[20:23], v[204:207]
  v_mfma_f32_16x16x32_bf16 v[204:207], a[232:235], v[24:27], v[204:207]
  v_mfma_f32_16x16x32_bf16 v[204:207], a[236:239], v[28:31], v[204:207]
  v_mfma_f32_16x16x32_bf16 v[208:211], a[240:243], v[16:19], 0
  v_mfma_f32_16x16x32_bf16 v[208:211], a[244:247], v[20:23], v[208:211]
  v_mfma_f32_16x16x32_bf16 v[208:211], a[248:251], v[24:27], v[208:211]
  v_mfma_f32_16x16x32_bf16 v[208:211], a[252:255], v[28:31], v[208:211]
  s_nop 7
  v_max3_f32 v237, v204, v205, v237
  v_max3_f32 v237, v206, v207, v237
  v_max3_f32 v237, v208, v209, v237
  v_max3_f32 v237, v210, v211, v237
  s_nop 3
  v_mfma_f32_16x16x32_bf16 v[204:207], a[224:227], v[32:35], 0
  v_mfma_f32_16x16x32_bf16 v[204:207], a[228:231], v[36:39], v[204:207]
  v_mfma_f32_16x16x32_bf16 v[204:207], a[232:235], v[40:43], v[204:207]
  v_mfma_f32_16x16x32_bf16 v[204:207], a[236:239], v[44:47], v[204:207]
  v_mfma_f32_16x16x32_bf16 v[208:211], a[240:243], v[32:35], 0
  v_mfma_f32_16x16x32_bf16 v[208:211], a[244:247], v[36:39], v[208:211]
  v_mfma_f32_16x16x32_bf16 v[208:211], a[248:251], v[40:43], v[208:211]
  v_mfma_f32_16x16x32_bf16 v[208:211], a[252:255], v[44:47], v[208:211]
  s_nop 7
  v_max3_f32 v238, v204, v205, v238
  v_max3_f32 v238, v206, v207, v238
  v_max3_f32 v238, v208, v209, v238
  v_max3_f32 v238, v210, v211, v238
  s_nop 3
  v_mfma_f32_16x16x32_bf16 v[204:207], a[224:227], v[48:51], 0
  v_mfma_f32_16x16x32_bf16 v[204:207], a[228:231], v[52:55], v[204:207]
  v_mfma_f32_16x16x32_bf16 v[204:207], a[232:235], v[56:59], v[204:207]
  v_mfma_f32_16x16x32_bf16 v[204:207], a[236:239], v[60:63], v[204:207]
  v_mfma_f32_16x16x32_bf16 v[208:211], a[240:243], v[48:51], 0
  v_mfma_f32_16x16x32_bf16 v[208:211], a[244:247], v[52:55], v[208:211]
  v_mfma_f32_16x16x32_bf16 v[208:211], a[248:251], v[56:59], v[208:211]
  v_mfma_f32_16x16x32_bf16 v[208:211], a[252:255], v[60:63], v[208:211]
  s_nop 7
  v_max3_f32 v239, v204, v205, v239
  v_max3_f32 v239, v206, v207, v239
  v_max3_f32 v239, v208, v209, v239
  v_max3_f32 v239, v210, v211, v239
  s_nop 3
  v_mfma_f32_16x16x32_bf16 v[204:207], a[224:227], v[64:67], 0
  v_mfma_f32_16x16x32_bf16 v[204:207], a[228:231], v[68:71], v[204:207]
  v_mfma_f32_16x16x32_bf16 v[204:207], a[232:235], v[72:75], v[204:207]
  v_mfma_f32_16x16x32_bf16 v[204:207], a[236:239], v[76:79], v[204:207]
  v_mfma_f32_16x16x32_bf16 v[208:211], a[240:243], v[64:67], 0
  v_mfma_f32_16x16x32_bf16 v[208:211], a[244:247], v[68:71], v[208:211]
  v_mfma_f32_16x16x32_bf16 v[208:211], a[248:251], v[72:75], v[208:211]
  v_mfma_f32_16x16x32_bf16 v[208:211], a[252:255], v[76:79], v[208:211]
  s_nop 7
  v_max3_f32 v240, v204, v205, v240
  v_max3_f32 v240, v206, v207, v240
  v_max3_f32 v240, v208, v209, v240
  v_max3_f32 v240, v210, v211, v240
  s_nop 3
  v_mfma_f32_16x16x32_bf16 v[204:207], a[224:227], v[80:83], 0
  v_mfma_f32_16x16x32_bf16 v[204:207], a[228:231], v[84:87], v[204:207]
  v_mfma_f32_16x16x32_bf16 v[204:207], a[232:235], v[88:91], v[204:207]
  v_mfma_f32_16x16x32_bf16 v[204:207], a[236:239], v[92:95], v[204:207]
  v_mfma_f32_16x16x32_bf16 v[208:211], a[240:243], v[80:83], 0
  v_mfma_f32_16x16x32_bf16 v[208:211], a[244:247], v[84:87], v[208:211]
  v_mfma_f32_16x16x32_bf16 v[208:211], a[248:251], v[88:91], v[208:211]
  v_mfma_f32_16x16x32_bf16 v[208:211], a[252:255], v[92:95], v[208:211]
  s_nop 7
  v_max3_f32 v241, v204, v205, v241
  v_max3_f32 v241, v206, v207, v241
  v_max3_f32 v241, v208, v209, v241
  v_max3_f32 v241, v210, v211, v241
  s_nop 3
  v_mfma_f32_16x16x32_bf16 v[204:207], a[224:227], v[96:99], 0
  v_mfma_f32_16x16x32_bf16 v[204:207], a[228:231], v[100:103], v[204:207]
  v_mfma_f32_16x16x32_bf16 v[204:207], a[232:235], v[104:107], v[204:207]
  v_mfma_f32_16x16x32_bf16 v[204:207], a[236:239], v[108:111], v[204:207]
  v_mfma_f32_16x16x32_bf16 v[208:211], a[240:243], v[96:99], 0
  v_mfma_f32_16x16x32_bf16 v[208:211], a[244:247], v[100:103], v[208:211]
  v_mfma_f32_16x16x32_bf16 v[208:211], a[248:251], v[104:107], v[208:211]
  v_mfma_f32_16x16x32_bf16 v[208:211], a[252:255], v[108:111], v[208:211]
  s_nop 7
  v_max3_f32 v242, v204, v205, v242
  v_max3_f32 v242, v206, v207, v242
  v_max3_f32 v242, v208, v209, v242
  v_max3_f32 v242, v210, v211, v242
  s_nop 3
  s_sub_u32 s30, s30, 1
  s_cmp_lg_u32 s30, 0
  s_cbranch_scc1 A_FBL
  v_mov_b32 v112, v236
  v_mov_b32 v113, v237
  v_mov_b32 v114, v238
  v_mov_b32 v115, v239
  v_mov_b32 v116, v240
  v_mov_b32 v117, v241
  v_mov_b32 v118, v242
  s_nop 0
  v_permlane32_swap_b32 v112, v236
  v_permlane32_swap_b32 v113, v237
  v_permlane32_swap_b32 v114, v238
  v_permlane32_swap_b32 v115, v239
  v_permlane32_swap_b32 v116, v240
  v_permlane32_swap_b32 v117, v241
  v_permlane32_swap_b32 v118, v242
  v_max_f32 v236, v236, v112
  v_max_f32 v237, v237, v113
  v_max_f32 v238, v238, v114
  v_max_f32 v239, v239, v115
  v_max_f32 v240, v240, v116
  v_max_f32 v241, v241, v117
  v_max_f32 v242, v242, v118
  v_mov_b32 v112, v236
  v_mov_b32 v113, v237
  v_mov_b32 v114, v238
  v_mov_b32 v115, v239
  v_mov_b32 v116, v240
  v_mov_b32 v117, v241
  v_mov_b32 v118, v242
  s_nop 0
  v_permlane16_swap_b32 v112, v236
  v_permlane16_swap_b32 v113, v237
  v_permlane16_swap_b32 v114, v238
  v_permlane16_swap_b32 v115, v239
  v_permlane16_swap_b32 v116, v240
  v_permlane16_swap_b32 v117, v241
  v_permlane16_swap_b32 v118, v242
  v_max_f32 v236, v236, v112
  v_max_f32 v237, v237, v113
  v_max_f32 v238, v238, v114
  v_max_f32 v239, v239, v115
  v_max_f32 v240, v240, v116
  v_max_f32 v241, v241, v117
  v_max_f32 v242, v242, v118
  v_xor_b32 v176, 0x80000000, v236
  v_xor_b32 v177, 0x80000000, v236
  v_xor_b32 v178, 0x80000000, v236
  v_xor_b32 v179, 0x80000000, v236
  v_xor_b32 v180, 0x80000000, v237
  v_xor_b32 v181, 0x80000000, v237
  v_xor_b32 v182, 0x80000000, v237
  v_xor_b32 v183, 0x80000000, v237
  v_xor_b32 v184, 0x80000000, v238
  v_xor_b32 v185, 0x80000000, v238
  v_xor_b32 v186, 0x80000000, v238
  v_xor_b32 v187, 0x80000000, v238
  v_xor_b32 v188, 0x80000000, v239
  v_xor_b32 v189, 0x80000000, v239
  v_xor_b32 v190, 0x80000000, v239
  v_xor_b32 v191, 0x80000000, v239
  v_xor_b32 v192, 0x80000000, v240
  v_xor_b32 v193, 0x80000000, v240
  v_xor_b32 v194, 0x80000000, v240
  v_xor_b32 v195, 0x80000000, v240
  v_xor_b32 v196, 0x80000000, v241
  v_xor_b32 v197, 0x80000000, v241
  v_xor_b32 v198, 0x80000000, v241
  v_xor_b32 v199, 0x80000000, v241
  v_xor_b32 v200, 0x80000000, v242
  v_xor_b32 v201, 0x80000000, v242
  v_xor_b32 v202, 0x80000000, v242
  v_xor_b32 v203, 0x80000000, v242
  s_mov_b32 s33, 1
  s_add_u32 s40, s3, 16
  s_lshl_b32 s40, s40, 8
  s_sub_u32 s41, 5242880, s40
  s_cmp_eq_u32 s22, 0
  s_cselect_b32 s40, s40, s36
  s_cselect_b32 s10, s41, 143360
  s_add_u32 s8, s34, s40
  s_addc_u32 s9, s35, 0
  s_mul_i32 s26, s22, 81920
  s_mov_b32 s31, s26
  s_lshl_b32 s40, s93, 8
  s_add_u32 s41, s54, s40
  s_addc_u32 s42, s55, 0
  s_sub_u32 s43, 5242880, s40
  s_mul_i32 s44, s20, 40960
  s_lshl_b32 s40, s20, 6
  v_lshrrev_b32 v233, 8, v230
  v_mul_u32_u24 v233, 10240, v233
  v_and_b32 v234, 0xf0, v230
  v_xor_b32 v234, s40, v234
  v_add_u32 v233, v233, v234
  s_cmp_eq_u32 s23, 0
  s_cselect_b32 s8, s8, s41
  s_cselect_b32 s9, s9, s42
  s_cselect_b32 s10, s10, s43
  s_cselect_b32 s26, s26, s44
  s_cselect_b32 s27, s27, 1280
  s_cselect_b32 s28, s28, 163840
  s_cselect_b32 s29, s29, 163840
  s_cselect_b64 vcc, -1, 0
  s_mov_b32 s31, s26
  v_cndmask_b32 v229, v233, v229, vcc
  s_add_u32 m0, s24, 0
  s_nop 0
  buffer_load_dwordx4 v230, s[4:7], s25 offen offset:0 nt lds
  s_add_u32 m0, s24, 32
  s_nop 0
  buffer_load_dwordx4 v230, s[4:7], s25 offen offset:1024 nt lds
  s_add_u32 m0, s24, 64
  s_nop 0
  buffer_load_dwordx4 v230, s[4:7], s25 offen offset:2048 nt lds
  s_add_u32 m0, s24, 96
  s_nop 0
  buffer_load_dwordx4 v230, s[4:7], s25 offen offset:3072 nt lds
  s_add_u32 s25, s25, 4096
  s_add_u32 m0, s24, 4224
  s_nop 0
  buffer_load_dwordx4 v230, s[4:7], s25 offen offset:0 nt lds
  s_add_u32 m0, s24, 4256
  s_nop 0
  buffer_load_dwordx4 v230, s[4:7], s25 offen offset:1024 nt lds
  s_add_u32 m0, s24, 4288
  s_nop 0
  buffer_load_dwordx4 v230, s[4:7], s25 offen offset:2048 nt lds
  s_add_u32 m0, s24, 4320
  s_nop 0
  buffer_load_dwordx4 v230, s[4:7], s25 offen offset:3072 nt lds
  s_add_u32 s25, s25, 4096
  s_and_b32 s25, s25, 0x3ffff
  s_add_u32 m0, s24, 8704
  s_nop 0
  buffer_load_dwordx4 v230, s[4:7], s25 offen offset:0 nt lds
  s_add_u32 m0, s24, 8736
  s_nop 0
  buffer_load_dwordx4 v230, s[4:7], s25 offen offset:1024 nt lds
  s_add_u32 m0, s24, 8768
  s_nop 0
  buffer_load_dwordx4 v230, s[4:7], s25 offen offset:2048 nt lds
  s_add_u32 m0, s24, 8800
  s_nop 0
  buffer_load_dwordx4 v230, s[4:7], s25 offen offset:3072 nt lds
  s_add_u32 s25, s25, 4096
  s_add_u32 m0, s24, 12928
  s_nop 0
  buffer_load_dwordx4 v230, s[4:7], s25 offen offset:0 nt lds
  s_add_u32 m0, s24, 12960
  s_nop 0
  buffer_load_dwordx4 v230, s[4:7], s25 offen offset:1024 nt lds
  s_add_u32 m0, s24, 12992
  s_nop 0
  buffer_load_dwordx4 v230, s[4:7], s25 offen offset:2048 nt lds
  s_add_u32 m0, s24, 13024
  s_nop 0
  buffer_load_dwordx4 v230, s[4:7], s25 offen offset:3072 nt lds
  s_add_u32 s25, s25, 4096
  s_and_b32 s25, s25, 0x3ffff
  s_add_u32 m0, s24, 17408
  s_nop 0
  buffer_load_dwordx4 v230, s[4:7], s25 offen offset:0 nt lds
  s_add_u32 m0, s24, 17440
  s_nop 0
  buffer_load_dwordx4 v230, s[4:7], s25 offen offset:1024 nt lds
  s_add_u32 m0, s24, 17472
  s_nop 0
  buffer_load_dwordx4 v230, s[4:7], s25 offen offset:2048 nt lds
  s_add_u32 m0, s24, 17504
  s_nop 0
  buffer_load_dwordx4 v230, s[4:7], s25 offen offset:3072 nt lds
  s_add_u32 s25, s25, 4096
  s_add_u32 m0, s24, 21632
  s_nop 0
  buffer_load_dwordx4 v230, s[4:7], s25 offen offset:0 nt lds
  s_add_u32 m0, s24, 21664
  s_nop 0
  buffer_load_dwordx4 v230, s[4:7], s25 offen offset:1024 nt lds
  s_add_u32 m0, s24, 21696
  s_nop 0
  buffer_load_dwordx4 v230, s[4:7], s25 offen offset:2048 nt lds
  s_add_u32 m0, s24, 21728
  s_nop 0
  buffer_load_dwordx4 v230, s[4:7], s25 offen offset:3072 nt lds
  s_add_u32 s25, s25, 4096
  s_and_b32 s25, s25, 0x3ffff
  s_add_u32 m0, s24, 26112
  s_nop 0
  buffer_load_dwordx4 v230, s[4:7], s25 offen offset:0 nt lds
  s_add_u32 m0, s24, 26144
  s_nop 0
  buffer_load_dwordx4 v230, s[4:7], s25 offen offset:1024 nt lds
  s_add_u32 m0, s24, 26176
  s_nop 0
  buffer_load_dwordx4 v230, s[4:7], s25 offen offset:2048 nt lds
  s_add_u32 m0, s24, 26208
  s_nop 0
  buffer_load_dwordx4 v230, s[4:7], s25 offen offset:3072 nt lds
  s_add_u32 s25, s25, 4096
  s_add_u32 m0, s24, 30336
  s_nop 0
  buffer_load_dwordx4 v230, s[4:7], s25 offen offset:0 nt lds
  s_add_u32 m0, s24, 30368
  s_nop 0
  buffer_load_dwordx4 v230, s[4:7], s25 offen offset:1024 nt lds
  s_add_u32 m0, s24, 30400
  s_nop 0
  buffer_load_dwordx4 v230, s[4:7], s25 offen offset:2048 nt lds
  s_add_u32 m0, s24, 30432
  s_nop 0
  buffer_load_dwordx4 v230, s[4:7], s25 offen offset:3072 nt lds
  s_add_u32 s25, s25, 4096
  s_and_b32 s25, s25, 0x3ffff
  s_waitcnt vmcnt(0)
  s_barrier
  ds_read_b128 a[224:227], v224 offset:0
  ds_read_b128 a[228:231], v224 offset:64
  ds_read_b128 a[232:235], v224 offset:128
  ds_read_b128 a[236:239], v224 offset:192
  ds_read_b128 a[240:243], v224 offset:512
  ds_read_b128 a[244:247], v224 offset:576
  ds_read_b128 a[248:251], v224 offset:640
  ds_read_b128 a[252:255], v224 offset:704
  s_waitcnt lgkmcnt(0)
  s_branch A_START
.section .rodata,"a"
.p2align 6
.amdhsa_kernel concat_heads__mha_block_cached__mha_block_cached__near_ridge_kernel
.amdhsa_next_free_vgpr 512
.amdhsa_next_free_sgpr 102
.amdhsa_accum_offset 256
.amdhsa_group_segment_fixed_size 0
.amdhsa_kernarg_size 104
.amdhsa_user_sgpr_count 2
.amdhsa_user_sgpr_kernarg_segment_ptr 1
.amdhsa_system_sgpr_workgroup_id_x 1
.end_amdhsa_kernel
```
